```python
import torch

def _softmax(x, axis=-1):
    return torch.softmax(x, dim=axis)

def _gelu(x):
    return torch.nn.functional.gelu(x, approximate='tanh')

def _silu(x):
    return torch.nn.functional.silu(x)

def _sigmoid(x):
    return torch.sigmoid(x)

def _layernorm(x, axis=-1, eps=1e-05):
    m = x.mean(dim=axis, keepdim=True)
    v = x.var(dim=axis, keepdim=True, unbiased=False)
    return (x - m) / torch.sqrt(v + eps)

def _scatter_add(tgt, idx, src, axis=0):
    return tgt.clone().index_add_(axis, idx, src)

def _segment_sum(src, seg, n):
    out = torch.zeros((n,) + src.shape[1:], dtype=src.dtype)
    return out.index_add_(0, seg, src)

def _pad(x, pw):
    flat = tuple((v for pair in reversed(pw) for v in pair))
    return torch.nn.functional.pad(x, flat)
kernel_name = 'interleave_layers__memory_aug_recurrent_mem_tr__glu_gated_bilinear__prompt'

def setup_inputs():

    _w = lambda a: (lambda t: t.to(torch.bfloat16) if t.is_floating_point() else t)(torch.as_tensor(a))

    def _A_setup():
        B, S, Dm = (1, 2048, 512)
        H, Dh = (32, 128)
        M, seg = (8, 32)
        seg = min(seg, S)
        S = S // seg * seg
        return {'x': _w((lambda *s: torch.randn(*s, dtype=torch.bfloat16) * 0.05)(B, S, Dm)), 'mem0': _w((lambda *s: torch.randn(*s, dtype=torch.bfloat16) * 0.2)(B, M, Dm)), 'Wq': _w((lambda *s: torch.randn(*s, dtype=torch.bfloat16) * 1.6)(Dm, H, Dh) * Dm ** (-0.5)), 'Wk': _w((lambda *s: torch.randn(*s, dtype=torch.bfloat16) * 1.6)(Dm, H, Dh) * Dm ** (-0.5)), 'Wv': _w((lambda *s: torch.randn(*s, dtype=torch.bfloat16) * 0.2)(Dm, H, Dh) * Dm ** (-0.5)), 'Wo': _w((lambda *s: torch.randn(*s, dtype=torch.bfloat16) * 0.2)(H, Dh, Dm) * (H * Dh) ** (-0.5)), 'seg_len': seg}
    _A_in = _A_setup()

    def _B_setup():
        B, S, D, F = (1, 2048, 512, 1376)
        return {'x': _w((lambda *s: torch.randn(*s, dtype=torch.bfloat16) * 0.05)(B, S, D)), 'w_gate': _w((lambda *s: torch.randn(*s, dtype=torch.bfloat16) * 0.4)(D, F) * D ** (-0.5)), 'w_up': _w((lambda *s: torch.randn(*s, dtype=torch.bfloat16) * 0.4)(D, F) * D ** (-0.5)), 'w_down': _w((lambda *s: torch.randn(*s, dtype=torch.bfloat16) * 0.4)(F, D) * F ** (-0.5))}
    _B_in = _B_setup()
    return {'A_x': _A_in['x'], 'A_mem0': _A_in['mem0'], 'A_Wq': _A_in['Wq'], 'A_Wk': _A_in['Wk'], 'A_Wv': _A_in['Wv'], 'A_Wo': _A_in['Wo'], 'A_seg_len': _A_in['seg_len'], 'B_x': _B_in['x'], 'B_w_gate': _B_in['w_gate'], 'B_w_up': _B_in['w_up'], 'B_w_down': _B_in['w_down']}

def reference(A_x, A_mem0, A_Wq, A_Wk, A_Wv, A_Wo, A_seg_len, B_x, B_w_gate, B_w_up, B_w_down):

    def _A_ref(x, mem0, Wq, Wk, Wv, Wo, seg_len):
        B, S, Dm = x.shape
        H, Dh = (Wq.shape[1], Wq.shape[2])
        M = mem0.shape[1]
        scale = Dh ** (-0.5)
        n_seg = S // seg_len
        L = M + seg_len
        idx = torch.arange(L)
        mask = (idx[:, None] < M) | (idx[:, None] >= idx[None, :])
        mem = mem0
        outs = []
        for s in range(n_seg):
            xs = x[:, s * seg_len:(s + 1) * seg_len, :].clone()
            h = torch.concatenate([mem, xs], axis=1)
            q = torch.einsum('btd,dhe->bhte', h, Wq)
            k = torch.einsum('btd,dhe->bhte', h, Wk)
            v = torch.einsum('btd,dhe->bhte', h, Wv)
            scores = torch.einsum('bhqe,bhke->bhqk', q, k) * scale
            scores = torch.where(mask[None, None], scores, -1000000000.0)
            p = _softmax(scores, axis=-1)
            o = torch.einsum('bhqk,bhke->bhqe', p, v)
            o = torch.einsum('bhte,hed->btd', o, Wo)
            mem = o[:, :M, :].clone()
            outs.append(o[:, M:, :])
        return torch.concatenate(outs, axis=1)

    def _B_ref(x, w_gate, w_up, w_down):
        g = torch.einsum('bsd,df->bsf', x, w_gate)
        u = torch.einsum('bsd,df->bsf', x, w_up)
        h = g * u
        return torch.einsum('bsf,fd->bsd', h, w_down)
    x = A_x
    x = x + _A_ref(_layernorm(x, axis=-1), A_mem0, A_Wq, A_Wk, A_Wv, A_Wo, A_seg_len)
    x = x + _B_ref(_layernorm(x, axis=-1), B_w_gate, B_w_up, B_w_down)
    x = x + _A_ref(_layernorm(x, axis=-1), A_mem0, A_Wq, A_Wk, A_Wv, A_Wo, A_seg_len)
    x = x + _B_ref(_layernorm(x, axis=-1), B_w_gate, B_w_up, B_w_down)
    return x
```

```asm
; @launch kernel=mega_kernel grid=(256,1,1) block=(256,1,1) lds=163840
.amdgcn_target "amdgcn-amd-amdhsa--gfx950"
.text
.globl mega_kernel
.p2align 8
.type mega_kernel,@function
mega_kernel:
  s_cmp_ge_u32 s2, 256
  s_cbranch_scc1 mega_exit
  s_load_dwordx16 s[16:31], s[0:1], 0
  s_load_dwordx8 s[32:39], s[0:1], 64
  s_load_dwordx4 s[40:43], s[0:1], 96
  s_getreg_b32 s3, hwreg(HW_REG_XCC_ID)
  s_and_b32 s3, s3, 15
  s_mov_b32 s69, 0x60000
  s_mov_b32 s70, 0x05040100
  s_mov_b32 s71, 0x07060302
  v_lshrrev_b32 v2, 6, v0
  s_nop 0
  v_readfirstlane_b32 s66, v2
  v_and_b32 v1, 63, v0
  s_waitcnt lgkmcnt(0)
  s_mov_b32 s44, s42
  s_mov_b32 s45, s43
  s_mov_b32 s46, 268435456
  s_mov_b32 s47, 0x00020000
  s_mov_b32 s60, s40
  s_mov_b32 s61, s41
  s_mov_b32 s62, 256
  s_mov_b32 s63, 0x00020000
  s_cmp_lg_u32 s66, 0
  s_cbranch_scc1 tk_done
  v_cmp_eq_u32 vcc, 0, v0
  s_nop 0
  s_and_saveexec_b64 s[4:5], vcc
  s_lshl_b32 s6, s3, 2
  v_mov_b32 v2, s6
  v_mov_b32 v3, 1
  v_mov_b32 v4, 1
  v_mov_b32 v5, 0
  buffer_atomic_add v3, v2, s[60:63], 0 offen sc0 sc1
  s_waitcnt vmcnt(0)
  buffer_atomic_add v4, v5, s[60:63], 0 offen offset:68 sc1
  v_readfirstlane_b32 s7, v3
  s_cmp_ge_u32 s3, 8
  s_nop 2
  s_cbranch_scc1 tk_over
  s_cmp_ge_u32 s7, 32
  s_cbranch_scc1 tk_over
  s_lshl_b32 s8, s3, 5
  s_add_u32 s8, s8, s7
  s_branch tk_have
tk_over:
  v_mov_b32 v3, 1
  buffer_atomic_add v3, v5, s[60:63], 0 offen offset:64 sc0 sc1
  s_waitcnt vmcnt(0)
  v_readfirstlane_b32 s7, v3
  s_mov_b32 s60, s40
  s_mov_b32 s61, s41
  s_mov_b32 s62, 256
  s_mov_b32 s63, 0x00020000
  v_mov_b32 v17, 0
  s_nop 1
mw_1:
  buffer_load_dword v16, v17, s[60:63], 0 offen offset:68 sc1
  s_waitcnt vmcnt(0)
  v_readfirstlane_b32 s72, v16
  s_nop 0
  s_cmp_ge_u32 s72, 256
  s_nop 1
  s_cbranch_scc1 md_2
  s_sub_u32 s69, s69, 1
  s_cbranch_scc0 mw_1
  s_branch mega_exit
md_2:
  buffer_load_dwordx4 v[8:11], v17, s[60:63], 0 offen sc1
  buffer_load_dwordx4 v[12:15], v17, s[60:63], 0 offen offset:16 sc1
  s_waitcnt vmcnt(0)
  v_readfirstlane_b32 s9, v8
  s_nop 0
  s_min_u32 s9, s9, 32
  s_sub_u32 s10, 32, s9
  s_add_u32 s8, s9, s7
  s_add_u32 s8, s8, 0
  s_cmp_lt_u32 s7, s10
  s_cbranch_scc1 tk_have
  s_sub_u32 s7, s7, s10
  v_readfirstlane_b32 s9, v9
  s_nop 0
  s_min_u32 s9, s9, 32
  s_sub_u32 s10, 32, s9
  s_add_u32 s8, s9, s7
  s_add_u32 s8, s8, 32
  s_cmp_lt_u32 s7, s10
  s_cbranch_scc1 tk_have
  s_sub_u32 s7, s7, s10
  v_readfirstlane_b32 s9, v10
  s_nop 0
  s_min_u32 s9, s9, 32
  s_sub_u32 s10, 32, s9
  s_add_u32 s8, s9, s7
  s_add_u32 s8, s8, 64
  s_cmp_lt_u32 s7, s10
  s_cbranch_scc1 tk_have
  s_sub_u32 s7, s7, s10
  v_readfirstlane_b32 s9, v11
  s_nop 0
  s_min_u32 s9, s9, 32
  s_sub_u32 s10, 32, s9
  s_add_u32 s8, s9, s7
  s_add_u32 s8, s8, 96
  s_cmp_lt_u32 s7, s10
  s_cbranch_scc1 tk_have
  s_sub_u32 s7, s7, s10
  v_readfirstlane_b32 s9, v12
  s_nop 0
  s_min_u32 s9, s9, 32
  s_sub_u32 s10, 32, s9
  s_add_u32 s8, s9, s7
  s_add_u32 s8, s8, 128
  s_cmp_lt_u32 s7, s10
  s_cbranch_scc1 tk_have
  s_sub_u32 s7, s7, s10
  v_readfirstlane_b32 s9, v13
  s_nop 0
  s_min_u32 s9, s9, 32
  s_sub_u32 s10, 32, s9
  s_add_u32 s8, s9, s7
  s_add_u32 s8, s8, 160
  s_cmp_lt_u32 s7, s10
  s_cbranch_scc1 tk_have
  s_sub_u32 s7, s7, s10
  v_readfirstlane_b32 s9, v14
  s_nop 0
  s_min_u32 s9, s9, 32
  s_sub_u32 s10, 32, s9
  s_add_u32 s8, s9, s7
  s_add_u32 s8, s8, 192
  s_cmp_lt_u32 s7, s10
  s_cbranch_scc1 tk_have
  s_sub_u32 s7, s7, s10
  v_readfirstlane_b32 s9, v15
  s_nop 0
  s_min_u32 s9, s9, 32
  s_sub_u32 s10, 32, s9
  s_add_u32 s8, s9, s7
  s_add_u32 s8, s8, 224
  s_cmp_lt_u32 s7, s10
  s_cbranch_scc1 tk_have
  s_sub_u32 s7, s7, s10
  s_branch mega_exit
tk_have:
  v_mov_b32 v3, s8
  ds_write_b32 v5, v3
  s_waitcnt lgkmcnt(0)
  s_mov_b64 exec, s[4:5]
tk_done:
  s_barrier
  v_mov_b32 v5, 0
  ds_read_b32 v3, v5
  s_waitcnt lgkmcnt(0)
  v_readfirstlane_b32 s8, v3
  s_barrier
  s_and_b32 s65, s8, 31
  s_bfe_u32 s64, s8, 0x10005
  s_lshr_b32 s9, s8, 6
  s_mov_b32 s67, 0
  v_and_b32 v2, 15, v1
  v_lshrrev_b32 v3, 4, v1
  s_cmp_eq_u32 s9, 1
  s_cbranch_scc1 role_kv
  s_cmp_eq_u32 s9, 2
  s_cbranch_scc1 role_q
  s_cmp_eq_u32 s9, 3
  s_cbranch_scc1 role_f
  s_mov_b32 s48, s20
  s_mov_b32 s49, s21
  s_mov_b32 s50, 4194304
  s_mov_b32 s51, 0x00020000
  s_mov_b32 s52, s22
  s_mov_b32 s53, s23
  s_mov_b32 s54, 4194304
  s_mov_b32 s55, 0x00020000
  s_mov_b32 s56, s24
  s_mov_b32 s57, s25
  s_mov_b32 s58, 4194304
  s_mov_b32 s59, 0x00020000
  s_mov_b32 s60, s26
  s_mov_b32 s61, s27
  s_mov_b32 s62, 4194304
  s_mov_b32 s63, 0x00020000
  s_lshl_b32 s72, s65, 8
  s_lshl_b32 s73, s66, 6
  s_add_u32 s72, s72, s73
  v_and_b32 v6, 1, v3
  v_lshrrev_b32 v7, 1, v3
  v_lshl_add_u32 v8, v6, 3, v7
  v_lshlrev_b32 v4, 13, v8
  v_lshl_add_u32 v4, v2, 2, v4
  v_add_u32 v4, s72, v4
  v_lshlrev_b32 v8, 2, v7
  v_add_u32 v8, v8, v6
  v_lshlrev_b32 v5, 12, v8
  v_lshl_add_u32 v5, v2, 2, v5
  s_lshl_b32 s72, s65, 17
  s_lshl_b32 s73, s66, 8
  s_add_u32 s72, s72, s73
  v_add_u32 v5, s72, v5
  s_lshl_b32 s72, s66, 15
  v_lshlrev_b32 v11, 4, v1
  v_add_u32 v11, s72, v11
  s_mov_b32 s72, 0
  buffer_load_dword v24, v4, s[48:51], s72 offen
  s_mov_b32 s73, 16384
  buffer_load_dword v25, v4, s[48:51], s73 offen
  s_mov_b32 s72, 131072
  buffer_load_dword v26, v4, s[48:51], s72 offen
  s_mov_b32 s73, 147456
  buffer_load_dword v27, v4, s[48:51], s73 offen
  s_mov_b32 s72, 32768
  buffer_load_dword v28, v4, s[48:51], s72 offen
  s_mov_b32 s73, 49152
  buffer_load_dword v29, v4, s[48:51], s73 offen
  s_mov_b32 s72, 163840
  buffer_load_dword v30, v4, s[48:51], s72 offen
  s_mov_b32 s73, 180224
  buffer_load_dword v31, v4, s[48:51], s73 offen
  s_mov_b32 s72, 262144
  buffer_load_dword v32, v4, s[48:51], s72 offen
  s_mov_b32 s73, 278528
  buffer_load_dword v33, v4, s[48:51], s73 offen
  s_mov_b32 s72, 393216
  buffer_load_dword v34, v4, s[48:51], s72 offen
  s_mov_b32 s73, 409600
  buffer_load_dword v35, v4, s[48:51], s73 offen
  s_mov_b32 s72, 294912
  buffer_load_dword v36, v4, s[48:51], s72 offen
  s_mov_b32 s73, 311296
  buffer_load_dword v37, v4, s[48:51], s73 offen
  s_mov_b32 s72, 425984
  buffer_load_dword v38, v4, s[48:51], s72 offen
  s_mov_b32 s73, 442368
  buffer_load_dword v39, v4, s[48:51], s73 offen
  s_mov_b32 s72, 524288
  buffer_load_dword v40, v4, s[48:51], s72 offen
  s_mov_b32 s73, 540672
  buffer_load_dword v41, v4, s[48:51], s73 offen
  s_mov_b32 s72, 655360
  buffer_load_dword v42, v4, s[48:51], s72 offen
  s_mov_b32 s73, 671744
  buffer_load_dword v43, v4, s[48:51], s73 offen
  s_mov_b32 s72, 557056
  buffer_load_dword v44, v4, s[48:51], s72 offen
  s_mov_b32 s73, 573440
  buffer_load_dword v45, v4, s[48:51], s73 offen
  s_mov_b32 s72, 688128
  buffer_load_dword v46, v4, s[48:51], s72 offen
  s_mov_b32 s73, 704512
  buffer_load_dword v47, v4, s[48:51], s73 offen
  s_mov_b32 s72, 786432
  buffer_load_dword v48, v4, s[48:51], s72 offen
  s_mov_b32 s73, 802816
  buffer_load_dword v49, v4, s[48:51], s73 offen
  s_mov_b32 s72, 917504
  buffer_load_dword v50, v4, s[48:51], s72 offen
  s_mov_b32 s73, 933888
  buffer_load_dword v51, v4, s[48:51], s73 offen
  s_mov_b32 s72, 819200
  buffer_load_dword v52, v4, s[48:51], s72 offen
  s_mov_b32 s73, 835584
  buffer_load_dword v53, v4, s[48:51], s73 offen
  s_mov_b32 s72, 950272
  buffer_load_dword v54, v4, s[48:51], s72 offen
  s_mov_b32 s73, 966656
  buffer_load_dword v55, v4, s[48:51], s73 offen
  s_mov_b32 s72, 1048576
  buffer_load_dword v56, v4, s[48:51], s72 offen
  s_mov_b32 s73, 1064960
  buffer_load_dword v57, v4, s[48:51], s73 offen
  s_mov_b32 s72, 1179648
  buffer_load_dword v58, v4, s[48:51], s72 offen
  s_mov_b32 s73, 1196032
  buffer_load_dword v59, v4, s[48:51], s73 offen
  s_mov_b32 s72, 1081344
  buffer_load_dword v60, v4, s[48:51], s72 offen
  s_mov_b32 s73, 1097728
  buffer_load_dword v61, v4, s[48:51], s73 offen
  s_mov_b32 s72, 1212416
  buffer_load_dword v62, v4, s[48:51], s72 offen
  s_mov_b32 s73, 1228800
  buffer_load_dword v63, v4, s[48:51], s73 offen
  s_mov_b32 s72, 1310720
  buffer_load_dword v64, v4, s[48:51], s72 offen
  s_mov_b32 s73, 1327104
  buffer_load_dword v65, v4, s[48:51], s73 offen
  s_mov_b32 s72, 1441792
  buffer_load_dword v66, v4, s[48:51], s72 offen
  s_mov_b32 s73, 1458176
  buffer_load_dword v67, v4, s[48:51], s73 offen
  s_mov_b32 s72, 1343488
  buffer_load_dword v68, v4, s[48:51], s72 offen
  s_mov_b32 s73, 1359872
  buffer_load_dword v69, v4, s[48:51], s73 offen
  s_mov_b32 s72, 1474560
  buffer_load_dword v70, v4, s[48:51], s72 offen
  s_mov_b32 s73, 1490944
  buffer_load_dword v71, v4, s[48:51], s73 offen
  s_mov_b32 s72, 1572864
  buffer_load_dword v72, v4, s[48:51], s72 offen
  s_mov_b32 s73, 1589248
  buffer_load_dword v73, v4, s[48:51], s73 offen
  s_mov_b32 s72, 1703936
  buffer_load_dword v74, v4, s[48:51], s72 offen
  s_mov_b32 s73, 1720320
  buffer_load_dword v75, v4, s[48:51], s73 offen
  s_mov_b32 s72, 1605632
  buffer_load_dword v76, v4, s[48:51], s72 offen
  s_mov_b32 s73, 1622016
  buffer_load_dword v77, v4, s[48:51], s73 offen
  s_mov_b32 s72, 1736704
  buffer_load_dword v78, v4, s[48:51], s72 offen
  s_mov_b32 s73, 1753088
  buffer_load_dword v79, v4, s[48:51], s73 offen
  s_mov_b32 s72, 1835008
  buffer_load_dword v80, v4, s[48:51], s72 offen
  s_mov_b32 s73, 1851392
  buffer_load_dword v81, v4, s[48:51], s73 offen
  s_mov_b32 s72, 1966080
  buffer_load_dword v82, v4, s[48:51], s72 offen
  s_mov_b32 s73, 1982464
  buffer_load_dword v83, v4, s[48:51], s73 offen
  s_mov_b32 s72, 1867776
  buffer_load_dword v84, v4, s[48:51], s72 offen
  s_mov_b32 s73, 1884160
  buffer_load_dword v85, v4, s[48:51], s73 offen
  s_mov_b32 s72, 1998848
  buffer_load_dword v86, v4, s[48:51], s72 offen
  s_mov_b32 s73, 2015232
  buffer_load_dword v87, v4, s[48:51], s73 offen
  s_mov_b32 s72, 2097152
  buffer_load_dword v88, v4, s[48:51], s72 offen
  s_mov_b32 s73, 2113536
  buffer_load_dword v89, v4, s[48:51], s73 offen
  s_mov_b32 s72, 2228224
  buffer_load_dword v90, v4, s[48:51], s72 offen
  s_mov_b32 s73, 2244608
  buffer_load_dword v91, v4, s[48:51], s73 offen
  s_mov_b32 s72, 2129920
  buffer_load_dword v92, v4, s[48:51], s72 offen
  s_mov_b32 s73, 2146304
  buffer_load_dword v93, v4, s[48:51], s73 offen
  s_mov_b32 s72, 2260992
  buffer_load_dword v94, v4, s[48:51], s72 offen
  s_mov_b32 s73, 2277376
  buffer_load_dword v95, v4, s[48:51], s73 offen
  s_mov_b32 s72, 2359296
  buffer_load_dword v96, v4, s[48:51], s72 offen
  s_mov_b32 s73, 2375680
  buffer_load_dword v97, v4, s[48:51], s73 offen
  s_mov_b32 s72, 2490368
  buffer_load_dword v98, v4, s[48:51], s72 offen
  s_mov_b32 s73, 2506752
  buffer_load_dword v99, v4, s[48:51], s73 offen
  s_mov_b32 s72, 2392064
  buffer_load_dword v100, v4, s[48:51], s72 offen
  s_mov_b32 s73, 2408448
  buffer_load_dword v101, v4, s[48:51], s73 offen
  s_mov_b32 s72, 2523136
  buffer_load_dword v102, v4, s[48:51], s72 offen
  s_mov_b32 s73, 2539520
  buffer_load_dword v103, v4, s[48:51], s73 offen
  s_mov_b32 s72, 2621440
  buffer_load_dword v104, v4, s[48:51], s72 offen
  s_mov_b32 s73, 2637824
  buffer_load_dword v105, v4, s[48:51], s73 offen
  s_mov_b32 s72, 2752512
  buffer_load_dword v106, v4, s[48:51], s72 offen
  s_mov_b32 s73, 2768896
  buffer_load_dword v107, v4, s[48:51], s73 offen
  s_mov_b32 s72, 2654208
  buffer_load_dword v108, v4, s[48:51], s72 offen
  s_mov_b32 s73, 2670592
  buffer_load_dword v109, v4, s[48:51], s73 offen
  s_mov_b32 s72, 2785280
  buffer_load_dword v110, v4, s[48:51], s72 offen
  s_mov_b32 s73, 2801664
  buffer_load_dword v111, v4, s[48:51], s73 offen
  s_mov_b32 s72, 2883584
  buffer_load_dword v112, v4, s[48:51], s72 offen
  s_mov_b32 s73, 2899968
  buffer_load_dword v113, v4, s[48:51], s73 offen
  s_mov_b32 s72, 3014656
  buffer_load_dword v114, v4, s[48:51], s72 offen
  s_mov_b32 s73, 3031040
  buffer_load_dword v115, v4, s[48:51], s73 offen
  s_mov_b32 s72, 2916352
  buffer_load_dword v116, v4, s[48:51], s72 offen
  s_mov_b32 s73, 2932736
  buffer_load_dword v117, v4, s[48:51], s73 offen
  s_mov_b32 s72, 3047424
  buffer_load_dword v118, v4, s[48:51], s72 offen
  s_mov_b32 s73, 3063808
  buffer_load_dword v119, v4, s[48:51], s73 offen
  s_waitcnt vmcnt(48)
  v_perm_b32 v120, v25, v24, s70
  v_accvgpr_write_b32 a0, v120
  v_perm_b32 v121, v25, v24, s71
  v_accvgpr_write_b32 a64, v121
  v_perm_b32 v122, v27, v26, s70
  v_accvgpr_write_b32 a1, v122
  v_perm_b32 v123, v27, v26, s71
  v_accvgpr_write_b32 a65, v123
  v_perm_b32 v120, v29, v28, s70
  v_accvgpr_write_b32 a2, v120
  v_perm_b32 v121, v29, v28, s71
  v_accvgpr_write_b32 a66, v121
  v_perm_b32 v122, v31, v30, s70
  v_accvgpr_write_b32 a3, v122
  v_perm_b32 v123, v31, v30, s71
  v_accvgpr_write_b32 a67, v123
  v_perm_b32 v120, v33, v32, s70
  v_accvgpr_write_b32 a4, v120
  v_perm_b32 v121, v33, v32, s71
  v_accvgpr_write_b32 a68, v121
  v_perm_b32 v122, v35, v34, s70
  v_accvgpr_write_b32 a5, v122
  v_perm_b32 v123, v35, v34, s71
  v_accvgpr_write_b32 a69, v123
  v_perm_b32 v120, v37, v36, s70
  v_accvgpr_write_b32 a6, v120
  v_perm_b32 v121, v37, v36, s71
  v_accvgpr_write_b32 a70, v121
  v_perm_b32 v122, v39, v38, s70
  v_accvgpr_write_b32 a7, v122
  v_perm_b32 v123, v39, v38, s71
  v_accvgpr_write_b32 a71, v123
  v_perm_b32 v120, v41, v40, s70
  v_accvgpr_write_b32 a8, v120
  v_perm_b32 v121, v41, v40, s71
  v_accvgpr_write_b32 a72, v121
  v_perm_b32 v122, v43, v42, s70
  v_accvgpr_write_b32 a9, v122
  v_perm_b32 v123, v43, v42, s71
  v_accvgpr_write_b32 a73, v123
  v_perm_b32 v120, v45, v44, s70
  v_accvgpr_write_b32 a10, v120
  v_perm_b32 v121, v45, v44, s71
  v_accvgpr_write_b32 a74, v121
  v_perm_b32 v122, v47, v46, s70
  v_accvgpr_write_b32 a11, v122
  v_perm_b32 v123, v47, v46, s71
  v_accvgpr_write_b32 a75, v123
  v_perm_b32 v120, v49, v48, s70
  v_accvgpr_write_b32 a12, v120
  v_perm_b32 v121, v49, v48, s71
  v_accvgpr_write_b32 a76, v121
  v_perm_b32 v122, v51, v50, s70
  v_accvgpr_write_b32 a13, v122
  v_perm_b32 v123, v51, v50, s71
  v_accvgpr_write_b32 a77, v123
  v_perm_b32 v120, v53, v52, s70
  v_accvgpr_write_b32 a14, v120
  v_perm_b32 v121, v53, v52, s71
  v_accvgpr_write_b32 a78, v121
  v_perm_b32 v122, v55, v54, s70
  v_accvgpr_write_b32 a15, v122
  v_perm_b32 v123, v55, v54, s71
  v_accvgpr_write_b32 a79, v123
  v_perm_b32 v120, v57, v56, s70
  v_accvgpr_write_b32 a16, v120
  v_perm_b32 v121, v57, v56, s71
  v_accvgpr_write_b32 a80, v121
  v_perm_b32 v122, v59, v58, s70
  v_accvgpr_write_b32 a17, v122
  v_perm_b32 v123, v59, v58, s71
  v_accvgpr_write_b32 a81, v123
  v_perm_b32 v120, v61, v60, s70
  v_accvgpr_write_b32 a18, v120
  v_perm_b32 v121, v61, v60, s71
  v_accvgpr_write_b32 a82, v121
  v_perm_b32 v122, v63, v62, s70
  v_accvgpr_write_b32 a19, v122
  v_perm_b32 v123, v63, v62, s71
  v_accvgpr_write_b32 a83, v123
  v_perm_b32 v120, v65, v64, s70
  v_accvgpr_write_b32 a20, v120
  v_perm_b32 v121, v65, v64, s71
  v_accvgpr_write_b32 a84, v121
  v_perm_b32 v122, v67, v66, s70
  v_accvgpr_write_b32 a21, v122
  v_perm_b32 v123, v67, v66, s71
  v_accvgpr_write_b32 a85, v123
  v_perm_b32 v120, v69, v68, s70
  v_accvgpr_write_b32 a22, v120
  v_perm_b32 v121, v69, v68, s71
  v_accvgpr_write_b32 a86, v121
  v_perm_b32 v122, v71, v70, s70
  v_accvgpr_write_b32 a23, v122
  v_perm_b32 v123, v71, v70, s71
  v_accvgpr_write_b32 a87, v123
  s_mov_b32 s72, 3145728
  buffer_load_dword v24, v4, s[48:51], s72 offen
  s_mov_b32 s73, 3162112
  buffer_load_dword v25, v4, s[48:51], s73 offen
  s_mov_b32 s72, 3276800
  buffer_load_dword v26, v4, s[48:51], s72 offen
  s_mov_b32 s73, 3293184
  buffer_load_dword v27, v4, s[48:51], s73 offen
  s_mov_b32 s72, 3178496
  buffer_load_dword v28, v4, s[48:51], s72 offen
  s_mov_b32 s73, 3194880
  buffer_load_dword v29, v4, s[48:51], s73 offen
  s_mov_b32 s72, 3309568
  buffer_load_dword v30, v4, s[48:51], s72 offen
  s_mov_b32 s73, 3325952
  buffer_load_dword v31, v4, s[48:51], s73 offen
  s_mov_b32 s72, 3407872
  buffer_load_dword v32, v4, s[48:51], s72 offen
  s_mov_b32 s73, 3424256
  buffer_load_dword v33, v4, s[48:51], s73 offen
  s_mov_b32 s72, 3538944
  buffer_load_dword v34, v4, s[48:51], s72 offen
  s_mov_b32 s73, 3555328
  buffer_load_dword v35, v4, s[48:51], s73 offen
  s_mov_b32 s72, 3440640
  buffer_load_dword v36, v4, s[48:51], s72 offen
  s_mov_b32 s73, 3457024
  buffer_load_dword v37, v4, s[48:51], s73 offen
  s_mov_b32 s72, 3571712
  buffer_load_dword v38, v4, s[48:51], s72 offen
  s_mov_b32 s73, 3588096
  buffer_load_dword v39, v4, s[48:51], s73 offen
  s_mov_b32 s72, 3670016
  buffer_load_dword v40, v4, s[48:51], s72 offen
  s_mov_b32 s73, 3686400
  buffer_load_dword v41, v4, s[48:51], s73 offen
  s_mov_b32 s72, 3801088
  buffer_load_dword v42, v4, s[48:51], s72 offen
  s_mov_b32 s73, 3817472
  buffer_load_dword v43, v4, s[48:51], s73 offen
  s_mov_b32 s72, 3702784
  buffer_load_dword v44, v4, s[48:51], s72 offen
  s_mov_b32 s73, 3719168
  buffer_load_dword v45, v4, s[48:51], s73 offen
  s_mov_b32 s72, 3833856
  buffer_load_dword v46, v4, s[48:51], s72 offen
  s_mov_b32 s73, 3850240
  buffer_load_dword v47, v4, s[48:51], s73 offen
  s_mov_b32 s72, 3932160
  buffer_load_dword v48, v4, s[48:51], s72 offen
  s_mov_b32 s73, 3948544
  buffer_load_dword v49, v4, s[48:51], s73 offen
  s_mov_b32 s72, 4063232
  buffer_load_dword v50, v4, s[48:51], s72 offen
  s_mov_b32 s73, 4079616
  buffer_load_dword v51, v4, s[48:51], s73 offen
  s_mov_b32 s72, 3964928
  buffer_load_dword v52, v4, s[48:51], s72 offen
  s_mov_b32 s73, 3981312
  buffer_load_dword v53, v4, s[48:51], s73 offen
  s_mov_b32 s72, 4096000
  buffer_load_dword v54, v4, s[48:51], s72 offen
  s_mov_b32 s73, 4112384
  buffer_load_dword v55, v4, s[48:51], s73 offen
  s_waitcnt vmcnt(32)
  v_perm_b32 v120, v73, v72, s70
  v_accvgpr_write_b32 a24, v120
  v_perm_b32 v121, v73, v72, s71
  v_accvgpr_write_b32 a88, v121
  v_perm_b32 v122, v75, v74, s70
  v_accvgpr_write_b32 a25, v122
  v_perm_b32 v123, v75, v74, s71
  v_accvgpr_write_b32 a89, v123
  v_perm_b32 v120, v77, v76, s70
  v_accvgpr_write_b32 a26, v120
  v_perm_b32 v121, v77, v76, s71
  v_accvgpr_write_b32 a90, v121
  v_perm_b32 v122, v79, v78, s70
  v_accvgpr_write_b32 a27, v122
  v_perm_b32 v123, v79, v78, s71
  v_accvgpr_write_b32 a91, v123
  v_perm_b32 v120, v81, v80, s70
  v_accvgpr_write_b32 a28, v120
  v_perm_b32 v121, v81, v80, s71
  v_accvgpr_write_b32 a92, v121
  v_perm_b32 v122, v83, v82, s70
  v_accvgpr_write_b32 a29, v122
  v_perm_b32 v123, v83, v82, s71
  v_accvgpr_write_b32 a93, v123
  v_perm_b32 v120, v85, v84, s70
  v_accvgpr_write_b32 a30, v120
  v_perm_b32 v121, v85, v84, s71
  v_accvgpr_write_b32 a94, v121
  v_perm_b32 v122, v87, v86, s70
  v_accvgpr_write_b32 a31, v122
  v_perm_b32 v123, v87, v86, s71
  v_accvgpr_write_b32 a95, v123
  v_perm_b32 v120, v89, v88, s70
  v_accvgpr_write_b32 a32, v120
  v_perm_b32 v121, v89, v88, s71
  v_accvgpr_write_b32 a96, v121
  v_perm_b32 v122, v91, v90, s70
  v_accvgpr_write_b32 a33, v122
  v_perm_b32 v123, v91, v90, s71
  v_accvgpr_write_b32 a97, v123
  v_perm_b32 v120, v93, v92, s70
  v_accvgpr_write_b32 a34, v120
  v_perm_b32 v121, v93, v92, s71
  v_accvgpr_write_b32 a98, v121
  v_perm_b32 v122, v95, v94, s70
  v_accvgpr_write_b32 a35, v122
  v_perm_b32 v123, v95, v94, s71
  v_accvgpr_write_b32 a99, v123
  v_perm_b32 v120, v97, v96, s70
  v_accvgpr_write_b32 a36, v120
  v_perm_b32 v121, v97, v96, s71
  v_accvgpr_write_b32 a100, v121
  v_perm_b32 v122, v99, v98, s70
  v_accvgpr_write_b32 a37, v122
  v_perm_b32 v123, v99, v98, s71
  v_accvgpr_write_b32 a101, v123
  v_perm_b32 v120, v101, v100, s70
  v_accvgpr_write_b32 a38, v120
  v_perm_b32 v121, v101, v100, s71
  v_accvgpr_write_b32 a102, v121
  v_perm_b32 v122, v103, v102, s70
  v_accvgpr_write_b32 a39, v122
  v_perm_b32 v123, v103, v102, s71
  v_accvgpr_write_b32 a103, v123
  v_perm_b32 v120, v105, v104, s70
  v_accvgpr_write_b32 a40, v120
  v_perm_b32 v121, v105, v104, s71
  v_accvgpr_write_b32 a104, v121
  v_perm_b32 v122, v107, v106, s70
  v_accvgpr_write_b32 a41, v122
  v_perm_b32 v123, v107, v106, s71
  v_accvgpr_write_b32 a105, v123
  v_perm_b32 v120, v109, v108, s70
  v_accvgpr_write_b32 a42, v120
  v_perm_b32 v121, v109, v108, s71
  v_accvgpr_write_b32 a106, v121
  v_perm_b32 v122, v111, v110, s70
  v_accvgpr_write_b32 a43, v122
  v_perm_b32 v123, v111, v110, s71
  v_accvgpr_write_b32 a107, v123
  v_perm_b32 v120, v113, v112, s70
  v_accvgpr_write_b32 a44, v120
  v_perm_b32 v121, v113, v112, s71
  v_accvgpr_write_b32 a108, v121
  v_perm_b32 v122, v115, v114, s70
  v_accvgpr_write_b32 a45, v122
  v_perm_b32 v123, v115, v114, s71
  v_accvgpr_write_b32 a109, v123
  v_perm_b32 v120, v117, v116, s70
  v_accvgpr_write_b32 a46, v120
  v_perm_b32 v121, v117, v116, s71
  v_accvgpr_write_b32 a110, v121
  v_perm_b32 v122, v119, v118, s70
  v_accvgpr_write_b32 a47, v122
  v_perm_b32 v123, v119, v118, s71
  v_accvgpr_write_b32 a111, v123
  s_waitcnt vmcnt(0)
  v_perm_b32 v120, v25, v24, s70
  v_accvgpr_write_b32 a48, v120
  v_perm_b32 v121, v25, v24, s71
  v_accvgpr_write_b32 a112, v121
  v_perm_b32 v122, v27, v26, s70
  v_accvgpr_write_b32 a49, v122
  v_perm_b32 v123, v27, v26, s71
  v_accvgpr_write_b32 a113, v123
  v_perm_b32 v120, v29, v28, s70
  v_accvgpr_write_b32 a50, v120
  v_perm_b32 v121, v29, v28, s71
  v_accvgpr_write_b32 a114, v121
  v_perm_b32 v122, v31, v30, s70
  v_accvgpr_write_b32 a51, v122
  v_perm_b32 v123, v31, v30, s71
  v_accvgpr_write_b32 a115, v123
  v_perm_b32 v120, v33, v32, s70
  v_accvgpr_write_b32 a52, v120
  v_perm_b32 v121, v33, v32, s71
  v_accvgpr_write_b32 a116, v121
  v_perm_b32 v122, v35, v34, s70
  v_accvgpr_write_b32 a53, v122
  v_perm_b32 v123, v35, v34, s71
  v_accvgpr_write_b32 a117, v123
  v_perm_b32 v120, v37, v36, s70
  v_accvgpr_write_b32 a54, v120
  v_perm_b32 v121, v37, v36, s71
  v_accvgpr_write_b32 a118, v121
  v_perm_b32 v122, v39, v38, s70
  v_accvgpr_write_b32 a55, v122
  v_perm_b32 v123, v39, v38, s71
  v_accvgpr_write_b32 a119, v123
  v_perm_b32 v120, v41, v40, s70
  v_accvgpr_write_b32 a56, v120
  v_perm_b32 v121, v41, v40, s71
  v_accvgpr_write_b32 a120, v121
  v_perm_b32 v122, v43, v42, s70
  v_accvgpr_write_b32 a57, v122
  v_perm_b32 v123, v43, v42, s71
  v_accvgpr_write_b32 a121, v123
  v_perm_b32 v120, v45, v44, s70
  v_accvgpr_write_b32 a58, v120
  v_perm_b32 v121, v45, v44, s71
  v_accvgpr_write_b32 a122, v121
  v_perm_b32 v122, v47, v46, s70
  v_accvgpr_write_b32 a59, v122
  v_perm_b32 v123, v47, v46, s71
  v_accvgpr_write_b32 a123, v123
  v_perm_b32 v120, v49, v48, s70
  v_accvgpr_write_b32 a60, v120
  v_perm_b32 v121, v49, v48, s71
  v_accvgpr_write_b32 a124, v121
  v_perm_b32 v122, v51, v50, s70
  v_accvgpr_write_b32 a61, v122
  v_perm_b32 v123, v51, v50, s71
  v_accvgpr_write_b32 a125, v123
  v_perm_b32 v120, v53, v52, s70
  v_accvgpr_write_b32 a62, v120
  v_perm_b32 v121, v53, v52, s71
  v_accvgpr_write_b32 a126, v121
  v_perm_b32 v122, v55, v54, s70
  v_accvgpr_write_b32 a63, v122
  v_perm_b32 v123, v55, v54, s71
  v_accvgpr_write_b32 a127, v123
  s_mov_b32 s72, 0
  buffer_load_dword v24, v4, s[52:55], s72 offen
  s_mov_b32 s73, 16384
  buffer_load_dword v25, v4, s[52:55], s73 offen
  s_mov_b32 s72, 131072
  buffer_load_dword v26, v4, s[52:55], s72 offen
  s_mov_b32 s73, 147456
  buffer_load_dword v27, v4, s[52:55], s73 offen
  s_mov_b32 s72, 32768
  buffer_load_dword v28, v4, s[52:55], s72 offen
  s_mov_b32 s73, 49152
  buffer_load_dword v29, v4, s[52:55], s73 offen
  s_mov_b32 s72, 163840
  buffer_load_dword v30, v4, s[52:55], s72 offen
  s_mov_b32 s73, 180224
  buffer_load_dword v31, v4, s[52:55], s73 offen
  s_mov_b32 s72, 262144
  buffer_load_dword v32, v4, s[52:55], s72 offen
  s_mov_b32 s73, 278528
  buffer_load_dword v33, v4, s[52:55], s73 offen
  s_mov_b32 s72, 393216
  buffer_load_dword v34, v4, s[52:55], s72 offen
  s_mov_b32 s73, 409600
  buffer_load_dword v35, v4, s[52:55], s73 offen
  s_mov_b32 s72, 294912
  buffer_load_dword v36, v4, s[52:55], s72 offen
  s_mov_b32 s73, 311296
  buffer_load_dword v37, v4, s[52:55], s73 offen
  s_mov_b32 s72, 425984
  buffer_load_dword v38, v4, s[52:55], s72 offen
  s_mov_b32 s73, 442368
  buffer_load_dword v39, v4, s[52:55], s73 offen
  s_mov_b32 s72, 524288
  buffer_load_dword v40, v4, s[52:55], s72 offen
  s_mov_b32 s73, 540672
  buffer_load_dword v41, v4, s[52:55], s73 offen
  s_mov_b32 s72, 655360
  buffer_load_dword v42, v4, s[52:55], s72 offen
  s_mov_b32 s73, 671744
  buffer_load_dword v43, v4, s[52:55], s73 offen
  s_mov_b32 s72, 557056
  buffer_load_dword v44, v4, s[52:55], s72 offen
  s_mov_b32 s73, 573440
  buffer_load_dword v45, v4, s[52:55], s73 offen
  s_mov_b32 s72, 688128
  buffer_load_dword v46, v4, s[52:55], s72 offen
  s_mov_b32 s73, 704512
  buffer_load_dword v47, v4, s[52:55], s73 offen
  s_mov_b32 s72, 786432
  buffer_load_dword v48, v4, s[52:55], s72 offen
  s_mov_b32 s73, 802816
  buffer_load_dword v49, v4, s[52:55], s73 offen
  s_mov_b32 s72, 917504
  buffer_load_dword v50, v4, s[52:55], s72 offen
  s_mov_b32 s73, 933888
  buffer_load_dword v51, v4, s[52:55], s73 offen
  s_mov_b32 s72, 819200
  buffer_load_dword v52, v4, s[52:55], s72 offen
  s_mov_b32 s73, 835584
  buffer_load_dword v53, v4, s[52:55], s73 offen
  s_mov_b32 s72, 950272
  buffer_load_dword v54, v4, s[52:55], s72 offen
  s_mov_b32 s73, 966656
  buffer_load_dword v55, v4, s[52:55], s73 offen
  s_mov_b32 s72, 1048576
  buffer_load_dword v56, v4, s[52:55], s72 offen
  s_mov_b32 s73, 1064960
  buffer_load_dword v57, v4, s[52:55], s73 offen
  s_mov_b32 s72, 1179648
  buffer_load_dword v58, v4, s[52:55], s72 offen
  s_mov_b32 s73, 1196032
  buffer_load_dword v59, v4, s[52:55], s73 offen
  s_mov_b32 s72, 1081344
  buffer_load_dword v60, v4, s[52:55], s72 offen
  s_mov_b32 s73, 1097728
  buffer_load_dword v61, v4, s[52:55], s73 offen
  s_mov_b32 s72, 1212416
  buffer_load_dword v62, v4, s[52:55], s72 offen
  s_mov_b32 s73, 1228800
  buffer_load_dword v63, v4, s[52:55], s73 offen
  s_mov_b32 s72, 1310720
  buffer_load_dword v64, v4, s[52:55], s72 offen
  s_mov_b32 s73, 1327104
  buffer_load_dword v65, v4, s[52:55], s73 offen
  s_mov_b32 s72, 1441792
  buffer_load_dword v66, v4, s[52:55], s72 offen
  s_mov_b32 s73, 1458176
  buffer_load_dword v67, v4, s[52:55], s73 offen
  s_mov_b32 s72, 1343488
  buffer_load_dword v68, v4, s[52:55], s72 offen
  s_mov_b32 s73, 1359872
  buffer_load_dword v69, v4, s[52:55], s73 offen
  s_mov_b32 s72, 1474560
  buffer_load_dword v70, v4, s[52:55], s72 offen
  s_mov_b32 s73, 1490944
  buffer_load_dword v71, v4, s[52:55], s73 offen
  s_mov_b32 s72, 1572864
  buffer_load_dword v72, v4, s[52:55], s72 offen
  s_mov_b32 s73, 1589248
  buffer_load_dword v73, v4, s[52:55], s73 offen
  s_mov_b32 s72, 1703936
  buffer_load_dword v74, v4, s[52:55], s72 offen
  s_mov_b32 s73, 1720320
  buffer_load_dword v75, v4, s[52:55], s73 offen
  s_mov_b32 s72, 1605632
  buffer_load_dword v76, v4, s[52:55], s72 offen
  s_mov_b32 s73, 1622016
  buffer_load_dword v77, v4, s[52:55], s73 offen
  s_mov_b32 s72, 1736704
  buffer_load_dword v78, v4, s[52:55], s72 offen
  s_mov_b32 s73, 1753088
  buffer_load_dword v79, v4, s[52:55], s73 offen
  s_mov_b32 s72, 1835008
  buffer_load_dword v80, v4, s[52:55], s72 offen
  s_mov_b32 s73, 1851392
  buffer_load_dword v81, v4, s[52:55], s73 offen
  s_mov_b32 s72, 1966080
  buffer_load_dword v82, v4, s[52:55], s72 offen
  s_mov_b32 s73, 1982464
  buffer_load_dword v83, v4, s[52:55], s73 offen
  s_mov_b32 s72, 1867776
  buffer_load_dword v84, v4, s[52:55], s72 offen
  s_mov_b32 s73, 1884160
  buffer_load_dword v85, v4, s[52:55], s73 offen
  s_mov_b32 s72, 1998848
  buffer_load_dword v86, v4, s[52:55], s72 offen
  s_mov_b32 s73, 2015232
  buffer_load_dword v87, v4, s[52:55], s73 offen
  s_mov_b32 s72, 2097152
  buffer_load_dword v88, v4, s[52:55], s72 offen
  s_mov_b32 s73, 2113536
  buffer_load_dword v89, v4, s[52:55], s73 offen
  s_mov_b32 s72, 2228224
  buffer_load_dword v90, v4, s[52:55], s72 offen
  s_mov_b32 s73, 2244608
  buffer_load_dword v91, v4, s[52:55], s73 offen
  s_mov_b32 s72, 2129920
  buffer_load_dword v92, v4, s[52:55], s72 offen
  s_mov_b32 s73, 2146304
  buffer_load_dword v93, v4, s[52:55], s73 offen
  s_mov_b32 s72, 2260992
  buffer_load_dword v94, v4, s[52:55], s72 offen
  s_mov_b32 s73, 2277376
  buffer_load_dword v95, v4, s[52:55], s73 offen
  s_mov_b32 s72, 2359296
  buffer_load_dword v96, v4, s[52:55], s72 offen
  s_mov_b32 s73, 2375680
  buffer_load_dword v97, v4, s[52:55], s73 offen
  s_mov_b32 s72, 2490368
  buffer_load_dword v98, v4, s[52:55], s72 offen
  s_mov_b32 s73, 2506752
  buffer_load_dword v99, v4, s[52:55], s73 offen
  s_mov_b32 s72, 2392064
  buffer_load_dword v100, v4, s[52:55], s72 offen
  s_mov_b32 s73, 2408448
  buffer_load_dword v101, v4, s[52:55], s73 offen
  s_mov_b32 s72, 2523136
  buffer_load_dword v102, v4, s[52:55], s72 offen
  s_mov_b32 s73, 2539520
  buffer_load_dword v103, v4, s[52:55], s73 offen
  s_mov_b32 s72, 2621440
  buffer_load_dword v104, v4, s[52:55], s72 offen
  s_mov_b32 s73, 2637824
  buffer_load_dword v105, v4, s[52:55], s73 offen
  s_mov_b32 s72, 2752512
  buffer_load_dword v106, v4, s[52:55], s72 offen
  s_mov_b32 s73, 2768896
  buffer_load_dword v107, v4, s[52:55], s73 offen
  s_mov_b32 s72, 2654208
  buffer_load_dword v108, v4, s[52:55], s72 offen
  s_mov_b32 s73, 2670592
  buffer_load_dword v109, v4, s[52:55], s73 offen
  s_mov_b32 s72, 2785280
  buffer_load_dword v110, v4, s[52:55], s72 offen
  s_mov_b32 s73, 2801664
  buffer_load_dword v111, v4, s[52:55], s73 offen
  s_mov_b32 s72, 2883584
  buffer_load_dword v112, v4, s[52:55], s72 offen
  s_mov_b32 s73, 2899968
  buffer_load_dword v113, v4, s[52:55], s73 offen
  s_mov_b32 s72, 3014656
  buffer_load_dword v114, v4, s[52:55], s72 offen
  s_mov_b32 s73, 3031040
  buffer_load_dword v115, v4, s[52:55], s73 offen
  s_mov_b32 s72, 2916352
  buffer_load_dword v116, v4, s[52:55], s72 offen
  s_mov_b32 s73, 2932736
  buffer_load_dword v117, v4, s[52:55], s73 offen
  s_mov_b32 s72, 3047424
  buffer_load_dword v118, v4, s[52:55], s72 offen
  s_mov_b32 s73, 3063808
  buffer_load_dword v119, v4, s[52:55], s73 offen
  s_waitcnt vmcnt(48)
  v_perm_b32 v120, v25, v24, s70
  v_accvgpr_write_b32 a128, v120
  v_perm_b32 v121, v25, v24, s71
  v_accvgpr_write_b32 a192, v121
  v_perm_b32 v122, v27, v26, s70
  v_accvgpr_write_b32 a129, v122
  v_perm_b32 v123, v27, v26, s71
  v_accvgpr_write_b32 a193, v123
  v_perm_b32 v120, v29, v28, s70
  v_accvgpr_write_b32 a130, v120
  v_perm_b32 v121, v29, v28, s71
  v_accvgpr_write_b32 a194, v121
  v_perm_b32 v122, v31, v30, s70
  v_accvgpr_write_b32 a131, v122
  v_perm_b32 v123, v31, v30, s71
  v_accvgpr_write_b32 a195, v123
  v_perm_b32 v120, v33, v32, s70
  v_accvgpr_write_b32 a132, v120
  v_perm_b32 v121, v33, v32, s71
  v_accvgpr_write_b32 a196, v121
  v_perm_b32 v122, v35, v34, s70
  v_accvgpr_write_b32 a133, v122
  v_perm_b32 v123, v35, v34, s71
  v_accvgpr_write_b32 a197, v123
  v_perm_b32 v120, v37, v36, s70
  v_accvgpr_write_b32 a134, v120
  v_perm_b32 v121, v37, v36, s71
  v_accvgpr_write_b32 a198, v121
  v_perm_b32 v122, v39, v38, s70
  v_accvgpr_write_b32 a135, v122
  v_perm_b32 v123, v39, v38, s71
  v_accvgpr_write_b32 a199, v123
  v_perm_b32 v120, v41, v40, s70
  v_accvgpr_write_b32 a136, v120
  v_perm_b32 v121, v41, v40, s71
  v_accvgpr_write_b32 a200, v121
  v_perm_b32 v122, v43, v42, s70
  v_accvgpr_write_b32 a137, v122
  v_perm_b32 v123, v43, v42, s71
  v_accvgpr_write_b32 a201, v123
  v_perm_b32 v120, v45, v44, s70
  v_accvgpr_write_b32 a138, v120
  v_perm_b32 v121, v45, v44, s71
  v_accvgpr_write_b32 a202, v121
  v_perm_b32 v122, v47, v46, s70
  v_accvgpr_write_b32 a139, v122
  v_perm_b32 v123, v47, v46, s71
  v_accvgpr_write_b32 a203, v123
  v_perm_b32 v120, v49, v48, s70
  v_accvgpr_write_b32 a140, v120
  v_perm_b32 v121, v49, v48, s71
  v_accvgpr_write_b32 a204, v121
  v_perm_b32 v122, v51, v50, s70
  v_accvgpr_write_b32 a141, v122
  v_perm_b32 v123, v51, v50, s71
  v_accvgpr_write_b32 a205, v123
  v_perm_b32 v120, v53, v52, s70
  v_accvgpr_write_b32 a142, v120
  v_perm_b32 v121, v53, v52, s71
  v_accvgpr_write_b32 a206, v121
  v_perm_b32 v122, v55, v54, s70
  v_accvgpr_write_b32 a143, v122
  v_perm_b32 v123, v55, v54, s71
  v_accvgpr_write_b32 a207, v123
  v_perm_b32 v120, v57, v56, s70
  v_accvgpr_write_b32 a144, v120
  v_perm_b32 v121, v57, v56, s71
  v_accvgpr_write_b32 a208, v121
  v_perm_b32 v122, v59, v58, s70
  v_accvgpr_write_b32 a145, v122
  v_perm_b32 v123, v59, v58, s71
  v_accvgpr_write_b32 a209, v123
  v_perm_b32 v120, v61, v60, s70
  v_accvgpr_write_b32 a146, v120
  v_perm_b32 v121, v61, v60, s71
  v_accvgpr_write_b32 a210, v121
  v_perm_b32 v122, v63, v62, s70
  v_accvgpr_write_b32 a147, v122
  v_perm_b32 v123, v63, v62, s71
  v_accvgpr_write_b32 a211, v123
  v_perm_b32 v120, v65, v64, s70
  v_accvgpr_write_b32 a148, v120
  v_perm_b32 v121, v65, v64, s71
  v_accvgpr_write_b32 a212, v121
  v_perm_b32 v122, v67, v66, s70
  v_accvgpr_write_b32 a149, v122
  v_perm_b32 v123, v67, v66, s71
  v_accvgpr_write_b32 a213, v123
  v_perm_b32 v120, v69, v68, s70
  v_accvgpr_write_b32 a150, v120
  v_perm_b32 v121, v69, v68, s71
  v_accvgpr_write_b32 a214, v121
  v_perm_b32 v122, v71, v70, s70
  v_accvgpr_write_b32 a151, v122
  v_perm_b32 v123, v71, v70, s71
  v_accvgpr_write_b32 a215, v123
  s_mov_b32 s72, 3145728
  buffer_load_dword v24, v4, s[52:55], s72 offen
  s_mov_b32 s73, 3162112
  buffer_load_dword v25, v4, s[52:55], s73 offen
  s_mov_b32 s72, 3276800
  buffer_load_dword v26, v4, s[52:55], s72 offen
  s_mov_b32 s73, 3293184
  buffer_load_dword v27, v4, s[52:55], s73 offen
  s_mov_b32 s72, 3178496
  buffer_load_dword v28, v4, s[52:55], s72 offen
  s_mov_b32 s73, 3194880
  buffer_load_dword v29, v4, s[52:55], s73 offen
  s_mov_b32 s72, 3309568
  buffer_load_dword v30, v4, s[52:55], s72 offen
  s_mov_b32 s73, 3325952
  buffer_load_dword v31, v4, s[52:55], s73 offen
  s_mov_b32 s72, 3407872
  buffer_load_dword v32, v4, s[52:55], s72 offen
  s_mov_b32 s73, 3424256
  buffer_load_dword v33, v4, s[52:55], s73 offen
  s_mov_b32 s72, 3538944
  buffer_load_dword v34, v4, s[52:55], s72 offen
  s_mov_b32 s73, 3555328
  buffer_load_dword v35, v4, s[52:55], s73 offen
  s_mov_b32 s72, 3440640
  buffer_load_dword v36, v4, s[52:55], s72 offen
  s_mov_b32 s73, 3457024
  buffer_load_dword v37, v4, s[52:55], s73 offen
  s_mov_b32 s72, 3571712
  buffer_load_dword v38, v4, s[52:55], s72 offen
  s_mov_b32 s73, 3588096
  buffer_load_dword v39, v4, s[52:55], s73 offen
  s_mov_b32 s72, 3670016
  buffer_load_dword v40, v4, s[52:55], s72 offen
  s_mov_b32 s73, 3686400
  buffer_load_dword v41, v4, s[52:55], s73 offen
  s_mov_b32 s72, 3801088
  buffer_load_dword v42, v4, s[52:55], s72 offen
  s_mov_b32 s73, 3817472
  buffer_load_dword v43, v4, s[52:55], s73 offen
  s_mov_b32 s72, 3702784
  buffer_load_dword v44, v4, s[52:55], s72 offen
  s_mov_b32 s73, 3719168
  buffer_load_dword v45, v4, s[52:55], s73 offen
  s_mov_b32 s72, 3833856
  buffer_load_dword v46, v4, s[52:55], s72 offen
  s_mov_b32 s73, 3850240
  buffer_load_dword v47, v4, s[52:55], s73 offen
  s_mov_b32 s72, 3932160
  buffer_load_dword v48, v4, s[52:55], s72 offen
  s_mov_b32 s73, 3948544
  buffer_load_dword v49, v4, s[52:55], s73 offen
  s_mov_b32 s72, 4063232
  buffer_load_dword v50, v4, s[52:55], s72 offen
  s_mov_b32 s73, 4079616
  buffer_load_dword v51, v4, s[52:55], s73 offen
  s_mov_b32 s72, 3964928
  buffer_load_dword v52, v4, s[52:55], s72 offen
  s_mov_b32 s73, 3981312
  buffer_load_dword v53, v4, s[52:55], s73 offen
  s_mov_b32 s72, 4096000
  buffer_load_dword v54, v4, s[52:55], s72 offen
  s_mov_b32 s73, 4112384
  buffer_load_dword v55, v4, s[52:55], s73 offen
  s_waitcnt vmcnt(32)
  v_perm_b32 v120, v73, v72, s70
  v_accvgpr_write_b32 a152, v120
  v_perm_b32 v121, v73, v72, s71
  v_accvgpr_write_b32 a216, v121
  v_perm_b32 v122, v75, v74, s70
  v_accvgpr_write_b32 a153, v122
  v_perm_b32 v123, v75, v74, s71
  v_accvgpr_write_b32 a217, v123
  v_perm_b32 v120, v77, v76, s70
  v_accvgpr_write_b32 a154, v120
  v_perm_b32 v121, v77, v76, s71
  v_accvgpr_write_b32 a218, v121
  v_perm_b32 v122, v79, v78, s70
  v_accvgpr_write_b32 a155, v122
  v_perm_b32 v123, v79, v78, s71
  v_accvgpr_write_b32 a219, v123
  v_perm_b32 v120, v81, v80, s70
  v_accvgpr_write_b32 a156, v120
  v_perm_b32 v121, v81, v80, s71
  v_accvgpr_write_b32 a220, v121
  v_perm_b32 v122, v83, v82, s70
  v_accvgpr_write_b32 a157, v122
  v_perm_b32 v123, v83, v82, s71
  v_accvgpr_write_b32 a221, v123
  v_perm_b32 v120, v85, v84, s70
  v_accvgpr_write_b32 a158, v120
  v_perm_b32 v121, v85, v84, s71
  v_accvgpr_write_b32 a222, v121
  v_perm_b32 v122, v87, v86, s70
  v_accvgpr_write_b32 a159, v122
  v_perm_b32 v123, v87, v86, s71
  v_accvgpr_write_b32 a223, v123
  v_perm_b32 v120, v89, v88, s70
  v_accvgpr_write_b32 a160, v120
  v_perm_b32 v121, v89, v88, s71
  v_accvgpr_write_b32 a224, v121
  v_perm_b32 v122, v91, v90, s70
  v_accvgpr_write_b32 a161, v122
  v_perm_b32 v123, v91, v90, s71
  v_accvgpr_write_b32 a225, v123
  v_perm_b32 v120, v93, v92, s70
  v_accvgpr_write_b32 a162, v120
  v_perm_b32 v121, v93, v92, s71
  v_accvgpr_write_b32 a226, v121
  v_perm_b32 v122, v95, v94, s70
  v_accvgpr_write_b32 a163, v122
  v_perm_b32 v123, v95, v94, s71
  v_accvgpr_write_b32 a227, v123
  v_perm_b32 v120, v97, v96, s70
  v_accvgpr_write_b32 a164, v120
  v_perm_b32 v121, v97, v96, s71
  v_accvgpr_write_b32 a228, v121
  v_perm_b32 v122, v99, v98, s70
  v_accvgpr_write_b32 a165, v122
  v_perm_b32 v123, v99, v98, s71
  v_accvgpr_write_b32 a229, v123
  v_perm_b32 v120, v101, v100, s70
  v_accvgpr_write_b32 a166, v120
  v_perm_b32 v121, v101, v100, s71
  v_accvgpr_write_b32 a230, v121
  v_perm_b32 v122, v103, v102, s70
  v_accvgpr_write_b32 a167, v122
  v_perm_b32 v123, v103, v102, s71
  v_accvgpr_write_b32 a231, v123
  v_perm_b32 v120, v105, v104, s70
  v_accvgpr_write_b32 a168, v120
  v_perm_b32 v121, v105, v104, s71
  v_accvgpr_write_b32 a232, v121
  v_perm_b32 v122, v107, v106, s70
  v_accvgpr_write_b32 a169, v122
  v_perm_b32 v123, v107, v106, s71
  v_accvgpr_write_b32 a233, v123
  v_perm_b32 v120, v109, v108, s70
  v_accvgpr_write_b32 a170, v120
  v_perm_b32 v121, v109, v108, s71
  v_accvgpr_write_b32 a234, v121
  v_perm_b32 v122, v111, v110, s70
  v_accvgpr_write_b32 a171, v122
  v_perm_b32 v123, v111, v110, s71
  v_accvgpr_write_b32 a235, v123
  v_perm_b32 v120, v113, v112, s70
  v_accvgpr_write_b32 a172, v120
  v_perm_b32 v121, v113, v112, s71
  v_accvgpr_write_b32 a236, v121
  v_perm_b32 v122, v115, v114, s70
  v_accvgpr_write_b32 a173, v122
  v_perm_b32 v123, v115, v114, s71
  v_accvgpr_write_b32 a237, v123
  v_perm_b32 v120, v117, v116, s70
  v_accvgpr_write_b32 a174, v120
  v_perm_b32 v121, v117, v116, s71
  v_accvgpr_write_b32 a238, v121
  v_perm_b32 v122, v119, v118, s70
  v_accvgpr_write_b32 a175, v122
  v_perm_b32 v123, v119, v118, s71
  v_accvgpr_write_b32 a239, v123
  s_waitcnt vmcnt(0)
  v_perm_b32 v120, v25, v24, s70
  v_accvgpr_write_b32 a176, v120
  v_perm_b32 v121, v25, v24, s71
  v_accvgpr_write_b32 a240, v121
  v_perm_b32 v122, v27, v26, s70
  v_accvgpr_write_b32 a177, v122
  v_perm_b32 v123, v27, v26, s71
  v_accvgpr_write_b32 a241, v123
  v_perm_b32 v120, v29, v28, s70
  v_accvgpr_write_b32 a178, v120
  v_perm_b32 v121, v29, v28, s71
  v_accvgpr_write_b32 a242, v121
  v_perm_b32 v122, v31, v30, s70
  v_accvgpr_write_b32 a179, v122
  v_perm_b32 v123, v31, v30, s71
  v_accvgpr_write_b32 a243, v123
  v_perm_b32 v120, v33, v32, s70
  v_accvgpr_write_b32 a180, v120
  v_perm_b32 v121, v33, v32, s71
  v_accvgpr_write_b32 a244, v121
  v_perm_b32 v122, v35, v34, s70
  v_accvgpr_write_b32 a181, v122
  v_perm_b32 v123, v35, v34, s71
  v_accvgpr_write_b32 a245, v123
  v_perm_b32 v120, v37, v36, s70
  v_accvgpr_write_b32 a182, v120
  v_perm_b32 v121, v37, v36, s71
  v_accvgpr_write_b32 a246, v121
  v_perm_b32 v122, v39, v38, s70
  v_accvgpr_write_b32 a183, v122
  v_perm_b32 v123, v39, v38, s71
  v_accvgpr_write_b32 a247, v123
  v_perm_b32 v120, v41, v40, s70
  v_accvgpr_write_b32 a184, v120
  v_perm_b32 v121, v41, v40, s71
  v_accvgpr_write_b32 a248, v121
  v_perm_b32 v122, v43, v42, s70
  v_accvgpr_write_b32 a185, v122
  v_perm_b32 v123, v43, v42, s71
  v_accvgpr_write_b32 a249, v123
  v_perm_b32 v120, v45, v44, s70
  v_accvgpr_write_b32 a186, v120
  v_perm_b32 v121, v45, v44, s71
  v_accvgpr_write_b32 a250, v121
  v_perm_b32 v122, v47, v46, s70
  v_accvgpr_write_b32 a187, v122
  v_perm_b32 v123, v47, v46, s71
  v_accvgpr_write_b32 a251, v123
  v_perm_b32 v120, v49, v48, s70
  v_accvgpr_write_b32 a188, v120
  v_perm_b32 v121, v49, v48, s71
  v_accvgpr_write_b32 a252, v121
  v_perm_b32 v122, v51, v50, s70
  v_accvgpr_write_b32 a189, v122
  v_perm_b32 v123, v51, v50, s71
  v_accvgpr_write_b32 a253, v123
  v_perm_b32 v120, v53, v52, s70
  v_accvgpr_write_b32 a190, v120
  v_perm_b32 v121, v53, v52, s71
  v_accvgpr_write_b32 a254, v121
  v_perm_b32 v122, v55, v54, s70
  v_accvgpr_write_b32 a191, v122
  v_perm_b32 v123, v55, v54, s71
  v_accvgpr_write_b32 a255, v123
  s_mov_b32 s72, 0
  buffer_load_dword v24, v4, s[56:59], s72 offen
  s_mov_b32 s73, 16384
  buffer_load_dword v25, v4, s[56:59], s73 offen
  s_mov_b32 s72, 131072
  buffer_load_dword v26, v4, s[56:59], s72 offen
  s_mov_b32 s73, 147456
  buffer_load_dword v27, v4, s[56:59], s73 offen
  s_mov_b32 s72, 32768
  buffer_load_dword v28, v4, s[56:59], s72 offen
  s_mov_b32 s73, 49152
  buffer_load_dword v29, v4, s[56:59], s73 offen
  s_mov_b32 s72, 163840
  buffer_load_dword v30, v4, s[56:59], s72 offen
  s_mov_b32 s73, 180224
  buffer_load_dword v31, v4, s[56:59], s73 offen
  s_mov_b32 s72, 262144
  buffer_load_dword v32, v4, s[56:59], s72 offen
  s_mov_b32 s73, 278528
  buffer_load_dword v33, v4, s[56:59], s73 offen
  s_mov_b32 s72, 393216
  buffer_load_dword v34, v4, s[56:59], s72 offen
  s_mov_b32 s73, 409600
  buffer_load_dword v35, v4, s[56:59], s73 offen
  s_mov_b32 s72, 294912
  buffer_load_dword v36, v4, s[56:59], s72 offen
  s_mov_b32 s73, 311296
  buffer_load_dword v37, v4, s[56:59], s73 offen
  s_mov_b32 s72, 425984
  buffer_load_dword v38, v4, s[56:59], s72 offen
  s_mov_b32 s73, 442368
  buffer_load_dword v39, v4, s[56:59], s73 offen
  s_mov_b32 s72, 524288
  buffer_load_dword v40, v4, s[56:59], s72 offen
  s_mov_b32 s73, 540672
  buffer_load_dword v41, v4, s[56:59], s73 offen
  s_mov_b32 s72, 655360
  buffer_load_dword v42, v4, s[56:59], s72 offen
  s_mov_b32 s73, 671744
  buffer_load_dword v43, v4, s[56:59], s73 offen
  s_mov_b32 s72, 557056
  buffer_load_dword v44, v4, s[56:59], s72 offen
  s_mov_b32 s73, 573440
  buffer_load_dword v45, v4, s[56:59], s73 offen
  s_mov_b32 s72, 688128
  buffer_load_dword v46, v4, s[56:59], s72 offen
  s_mov_b32 s73, 704512
  buffer_load_dword v47, v4, s[56:59], s73 offen
  s_mov_b32 s72, 786432
  buffer_load_dword v48, v4, s[56:59], s72 offen
  s_mov_b32 s73, 802816
  buffer_load_dword v49, v4, s[56:59], s73 offen
  s_mov_b32 s72, 917504
  buffer_load_dword v50, v4, s[56:59], s72 offen
  s_mov_b32 s73, 933888
  buffer_load_dword v51, v4, s[56:59], s73 offen
  s_mov_b32 s72, 819200
  buffer_load_dword v52, v4, s[56:59], s72 offen
  s_mov_b32 s73, 835584
  buffer_load_dword v53, v4, s[56:59], s73 offen
  s_mov_b32 s72, 950272
  buffer_load_dword v54, v4, s[56:59], s72 offen
  s_mov_b32 s73, 966656
  buffer_load_dword v55, v4, s[56:59], s73 offen
  s_mov_b32 s72, 1048576
  buffer_load_dword v56, v4, s[56:59], s72 offen
  s_mov_b32 s73, 1064960
  buffer_load_dword v57, v4, s[56:59], s73 offen
  s_mov_b32 s72, 1179648
  buffer_load_dword v58, v4, s[56:59], s72 offen
  s_mov_b32 s73, 1196032
  buffer_load_dword v59, v4, s[56:59], s73 offen
  s_mov_b32 s72, 1081344
  buffer_load_dword v60, v4, s[56:59], s72 offen
  s_mov_b32 s73, 1097728
  buffer_load_dword v61, v4, s[56:59], s73 offen
  s_mov_b32 s72, 1212416
  buffer_load_dword v62, v4, s[56:59], s72 offen
  s_mov_b32 s73, 1228800
  buffer_load_dword v63, v4, s[56:59], s73 offen
  s_mov_b32 s72, 1310720
  buffer_load_dword v64, v4, s[56:59], s72 offen
  s_mov_b32 s73, 1327104
  buffer_load_dword v65, v4, s[56:59], s73 offen
  s_mov_b32 s72, 1441792
  buffer_load_dword v66, v4, s[56:59], s72 offen
  s_mov_b32 s73, 1458176
  buffer_load_dword v67, v4, s[56:59], s73 offen
  s_mov_b32 s72, 1343488
  buffer_load_dword v68, v4, s[56:59], s72 offen
  s_mov_b32 s73, 1359872
  buffer_load_dword v69, v4, s[56:59], s73 offen
  s_mov_b32 s72, 1474560
  buffer_load_dword v70, v4, s[56:59], s72 offen
  s_mov_b32 s73, 1490944
  buffer_load_dword v71, v4, s[56:59], s73 offen
  s_mov_b32 s72, 1572864
  buffer_load_dword v72, v4, s[56:59], s72 offen
  s_mov_b32 s73, 1589248
  buffer_load_dword v73, v4, s[56:59], s73 offen
  s_mov_b32 s72, 1703936
  buffer_load_dword v74, v4, s[56:59], s72 offen
  s_mov_b32 s73, 1720320
  buffer_load_dword v75, v4, s[56:59], s73 offen
  s_mov_b32 s72, 1605632
  buffer_load_dword v76, v4, s[56:59], s72 offen
  s_mov_b32 s73, 1622016
  buffer_load_dword v77, v4, s[56:59], s73 offen
  s_mov_b32 s72, 1736704
  buffer_load_dword v78, v4, s[56:59], s72 offen
  s_mov_b32 s73, 1753088
  buffer_load_dword v79, v4, s[56:59], s73 offen
  s_mov_b32 s72, 1835008
  buffer_load_dword v80, v4, s[56:59], s72 offen
  s_mov_b32 s73, 1851392
  buffer_load_dword v81, v4, s[56:59], s73 offen
  s_mov_b32 s72, 1966080
  buffer_load_dword v82, v4, s[56:59], s72 offen
  s_mov_b32 s73, 1982464
  buffer_load_dword v83, v4, s[56:59], s73 offen
  s_mov_b32 s72, 1867776
  buffer_load_dword v84, v4, s[56:59], s72 offen
  s_mov_b32 s73, 1884160
  buffer_load_dword v85, v4, s[56:59], s73 offen
  s_mov_b32 s72, 1998848
  buffer_load_dword v86, v4, s[56:59], s72 offen
  s_mov_b32 s73, 2015232
  buffer_load_dword v87, v4, s[56:59], s73 offen
  s_mov_b32 s72, 2097152
  buffer_load_dword v88, v4, s[56:59], s72 offen
  s_mov_b32 s73, 2113536
  buffer_load_dword v89, v4, s[56:59], s73 offen
  s_mov_b32 s72, 2228224
  buffer_load_dword v90, v4, s[56:59], s72 offen
  s_mov_b32 s73, 2244608
  buffer_load_dword v91, v4, s[56:59], s73 offen
  s_mov_b32 s72, 2129920
  buffer_load_dword v92, v4, s[56:59], s72 offen
  s_mov_b32 s73, 2146304
  buffer_load_dword v93, v4, s[56:59], s73 offen
  s_mov_b32 s72, 2260992
  buffer_load_dword v94, v4, s[56:59], s72 offen
  s_mov_b32 s73, 2277376
  buffer_load_dword v95, v4, s[56:59], s73 offen
  s_mov_b32 s72, 2359296
  buffer_load_dword v96, v4, s[56:59], s72 offen
  s_mov_b32 s73, 2375680
  buffer_load_dword v97, v4, s[56:59], s73 offen
  s_mov_b32 s72, 2490368
  buffer_load_dword v98, v4, s[56:59], s72 offen
  s_mov_b32 s73, 2506752
  buffer_load_dword v99, v4, s[56:59], s73 offen
  s_mov_b32 s72, 2392064
  buffer_load_dword v100, v4, s[56:59], s72 offen
  s_mov_b32 s73, 2408448
  buffer_load_dword v101, v4, s[56:59], s73 offen
  s_mov_b32 s72, 2523136
  buffer_load_dword v102, v4, s[56:59], s72 offen
  s_mov_b32 s73, 2539520
  buffer_load_dword v103, v4, s[56:59], s73 offen
  s_mov_b32 s72, 2621440
  buffer_load_dword v104, v4, s[56:59], s72 offen
  s_mov_b32 s73, 2637824
  buffer_load_dword v105, v4, s[56:59], s73 offen
  s_mov_b32 s72, 2752512
  buffer_load_dword v106, v4, s[56:59], s72 offen
  s_mov_b32 s73, 2768896
  buffer_load_dword v107, v4, s[56:59], s73 offen
  s_mov_b32 s72, 2654208
  buffer_load_dword v108, v4, s[56:59], s72 offen
  s_mov_b32 s73, 2670592
  buffer_load_dword v109, v4, s[56:59], s73 offen
  s_mov_b32 s72, 2785280
  buffer_load_dword v110, v4, s[56:59], s72 offen
  s_mov_b32 s73, 2801664
  buffer_load_dword v111, v4, s[56:59], s73 offen
  s_mov_b32 s72, 2883584
  buffer_load_dword v112, v4, s[56:59], s72 offen
  s_mov_b32 s73, 2899968
  buffer_load_dword v113, v4, s[56:59], s73 offen
  s_mov_b32 s72, 3014656
  buffer_load_dword v114, v4, s[56:59], s72 offen
  s_mov_b32 s73, 3031040
  buffer_load_dword v115, v4, s[56:59], s73 offen
  s_mov_b32 s72, 2916352
  buffer_load_dword v116, v4, s[56:59], s72 offen
  s_mov_b32 s73, 2932736
  buffer_load_dword v117, v4, s[56:59], s73 offen
  s_mov_b32 s72, 3047424
  buffer_load_dword v118, v4, s[56:59], s72 offen
  s_mov_b32 s73, 3063808
  buffer_load_dword v119, v4, s[56:59], s73 offen
  s_waitcnt vmcnt(48)
  v_perm_b32 v128, v25, v24, s70
  v_perm_b32 v192, v25, v24, s71
  v_perm_b32 v129, v27, v26, s70
  v_perm_b32 v193, v27, v26, s71
  v_perm_b32 v130, v29, v28, s70
  v_perm_b32 v194, v29, v28, s71
  v_perm_b32 v131, v31, v30, s70
  v_perm_b32 v195, v31, v30, s71
  v_perm_b32 v132, v33, v32, s70
  v_perm_b32 v196, v33, v32, s71
  v_perm_b32 v133, v35, v34, s70
  v_perm_b32 v197, v35, v34, s71
  v_perm_b32 v134, v37, v36, s70
  v_perm_b32 v198, v37, v36, s71
  v_perm_b32 v135, v39, v38, s70
  v_perm_b32 v199, v39, v38, s71
  v_perm_b32 v136, v41, v40, s70
  v_perm_b32 v200, v41, v40, s71
  v_perm_b32 v137, v43, v42, s70
  v_perm_b32 v201, v43, v42, s71
  v_perm_b32 v138, v45, v44, s70
  v_perm_b32 v202, v45, v44, s71
  v_perm_b32 v139, v47, v46, s70
  v_perm_b32 v203, v47, v46, s71
  v_perm_b32 v140, v49, v48, s70
  v_perm_b32 v204, v49, v48, s71
  v_perm_b32 v141, v51, v50, s70
  v_perm_b32 v205, v51, v50, s71
  v_perm_b32 v142, v53, v52, s70
  v_perm_b32 v206, v53, v52, s71
  v_perm_b32 v143, v55, v54, s70
  v_perm_b32 v207, v55, v54, s71
  v_perm_b32 v144, v57, v56, s70
  v_perm_b32 v208, v57, v56, s71
  v_perm_b32 v145, v59, v58, s70
  v_perm_b32 v209, v59, v58, s71
  v_perm_b32 v146, v61, v60, s70
  v_perm_b32 v210, v61, v60, s71
  v_perm_b32 v147, v63, v62, s70
  v_perm_b32 v211, v63, v62, s71
  v_perm_b32 v148, v65, v64, s70
  v_perm_b32 v212, v65, v64, s71
  v_perm_b32 v149, v67, v66, s70
  v_perm_b32 v213, v67, v66, s71
  v_perm_b32 v150, v69, v68, s70
  v_perm_b32 v214, v69, v68, s71
  v_perm_b32 v151, v71, v70, s70
  v_perm_b32 v215, v71, v70, s71
  s_mov_b32 s72, 3145728
  buffer_load_dword v24, v4, s[56:59], s72 offen
  s_mov_b32 s73, 3162112
  buffer_load_dword v25, v4, s[56:59], s73 offen
  s_mov_b32 s72, 3276800
  buffer_load_dword v26, v4, s[56:59], s72 offen
  s_mov_b32 s73, 3293184
  buffer_load_dword v27, v4, s[56:59], s73 offen
  s_mov_b32 s72, 3178496
  buffer_load_dword v28, v4, s[56:59], s72 offen
  s_mov_b32 s73, 3194880
  buffer_load_dword v29, v4, s[56:59], s73 offen
  s_mov_b32 s72, 3309568
  buffer_load_dword v30, v4, s[56:59], s72 offen
  s_mov_b32 s73, 3325952
  buffer_load_dword v31, v4, s[56:59], s73 offen
  s_mov_b32 s72, 3407872
  buffer_load_dword v32, v4, s[56:59], s72 offen
  s_mov_b32 s73, 3424256
  buffer_load_dword v33, v4, s[56:59], s73 offen
  s_mov_b32 s72, 3538944
  buffer_load_dword v34, v4, s[56:59], s72 offen
  s_mov_b32 s73, 3555328
  buffer_load_dword v35, v4, s[56:59], s73 offen
  s_mov_b32 s72, 3440640
  buffer_load_dword v36, v4, s[56:59], s72 offen
  s_mov_b32 s73, 3457024
  buffer_load_dword v37, v4, s[56:59], s73 offen
  s_mov_b32 s72, 3571712
  buffer_load_dword v38, v4, s[56:59], s72 offen
  s_mov_b32 s73, 3588096
  buffer_load_dword v39, v4, s[56:59], s73 offen
  s_mov_b32 s72, 3670016
  buffer_load_dword v40, v4, s[56:59], s72 offen
  s_mov_b32 s73, 3686400
  buffer_load_dword v41, v4, s[56:59], s73 offen
  s_mov_b32 s72, 3801088
  buffer_load_dword v42, v4, s[56:59], s72 offen
  s_mov_b32 s73, 3817472
  buffer_load_dword v43, v4, s[56:59], s73 offen
  s_mov_b32 s72, 3702784
  buffer_load_dword v44, v4, s[56:59], s72 offen
  s_mov_b32 s73, 3719168
  buffer_load_dword v45, v4, s[56:59], s73 offen
  s_mov_b32 s72, 3833856
  buffer_load_dword v46, v4, s[56:59], s72 offen
  s_mov_b32 s73, 3850240
  buffer_load_dword v47, v4, s[56:59], s73 offen
  s_mov_b32 s72, 3932160
  buffer_load_dword v48, v4, s[56:59], s72 offen
  s_mov_b32 s73, 3948544
  buffer_load_dword v49, v4, s[56:59], s73 offen
  s_mov_b32 s72, 4063232
  buffer_load_dword v50, v4, s[56:59], s72 offen
  s_mov_b32 s73, 4079616
  buffer_load_dword v51, v4, s[56:59], s73 offen
  s_mov_b32 s72, 3964928
  buffer_load_dword v52, v4, s[56:59], s72 offen
  s_mov_b32 s73, 3981312
  buffer_load_dword v53, v4, s[56:59], s73 offen
  s_mov_b32 s72, 4096000
  buffer_load_dword v54, v4, s[56:59], s72 offen
  s_mov_b32 s73, 4112384
  buffer_load_dword v55, v4, s[56:59], s73 offen
  s_waitcnt vmcnt(32)
  v_perm_b32 v152, v73, v72, s70
  v_perm_b32 v216, v73, v72, s71
  v_perm_b32 v153, v75, v74, s70
  v_perm_b32 v217, v75, v74, s71
  v_perm_b32 v154, v77, v76, s70
  v_perm_b32 v218, v77, v76, s71
  v_perm_b32 v155, v79, v78, s70
  v_perm_b32 v219, v79, v78, s71
  v_perm_b32 v156, v81, v80, s70
  v_perm_b32 v220, v81, v80, s71
  v_perm_b32 v157, v83, v82, s70
  v_perm_b32 v221, v83, v82, s71
  v_perm_b32 v158, v85, v84, s70
  v_perm_b32 v222, v85, v84, s71
  v_perm_b32 v159, v87, v86, s70
  v_perm_b32 v223, v87, v86, s71
  v_perm_b32 v160, v89, v88, s70
  v_perm_b32 v224, v89, v88, s71
  v_perm_b32 v161, v91, v90, s70
  v_perm_b32 v225, v91, v90, s71
  v_perm_b32 v162, v93, v92, s70
  v_perm_b32 v226, v93, v92, s71
  v_perm_b32 v163, v95, v94, s70
  v_perm_b32 v227, v95, v94, s71
  v_perm_b32 v164, v97, v96, s70
  v_perm_b32 v228, v97, v96, s71
  v_perm_b32 v165, v99, v98, s70
  v_perm_b32 v229, v99, v98, s71
  v_perm_b32 v166, v101, v100, s70
  v_perm_b32 v230, v101, v100, s71
  v_perm_b32 v167, v103, v102, s70
  v_perm_b32 v231, v103, v102, s71
  v_perm_b32 v168, v105, v104, s70
  v_perm_b32 v232, v105, v104, s71
  v_perm_b32 v169, v107, v106, s70
  v_perm_b32 v233, v107, v106, s71
  v_perm_b32 v170, v109, v108, s70
  v_perm_b32 v234, v109, v108, s71
  v_perm_b32 v171, v111, v110, s70
  v_perm_b32 v235, v111, v110, s71
  v_perm_b32 v172, v113, v112, s70
  v_perm_b32 v236, v113, v112, s71
  v_perm_b32 v173, v115, v114, s70
  v_perm_b32 v237, v115, v114, s71
  v_perm_b32 v174, v117, v116, s70
  v_perm_b32 v238, v117, v116, s71
  v_perm_b32 v175, v119, v118, s70
  v_perm_b32 v239, v119, v118, s71
  s_waitcnt vmcnt(0)
  v_perm_b32 v176, v25, v24, s70
  v_perm_b32 v240, v25, v24, s71
  v_perm_b32 v177, v27, v26, s70
  v_perm_b32 v241, v27, v26, s71
  v_perm_b32 v178, v29, v28, s70
  v_perm_b32 v242, v29, v28, s71
  v_perm_b32 v179, v31, v30, s70
  v_perm_b32 v243, v31, v30, s71
  v_perm_b32 v180, v33, v32, s70
  v_perm_b32 v244, v33, v32, s71
  v_perm_b32 v181, v35, v34, s70
  v_perm_b32 v245, v35, v34, s71
  v_perm_b32 v182, v37, v36, s70
  v_perm_b32 v246, v37, v36, s71
  v_perm_b32 v183, v39, v38, s70
  v_perm_b32 v247, v39, v38, s71
  v_perm_b32 v184, v41, v40, s70
  v_perm_b32 v248, v41, v40, s71
  v_perm_b32 v185, v43, v42, s70
  v_perm_b32 v249, v43, v42, s71
  v_perm_b32 v186, v45, v44, s70
  v_perm_b32 v250, v45, v44, s71
  v_perm_b32 v187, v47, v46, s70
  v_perm_b32 v251, v47, v46, s71
  v_perm_b32 v188, v49, v48, s70
  v_perm_b32 v252, v49, v48, s71
  v_perm_b32 v189, v51, v50, s70
  v_perm_b32 v253, v51, v50, s71
  v_perm_b32 v190, v53, v52, s70
  v_perm_b32 v254, v53, v52, s71
  v_perm_b32 v191, v55, v54, s70
  v_perm_b32 v255, v55, v54, s71
  s_mov_b32 s72, 0
  buffer_load_dword v24, v5, s[60:63], s72 offen
  s_mov_b32 s73, 1024
  buffer_load_dword v25, v5, s[60:63], s73 offen
  s_mov_b32 s72, 8192
  buffer_load_dword v26, v5, s[60:63], s72 offen
  s_mov_b32 s73, 9216
  buffer_load_dword v27, v5, s[60:63], s73 offen
  s_mov_b32 s72, 2048
  buffer_load_dword v28, v5, s[60:63], s72 offen
  s_mov_b32 s73, 3072
  buffer_load_dword v29, v5, s[60:63], s73 offen
  s_mov_b32 s72, 10240
  buffer_load_dword v30, v5, s[60:63], s72 offen
  s_mov_b32 s73, 11264
  buffer_load_dword v31, v5, s[60:63], s73 offen
  s_mov_b32 s72, 32768
  buffer_load_dword v32, v5, s[60:63], s72 offen
  s_mov_b32 s73, 33792
  buffer_load_dword v33, v5, s[60:63], s73 offen
  s_mov_b32 s72, 40960
  buffer_load_dword v34, v5, s[60:63], s72 offen
  s_mov_b32 s73, 41984
  buffer_load_dword v35, v5, s[60:63], s73 offen
  s_mov_b32 s72, 34816
  buffer_load_dword v36, v5, s[60:63], s72 offen
  s_mov_b32 s73, 35840
  buffer_load_dword v37, v5, s[60:63], s73 offen
  s_mov_b32 s72, 43008
  buffer_load_dword v38, v5, s[60:63], s72 offen
  s_mov_b32 s73, 44032
  buffer_load_dword v39, v5, s[60:63], s73 offen
  s_mov_b32 s72, 65536
  buffer_load_dword v40, v5, s[60:63], s72 offen
  s_mov_b32 s73, 66560
  buffer_load_dword v41, v5, s[60:63], s73 offen
  s_mov_b32 s72, 73728
  buffer_load_dword v42, v5, s[60:63], s72 offen
  s_mov_b32 s73, 74752
  buffer_load_dword v43, v5, s[60:63], s73 offen
  s_mov_b32 s72, 67584
  buffer_load_dword v44, v5, s[60:63], s72 offen
  s_mov_b32 s73, 68608
  buffer_load_dword v45, v5, s[60:63], s73 offen
  s_mov_b32 s72, 75776
  buffer_load_dword v46, v5, s[60:63], s72 offen
  s_mov_b32 s73, 76800
  buffer_load_dword v47, v5, s[60:63], s73 offen
  s_mov_b32 s72, 98304
  buffer_load_dword v48, v5, s[60:63], s72 offen
  s_mov_b32 s73, 99328
  buffer_load_dword v49, v5, s[60:63], s73 offen
  s_mov_b32 s72, 106496
  buffer_load_dword v50, v5, s[60:63], s72 offen
  s_mov_b32 s73, 107520
  buffer_load_dword v51, v5, s[60:63], s73 offen
  s_mov_b32 s72, 100352
  buffer_load_dword v52, v5, s[60:63], s72 offen
  s_mov_b32 s73, 101376
  buffer_load_dword v53, v5, s[60:63], s73 offen
  s_mov_b32 s72, 108544
  buffer_load_dword v54, v5, s[60:63], s72 offen
  s_mov_b32 s73, 109568
  buffer_load_dword v55, v5, s[60:63], s73 offen
  s_mov_b32 s72, 64
  buffer_load_dword v56, v5, s[60:63], s72 offen
  s_mov_b32 s73, 1088
  buffer_load_dword v57, v5, s[60:63], s73 offen
  s_mov_b32 s72, 8256
  buffer_load_dword v58, v5, s[60:63], s72 offen
  s_mov_b32 s73, 9280
  buffer_load_dword v59, v5, s[60:63], s73 offen
  s_mov_b32 s72, 2112
  buffer_load_dword v60, v5, s[60:63], s72 offen
  s_mov_b32 s73, 3136
  buffer_load_dword v61, v5, s[60:63], s73 offen
  s_mov_b32 s72, 10304
  buffer_load_dword v62, v5, s[60:63], s72 offen
  s_mov_b32 s73, 11328
  buffer_load_dword v63, v5, s[60:63], s73 offen
  s_mov_b32 s72, 32832
  buffer_load_dword v64, v5, s[60:63], s72 offen
  s_mov_b32 s73, 33856
  buffer_load_dword v65, v5, s[60:63], s73 offen
  s_mov_b32 s72, 41024
  buffer_load_dword v66, v5, s[60:63], s72 offen
  s_mov_b32 s73, 42048
  buffer_load_dword v67, v5, s[60:63], s73 offen
  s_mov_b32 s72, 34880
  buffer_load_dword v68, v5, s[60:63], s72 offen
  s_mov_b32 s73, 35904
  buffer_load_dword v69, v5, s[60:63], s73 offen
  s_mov_b32 s72, 43072
  buffer_load_dword v70, v5, s[60:63], s72 offen
  s_mov_b32 s73, 44096
  buffer_load_dword v71, v5, s[60:63], s73 offen
  s_mov_b32 s72, 65600
  buffer_load_dword v72, v5, s[60:63], s72 offen
  s_mov_b32 s73, 66624
  buffer_load_dword v73, v5, s[60:63], s73 offen
  s_mov_b32 s72, 73792
  buffer_load_dword v74, v5, s[60:63], s72 offen
  s_mov_b32 s73, 74816
  buffer_load_dword v75, v5, s[60:63], s73 offen
  s_mov_b32 s72, 67648
  buffer_load_dword v76, v5, s[60:63], s72 offen
  s_mov_b32 s73, 68672
  buffer_load_dword v77, v5, s[60:63], s73 offen
  s_mov_b32 s72, 75840
  buffer_load_dword v78, v5, s[60:63], s72 offen
  s_mov_b32 s73, 76864
  buffer_load_dword v79, v5, s[60:63], s73 offen
  s_mov_b32 s72, 98368
  buffer_load_dword v80, v5, s[60:63], s72 offen
  s_mov_b32 s73, 99392
  buffer_load_dword v81, v5, s[60:63], s73 offen
  s_mov_b32 s72, 106560
  buffer_load_dword v82, v5, s[60:63], s72 offen
  s_mov_b32 s73, 107584
  buffer_load_dword v83, v5, s[60:63], s73 offen
  s_mov_b32 s72, 100416
  buffer_load_dword v84, v5, s[60:63], s72 offen
  s_mov_b32 s73, 101440
  buffer_load_dword v85, v5, s[60:63], s73 offen
  s_mov_b32 s72, 108608
  buffer_load_dword v86, v5, s[60:63], s72 offen
  s_mov_b32 s73, 109632
  buffer_load_dword v87, v5, s[60:63], s73 offen
  s_waitcnt vmcnt(32)
  v_perm_b32 v96, v25, v24, s70
  v_perm_b32 v104, v25, v24, s71
  v_perm_b32 v97, v27, v26, s70
  v_perm_b32 v105, v27, v26, s71
  v_perm_b32 v98, v29, v28, s70
  v_perm_b32 v106, v29, v28, s71
  v_perm_b32 v99, v31, v30, s70
  v_perm_b32 v107, v31, v30, s71
  v_perm_b32 v100, v33, v32, s70
  v_perm_b32 v108, v33, v32, s71
  v_perm_b32 v101, v35, v34, s70
  v_perm_b32 v109, v35, v34, s71
  v_perm_b32 v102, v37, v36, s70
  v_perm_b32 v110, v37, v36, s71
  v_perm_b32 v103, v39, v38, s70
  v_perm_b32 v111, v39, v38, s71
  ds_write_b128 v11, v[96:99] offset:0
  ds_write_b128 v11, v[100:103] offset:1024
  ds_write_b128 v11, v[104:107] offset:4096
  ds_write_b128 v11, v[108:111] offset:5120
  v_perm_b32 v112, v41, v40, s70
  v_perm_b32 v120, v41, v40, s71
  v_perm_b32 v113, v43, v42, s70
  v_perm_b32 v121, v43, v42, s71
  v_perm_b32 v114, v45, v44, s70
  v_perm_b32 v122, v45, v44, s71
  v_perm_b32 v115, v47, v46, s70
  v_perm_b32 v123, v47, v46, s71
  v_perm_b32 v116, v49, v48, s70
  v_perm_b32 v124, v49, v48, s71
  v_perm_b32 v117, v51, v50, s70
  v_perm_b32 v125, v51, v50, s71
  v_perm_b32 v118, v53, v52, s70
  v_perm_b32 v126, v53, v52, s71
  v_perm_b32 v119, v55, v54, s70
  v_perm_b32 v127, v55, v54, s71
  ds_write_b128 v11, v[112:115] offset:2048
  ds_write_b128 v11, v[116:119] offset:3072
  ds_write_b128 v11, v[120:123] offset:6144
  ds_write_b128 v11, v[124:127] offset:7168
  s_mov_b32 s72, 128
  buffer_load_dword v24, v5, s[60:63], s72 offen
  s_mov_b32 s73, 1152
  buffer_load_dword v25, v5, s[60:63], s73 offen
  s_mov_b32 s72, 8320
  buffer_load_dword v26, v5, s[60:63], s72 offen
  s_mov_b32 s73, 9344
  buffer_load_dword v27, v5, s[60:63], s73 offen
  s_mov_b32 s72, 2176
  buffer_load_dword v28, v5, s[60:63], s72 offen
  s_mov_b32 s73, 3200
  buffer_load_dword v29, v5, s[60:63], s73 offen
  s_mov_b32 s72, 10368
  buffer_load_dword v30, v5, s[60:63], s72 offen
  s_mov_b32 s73, 11392
  buffer_load_dword v31, v5, s[60:63], s73 offen
  s_mov_b32 s72, 32896
  buffer_load_dword v32, v5, s[60:63], s72 offen
  s_mov_b32 s73, 33920
  buffer_load_dword v33, v5, s[60:63], s73 offen
  s_mov_b32 s72, 41088
  buffer_load_dword v34, v5, s[60:63], s72 offen
  s_mov_b32 s73, 42112
  buffer_load_dword v35, v5, s[60:63], s73 offen
  s_mov_b32 s72, 34944
  buffer_load_dword v36, v5, s[60:63], s72 offen
  s_mov_b32 s73, 35968
  buffer_load_dword v37, v5, s[60:63], s73 offen
  s_mov_b32 s72, 43136
  buffer_load_dword v38, v5, s[60:63], s72 offen
  s_mov_b32 s73, 44160
  buffer_load_dword v39, v5, s[60:63], s73 offen
  s_mov_b32 s72, 65664
  buffer_load_dword v40, v5, s[60:63], s72 offen
  s_mov_b32 s73, 66688
  buffer_load_dword v41, v5, s[60:63], s73 offen
  s_mov_b32 s72, 73856
  buffer_load_dword v42, v5, s[60:63], s72 offen
  s_mov_b32 s73, 74880
  buffer_load_dword v43, v5, s[60:63], s73 offen
  s_mov_b32 s72, 67712
  buffer_load_dword v44, v5, s[60:63], s72 offen
  s_mov_b32 s73, 68736
  buffer_load_dword v45, v5, s[60:63], s73 offen
  s_mov_b32 s72, 75904
  buffer_load_dword v46, v5, s[60:63], s72 offen
  s_mov_b32 s73, 76928
  buffer_load_dword v47, v5, s[60:63], s73 offen
  s_mov_b32 s72, 98432
  buffer_load_dword v48, v5, s[60:63], s72 offen
  s_mov_b32 s73, 99456
  buffer_load_dword v49, v5, s[60:63], s73 offen
  s_mov_b32 s72, 106624
  buffer_load_dword v50, v5, s[60:63], s72 offen
  s_mov_b32 s73, 107648
  buffer_load_dword v51, v5, s[60:63], s73 offen
  s_mov_b32 s72, 100480
  buffer_load_dword v52, v5, s[60:63], s72 offen
  s_mov_b32 s73, 101504
  buffer_load_dword v53, v5, s[60:63], s73 offen
  s_mov_b32 s72, 108672
  buffer_load_dword v54, v5, s[60:63], s72 offen
  s_mov_b32 s73, 109696
  buffer_load_dword v55, v5, s[60:63], s73 offen
  s_waitcnt vmcnt(32)
  v_perm_b32 v96, v57, v56, s70
  v_perm_b32 v104, v57, v56, s71
  v_perm_b32 v97, v59, v58, s70
  v_perm_b32 v105, v59, v58, s71
  v_perm_b32 v98, v61, v60, s70
  v_perm_b32 v106, v61, v60, s71
  v_perm_b32 v99, v63, v62, s70
  v_perm_b32 v107, v63, v62, s71
  v_perm_b32 v100, v65, v64, s70
  v_perm_b32 v108, v65, v64, s71
  v_perm_b32 v101, v67, v66, s70
  v_perm_b32 v109, v67, v66, s71
  v_perm_b32 v102, v69, v68, s70
  v_perm_b32 v110, v69, v68, s71
  v_perm_b32 v103, v71, v70, s70
  v_perm_b32 v111, v71, v70, s71
  ds_write_b128 v11, v[96:99] offset:8192
  ds_write_b128 v11, v[100:103] offset:9216
  ds_write_b128 v11, v[104:107] offset:12288
  ds_write_b128 v11, v[108:111] offset:13312
  v_perm_b32 v112, v73, v72, s70
  v_perm_b32 v120, v73, v72, s71
  v_perm_b32 v113, v75, v74, s70
  v_perm_b32 v121, v75, v74, s71
  v_perm_b32 v114, v77, v76, s70
  v_perm_b32 v122, v77, v76, s71
  v_perm_b32 v115, v79, v78, s70
  v_perm_b32 v123, v79, v78, s71
  v_perm_b32 v116, v81, v80, s70
  v_perm_b32 v124, v81, v80, s71
  v_perm_b32 v117, v83, v82, s70
  v_perm_b32 v125, v83, v82, s71
  v_perm_b32 v118, v85, v84, s70
  v_perm_b32 v126, v85, v84, s71
  v_perm_b32 v119, v87, v86, s70
  v_perm_b32 v127, v87, v86, s71
  ds_write_b128 v11, v[112:115] offset:10240
  ds_write_b128 v11, v[116:119] offset:11264
  ds_write_b128 v11, v[120:123] offset:14336
  ds_write_b128 v11, v[124:127] offset:15360
  s_mov_b32 s72, 192
  buffer_load_dword v56, v5, s[60:63], s72 offen
  s_mov_b32 s73, 1216
  buffer_load_dword v57, v5, s[60:63], s73 offen
  s_mov_b32 s72, 8384
  buffer_load_dword v58, v5, s[60:63], s72 offen
  s_mov_b32 s73, 9408
  buffer_load_dword v59, v5, s[60:63], s73 offen
  s_mov_b32 s72, 2240
  buffer_load_dword v60, v5, s[60:63], s72 offen
  s_mov_b32 s73, 3264
  buffer_load_dword v61, v5, s[60:63], s73 offen
  s_mov_b32 s72, 10432
  buffer_load_dword v62, v5, s[60:63], s72 offen
  s_mov_b32 s73, 11456
  buffer_load_dword v63, v5, s[60:63], s73 offen
  s_mov_b32 s72, 32960
  buffer_load_dword v64, v5, s[60:63], s72 offen
  s_mov_b32 s73, 33984
  buffer_load_dword v65, v5, s[60:63], s73 offen
  s_mov_b32 s72, 41152
  buffer_load_dword v66, v5, s[60:63], s72 offen
  s_mov_b32 s73, 42176
  buffer_load_dword v67, v5, s[60:63], s73 offen
  s_mov_b32 s72, 35008
  buffer_load_dword v68, v5, s[60:63], s72 offen
  s_mov_b32 s73, 36032
  buffer_load_dword v69, v5, s[60:63], s73 offen
  s_mov_b32 s72, 43200
  buffer_load_dword v70, v5, s[60:63], s72 offen
  s_mov_b32 s73, 44224
  buffer_load_dword v71, v5, s[60:63], s73 offen
  s_mov_b32 s72, 65728
  buffer_load_dword v72, v5, s[60:63], s72 offen
  s_mov_b32 s73, 66752
  buffer_load_dword v73, v5, s[60:63], s73 offen
  s_mov_b32 s72, 73920
  buffer_load_dword v74, v5, s[60:63], s72 offen
  s_mov_b32 s73, 74944
  buffer_load_dword v75, v5, s[60:63], s73 offen
  s_mov_b32 s72, 67776
  buffer_load_dword v76, v5, s[60:63], s72 offen
  s_mov_b32 s73, 68800
  buffer_load_dword v77, v5, s[60:63], s73 offen
  s_mov_b32 s72, 75968
  buffer_load_dword v78, v5, s[60:63], s72 offen
  s_mov_b32 s73, 76992
  buffer_load_dword v79, v5, s[60:63], s73 offen
  s_mov_b32 s72, 98496
  buffer_load_dword v80, v5, s[60:63], s72 offen
  s_mov_b32 s73, 99520
  buffer_load_dword v81, v5, s[60:63], s73 offen
  s_mov_b32 s72, 106688
  buffer_load_dword v82, v5, s[60:63], s72 offen
  s_mov_b32 s73, 107712
  buffer_load_dword v83, v5, s[60:63], s73 offen
  s_mov_b32 s72, 100544
  buffer_load_dword v84, v5, s[60:63], s72 offen
  s_mov_b32 s73, 101568
  buffer_load_dword v85, v5, s[60:63], s73 offen
  s_mov_b32 s72, 108736
  buffer_load_dword v86, v5, s[60:63], s72 offen
  s_mov_b32 s73, 109760
  buffer_load_dword v87, v5, s[60:63], s73 offen
  s_waitcnt vmcnt(32)
  v_perm_b32 v96, v25, v24, s70
  v_perm_b32 v104, v25, v24, s71
  v_perm_b32 v97, v27, v26, s70
  v_perm_b32 v105, v27, v26, s71
  v_perm_b32 v98, v29, v28, s70
  v_perm_b32 v106, v29, v28, s71
  v_perm_b32 v99, v31, v30, s70
  v_perm_b32 v107, v31, v30, s71
  v_perm_b32 v100, v33, v32, s70
  v_perm_b32 v108, v33, v32, s71
  v_perm_b32 v101, v35, v34, s70
  v_perm_b32 v109, v35, v34, s71
  v_perm_b32 v102, v37, v36, s70
  v_perm_b32 v110, v37, v36, s71
  v_perm_b32 v103, v39, v38, s70
  v_perm_b32 v111, v39, v38, s71
  ds_write_b128 v11, v[96:99] offset:16384
  ds_write_b128 v11, v[100:103] offset:17408
  ds_write_b128 v11, v[104:107] offset:20480
  ds_write_b128 v11, v[108:111] offset:21504
  v_perm_b32 v112, v41, v40, s70
  v_perm_b32 v120, v41, v40, s71
  v_perm_b32 v113, v43, v42, s70
  v_perm_b32 v121, v43, v42, s71
  v_perm_b32 v114, v45, v44, s70
  v_perm_b32 v122, v45, v44, s71
  v_perm_b32 v115, v47, v46, s70
  v_perm_b32 v123, v47, v46, s71
  v_perm_b32 v116, v49, v48, s70
  v_perm_b32 v124, v49, v48, s71
  v_perm_b32 v117, v51, v50, s70
  v_perm_b32 v125, v51, v50, s71
  v_perm_b32 v118, v53, v52, s70
  v_perm_b32 v126, v53, v52, s71
  v_perm_b32 v119, v55, v54, s70
  v_perm_b32 v127, v55, v54, s71
  ds_write_b128 v11, v[112:115] offset:18432
  ds_write_b128 v11, v[116:119] offset:19456
  ds_write_b128 v11, v[120:123] offset:22528
  ds_write_b128 v11, v[124:127] offset:23552
  s_waitcnt vmcnt(0)
  v_perm_b32 v96, v57, v56, s70
  v_perm_b32 v104, v57, v56, s71
  v_perm_b32 v97, v59, v58, s70
  v_perm_b32 v105, v59, v58, s71
  v_perm_b32 v98, v61, v60, s70
  v_perm_b32 v106, v61, v60, s71
  v_perm_b32 v99, v63, v62, s70
  v_perm_b32 v107, v63, v62, s71
  v_perm_b32 v100, v65, v64, s70
  v_perm_b32 v108, v65, v64, s71
  v_perm_b32 v101, v67, v66, s70
  v_perm_b32 v109, v67, v66, s71
  v_perm_b32 v102, v69, v68, s70
  v_perm_b32 v110, v69, v68, s71
  v_perm_b32 v103, v71, v70, s70
  v_perm_b32 v111, v71, v70, s71
  ds_write_b128 v11, v[96:99] offset:24576
  ds_write_b128 v11, v[100:103] offset:25600
  ds_write_b128 v11, v[104:107] offset:28672
  ds_write_b128 v11, v[108:111] offset:29696
  v_perm_b32 v112, v73, v72, s70
  v_perm_b32 v120, v73, v72, s71
  v_perm_b32 v113, v75, v74, s70
  v_perm_b32 v121, v75, v74, s71
  v_perm_b32 v114, v77, v76, s70
  v_perm_b32 v122, v77, v76, s71
  v_perm_b32 v115, v79, v78, s70
  v_perm_b32 v123, v79, v78, s71
  v_perm_b32 v116, v81, v80, s70
  v_perm_b32 v124, v81, v80, s71
  v_perm_b32 v117, v83, v82, s70
  v_perm_b32 v125, v83, v82, s71
  v_perm_b32 v118, v85, v84, s70
  v_perm_b32 v126, v85, v84, s71
  v_perm_b32 v119, v87, v86, s70
  v_perm_b32 v127, v87, v86, s71
  ds_write_b128 v11, v[112:115] offset:26624
  ds_write_b128 v11, v[116:119] offset:27648
  ds_write_b128 v11, v[120:123] offset:30720
  ds_write_b128 v11, v[124:127] offset:31744
  s_mov_b32 s60, s40
  s_mov_b32 s61, s41
  s_mov_b32 s62, 256
  s_mov_b32 s63, 0x00020000
  v_mov_b32 v33, 0
  s_nop 1
mw_3:
  buffer_load_dword v32, v33, s[60:63], 0 offen offset:68 sc1
  s_waitcnt vmcnt(0)
  v_readfirstlane_b32 s72, v32
  s_nop 0
  s_cmp_ge_u32 s72, 256
  s_nop 1
  s_cbranch_scc1 md_4
  s_sub_u32 s69, s69, 1
  s_cbranch_scc0 mw_3
  s_branch mega_exit
md_4:
  buffer_load_dwordx4 v[24:27], v33, s[60:63], 0 offen sc1
  buffer_load_dwordx4 v[28:31], v33, s[60:63], 0 offen offset:16 sc1
  s_waitcnt vmcnt(0)
  v_xor_b32 v24, 32, v24
  v_xor_b32 v25, 32, v25
  v_xor_b32 v26, 32, v26
  v_xor_b32 v27, 32, v27
  v_xor_b32 v28, 32, v28
  v_xor_b32 v29, 32, v29
  v_xor_b32 v30, 32, v30
  v_xor_b32 v31, 32, v31
  v_or3_b32 v24, v24, v25, v26
  v_or3_b32 v24, v24, v27, v28
  v_or3_b32 v24, v24, v29, v30
  v_or_b32 v24, v24, v31
  s_nop 0
  v_readfirstlane_b32 s68, v24
  s_mov_b32 s60, s40
  s_mov_b32 s61, s41
  s_mov_b32 s62, 256
  s_mov_b32 s63, 0x00020000
  s_nop 0
iw_5:
  buffer_load_dword v24, off, s[60:63], 0 offset:192 sc1
  s_waitcnt vmcnt(0)
  v_readfirstlane_b32 s72, v24
  s_nop 0
  s_cmp_ge_u32 s72, 208
  s_nop 1
  s_cbranch_scc1 id_6
  s_sub_u32 s69, s69, 1
  s_cbranch_scc0 iw_5
  s_branch mega_exit
id_6:
  v_lshlrev_b32 v4, 4, v1
  s_mul_i32 s73, s66, 2176
  s_add_u32 s73, s73, 131072
  v_add_u32 v5, s73, v4
  v_and_b32 v24, 7, v1
  v_bfe_u32 v25, v1, 3, 1
  v_lshl_add_u32 v26, v3, 1, v25
  v_lshlrev_b32 v26, 4, v26
  v_mul_u32_u24 v6, 1088, v24
  v_add_u32 v6, v6, v26
  v_add_u32 v6, 131072, v6
  v_mul_u32_u24 v10, 320, v24
  v_add_u32 v9, 144896, v10
  v_add_u32 v10, v9, v26
  s_lshl_b32 s73, s66, 6
  v_lshl_add_u32 v9, v3, 4, v9
  v_add_u32 v9, s73, v9
  v_lshrrev_b32 v27, 5, v1
  v_and_b32 v28, 1, v3
  v_mul_u32_u24 v7, 1280, v27
  v_mul_u32_u24 v29, 576, v28
  v_add_u32 v7, v7, v29
  v_lshl_add_u32 v7, v2, 3, v7
  s_lshl_b32 s73, s66, 7
  s_add_u32 s74, s73, 139776
  v_add_u32 v7, s74, v7
  v_bfe_u32 v29, v1, 2, 1
  v_mul_u32_u24 v8, 1280, v29
  v_and_b32 v29, 1, v1
  v_mul_u32_u24 v29, 576, v29
  v_add_u32 v8, v8, v29
  v_lshl_add_u32 v8, v25, 3, v8
  v_lshl_add_u32 v8, v3, 5, v8
  v_add_u32 v8, 139776, v8
  s_add_u32 s73, s73, 2560
  v_add_u32 v21, s73, v8
  s_lshl_b32 s72, s64, 20
  s_lshl_b32 s73, s66, 16
  s_add_u32 s73, s73, s72
  s_lshl_b32 s74, s65, 8
  s_add_u32 s73, s73, s74
  v_lshlrev_b32 v12, 14, v28
  v_lshl_add_u32 v12, v27, 13, v12
  v_lshl_add_u32 v12, v2, 4, v12
  v_add_u32 v12, s73, v12
  s_lshl_b32 s73, s65, 13
  s_add_u32 s73, s73, s72
  s_lshl_b32 s74, s66, 6
  s_add_u32 s73, s73, s74
  v_lshrrev_b32 v13, 2, v1
  v_lshlrev_b32 v13, 8, v13
  v_and_b32 v29, 3, v1
  v_lshl_add_u32 v13, v29, 4, v13
  v_add_u32 v13, s73, v13
  s_lshr_b32 s73, s65, 2
  s_lshl_b32 s73, s73, 7
  s_and_b32 s74, s65, 1
  s_lshl_b32 s74, s74, 5
  s_add_u32 s73, s73, s74
  s_bfe_u32 s74, s65, 0x10001
  s_lshl_b32 s74, s74, 12
  s_add_u32 s73, s73, s74
  s_lshl_b32 s74, s66, 3
  s_add_u32 s73, s73, s74
  s_lshl_b32 s74, s64, 15
  s_add_u32 s73, s73, s74
  s_add_u32 s73, s73, 14745600
  v_lshlrev_b32 v14, 10, v29
  v_bfe_u32 v29, v1, 2, 1
  v_lshl_add_u32 v14, v29, 6, v14
  v_add_u32 v14, s73, v14
  s_lshl_b32 s92, s66, 11
  s_add_u32 s92, s92, s74
  s_add_u32 s92, s92, 14745600
  s_lshl_b32 s72, s64, 11
  s_add_u32 s72, s72, s65
  s_lshl_b32 s73, s72, 15
  v_lshlrev_b32 v15, 9, v3
  v_lshl_add_u32 v15, v2, 4, v15
  v_add_u32 v15, 147456, v15
  s_lshl_b32 s74, s66, 12
  s_add_u32 s91, s73, s74
  s_add_u32 s91, s91, 134217728
  v_lshlrev_b32 v19, 3, v1
  s_add_u32 m0, s74, 147456
  s_lshl_b32 s93, s64, 25
  s_lshl_b32 s73, s65, 13
  s_add_u32 s93, s93, s73
  s_lshl_b32 s74, s66, 10
  s_add_u32 s93, s93, s74
  s_add_u32 s93, s93, 67371008
  s_lshl_b32 s73, s64, 9
  s_lshl_b32 s74, s65, 4
  s_add_u32 s73, s73, s74
  v_and_b32 v17, 3, v1
  v_lshlrev_b32 v17, 2, v17
  v_add_u32 v17, s73, v17
  s_lshl_b32 s79, s66, 2
  s_add_u32 s79, s79, s73
  s_add_u32 s79, s79, 14681088
  v_mov_b32 v16, 0x44444444
  v_mov_b32 v29, 0xeeeeeeee
  v_cmp_eq_u32 vcc, 1, v25
  s_nop 1
  v_cndmask_b32 v16, v16, v29, vcc
  s_mov_b32 s75, 1040356334
  s_mov_b32 s76, -1
  s_mov_b32 s77, 0
  s_lshr_b32 s78, s66, 1
  s_lshl_b32 s78, s78, 12
  s_and_b32 s74, s66, 1
  s_lshl_b32 s74, s74, 8
  s_add_u32 s78, s78, s74
  s_add_u32 s78, s78, 8192
  s_mov_b32 s80, 14680064
  s_mov_b32 s94, 0x3f80
  s_mov_b32 s95, 0
  s_mov_b32 s2, 0x0f0f0f0f
  s_mov_b32 s3, 0x0f0f0f0f
  s_mov_b32 s72, s92
  v_mov_b32 v0, 0x3f803f80
  v_mov_b32 v1, 0x3f803f80
  v_mov_b32 v2, 0x3f803f80
  v_mov_b32 v3, 0x3f803f80
  s_nop 1
pf_7:
  buffer_load_dword v20, v17, s[44:47], s80 offen sc1
  s_waitcnt vmcnt(0)
  v_cmp_gt_u32 vcc, 1, v20
  s_nop 0
  s_cbranch_vccz pd_8
  s_nop 2
pr_9:
  s_sub_u32 s69, s69, 1
  s_cbranch_scc0 pf_7
  s_branch mega_exit
pd_8:
  s_mov_b32 s81, s91
  buffer_load_dwordx4 v4, s[44:47], s81 offen offset:0 lds
  buffer_load_dwordx4 v4, s[44:47], s81 offen offset:1024 lds
  buffer_load_dwordx4 v4, s[44:47], s81 offen offset:2048 lds
  buffer_load_dwordx4 v4, s[44:47], s81 offen offset:3072 lds
  buffer_load_dword v20, v17, s[44:47], s80 offen sc1
  v_mov_b32 v72, 0
  v_mov_b32 v73, 0
  v_mov_b32 v74, 0
  v_mov_b32 v75, 0
  v_mov_b32 v76, 0
  v_mov_b32 v77, 0
  v_mov_b32 v78, 0
  v_mov_b32 v79, 0
  v_mov_b32 v80, 0
  v_mov_b32 v81, 0
  v_mov_b32 v82, 0
  v_mov_b32 v83, 0
  v_mov_b32 v84, 0
  v_mov_b32 v85, 0
  v_mov_b32 v86, 0
  v_mov_b32 v87, 0
  v_mov_b32 v88, 0
  v_mov_b32 v89, 0
  v_mov_b32 v90, 0
  v_mov_b32 v91, 0
  v_mov_b32 v92, 0
  v_mov_b32 v93, 0
  v_mov_b32 v94, 0
  v_mov_b32 v95, 0
  s_cmp_lg_u32 s68, 0
  s_cbranch_scc1 r1_top
r0_top:
  buffer_load_dwordx4 v[96:99], v4, s[44:47], s72 offen offset:0 sc1
  buffer_load_dwordx4 v[100:103], v4, s[44:47], s72 offen offset:1024 sc1
  s_waitcnt vmcnt(0)
  v_max3_u32 v104, v96, v98, v100
  v_max_u32 v104, v104, v102
  v_cmp_eq_u32 vcc, -1, v104
  s_nop 0
  s_cbranch_vccnz r0_spin0
  ds_write_b128 v5, v[96:99]
  ds_write_b128 v5, v[100:103] offset:1088
  s_waitcnt lgkmcnt(0)
  s_barrier
  ds_read_b128 v[96:99], v6 offset:0
  ds_read_b128 v[100:103], v6 offset:128
  ds_read_b128 v[104:107], v6 offset:256
  ds_read_b128 v[108:111], v6 offset:384
  ds_read_b128 v[112:115], v6 offset:512
  ds_read_b128 v[116:119], v6 offset:640
  ds_read_b128 v[120:123], v6 offset:768
  ds_read_b128 v[124:127], v6 offset:896
  v_mov_b32 v68, s67
  s_mov_b64 exec, 1
  buffer_store_dword v68, off, s[44:47], s79 sc1
  s_mov_b64 exec, -1
  s_add_u32 s85, s67, 2
  s_min_u32 s85, s85, 64
  v_cmp_gt_u32 vcc, s85, v20
  v_add_u32 v69, s78, v15
  s_lshl_b32 s84, s67, 18
  s_add_u32 s84, s84, s93
  s_cbranch_vccnz r0_kvw
r0_kvok:
  buffer_load_dword v20, v17, s[44:47], s80 offen sc1
  s_waitcnt lgkmcnt(7)
  v_smfmac_f32_16x16x64_bf16 v[72:75], v[96:99], a[0:7], v16
  s_waitcnt lgkmcnt(6)
  v_smfmac_f32_16x16x64_bf16 v[72:75], v[100:103], a[8:15], v16
  s_waitcnt lgkmcnt(5)
  v_smfmac_f32_16x16x64_bf16 v[72:75], v[104:107], a[16:23], v16
  s_waitcnt lgkmcnt(4)
  v_smfmac_f32_16x16x64_bf16 v[72:75], v[108:111], a[24:31], v16
  s_waitcnt lgkmcnt(3)
  v_smfmac_f32_16x16x64_bf16 v[72:75], v[112:115], a[32:39], v16
  s_waitcnt lgkmcnt(2)
  v_smfmac_f32_16x16x64_bf16 v[72:75], v[116:119], a[40:47], v16
  s_waitcnt lgkmcnt(1)
  v_smfmac_f32_16x16x64_bf16 v[72:75], v[120:123], a[48:55], v16
  s_waitcnt lgkmcnt(0)
  v_smfmac_f32_16x16x64_bf16 v[72:75], v[124:127], a[56:63], v16
  v_smfmac_f32_16x16x64_bf16 v[76:79], v[96:99], a[64:71], v16
  ds_read_b128 v[24:27], v15 offset:0
  s_sub_u32 s85, s85, 1
  v_smfmac_f32_16x16x64_bf16 v[76:79], v[100:103], a[72:79], v16
  ds_read_b128 v[40:43], v15 offset:256
  s_lshl_b32 s81, s85, 20
  v_smfmac_f32_16x16x64_bf16 v[76:79], v[104:107], a[80:87], v16
  ds_read_b128 v[28:31], v15 offset:2048
  s_add_u32 s81, s81, s91
  v_smfmac_f32_16x16x64_bf16 v[76:79], v[108:111], a[88:95], v16
  ds_read_b128 v[44:47], v15 offset:2304
  s_and_b32 s86, s67, 1
  v_smfmac_f32_16x16x64_bf16 v[76:79], v[112:115], a[96:103], v16
  ds_read_b128 v[32:35], v15 offset:4096
  s_lshl_b32 s86, s86, 19
  v_smfmac_f32_16x16x64_bf16 v[76:79], v[116:119], a[104:111], v16
  ds_read_b128 v[48:51], v15 offset:4352
  s_add_u32 s86, s86, 14811136
  v_smfmac_f32_16x16x64_bf16 v[76:79], v[120:123], a[112:119], v16
  ds_read_b128 v[36:39], v15 offset:6144
  s_add_u32 s87, s86, 32768
  v_smfmac_f32_16x16x64_bf16 v[76:79], v[124:127], a[120:127], v16
  ds_read_b128 v[52:55], v15 offset:6400
  s_add_u32 s88, s86, 4096
  v_smfmac_f32_16x16x64_bf16 v[80:83], v[96:99], a[128:135], v16
  ds_read_b128 v[56:59], v69 offset:0
  s_bfe_u32 s90, s67, 0x10001
  v_smfmac_f32_16x16x64_bf16 v[80:83], v[100:103], a[136:143], v16
  ds_read_b128 v[60:63], v69 offset:2048
  s_xor_b32 s90, s90, 1
  v_smfmac_f32_16x16x64_bf16 v[80:83], v[104:107], a[144:151], v16
  s_add_u32 s73, s67, 1
  v_smfmac_f32_16x16x64_bf16 v[80:83], v[108:111], a[152:159], v16
  s_and_b32 s73, s73, 3
  v_smfmac_f32_16x16x64_bf16 v[80:83], v[112:115], a[160:167], v16
  s_lshl_b32 s73, s73, 13
  v_smfmac_f32_16x16x64_bf16 v[80:83], v[116:119], a[168:175], v16
  s_add_u32 s72, s73, s92
  v_smfmac_f32_16x16x64_bf16 v[80:83], v[120:123], a[176:183], v16
  s_xor_b32 s74, s73, 16384
  v_smfmac_f32_16x16x64_bf16 v[80:83], v[124:127], a[184:191], v16
  v_smfmac_f32_16x16x64_bf16 v[84:87], v[96:99], a[192:199], v16
  v_smfmac_f32_16x16x64_bf16 v[84:87], v[100:103], a[200:207], v16
  v_smfmac_f32_16x16x64_bf16 v[84:87], v[104:107], a[208:215], v16
  v_smfmac_f32_16x16x64_bf16 v[84:87], v[108:111], a[216:223], v16
  v_smfmac_f32_16x16x64_bf16 v[84:87], v[112:115], a[224:231], v16
  v_smfmac_f32_16x16x64_bf16 v[84:87], v[116:119], a[232:239], v16
  v_smfmac_f32_16x16x64_bf16 v[84:87], v[120:123], a[240:247], v16
  v_smfmac_f32_16x16x64_bf16 v[84:87], v[124:127], a[248:255], v16
  v_permlane32_swap_b32 v72, v76
  v_permlane32_swap_b32 v73, v77
  v_permlane32_swap_b32 v74, v78
  v_permlane32_swap_b32 v75, v79
  v_pk_add_f32 v[72:73], v[72:73], v[76:77]
  v_pk_add_f32 v[74:75], v[74:75], v[78:79]
  v_cvt_pk_bf16_f32 v76, v72, v73
  v_cvt_pk_bf16_f32 v77, v74, v75
  ds_write_b64 v7, v[76:77] offset:0
  v_permlane32_swap_b32 v80, v84
  v_permlane32_swap_b32 v81, v85
  v_permlane32_swap_b32 v82, v86
  v_permlane32_swap_b32 v83, v87
  v_pk_add_f32 v[80:81], v[80:81], v[84:85]
  v_pk_add_f32 v[82:83], v[82:83], v[86:87]
  v_cvt_pk_bf16_f32 v84, v80, v81
  v_cvt_pk_bf16_f32 v85, v82, v83
  ds_write_b64 v7, v[84:85] offset:2560
  v_smfmac_f32_16x16x64_bf16 v[88:91], v[96:99], v[128:135], v16
  v_smfmac_f32_16x16x64_bf16 v[88:91], v[100:103], v[136:143], v16
  v_smfmac_f32_16x16x64_bf16 v[88:91], v[104:107], v[144:151], v16
  v_smfmac_f32_16x16x64_bf16 v[88:91], v[108:111], v[152:159], v16
  v_smfmac_f32_16x16x64_bf16 v[88:91], v[112:115], v[160:167], v16
  v_smfmac_f32_16x16x64_bf16 v[88:91], v[116:119], v[168:175], v16
  v_smfmac_f32_16x16x64_bf16 v[88:91], v[120:123], v[176:183], v16
  v_smfmac_f32_16x16x64_bf16 v[88:91], v[124:127], v[184:191], v16
  s_waitcnt lgkmcnt(0)
  s_barrier
  v_smfmac_f32_16x16x64_bf16 v[92:95], v[112:115], v[224:231], v16
  ds_read_b64_tr_b16 v[72:73], v8 offset:0
  ds_read_b64_tr_b16 v[74:75], v8 offset:16
  v_smfmac_f32_16x16x64_bf16 v[92:95], v[116:119], v[232:239], v16
  ds_read_b64_tr_b16 v[76:77], v8 offset:128
  ds_read_b64_tr_b16 v[78:79], v8 offset:144
  v_smfmac_f32_16x16x64_bf16 v[92:95], v[120:123], v[240:247], v16
  ds_read_b64_tr_b16 v[80:81], v8 offset:256
  ds_read_b64_tr_b16 v[82:83], v8 offset:272
  v_smfmac_f32_16x16x64_bf16 v[92:95], v[124:127], v[248:255], v16
  ds_read_b64_tr_b16 v[84:85], v8 offset:384
  ds_read_b64_tr_b16 v[86:87], v8 offset:400
  v_smfmac_f32_16x16x64_bf16 v[92:95], v[96:99], v[192:199], v16
  ds_read_b64_tr_b16 v[112:113], v8 offset:2560
  ds_read_b64_tr_b16 v[114:115], v8 offset:2576
  v_smfmac_f32_16x16x64_bf16 v[92:95], v[100:103], v[200:207], v16
  ds_read_b64_tr_b16 v[116:117], v8 offset:2688
  ds_read_b64_tr_b16 v[118:119], v8 offset:2704
  v_smfmac_f32_16x16x64_bf16 v[92:95], v[104:107], v[208:215], v16
  ds_read_b64_tr_b16 v[120:121], v8 offset:2816
  ds_read_b64_tr_b16 v[122:123], v8 offset:2832
  v_smfmac_f32_16x16x64_bf16 v[92:95], v[108:111], v[216:223], v16
  ds_read_b64_tr_b16 v[124:125], v8 offset:2944
  ds_read_b64_tr_b16 v[126:127], v8 offset:2960
  ds_read_b64_tr_b16 v[64:65], v21 offset:0
  ds_read_b64_tr_b16 v[66:67], v21 offset:16
  s_waitcnt lgkmcnt(10)
  v_mfma_f32_16x16x32_bf16 v[96:99], v[24:27], v[72:75], 0
  buffer_load_dwordx4 v4, s[44:47], s81 offen offset:0 lds
  v_mfma_f32_16x16x32_bf16 v[100:103], v[40:43], v[72:75], 0
  buffer_load_dwordx4 v4, s[44:47], s81 offen offset:1024 lds
  v_mfma_f32_16x16x32_bf16 v[96:99], v[28:31], v[76:79], v[96:99]
  v_mfma_f32_16x16x32_bf16 v[100:103], v[44:47], v[76:79], v[100:103]
  v_permlane32_swap_b32 v88, v92
  v_permlane32_swap_b32 v89, v93
  v_mfma_f32_16x16x32_bf16 v[96:99], v[32:35], v[80:83], v[96:99]
  v_permlane32_swap_b32 v90, v94
  v_permlane32_swap_b32 v91, v95
  v_mfma_f32_16x16x32_bf16 v[100:103], v[48:51], v[80:83], v[100:103]
  v_pk_add_f32 v[88:89], v[88:89], v[92:93]
  v_pk_add_f32 v[90:91], v[90:91], v[94:95]
  v_mfma_f32_16x16x32_bf16 v[96:99], v[36:39], v[84:87], v[96:99]
  v_cvt_pk_bf16_f32 v22, v88, v89
  v_cvt_pk_bf16_f32 v23, v90, v91
  v_mfma_f32_16x16x32_bf16 v[100:103], v[52:55], v[84:87], v[100:103]
  s_waitcnt lgkmcnt(0)
  v_mfma_f32_16x16x32_bf16 v[104:107], v[112:115], v[72:75], 0
  ds_read_b128 v[24:27], v11 offset:0
  ds_read_b128 v[28:31], v11 offset:1024
  v_mfma_f32_16x16x32_bf16 v[104:107], v[116:119], v[76:79], v[104:107]
  ds_read_b128 v[32:35], v11 offset:2048
  ds_read_b128 v[36:39], v11 offset:3072
  v_mfma_f32_16x16x32_bf16 v[104:107], v[120:123], v[80:83], v[104:107]
  ds_read_b128 v[40:43], v11 offset:4096
  ds_read_b128 v[44:47], v11 offset:5120
  v_mfma_f32_16x16x32_bf16 v[104:107], v[124:127], v[84:87], v[104:107]
  ds_read_b128 v[48:51], v11 offset:6144
  ds_read_b128 v[52:55], v11 offset:7168
  ds_read_b128 v[72:75], v11 offset:8192
  ds_read_b128 v[76:79], v11 offset:9216
  ds_read_b128 v[80:83], v11 offset:10240
  ds_read_b128 v[84:87], v11 offset:11264
  ds_read_b128 v[112:115], v11 offset:12288
  ds_read_b128 v[116:119], v11 offset:13312
  ds_read_b128 v[120:123], v11 offset:14336
  ds_read_b128 v[124:127], v11 offset:15360
  v_max3_f32 v108, v96, v97, v98
  v_max3_f32 v108, v108, v99, v100
  v_max3_f32 v108, v108, v101, v102
  v_max3_f32 v108, v108, v103, v104
  v_max3_f32 v108, v108, v105, v106
  v_max_f32 v108, v108, v107
  v_mov_b32 v109, v108
  buffer_load_dwordx4 v4, s[44:47], s81 offen offset:2048 lds
  s_nop 0
  v_permlane16_swap_b32 v108, v109
  v_max_f32 v108, v108, v109
  v_mov_b32 v109, v108
  s_nop 1
  v_permlane32_swap_b32 v108, v109
  v_max_f32 v108, v108, v109
  v_mul_f32 v108, 0xbe0293ee, v108
  buffer_load_dwordx4 v4, s[44:47], s81 offen offset:3072 lds
  v_pk_fma_f32 v[96:97], v[96:97], s[74:75], v[108:109] op_sel:[0,1,0] op_sel_hi:[1,1,0]
  v_pk_fma_f32 v[98:99], v[98:99], s[74:75], v[108:109] op_sel:[0,1,0] op_sel_hi:[1,1,0]
  v_pk_fma_f32 v[100:101], v[100:101], s[74:75], v[108:109] op_sel:[0,1,0] op_sel_hi:[1,1,0]
  v_pk_fma_f32 v[102:103], v[102:103], s[74:75], v[108:109] op_sel:[0,1,0] op_sel_hi:[1,1,0]
  v_pk_fma_f32 v[104:105], v[104:105], s[74:75], v[108:109] op_sel:[0,1,0] op_sel_hi:[1,1,0]
  v_pk_fma_f32 v[106:107], v[106:107], s[74:75], v[108:109] op_sel:[0,1,0] op_sel_hi:[1,1,0]
  v_exp_f32 v96, v96
  v_exp_f32 v97, v97
  buffer_store_dwordx4 v[64:67], v4, s[44:47], s84 offen sc1
  v_exp_f32 v98, v98
  v_exp_f32 v99, v99
  v_exp_f32 v100, v100
  v_exp_f32 v101, v101
  s_add_u32 s84, s84, 4096
  buffer_store_dwordx2 v[22:23], v19, s[44:47], s84 offen sc1
  v_exp_f32 v102, v102
  v_exp_f32 v103, v103
  v_exp_f32 v104, v104
  v_exp_f32 v105, v105
  v_exp_f32 v106, v106
  v_exp_f32 v107, v107
  v_cvt_pk_bf16_f32 v88, v96, v97
  v_cvt_pk_bf16_f32 v89, v98, v99
  v_cvt_pk_bf16_f32 v90, v100, v101
  v_cvt_pk_bf16_f32 v91, v102, v103
  v_cvt_pk_bf16_f32 v108, v104, v105
  v_cvt_pk_bf16_f32 v109, v106, v107
  v_cndmask_b32 v92, 0, v108, s[76:77]
  v_cndmask_b32 v94, v108, 0, s[76:77]
  v_cndmask_b32 v93, 0, v109, s[76:77]
  v_cndmask_b32 v95, v109, 0, s[76:77]
  v_mfma_f32_16x16x32_bf16 v[104:107], v[0:3], v[88:91], 0
  v_mfma_f32_16x16x32_bf16 v[96:99], v[56:59], v[88:91], 0
  v_mfma_f32_16x16x32_bf16 v[100:103], v[60:63], v[88:91], 0
  v_mov_b32 v110, 0
  v_mov_b32 v111, 0
  v_mov_b32 v109, 0
  v_mov_b32 v64, 0
  v_mfma_f32_16x16x16_bf16 v[104:107], v[0:1], v[92:93], v[104:107]
  v_mov_b32 v56, 0
  v_mov_b32 v57, 0
  v_mfma_f32_16x16x16_bf16 v[96:99], v[22:23], v[92:93], v[96:99]
  v_mov_b32 v58, 0
  v_mov_b32 v59, 0
  v_mfma_f32_16x16x16_bf16 v[100:103], v[22:23], v[94:95], v[100:103]
  v_mov_b32 v60, 0
  v_mov_b32 v61, 0
  v_mov_b32 v62, 0
  v_mov_b32 v63, 0
  v_rcp_f32 v108, v104
  v_mov_b32 v65, 0
  v_mov_b32 v66, 0
  v_mov_b32 v67, 0
  v_pk_mul_f32 v[96:97], v[96:97], v[108:109] op_sel_hi:[1,0]
  v_pk_mul_f32 v[98:99], v[98:99], v[108:109] op_sel_hi:[1,0]
  v_pk_mul_f32 v[100:101], v[100:101], v[108:109] op_sel_hi:[1,0]
  v_pk_mul_f32 v[102:103], v[102:103], v[108:109] op_sel_hi:[1,0]
  v_cvt_pk_bf16_f32 v68, v96, v100
  v_cvt_pk_bf16_f32 v69, v97, v101
  v_cvt_pk_bf16_f32 v70, v98, v102
  v_cvt_pk_bf16_f32 v71, v99, v103
  ds_write_b128 v9, v[68:71]
  v_mov_b32 v96, 0
  v_mov_b32 v97, 0
  v_mov_b32 v98, 0
  v_mov_b32 v99, 0
  v_mov_b32 v100, 0
  v_mov_b32 v101, 0
  v_mov_b32 v102, 0
  v_mov_b32 v103, 0
  v_mov_b32 v104, 0
  v_mov_b32 v105, 0
  v_mov_b32 v106, 0
  v_mov_b32 v107, 0
  v_mov_b32 v108, 0
  s_waitcnt lgkmcnt(0)
  s_barrier
  ds_read_b128 v[88:91], v10
  ds_read_b128 v[92:95], v10 offset:128
  v_mov_b32 v68, 0
  v_mov_b32 v69, 0
  v_mov_b32 v70, 0
  v_mov_b32 v71, 0
  s_waitcnt lgkmcnt(0)
  v_smfmac_f32_16x16x64_bf16 v[96:99], v[88:91], v[24:31], v16
  v_smfmac_f32_16x16x64_bf16 v[96:99], v[92:95], v[32:39], v16
  ds_read_b128 v[24:27], v11 offset:16384
  ds_read_b128 v[28:31], v11 offset:17408
  v_smfmac_f32_16x16x64_bf16 v[100:103], v[88:91], v[40:47], v16
  ds_read_b128 v[32:35], v11 offset:18432
  ds_read_b128 v[36:39], v11 offset:19456
  v_smfmac_f32_16x16x64_bf16 v[100:103], v[92:95], v[48:55], v16
  ds_read_b128 v[40:43], v11 offset:20480
  ds_read_b128 v[44:47], v11 offset:21504
  v_smfmac_f32_16x16x64_bf16 v[104:107], v[88:91], v[72:79], v16
  ds_read_b128 v[48:51], v11 offset:22528
  ds_read_b128 v[52:55], v11 offset:23552
  v_smfmac_f32_16x16x64_bf16 v[104:107], v[92:95], v[80:87], v16
  ds_read_b128 v[72:75], v11 offset:24576
  ds_read_b128 v[76:79], v11 offset:25600
  v_smfmac_f32_16x16x64_bf16 v[108:111], v[88:91], v[112:119], v16
  ds_read_b128 v[80:83], v11 offset:26624
  ds_read_b128 v[84:87], v11 offset:27648
  v_smfmac_f32_16x16x64_bf16 v[108:111], v[92:95], v[120:127], v16
  ds_read_b128 v[112:115], v11 offset:28672
  ds_read_b128 v[116:119], v11 offset:29696
  ds_read_b128 v[120:123], v11 offset:30720
  ds_read_b128 v[124:127], v11 offset:31744
  v_permlane32_swap_b32 v96, v100
  v_permlane32_swap_b32 v97, v101
  v_permlane32_swap_b32 v98, v102
  v_permlane32_swap_b32 v99, v103
  v_permlane32_swap_b32 v104, v108
  v_permlane32_swap_b32 v105, v109
  v_permlane32_swap_b32 v106, v110
  v_permlane32_swap_b32 v107, v111
  v_pk_add_f32 v[96:97], v[96:97], v[100:101]
  v_pk_add_f32 v[98:99], v[98:99], v[102:103]
  v_pk_add_f32 v[104:105], v[104:105], v[108:109]
  v_pk_add_f32 v[106:107], v[106:107], v[110:111]
  v_cvt_pk_bf16_f32 v100, v96, v97
  v_cvt_pk_bf16_f32 v101, v98, v99
  v_cvt_pk_bf16_f32 v102, v104, v105
  v_cvt_pk_bf16_f32 v103, v106, v107
  v_bfi_b32 v100, 1, s90, v100
  buffer_store_dwordx4 v[100:103], v12, s[44:47], s86 offen
  s_waitcnt lgkmcnt(0)
  v_smfmac_f32_16x16x64_bf16 v[56:59], v[88:91], v[24:31], v16
  v_smfmac_f32_16x16x64_bf16 v[56:59], v[92:95], v[32:39], v16
  v_smfmac_f32_16x16x64_bf16 v[60:63], v[88:91], v[40:47], v16
  v_smfmac_f32_16x16x64_bf16 v[60:63], v[92:95], v[48:55], v16
  v_smfmac_f32_16x16x64_bf16 v[64:67], v[88:91], v[72:79], v16
  v_smfmac_f32_16x16x64_bf16 v[64:67], v[92:95], v[80:87], v16
  v_smfmac_f32_16x16x64_bf16 v[68:71], v[88:91], v[112:119], v16
  v_smfmac_f32_16x16x64_bf16 v[68:71], v[92:95], v[120:127], v16
  v_lshlrev_b64 v[116:117], v4, s[94:95]
  v_mov_b32 v110, -1
  v_mov_b32 v111, -1
  s_nop 0
  v_permlane32_swap_b32 v56, v60
  v_permlane32_swap_b32 v57, v61
  v_permlane32_swap_b32 v58, v62
  v_permlane32_swap_b32 v59, v63
  v_permlane32_swap_b32 v64, v68
  v_permlane32_swap_b32 v65, v69
  v_permlane32_swap_b32 v66, v70
  v_permlane32_swap_b32 v67, v71
  v_pk_add_f32 v[56:57], v[56:57], v[60:61]
  v_pk_add_f32 v[58:59], v[58:59], v[62:63]
  v_pk_add_f32 v[64:65], v[64:65], v[68:69]
  v_pk_add_f32 v[66:67], v[66:67], v[70:71]
  v_cvt_pk_bf16_f32 v60, v56, v57
  v_cvt_pk_bf16_f32 v61, v58, v59
  v_cvt_pk_bf16_f32 v62, v64, v65
  v_cvt_pk_bf16_f32 v63, v66, v67
  v_bfi_b32 v60, 1, s90, v60
  buffer_store_dwordx4 v[60:63], v12, s[44:47], s87 offen
  v_mov_b32 v72, 0
  v_mov_b32 v73, 0
  v_mov_b32 v74, 0
  v_mov_b32 v75, 0
  v_mov_b32 v76, 0
  v_mov_b32 v77, 0
  v_mov_b32 v78, 0
  v_mov_b32 v79, 0
  v_mov_b32 v80, 0
  v_mov_b32 v81, 0
  v_mov_b32 v82, 0
  v_mov_b32 v83, 0
  v_mov_b32 v84, 0
  v_mov_b32 v85, 0
  v_mov_b32 v86, 0
  v_mov_b32 v87, 0
  v_mov_b32 v88, 0
  v_mov_b32 v89, 0
  v_mov_b32 v90, 0
  v_mov_b32 v91, 0
  v_mov_b32 v92, 0
  v_mov_b32 v93, 0
  v_mov_b32 v94, 0
  v_mov_b32 v95, 0
  v_cndmask_b32 v112, 0, v116, s[2:3]
  v_cndmask_b32 v113, 0, v117, s[2:3]
  v_cndmask_b32 v114, v116, 0, s[2:3]
  v_cndmask_b32 v115, v117, 0, s[2:3]
  s_waitcnt vmcnt(0)
  s_nop 0
r0_rp:
  buffer_load_dwordx4 v[96:99], v13, s[44:47], s86 offen sc1
  buffer_load_dwordx4 v[100:103], v13, s[44:47], s88 offen sc1
  s_waitcnt vmcnt(0)
  v_mfma_f32_16x16x32_bf16 v[104:107], v[96:99], v[112:115], 0
  v_bitop3_b32 v108, v96, v100, s90 bitop3:0x7e
  v_and_b32 v108, 1, v108
  v_mfma_f32_16x16x32_bf16 v[104:107], v[100:103], v[112:115], v[104:107]
  v_cmp_ne_u32 vcc, 0, v108
  s_nop 0
  s_cbranch_vccnz r0_spin1
  s_nop 4
  v_permlane32_swap_b32 v104, v105
  v_permlane32_swap_b32 v106, v107
  v_add_f32 v104, v104, v105
  v_add_f32 v106, v106, v107
  s_nop 1
  v_permlane16_swap_b32 v104, v106
  v_add_f32 v104, v104, v106
  v_mov_b32 v105, v104
  s_nop 1
  v_permlane32_swap_b32 v104, v105
  v_cvt_pk_bf16_f32 v104, v104, v105
  v_min_u32 v104, -2, v104
  v_mov_b32 v105, v104
  s_nop 1
  v_permlane16_swap_b32 v104, v105
  s_mov_b64 exec, 0xff
  buffer_store_dwordx2 v[104:105], v14, s[44:47], s73 offen
  buffer_store_dwordx2 v[110:111], v14, s[44:47], s74 offen
  s_mov_b64 exec, -1
  s_add_u32 s67, s67, 1
  s_cmp_lt_u32 s67, 64
  s_waitcnt vmcnt(0)
  s_cbranch_scc1 r0_top
  s_branch r_end
r0_spin0:
  s_sub_u32 s69, s69, 1
  s_cbranch_scc0 r0_top
  s_branch mega_exit
r0_spin1:
  s_sub_u32 s69, s69, 1
  s_cbranch_scc0 r0_rp
  s_branch mega_exit
r0_kvw:
pf_10:
  buffer_load_dword v20, v17, s[44:47], s80 offen sc1
  s_waitcnt vmcnt(0)
  v_cmp_gt_u32 vcc, s85, v20
  s_nop 0
  s_cbranch_vccz pd_11
  s_nop 2
pr_12:
  s_sub_u32 s69, s69, 1
  s_cbranch_scc0 pf_10
  s_branch mega_exit
pd_11:
  s_branch r0_kvok
r1_top:
  buffer_load_dwordx4 v[96:99], v4, s[44:47], s72 offen offset:0 sc1
  buffer_load_dwordx4 v[100:103], v4, s[44:47], s72 offen offset:1024 sc1
  s_waitcnt vmcnt(0)
  v_max3_u32 v104, v96, v98, v100
  v_max_u32 v104, v104, v102
  v_cmp_eq_u32 vcc, -1, v104
  s_nop 0
  s_cbranch_vccnz r1_spin0
  ds_write_b128 v5, v[96:99]
  ds_write_b128 v5, v[100:103] offset:1088
  s_waitcnt lgkmcnt(0)
  s_barrier
  ds_read_b128 v[96:99], v6 offset:0
  ds_read_b128 v[100:103], v6 offset:128
  ds_read_b128 v[104:107], v6 offset:256
  ds_read_b128 v[108:111], v6 offset:384
  ds_read_b128 v[112:115], v6 offset:512
  ds_read_b128 v[116:119], v6 offset:640
  ds_read_b128 v[120:123], v6 offset:768
  ds_read_b128 v[124:127], v6 offset:896
  v_mov_b32 v68, s67
  s_mov_b64 exec, 1
  buffer_store_dword v68, off, s[44:47], s79 sc1
  s_mov_b64 exec, -1
  s_add_u32 s85, s67, 2
  s_min_u32 s85, s85, 64
  v_cmp_gt_u32 vcc, s85, v20
  v_add_u32 v69, s78, v15
  s_lshl_b32 s84, s67, 18
  s_add_u32 s84, s84, s93
  s_cbranch_vccnz r1_kvw
r1_kvok:
  buffer_load_dword v20, v17, s[44:47], s80 offen sc1
  s_waitcnt lgkmcnt(7)
  v_smfmac_f32_16x16x64_bf16 v[72:75], v[96:99], a[0:7], v16
  s_waitcnt lgkmcnt(6)
  v_smfmac_f32_16x16x64_bf16 v[72:75], v[100:103], a[8:15], v16
  s_waitcnt lgkmcnt(5)
  v_smfmac_f32_16x16x64_bf16 v[72:75], v[104:107], a[16:23], v16
  s_waitcnt lgkmcnt(4)
  v_smfmac_f32_16x16x64_bf16 v[72:75], v[108:111], a[24:31], v16
  s_waitcnt lgkmcnt(3)
  v_smfmac_f32_16x16x64_bf16 v[72:75], v[112:115], a[32:39], v16
  s_waitcnt lgkmcnt(2)
  v_smfmac_f32_16x16x64_bf16 v[72:75], v[116:119], a[40:47], v16
  s_waitcnt lgkmcnt(1)
  v_smfmac_f32_16x16x64_bf16 v[72:75], v[120:123], a[48:55], v16
  s_waitcnt lgkmcnt(0)
  v_smfmac_f32_16x16x64_bf16 v[72:75], v[124:127], a[56:63], v16
  v_smfmac_f32_16x16x64_bf16 v[76:79], v[96:99], a[64:71], v16
  ds_read_b128 v[24:27], v15 offset:0
  s_sub_u32 s85, s85, 1
  v_smfmac_f32_16x16x64_bf16 v[76:79], v[100:103], a[72:79], v16
  ds_read_b128 v[40:43], v15 offset:256
  s_lshl_b32 s81, s85, 20
  v_smfmac_f32_16x16x64_bf16 v[76:79], v[104:107], a[80:87], v16
  ds_read_b128 v[28:31], v15 offset:2048
  s_add_u32 s81, s81, s91
  v_smfmac_f32_16x16x64_bf16 v[76:79], v[108:111], a[88:95], v16
  ds_read_b128 v[44:47], v15 offset:2304
  s_and_b32 s86, s67, 1
  v_smfmac_f32_16x16x64_bf16 v[76:79], v[112:115], a[96:103], v16
  ds_read_b128 v[32:35], v15 offset:4096
  s_lshl_b32 s86, s86, 19
  v_smfmac_f32_16x16x64_bf16 v[76:79], v[116:119], a[104:111], v16
  ds_read_b128 v[48:51], v15 offset:4352
  s_add_u32 s86, s86, 14811136
  v_smfmac_f32_16x16x64_bf16 v[76:79], v[120:123], a[112:119], v16
  ds_read_b128 v[36:39], v15 offset:6144
  s_add_u32 s87, s86, 32768
  v_smfmac_f32_16x16x64_bf16 v[76:79], v[124:127], a[120:127], v16
  ds_read_b128 v[52:55], v15 offset:6400
  s_add_u32 s88, s86, 4096
  v_smfmac_f32_16x16x64_bf16 v[80:83], v[96:99], a[128:135], v16
  ds_read_b128 v[56:59], v69 offset:0
  s_bfe_u32 s90, s67, 0x10001
  v_smfmac_f32_16x16x64_bf16 v[80:83], v[100:103], a[136:143], v16
  ds_read_b128 v[60:63], v69 offset:2048
  s_xor_b32 s90, s90, 1
  v_smfmac_f32_16x16x64_bf16 v[80:83], v[104:107], a[144:151], v16
  s_add_u32 s73, s67, 1
  v_smfmac_f32_16x16x64_bf16 v[80:83], v[108:111], a[152:159], v16
  s_and_b32 s73, s73, 3
  v_smfmac_f32_16x16x64_bf16 v[80:83], v[112:115], a[160:167], v16
  s_lshl_b32 s73, s73, 13
  v_smfmac_f32_16x16x64_bf16 v[80:83], v[116:119], a[168:175], v16
  s_add_u32 s72, s73, s92
  v_smfmac_f32_16x16x64_bf16 v[80:83], v[120:123], a[176:183], v16
  s_xor_b32 s74, s73, 16384
  v_smfmac_f32_16x16x64_bf16 v[80:83], v[124:127], a[184:191], v16
  v_smfmac_f32_16x16x64_bf16 v[84:87], v[96:99], a[192:199], v16
  v_smfmac_f32_16x16x64_bf16 v[84:87], v[100:103], a[200:207], v16
  v_smfmac_f32_16x16x64_bf16 v[84:87], v[104:107], a[208:215], v16
  v_smfmac_f32_16x16x64_bf16 v[84:87], v[108:111], a[216:223], v16
  v_smfmac_f32_16x16x64_bf16 v[84:87], v[112:115], a[224:231], v16
  v_smfmac_f32_16x16x64_bf16 v[84:87], v[116:119], a[232:239], v16
  v_smfmac_f32_16x16x64_bf16 v[84:87], v[120:123], a[240:247], v16
  v_smfmac_f32_16x16x64_bf16 v[84:87], v[124:127], a[248:255], v16
  v_permlane32_swap_b32 v72, v76
  v_permlane32_swap_b32 v73, v77
  v_permlane32_swap_b32 v74, v78
  v_permlane32_swap_b32 v75, v79
  v_pk_add_f32 v[72:73], v[72:73], v[76:77]
  v_pk_add_f32 v[74:75], v[74:75], v[78:79]
  v_cvt_pk_bf16_f32 v76, v72, v73
  v_cvt_pk_bf16_f32 v77, v74, v75
  ds_write_b64 v7, v[76:77] offset:0
  v_permlane32_swap_b32 v80, v84
  v_permlane32_swap_b32 v81, v85
  v_permlane32_swap_b32 v82, v86
  v_permlane32_swap_b32 v83, v87
  v_pk_add_f32 v[80:81], v[80:81], v[84:85]
  v_pk_add_f32 v[82:83], v[82:83], v[86:87]
  v_cvt_pk_bf16_f32 v84, v80, v81
  v_cvt_pk_bf16_f32 v85, v82, v83
  ds_write_b64 v7, v[84:85] offset:2560
  v_smfmac_f32_16x16x64_bf16 v[88:91], v[96:99], v[128:135], v16
  v_smfmac_f32_16x16x64_bf16 v[88:91], v[100:103], v[136:143], v16
  v_smfmac_f32_16x16x64_bf16 v[88:91], v[104:107], v[144:151], v16
  v_smfmac_f32_16x16x64_bf16 v[88:91], v[108:111], v[152:159], v16
  v_smfmac_f32_16x16x64_bf16 v[88:91], v[112:115], v[160:167], v16
  v_smfmac_f32_16x16x64_bf16 v[88:91], v[116:119], v[168:175], v16
  v_smfmac_f32_16x16x64_bf16 v[88:91], v[120:123], v[176:183], v16
  v_smfmac_f32_16x16x64_bf16 v[88:91], v[124:127], v[184:191], v16
  s_waitcnt lgkmcnt(0)
  s_barrier
  v_smfmac_f32_16x16x64_bf16 v[92:95], v[112:115], v[224:231], v16
  ds_read_b64_tr_b16 v[72:73], v8 offset:0
  ds_read_b64_tr_b16 v[74:75], v8 offset:16
  v_smfmac_f32_16x16x64_bf16 v[92:95], v[116:119], v[232:239], v16
  ds_read_b64_tr_b16 v[76:77], v8 offset:128
  ds_read_b64_tr_b16 v[78:79], v8 offset:144
  v_smfmac_f32_16x16x64_bf16 v[92:95], v[120:123], v[240:247], v16
  ds_read_b64_tr_b16 v[80:81], v8 offset:256
  ds_read_b64_tr_b16 v[82:83], v8 offset:272
  v_smfmac_f32_16x16x64_bf16 v[92:95], v[124:127], v[248:255], v16
  ds_read_b64_tr_b16 v[84:85], v8 offset:384
  ds_read_b64_tr_b16 v[86:87], v8 offset:400
  v_smfmac_f32_16x16x64_bf16 v[92:95], v[96:99], v[192:199], v16
  ds_read_b64_tr_b16 v[112:113], v8 offset:2560
  ds_read_b64_tr_b16 v[114:115], v8 offset:2576
  v_smfmac_f32_16x16x64_bf16 v[92:95], v[100:103], v[200:207], v16
  ds_read_b64_tr_b16 v[116:117], v8 offset:2688
  ds_read_b64_tr_b16 v[118:119], v8 offset:2704
  v_smfmac_f32_16x16x64_bf16 v[92:95], v[104:107], v[208:215], v16
  ds_read_b64_tr_b16 v[120:121], v8 offset:2816
  ds_read_b64_tr_b16 v[122:123], v8 offset:2832
  v_smfmac_f32_16x16x64_bf16 v[92:95], v[108:111], v[216:223], v16
  ds_read_b64_tr_b16 v[124:125], v8 offset:2944
  ds_read_b64_tr_b16 v[126:127], v8 offset:2960
  ds_read_b64_tr_b16 v[64:65], v21 offset:0
  ds_read_b64_tr_b16 v[66:67], v21 offset:16
  s_waitcnt lgkmcnt(10)
  v_mfma_f32_16x16x32_bf16 v[96:99], v[24:27], v[72:75], 0
  buffer_load_dwordx4 v4, s[44:47], s81 offen offset:0 lds
  v_mfma_f32_16x16x32_bf16 v[100:103], v[40:43], v[72:75], 0
  buffer_load_dwordx4 v4, s[44:47], s81 offen offset:1024 lds
  v_mfma_f32_16x16x32_bf16 v[96:99], v[28:31], v[76:79], v[96:99]
  v_mfma_f32_16x16x32_bf16 v[100:103], v[44:47], v[76:79], v[100:103]
  v_permlane32_swap_b32 v88, v92
  v_permlane32_swap_b32 v89, v93
  v_mfma_f32_16x16x32_bf16 v[96:99], v[32:35], v[80:83], v[96:99]
  v_permlane32_swap_b32 v90, v94
  v_permlane32_swap_b32 v91, v95
  v_mfma_f32_16x16x32_bf16 v[100:103], v[48:51], v[80:83], v[100:103]
  v_pk_add_f32 v[88:89], v[88:89], v[92:93]
  v_pk_add_f32 v[90:91], v[90:91], v[94:95]
  v_mfma_f32_16x16x32_bf16 v[96:99], v[36:39], v[84:87], v[96:99]
  v_cvt_pk_bf16_f32 v22, v88, v89
  v_cvt_pk_bf16_f32 v23, v90, v91
  v_mfma_f32_16x16x32_bf16 v[100:103], v[52:55], v[84:87], v[100:103]
  s_waitcnt lgkmcnt(0)
  v_mfma_f32_16x16x32_bf16 v[104:107], v[112:115], v[72:75], 0
  ds_read_b128 v[24:27], v11 offset:0
  ds_read_b128 v[28:31], v11 offset:1024
  v_mfma_f32_16x16x32_bf16 v[104:107], v[116:119], v[76:79], v[104:107]
  ds_read_b128 v[32:35], v11 offset:2048
  ds_read_b128 v[36:39], v11 offset:3072
  v_mfma_f32_16x16x32_bf16 v[104:107], v[120:123], v[80:83], v[104:107]
  ds_read_b128 v[40:43], v11 offset:4096
  ds_read_b128 v[44:47], v11 offset:5120
  v_mfma_f32_16x16x32_bf16 v[104:107], v[124:127], v[84:87], v[104:107]
  ds_read_b128 v[48:51], v11 offset:6144
  ds_read_b128 v[52:55], v11 offset:7168
  ds_read_b128 v[72:75], v11 offset:8192
  ds_read_b128 v[76:79], v11 offset:9216
  ds_read_b128 v[80:83], v11 offset:10240
  ds_read_b128 v[84:87], v11 offset:11264
  ds_read_b128 v[112:115], v11 offset:12288
  ds_read_b128 v[116:119], v11 offset:13312
  ds_read_b128 v[120:123], v11 offset:14336
  ds_read_b128 v[124:127], v11 offset:15360
  v_max3_f32 v108, v96, v97, v98
  v_max3_f32 v108, v108, v99, v100
  v_max3_f32 v108, v108, v101, v102
  v_max3_f32 v108, v108, v103, v104
  v_max3_f32 v108, v108, v105, v106
  v_max_f32 v108, v108, v107
  v_mov_b32 v109, v108
  buffer_load_dwordx4 v4, s[44:47], s81 offen offset:2048 lds
  s_nop 0
  v_permlane16_swap_b32 v108, v109
  v_max_f32 v108, v108, v109
  v_mov_b32 v109, v108
  s_nop 1
  v_permlane32_swap_b32 v108, v109
  v_max_f32 v108, v108, v109
  v_mul_f32 v108, 0xbe0293ee, v108
  buffer_load_dwordx4 v4, s[44:47], s81 offen offset:3072 lds
  v_pk_fma_f32 v[96:97], v[96:97], s[74:75], v[108:109] op_sel:[0,1,0] op_sel_hi:[1,1,0]
  v_pk_fma_f32 v[98:99], v[98:99], s[74:75], v[108:109] op_sel:[0,1,0] op_sel_hi:[1,1,0]
  v_pk_fma_f32 v[100:101], v[100:101], s[74:75], v[108:109] op_sel:[0,1,0] op_sel_hi:[1,1,0]
  v_pk_fma_f32 v[102:103], v[102:103], s[74:75], v[108:109] op_sel:[0,1,0] op_sel_hi:[1,1,0]
  v_pk_fma_f32 v[104:105], v[104:105], s[74:75], v[108:109] op_sel:[0,1,0] op_sel_hi:[1,1,0]
  v_pk_fma_f32 v[106:107], v[106:107], s[74:75], v[108:109] op_sel:[0,1,0] op_sel_hi:[1,1,0]
  v_exp_f32 v96, v96
  v_exp_f32 v97, v97
  buffer_store_dwordx4 v[64:67], v4, s[44:47], s84 offen sc1
  v_exp_f32 v98, v98
  v_exp_f32 v99, v99
  v_exp_f32 v100, v100
  v_exp_f32 v101, v101
  s_add_u32 s84, s84, 4096
  buffer_store_dwordx2 v[22:23], v19, s[44:47], s84 offen sc1
  v_exp_f32 v102, v102
  v_exp_f32 v103, v103
  v_exp_f32 v104, v104
  v_exp_f32 v105, v105
  v_exp_f32 v106, v106
  v_exp_f32 v107, v107
  v_cvt_pk_bf16_f32 v88, v96, v97
  v_cvt_pk_bf16_f32 v89, v98, v99
  v_cvt_pk_bf16_f32 v90, v100, v101
  v_cvt_pk_bf16_f32 v91, v102, v103
  v_cvt_pk_bf16_f32 v108, v104, v105
  v_cvt_pk_bf16_f32 v109, v106, v107
  v_cndmask_b32 v92, 0, v108, s[76:77]
  v_cndmask_b32 v94, v108, 0, s[76:77]
  v_cndmask_b32 v93, 0, v109, s[76:77]
  v_cndmask_b32 v95, v109, 0, s[76:77]
  v_mfma_f32_16x16x32_bf16 v[104:107], v[0:3], v[88:91], 0
  v_mfma_f32_16x16x32_bf16 v[96:99], v[56:59], v[88:91], 0
  v_mfma_f32_16x16x32_bf16 v[100:103], v[60:63], v[88:91], 0
  v_mov_b32 v110, 0
  v_mov_b32 v111, 0
  v_mov_b32 v109, 0
  v_mov_b32 v64, 0
  v_mfma_f32_16x16x16_bf16 v[104:107], v[0:1], v[92:93], v[104:107]
  v_mov_b32 v56, 0
  v_mov_b32 v57, 0
  v_mfma_f32_16x16x16_bf16 v[96:99], v[22:23], v[92:93], v[96:99]
  v_mov_b32 v58, 0
  v_mov_b32 v59, 0
  v_mfma_f32_16x16x16_bf16 v[100:103], v[22:23], v[94:95], v[100:103]
  v_mov_b32 v60, 0
  v_mov_b32 v61, 0
  v_mov_b32 v62, 0
  v_mov_b32 v63, 0
  v_rcp_f32 v108, v104
  v_mov_b32 v65, 0
  v_mov_b32 v66, 0
  v_mov_b32 v67, 0
  v_pk_mul_f32 v[96:97], v[96:97], v[108:109] op_sel_hi:[1,0]
  v_pk_mul_f32 v[98:99], v[98:99], v[108:109] op_sel_hi:[1,0]
  v_pk_mul_f32 v[100:101], v[100:101], v[108:109] op_sel_hi:[1,0]
  v_pk_mul_f32 v[102:103], v[102:103], v[108:109] op_sel_hi:[1,0]
  v_cvt_pk_bf16_f32 v68, v96, v100
  v_cvt_pk_bf16_f32 v69, v97, v101
  v_cvt_pk_bf16_f32 v70, v98, v102
  v_cvt_pk_bf16_f32 v71, v99, v103
  ds_write_b128 v9, v[68:71]
  v_mov_b32 v96, 0
  v_mov_b32 v97, 0
  v_mov_b32 v98, 0
  v_mov_b32 v99, 0
  v_mov_b32 v100, 0
  v_mov_b32 v101, 0
  v_mov_b32 v102, 0
  v_mov_b32 v103, 0
  v_mov_b32 v104, 0
  v_mov_b32 v105, 0
  v_mov_b32 v106, 0
  v_mov_b32 v107, 0
  v_mov_b32 v108, 0
  s_waitcnt lgkmcnt(0)
  s_barrier
  ds_read_b128 v[88:91], v10
  ds_read_b128 v[92:95], v10 offset:128
  v_mov_b32 v68, 0
  v_mov_b32 v69, 0
  v_mov_b32 v70, 0
  v_mov_b32 v71, 0
  s_waitcnt lgkmcnt(0)
  v_smfmac_f32_16x16x64_bf16 v[96:99], v[88:91], v[24:31], v16
  v_smfmac_f32_16x16x64_bf16 v[96:99], v[92:95], v[32:39], v16
  ds_read_b128 v[24:27], v11 offset:16384
  ds_read_b128 v[28:31], v11 offset:17408
  v_smfmac_f32_16x16x64_bf16 v[100:103], v[88:91], v[40:47], v16
  ds_read_b128 v[32:35], v11 offset:18432
  ds_read_b128 v[36:39], v11 offset:19456
  v_smfmac_f32_16x16x64_bf16 v[100:103], v[92:95], v[48:55], v16
  ds_read_b128 v[40:43], v11 offset:20480
  ds_read_b128 v[44:47], v11 offset:21504
  v_smfmac_f32_16x16x64_bf16 v[104:107], v[88:91], v[72:79], v16
  ds_read_b128 v[48:51], v11 offset:22528
  ds_read_b128 v[52:55], v11 offset:23552
  v_smfmac_f32_16x16x64_bf16 v[104:107], v[92:95], v[80:87], v16
  ds_read_b128 v[72:75], v11 offset:24576
  ds_read_b128 v[76:79], v11 offset:25600
  v_smfmac_f32_16x16x64_bf16 v[108:111], v[88:91], v[112:119], v16
  ds_read_b128 v[80:83], v11 offset:26624
  ds_read_b128 v[84:87], v11 offset:27648
  v_smfmac_f32_16x16x64_bf16 v[108:111], v[92:95], v[120:127], v16
  ds_read_b128 v[112:115], v11 offset:28672
  ds_read_b128 v[116:119], v11 offset:29696
  ds_read_b128 v[120:123], v11 offset:30720
  ds_read_b128 v[124:127], v11 offset:31744
  v_permlane32_swap_b32 v96, v100
  v_permlane32_swap_b32 v97, v101
  v_permlane32_swap_b32 v98, v102
  v_permlane32_swap_b32 v99, v103
  v_permlane32_swap_b32 v104, v108
  v_permlane32_swap_b32 v105, v109
  v_permlane32_swap_b32 v106, v110
  v_permlane32_swap_b32 v107, v111
  v_pk_add_f32 v[96:97], v[96:97], v[100:101]
  v_pk_add_f32 v[98:99], v[98:99], v[102:103]
  v_pk_add_f32 v[104:105], v[104:105], v[108:109]
  v_pk_add_f32 v[106:107], v[106:107], v[110:111]
  v_cvt_pk_bf16_f32 v100, v96, v97
  v_cvt_pk_bf16_f32 v101, v98, v99
  v_cvt_pk_bf16_f32 v102, v104, v105
  v_cvt_pk_bf16_f32 v103, v106, v107
  v_bfi_b32 v100, 1, s90, v100
  buffer_store_dwordx4 v[100:103], v12, s[44:47], s86 offen sc1
  s_waitcnt lgkmcnt(0)
  v_smfmac_f32_16x16x64_bf16 v[56:59], v[88:91], v[24:31], v16
  v_smfmac_f32_16x16x64_bf16 v[56:59], v[92:95], v[32:39], v16
  v_smfmac_f32_16x16x64_bf16 v[60:63], v[88:91], v[40:47], v16
  v_smfmac_f32_16x16x64_bf16 v[60:63], v[92:95], v[48:55], v16
  v_smfmac_f32_16x16x64_bf16 v[64:67], v[88:91], v[72:79], v16
  v_smfmac_f32_16x16x64_bf16 v[64:67], v[92:95], v[80:87], v16
  v_smfmac_f32_16x16x64_bf16 v[68:71], v[88:91], v[112:119], v16
  v_smfmac_f32_16x16x64_bf16 v[68:71], v[92:95], v[120:127], v16
  v_lshlrev_b64 v[116:117], v4, s[94:95]
  v_mov_b32 v110, -1
  v_mov_b32 v111, -1
  s_nop 0
  v_permlane32_swap_b32 v56, v60
  v_permlane32_swap_b32 v57, v61
  v_permlane32_swap_b32 v58, v62
  v_permlane32_swap_b32 v59, v63
  v_permlane32_swap_b32 v64, v68
  v_permlane32_swap_b32 v65, v69
  v_permlane32_swap_b32 v66, v70
  v_permlane32_swap_b32 v67, v71
  v_pk_add_f32 v[56:57], v[56:57], v[60:61]
  v_pk_add_f32 v[58:59], v[58:59], v[62:63]
  v_pk_add_f32 v[64:65], v[64:65], v[68:69]
  v_pk_add_f32 v[66:67], v[66:67], v[70:71]
  v_cvt_pk_bf16_f32 v60, v56, v57
  v_cvt_pk_bf16_f32 v61, v58, v59
  v_cvt_pk_bf16_f32 v62, v64, v65
  v_cvt_pk_bf16_f32 v63, v66, v67
  v_bfi_b32 v60, 1, s90, v60
  buffer_store_dwordx4 v[60:63], v12, s[44:47], s87 offen sc1
  v_mov_b32 v72, 0
  v_mov_b32 v73, 0
  v_mov_b32 v74, 0
  v_mov_b32 v75, 0
  v_mov_b32 v76, 0
  v_mov_b32 v77, 0
  v_mov_b32 v78, 0
  v_mov_b32 v79, 0
  v_mov_b32 v80, 0
  v_mov_b32 v81, 0
  v_mov_b32 v82, 0
  v_mov_b32 v83, 0
  v_mov_b32 v84, 0
  v_mov_b32 v85, 0
  v_mov_b32 v86, 0
  v_mov_b32 v87, 0
  v_mov_b32 v88, 0
  v_mov_b32 v89, 0
  v_mov_b32 v90, 0
  v_mov_b32 v91, 0
  v_mov_b32 v92, 0
  v_mov_b32 v93, 0
  v_mov_b32 v94, 0
  v_mov_b32 v95, 0
  v_cndmask_b32 v112, 0, v116, s[2:3]
  v_cndmask_b32 v113, 0, v117, s[2:3]
  v_cndmask_b32 v114, v116, 0, s[2:3]
  v_cndmask_b32 v115, v117, 0, s[2:3]
  s_waitcnt vmcnt(0)
  s_nop 0
r1_rp:
  buffer_load_dwordx4 v[96:99], v13, s[44:47], s86 offen sc1
  buffer_load_dwordx4 v[100:103], v13, s[44:47], s88 offen sc1
  s_waitcnt vmcnt(0)
  v_mfma_f32_16x16x32_bf16 v[104:107], v[96:99], v[112:115], 0
  v_bitop3_b32 v108, v96, v100, s90 bitop3:0x7e
  v_and_b32 v108, 1, v108
  v_mfma_f32_16x16x32_bf16 v[104:107], v[100:103], v[112:115], v[104:107]
  v_cmp_ne_u32 vcc, 0, v108
  s_nop 0
  s_cbranch_vccnz r1_spin1
  s_nop 4
  v_permlane32_swap_b32 v104, v105
  v_permlane32_swap_b32 v106, v107
  v_add_f32 v104, v104, v105
  v_add_f32 v106, v106, v107
  s_nop 1
  v_permlane16_swap_b32 v104, v106
  v_add_f32 v104, v104, v106
  v_mov_b32 v105, v104
  s_nop 1
  v_permlane32_swap_b32 v104, v105
  v_cvt_pk_bf16_f32 v104, v104, v105
  v_min_u32 v104, -2, v104
  v_mov_b32 v105, v104
  s_nop 1
  v_permlane16_swap_b32 v104, v105
  s_mov_b64 exec, 0xff
  buffer_store_dwordx2 v[104:105], v14, s[44:47], s73 offen sc1
  buffer_store_dwordx2 v[110:111], v14, s[44:47], s74 offen sc1
  s_mov_b64 exec, -1
  s_add_u32 s67, s67, 1
  s_cmp_lt_u32 s67, 64
  s_waitcnt vmcnt(0)
  s_cbranch_scc1 r1_top
  s_branch r_end
r1_spin0:
  s_sub_u32 s69, s69, 1
  s_cbranch_scc0 r1_top
  s_branch mega_exit
r1_spin1:
  s_sub_u32 s69, s69, 1
  s_cbranch_scc0 r1_rp
  s_branch mega_exit
r1_kvw:
pf_13:
  buffer_load_dword v20, v17, s[44:47], s80 offen sc1
  s_waitcnt vmcnt(0)
  v_cmp_gt_u32 vcc, s85, v20
  s_nop 0
  s_cbranch_vccz pd_14
  s_nop 2
pr_15:
  s_sub_u32 s69, s69, 1
  s_cbranch_scc0 pf_13
  s_branch mega_exit
pd_14:
  s_branch r1_kvok
r_end:
  v_mov_b32 v68, 64
  s_waitcnt vmcnt(0)
  buffer_store_dword v68, off, s[44:47], s79 sc1
  s_branch mega_end
role_kv:
  s_cmp_lt_u32 s66, 2
  s_cselect_b32 s72, s22, s24
  s_cselect_b32 s73, s23, s25
  s_mov_b32 s48, s72
  s_mov_b32 s49, s73
  s_mov_b32 s50, 4194304
  s_mov_b32 s51, 0x00020000
  s_mov_b32 s52, s20
  s_mov_b32 s53, s21
  s_mov_b32 s54, 4194304
  s_mov_b32 s55, 0x00020000
  s_lshl_b32 s72, s65, 8
  s_and_b32 s73, s66, 1
  s_lshl_b32 s73, s73, 7
  s_add_u32 s73, s72, s73
  v_lshrrev_b32 v5, 5, v1
  v_lshlrev_b32 v6, 16, v5
  v_and_b32 v5, 31, v1
  v_lshl_add_u32 v4, v5, 2, v6
  v_add_u32 v4, s73, v4
  s_lshl_b32 s73, s66, 6
  s_add_u32 s72, s72, s73
  v_and_b32 v5, 0x12, v1
  v_bfe_u32 v7, v1, 2, 1
  v_lshl_add_u32 v5, v7, 3, v5
  v_bfe_u32 v7, v1, 3, 1
  v_lshl_add_u32 v5, v7, 2, v5
  v_lshl_add_u32 v5, v5, 1, v6
  v_add_u32 v5, s72, v5
  v_and_b32 v7, 1, v1
  v_mul_u32_u24 v7, 0x0202, v7
  v_lshl_or_b32 v7, v7, 16, v7
  v_add_u32 v7, s70, v7
  s_mov_b32 s72, 0
  buffer_load_dword v24, v4, s[48:51], s72 offen
  s_mov_b32 s73, 8192
  buffer_load_dword v25, v4, s[48:51], s73 offen
  s_mov_b32 s72, 16384
  buffer_load_dword v26, v4, s[48:51], s72 offen
  s_mov_b32 s73, 24576
  buffer_load_dword v27, v4, s[48:51], s73 offen
  s_mov_b32 s72, 32768
  buffer_load_dword v28, v4, s[48:51], s72 offen
  s_mov_b32 s73, 40960
  buffer_load_dword v29, v4, s[48:51], s73 offen
  s_mov_b32 s72, 49152
  buffer_load_dword v30, v4, s[48:51], s72 offen
  s_mov_b32 s73, 57344
  buffer_load_dword v31, v4, s[48:51], s73 offen
  s_mov_b32 s72, 131072
  buffer_load_dword v32, v4, s[48:51], s72 offen
  s_mov_b32 s73, 139264
  buffer_load_dword v33, v4, s[48:51], s73 offen
  s_mov_b32 s72, 147456
  buffer_load_dword v34, v4, s[48:51], s72 offen
  s_mov_b32 s73, 155648
  buffer_load_dword v35, v4, s[48:51], s73 offen
  s_mov_b32 s72, 163840
  buffer_load_dword v36, v4, s[48:51], s72 offen
  s_mov_b32 s73, 172032
  buffer_load_dword v37, v4, s[48:51], s73 offen
  s_mov_b32 s72, 180224
  buffer_load_dword v38, v4, s[48:51], s72 offen
  s_mov_b32 s73, 188416
  buffer_load_dword v39, v4, s[48:51], s73 offen
  s_mov_b32 s72, 262144
  buffer_load_dword v40, v4, s[48:51], s72 offen
  s_mov_b32 s73, 270336
  buffer_load_dword v41, v4, s[48:51], s73 offen
  s_mov_b32 s72, 278528
  buffer_load_dword v42, v4, s[48:51], s72 offen
  s_mov_b32 s73, 286720
  buffer_load_dword v43, v4, s[48:51], s73 offen
  s_mov_b32 s72, 294912
  buffer_load_dword v44, v4, s[48:51], s72 offen
  s_mov_b32 s73, 303104
  buffer_load_dword v45, v4, s[48:51], s73 offen
  s_mov_b32 s72, 311296
  buffer_load_dword v46, v4, s[48:51], s72 offen
  s_mov_b32 s73, 319488
  buffer_load_dword v47, v4, s[48:51], s73 offen
  s_mov_b32 s72, 393216
  buffer_load_dword v48, v4, s[48:51], s72 offen
  s_mov_b32 s73, 401408
  buffer_load_dword v49, v4, s[48:51], s73 offen
  s_mov_b32 s72, 409600
  buffer_load_dword v50, v4, s[48:51], s72 offen
  s_mov_b32 s73, 417792
  buffer_load_dword v51, v4, s[48:51], s73 offen
  s_mov_b32 s72, 425984
  buffer_load_dword v52, v4, s[48:51], s72 offen
  s_mov_b32 s73, 434176
  buffer_load_dword v53, v4, s[48:51], s73 offen
  s_mov_b32 s72, 442368
  buffer_load_dword v54, v4, s[48:51], s72 offen
  s_mov_b32 s73, 450560
  buffer_load_dword v55, v4, s[48:51], s73 offen
  s_mov_b32 s72, 524288
  buffer_load_dword v56, v4, s[48:51], s72 offen
  s_mov_b32 s73, 532480
  buffer_load_dword v57, v4, s[48:51], s73 offen
  s_mov_b32 s72, 540672
  buffer_load_dword v58, v4, s[48:51], s72 offen
  s_mov_b32 s73, 548864
  buffer_load_dword v59, v4, s[48:51], s73 offen
  s_mov_b32 s72, 557056
  buffer_load_dword v60, v4, s[48:51], s72 offen
  s_mov_b32 s73, 565248
  buffer_load_dword v61, v4, s[48:51], s73 offen
  s_mov_b32 s72, 573440
  buffer_load_dword v62, v4, s[48:51], s72 offen
  s_mov_b32 s73, 581632
  buffer_load_dword v63, v4, s[48:51], s73 offen
  s_mov_b32 s72, 655360
  buffer_load_dword v64, v4, s[48:51], s72 offen
  s_mov_b32 s73, 663552
  buffer_load_dword v65, v4, s[48:51], s73 offen
  s_mov_b32 s72, 671744
  buffer_load_dword v66, v4, s[48:51], s72 offen
  s_mov_b32 s73, 679936
  buffer_load_dword v67, v4, s[48:51], s73 offen
  s_mov_b32 s72, 688128
  buffer_load_dword v68, v4, s[48:51], s72 offen
  s_mov_b32 s73, 696320
  buffer_load_dword v69, v4, s[48:51], s73 offen
  s_mov_b32 s72, 704512
  buffer_load_dword v70, v4, s[48:51], s72 offen
  s_mov_b32 s73, 712704
  buffer_load_dword v71, v4, s[48:51], s73 offen
  s_mov_b32 s72, 786432
  buffer_load_dword v72, v4, s[48:51], s72 offen
  s_mov_b32 s73, 794624
  buffer_load_dword v73, v4, s[48:51], s73 offen
  s_mov_b32 s72, 802816
  buffer_load_dword v74, v4, s[48:51], s72 offen
  s_mov_b32 s73, 811008
  buffer_load_dword v75, v4, s[48:51], s73 offen
  s_mov_b32 s72, 819200
  buffer_load_dword v76, v4, s[48:51], s72 offen
  s_mov_b32 s73, 827392
  buffer_load_dword v77, v4, s[48:51], s73 offen
  s_mov_b32 s72, 835584
  buffer_load_dword v78, v4, s[48:51], s72 offen
  s_mov_b32 s73, 843776
  buffer_load_dword v79, v4, s[48:51], s73 offen
  s_mov_b32 s72, 917504
  buffer_load_dword v80, v4, s[48:51], s72 offen
  s_mov_b32 s73, 925696
  buffer_load_dword v81, v4, s[48:51], s73 offen
  s_mov_b32 s72, 933888
  buffer_load_dword v82, v4, s[48:51], s72 offen
  s_mov_b32 s73, 942080
  buffer_load_dword v83, v4, s[48:51], s73 offen
  s_mov_b32 s72, 950272
  buffer_load_dword v84, v4, s[48:51], s72 offen
  s_mov_b32 s73, 958464
  buffer_load_dword v85, v4, s[48:51], s73 offen
  s_mov_b32 s72, 966656
  buffer_load_dword v86, v4, s[48:51], s72 offen
  s_mov_b32 s73, 974848
  buffer_load_dword v87, v4, s[48:51], s73 offen
  s_mov_b32 s72, 1048576
  buffer_load_dword v88, v4, s[48:51], s72 offen
  s_mov_b32 s73, 1056768
  buffer_load_dword v89, v4, s[48:51], s73 offen
  s_mov_b32 s72, 1064960
  buffer_load_dword v90, v4, s[48:51], s72 offen
  s_mov_b32 s73, 1073152
  buffer_load_dword v91, v4, s[48:51], s73 offen
  s_mov_b32 s72, 1081344
  buffer_load_dword v92, v4, s[48:51], s72 offen
  s_mov_b32 s73, 1089536
  buffer_load_dword v93, v4, s[48:51], s73 offen
  s_mov_b32 s72, 1097728
  buffer_load_dword v94, v4, s[48:51], s72 offen
  s_mov_b32 s73, 1105920
  buffer_load_dword v95, v4, s[48:51], s73 offen
  s_mov_b32 s72, 1179648
  buffer_load_dword v96, v4, s[48:51], s72 offen
  s_mov_b32 s73, 1187840
  buffer_load_dword v97, v4, s[48:51], s73 offen
  s_mov_b32 s72, 1196032
  buffer_load_dword v98, v4, s[48:51], s72 offen
  s_mov_b32 s73, 1204224
  buffer_load_dword v99, v4, s[48:51], s73 offen
  s_mov_b32 s72, 1212416
  buffer_load_dword v100, v4, s[48:51], s72 offen
  s_mov_b32 s73, 1220608
  buffer_load_dword v101, v4, s[48:51], s73 offen
  s_mov_b32 s72, 1228800
  buffer_load_dword v102, v4, s[48:51], s72 offen
  s_mov_b32 s73, 1236992
  buffer_load_dword v103, v4, s[48:51], s73 offen
  s_mov_b32 s72, 1310720
  buffer_load_dword v104, v4, s[48:51], s72 offen
  s_mov_b32 s73, 1318912
  buffer_load_dword v105, v4, s[48:51], s73 offen
  s_mov_b32 s72, 1327104
  buffer_load_dword v106, v4, s[48:51], s72 offen
  s_mov_b32 s73, 1335296
  buffer_load_dword v107, v4, s[48:51], s73 offen
  s_mov_b32 s72, 1343488
  buffer_load_dword v108, v4, s[48:51], s72 offen
  s_mov_b32 s73, 1351680
  buffer_load_dword v109, v4, s[48:51], s73 offen
  s_mov_b32 s72, 1359872
  buffer_load_dword v110, v4, s[48:51], s72 offen
  s_mov_b32 s73, 1368064
  buffer_load_dword v111, v4, s[48:51], s73 offen
  s_mov_b32 s72, 1441792
  buffer_load_dword v112, v4, s[48:51], s72 offen
  s_mov_b32 s73, 1449984
  buffer_load_dword v113, v4, s[48:51], s73 offen
  s_mov_b32 s72, 1458176
  buffer_load_dword v114, v4, s[48:51], s72 offen
  s_mov_b32 s73, 1466368
  buffer_load_dword v115, v4, s[48:51], s73 offen
  s_mov_b32 s72, 1474560
  buffer_load_dword v116, v4, s[48:51], s72 offen
  s_mov_b32 s73, 1482752
  buffer_load_dword v117, v4, s[48:51], s73 offen
  s_mov_b32 s72, 1490944
  buffer_load_dword v118, v4, s[48:51], s72 offen
  s_mov_b32 s73, 1499136
  buffer_load_dword v119, v4, s[48:51], s73 offen
  s_waitcnt vmcnt(48)
  v_perm_b32 v120, v25, v24, s70
  v_accvgpr_write_b32 a0, v120
  v_perm_b32 v121, v25, v24, s71
  v_accvgpr_write_b32 a128, v121
  v_perm_b32 v122, v27, v26, s70
  v_accvgpr_write_b32 a1, v122
  v_perm_b32 v123, v27, v26, s71
  v_accvgpr_write_b32 a129, v123
  v_perm_b32 v120, v29, v28, s70
  v_accvgpr_write_b32 a2, v120
  v_perm_b32 v121, v29, v28, s71
  v_accvgpr_write_b32 a130, v121
  v_perm_b32 v122, v31, v30, s70
  v_accvgpr_write_b32 a3, v122
  v_perm_b32 v123, v31, v30, s71
  v_accvgpr_write_b32 a131, v123
  v_perm_b32 v120, v33, v32, s70
  v_accvgpr_write_b32 a4, v120
  v_perm_b32 v121, v33, v32, s71
  v_accvgpr_write_b32 a132, v121
  v_perm_b32 v122, v35, v34, s70
  v_accvgpr_write_b32 a5, v122
  v_perm_b32 v123, v35, v34, s71
  v_accvgpr_write_b32 a133, v123
  v_perm_b32 v120, v37, v36, s70
  v_accvgpr_write_b32 a6, v120
  v_perm_b32 v121, v37, v36, s71
  v_accvgpr_write_b32 a134, v121
  v_perm_b32 v122, v39, v38, s70
  v_accvgpr_write_b32 a7, v122
  v_perm_b32 v123, v39, v38, s71
  v_accvgpr_write_b32 a135, v123
  v_perm_b32 v120, v41, v40, s70
  v_accvgpr_write_b32 a8, v120
  v_perm_b32 v121, v41, v40, s71
  v_accvgpr_write_b32 a136, v121
  v_perm_b32 v122, v43, v42, s70
  v_accvgpr_write_b32 a9, v122
  v_perm_b32 v123, v43, v42, s71
  v_accvgpr_write_b32 a137, v123
  v_perm_b32 v120, v45, v44, s70
  v_accvgpr_write_b32 a10, v120
  v_perm_b32 v121, v45, v44, s71
  v_accvgpr_write_b32 a138, v121
  v_perm_b32 v122, v47, v46, s70
  v_accvgpr_write_b32 a11, v122
  v_perm_b32 v123, v47, v46, s71
  v_accvgpr_write_b32 a139, v123
  v_perm_b32 v120, v49, v48, s70
  v_accvgpr_write_b32 a12, v120
  v_perm_b32 v121, v49, v48, s71
  v_accvgpr_write_b32 a140, v121
  v_perm_b32 v122, v51, v50, s70
  v_accvgpr_write_b32 a13, v122
  v_perm_b32 v123, v51, v50, s71
  v_accvgpr_write_b32 a141, v123
  v_perm_b32 v120, v53, v52, s70
  v_accvgpr_write_b32 a14, v120
  v_perm_b32 v121, v53, v52, s71
  v_accvgpr_write_b32 a142, v121
  v_perm_b32 v122, v55, v54, s70
  v_accvgpr_write_b32 a15, v122
  v_perm_b32 v123, v55, v54, s71
  v_accvgpr_write_b32 a143, v123
  v_perm_b32 v120, v57, v56, s70
  v_accvgpr_write_b32 a16, v120
  v_perm_b32 v121, v57, v56, s71
  v_accvgpr_write_b32 a144, v121
  v_perm_b32 v122, v59, v58, s70
  v_accvgpr_write_b32 a17, v122
  v_perm_b32 v123, v59, v58, s71
  v_accvgpr_write_b32 a145, v123
  v_perm_b32 v120, v61, v60, s70
  v_accvgpr_write_b32 a18, v120
  v_perm_b32 v121, v61, v60, s71
  v_accvgpr_write_b32 a146, v121
  v_perm_b32 v122, v63, v62, s70
  v_accvgpr_write_b32 a19, v122
  v_perm_b32 v123, v63, v62, s71
  v_accvgpr_write_b32 a147, v123
  v_perm_b32 v120, v65, v64, s70
  v_accvgpr_write_b32 a20, v120
  v_perm_b32 v121, v65, v64, s71
  v_accvgpr_write_b32 a148, v121
  v_perm_b32 v122, v67, v66, s70
  v_accvgpr_write_b32 a21, v122
  v_perm_b32 v123, v67, v66, s71
  v_accvgpr_write_b32 a149, v123
  v_perm_b32 v120, v69, v68, s70
  v_accvgpr_write_b32 a22, v120
  v_perm_b32 v121, v69, v68, s71
  v_accvgpr_write_b32 a150, v121
  v_perm_b32 v122, v71, v70, s70
  v_accvgpr_write_b32 a23, v122
  v_perm_b32 v123, v71, v70, s71
  v_accvgpr_write_b32 a151, v123
  s_mov_b32 s72, 1572864
  buffer_load_dword v24, v4, s[48:51], s72 offen
  s_mov_b32 s73, 1581056
  buffer_load_dword v25, v4, s[48:51], s73 offen
  s_mov_b32 s72, 1589248
  buffer_load_dword v26, v4, s[48:51], s72 offen
  s_mov_b32 s73, 1597440
  buffer_load_dword v27, v4, s[48:51], s73 offen
  s_mov_b32 s72, 1605632
  buffer_load_dword v28, v4, s[48:51], s72 offen
  s_mov_b32 s73, 1613824
  buffer_load_dword v29, v4, s[48:51], s73 offen
  s_mov_b32 s72, 1622016
  buffer_load_dword v30, v4, s[48:51], s72 offen
  s_mov_b32 s73, 1630208
  buffer_load_dword v31, v4, s[48:51], s73 offen
  s_mov_b32 s72, 1703936
  buffer_load_dword v32, v4, s[48:51], s72 offen
  s_mov_b32 s73, 1712128
  buffer_load_dword v33, v4, s[48:51], s73 offen
  s_mov_b32 s72, 1720320
  buffer_load_dword v34, v4, s[48:51], s72 offen
  s_mov_b32 s73, 1728512
  buffer_load_dword v35, v4, s[48:51], s73 offen
  s_mov_b32 s72, 1736704
  buffer_load_dword v36, v4, s[48:51], s72 offen
  s_mov_b32 s73, 1744896
  buffer_load_dword v37, v4, s[48:51], s73 offen
  s_mov_b32 s72, 1753088
  buffer_load_dword v38, v4, s[48:51], s72 offen
  s_mov_b32 s73, 1761280
  buffer_load_dword v39, v4, s[48:51], s73 offen
  s_mov_b32 s72, 1835008
  buffer_load_dword v40, v4, s[48:51], s72 offen
  s_mov_b32 s73, 1843200
  buffer_load_dword v41, v4, s[48:51], s73 offen
  s_mov_b32 s72, 1851392
  buffer_load_dword v42, v4, s[48:51], s72 offen
  s_mov_b32 s73, 1859584
  buffer_load_dword v43, v4, s[48:51], s73 offen
  s_mov_b32 s72, 1867776
  buffer_load_dword v44, v4, s[48:51], s72 offen
  s_mov_b32 s73, 1875968
  buffer_load_dword v45, v4, s[48:51], s73 offen
  s_mov_b32 s72, 1884160
  buffer_load_dword v46, v4, s[48:51], s72 offen
  s_mov_b32 s73, 1892352
  buffer_load_dword v47, v4, s[48:51], s73 offen
  s_mov_b32 s72, 1966080
  buffer_load_dword v48, v4, s[48:51], s72 offen
  s_mov_b32 s73, 1974272
  buffer_load_dword v49, v4, s[48:51], s73 offen
  s_mov_b32 s72, 1982464
  buffer_load_dword v50, v4, s[48:51], s72 offen
  s_mov_b32 s73, 1990656
  buffer_load_dword v51, v4, s[48:51], s73 offen
  s_mov_b32 s72, 1998848
  buffer_load_dword v52, v4, s[48:51], s72 offen
  s_mov_b32 s73, 2007040
  buffer_load_dword v53, v4, s[48:51], s73 offen
  s_mov_b32 s72, 2015232
  buffer_load_dword v54, v4, s[48:51], s72 offen
  s_mov_b32 s73, 2023424
  buffer_load_dword v55, v4, s[48:51], s73 offen
  s_mov_b32 s72, 2097152
  buffer_load_dword v56, v4, s[48:51], s72 offen
  s_mov_b32 s73, 2105344
  buffer_load_dword v57, v4, s[48:51], s73 offen
  s_mov_b32 s72, 2113536
  buffer_load_dword v58, v4, s[48:51], s72 offen
  s_mov_b32 s73, 2121728
  buffer_load_dword v59, v4, s[48:51], s73 offen
  s_mov_b32 s72, 2129920
  buffer_load_dword v60, v4, s[48:51], s72 offen
  s_mov_b32 s73, 2138112
  buffer_load_dword v61, v4, s[48:51], s73 offen
  s_mov_b32 s72, 2146304
  buffer_load_dword v62, v4, s[48:51], s72 offen
  s_mov_b32 s73, 2154496
  buffer_load_dword v63, v4, s[48:51], s73 offen
  s_mov_b32 s72, 2228224
  buffer_load_dword v64, v4, s[48:51], s72 offen
  s_mov_b32 s73, 2236416
  buffer_load_dword v65, v4, s[48:51], s73 offen
  s_mov_b32 s72, 2244608
  buffer_load_dword v66, v4, s[48:51], s72 offen
  s_mov_b32 s73, 2252800
  buffer_load_dword v67, v4, s[48:51], s73 offen
  s_mov_b32 s72, 2260992
  buffer_load_dword v68, v4, s[48:51], s72 offen
  s_mov_b32 s73, 2269184
  buffer_load_dword v69, v4, s[48:51], s73 offen
  s_mov_b32 s72, 2277376
  buffer_load_dword v70, v4, s[48:51], s72 offen
  s_mov_b32 s73, 2285568
  buffer_load_dword v71, v4, s[48:51], s73 offen
  s_waitcnt vmcnt(48)
  v_perm_b32 v120, v73, v72, s70
  v_accvgpr_write_b32 a24, v120
  v_perm_b32 v121, v73, v72, s71
  v_accvgpr_write_b32 a152, v121
  v_perm_b32 v122, v75, v74, s70
  v_accvgpr_write_b32 a25, v122
  v_perm_b32 v123, v75, v74, s71
  v_accvgpr_write_b32 a153, v123
  v_perm_b32 v120, v77, v76, s70
  v_accvgpr_write_b32 a26, v120
  v_perm_b32 v121, v77, v76, s71
  v_accvgpr_write_b32 a154, v121
  v_perm_b32 v122, v79, v78, s70
  v_accvgpr_write_b32 a27, v122
  v_perm_b32 v123, v79, v78, s71
  v_accvgpr_write_b32 a155, v123
  v_perm_b32 v120, v81, v80, s70
  v_accvgpr_write_b32 a28, v120
  v_perm_b32 v121, v81, v80, s71
  v_accvgpr_write_b32 a156, v121
  v_perm_b32 v122, v83, v82, s70
  v_accvgpr_write_b32 a29, v122
  v_perm_b32 v123, v83, v82, s71
  v_accvgpr_write_b32 a157, v123
  v_perm_b32 v120, v85, v84, s70
  v_accvgpr_write_b32 a30, v120
  v_perm_b32 v121, v85, v84, s71
  v_accvgpr_write_b32 a158, v121
  v_perm_b32 v122, v87, v86, s70
  v_accvgpr_write_b32 a31, v122
  v_perm_b32 v123, v87, v86, s71
  v_accvgpr_write_b32 a159, v123
  v_perm_b32 v120, v89, v88, s70
  v_accvgpr_write_b32 a32, v120
  v_perm_b32 v121, v89, v88, s71
  v_accvgpr_write_b32 a160, v121
  v_perm_b32 v122, v91, v90, s70
  v_accvgpr_write_b32 a33, v122
  v_perm_b32 v123, v91, v90, s71
  v_accvgpr_write_b32 a161, v123
  v_perm_b32 v120, v93, v92, s70
  v_accvgpr_write_b32 a34, v120
  v_perm_b32 v121, v93, v92, s71
  v_accvgpr_write_b32 a162, v121
  v_perm_b32 v122, v95, v94, s70
  v_accvgpr_write_b32 a35, v122
  v_perm_b32 v123, v95, v94, s71
  v_accvgpr_write_b32 a163, v123
  v_perm_b32 v120, v97, v96, s70
  v_accvgpr_write_b32 a36, v120
  v_perm_b32 v121, v97, v96, s71
  v_accvgpr_write_b32 a164, v121
  v_perm_b32 v122, v99, v98, s70
  v_accvgpr_write_b32 a37, v122
  v_perm_b32 v123, v99, v98, s71
  v_accvgpr_write_b32 a165, v123
  v_perm_b32 v120, v101, v100, s70
  v_accvgpr_write_b32 a38, v120
  v_perm_b32 v121, v101, v100, s71
  v_accvgpr_write_b32 a166, v121
  v_perm_b32 v122, v103, v102, s70
  v_accvgpr_write_b32 a39, v122
  v_perm_b32 v123, v103, v102, s71
  v_accvgpr_write_b32 a167, v123
  v_perm_b32 v120, v105, v104, s70
  v_accvgpr_write_b32 a40, v120
  v_perm_b32 v121, v105, v104, s71
  v_accvgpr_write_b32 a168, v121
  v_perm_b32 v122, v107, v106, s70
  v_accvgpr_write_b32 a41, v122
  v_perm_b32 v123, v107, v106, s71
  v_accvgpr_write_b32 a169, v123
  v_perm_b32 v120, v109, v108, s70
  v_accvgpr_write_b32 a42, v120
  v_perm_b32 v121, v109, v108, s71
  v_accvgpr_write_b32 a170, v121
  v_perm_b32 v122, v111, v110, s70
  v_accvgpr_write_b32 a43, v122
  v_perm_b32 v123, v111, v110, s71
  v_accvgpr_write_b32 a171, v123
  v_perm_b32 v120, v113, v112, s70
  v_accvgpr_write_b32 a44, v120
  v_perm_b32 v121, v113, v112, s71
  v_accvgpr_write_b32 a172, v121
  v_perm_b32 v122, v115, v114, s70
  v_accvgpr_write_b32 a45, v122
  v_perm_b32 v123, v115, v114, s71
  v_accvgpr_write_b32 a173, v123
  v_perm_b32 v120, v117, v116, s70
  v_accvgpr_write_b32 a46, v120
  v_perm_b32 v121, v117, v116, s71
  v_accvgpr_write_b32 a174, v121
  v_perm_b32 v122, v119, v118, s70
  v_accvgpr_write_b32 a47, v122
  v_perm_b32 v123, v119, v118, s71
  v_accvgpr_write_b32 a175, v123
  s_mov_b32 s72, 2359296
  buffer_load_dword v72, v4, s[48:51], s72 offen
  s_mov_b32 s73, 2367488
  buffer_load_dword v73, v4, s[48:51], s73 offen
  s_mov_b32 s72, 2375680
  buffer_load_dword v74, v4, s[48:51], s72 offen
  s_mov_b32 s73, 2383872
  buffer_load_dword v75, v4, s[48:51], s73 offen
  s_mov_b32 s72, 2392064
  buffer_load_dword v76, v4, s[48:51], s72 offen
  s_mov_b32 s73, 2400256
  buffer_load_dword v77, v4, s[48:51], s73 offen
  s_mov_b32 s72, 2408448
  buffer_load_dword v78, v4, s[48:51], s72 offen
  s_mov_b32 s73, 2416640
  buffer_load_dword v79, v4, s[48:51], s73 offen
  s_mov_b32 s72, 2490368
  buffer_load_dword v80, v4, s[48:51], s72 offen
  s_mov_b32 s73, 2498560
  buffer_load_dword v81, v4, s[48:51], s73 offen
  s_mov_b32 s72, 2506752
  buffer_load_dword v82, v4, s[48:51], s72 offen
  s_mov_b32 s73, 2514944
  buffer_load_dword v83, v4, s[48:51], s73 offen
  s_mov_b32 s72, 2523136
  buffer_load_dword v84, v4, s[48:51], s72 offen
  s_mov_b32 s73, 2531328
  buffer_load_dword v85, v4, s[48:51], s73 offen
  s_mov_b32 s72, 2539520
  buffer_load_dword v86, v4, s[48:51], s72 offen
  s_mov_b32 s73, 2547712
  buffer_load_dword v87, v4, s[48:51], s73 offen
  s_mov_b32 s72, 2621440
  buffer_load_dword v88, v4, s[48:51], s72 offen
  s_mov_b32 s73, 2629632
  buffer_load_dword v89, v4, s[48:51], s73 offen
  s_mov_b32 s72, 2637824
  buffer_load_dword v90, v4, s[48:51], s72 offen
  s_mov_b32 s73, 2646016
  buffer_load_dword v91, v4, s[48:51], s73 offen
  s_mov_b32 s72, 2654208
  buffer_load_dword v92, v4, s[48:51], s72 offen
  s_mov_b32 s73, 2662400
  buffer_load_dword v93, v4, s[48:51], s73 offen
  s_mov_b32 s72, 2670592
  buffer_load_dword v94, v4, s[48:51], s72 offen
  s_mov_b32 s73, 2678784
  buffer_load_dword v95, v4, s[48:51], s73 offen
  s_mov_b32 s72, 2752512
  buffer_load_dword v96, v4, s[48:51], s72 offen
  s_mov_b32 s73, 2760704
  buffer_load_dword v97, v4, s[48:51], s73 offen
  s_mov_b32 s72, 2768896
  buffer_load_dword v98, v4, s[48:51], s72 offen
  s_mov_b32 s73, 2777088
  buffer_load_dword v99, v4, s[48:51], s73 offen
  s_mov_b32 s72, 2785280
  buffer_load_dword v100, v4, s[48:51], s72 offen
  s_mov_b32 s73, 2793472
  buffer_load_dword v101, v4, s[48:51], s73 offen
  s_mov_b32 s72, 2801664
  buffer_load_dword v102, v4, s[48:51], s72 offen
  s_mov_b32 s73, 2809856
  buffer_load_dword v103, v4, s[48:51], s73 offen
  s_mov_b32 s72, 2883584
  buffer_load_dword v104, v4, s[48:51], s72 offen
  s_mov_b32 s73, 2891776
  buffer_load_dword v105, v4, s[48:51], s73 offen
  s_mov_b32 s72, 2899968
  buffer_load_dword v106, v4, s[48:51], s72 offen
  s_mov_b32 s73, 2908160
  buffer_load_dword v107, v4, s[48:51], s73 offen
  s_mov_b32 s72, 2916352
  buffer_load_dword v108, v4, s[48:51], s72 offen
  s_mov_b32 s73, 2924544
  buffer_load_dword v109, v4, s[48:51], s73 offen
  s_mov_b32 s72, 2932736
  buffer_load_dword v110, v4, s[48:51], s72 offen
  s_mov_b32 s73, 2940928
  buffer_load_dword v111, v4, s[48:51], s73 offen
  s_mov_b32 s72, 3014656
  buffer_load_dword v112, v4, s[48:51], s72 offen
  s_mov_b32 s73, 3022848
  buffer_load_dword v113, v4, s[48:51], s73 offen
  s_mov_b32 s72, 3031040
  buffer_load_dword v114, v4, s[48:51], s72 offen
  s_mov_b32 s73, 3039232
  buffer_load_dword v115, v4, s[48:51], s73 offen
  s_mov_b32 s72, 3047424
  buffer_load_dword v116, v4, s[48:51], s72 offen
  s_mov_b32 s73, 3055616
  buffer_load_dword v117, v4, s[48:51], s73 offen
  s_mov_b32 s72, 3063808
  buffer_load_dword v118, v4, s[48:51], s72 offen
  s_mov_b32 s73, 3072000
  buffer_load_dword v119, v4, s[48:51], s73 offen
  s_waitcnt vmcnt(48)
  v_perm_b32 v120, v25, v24, s70
  v_accvgpr_write_b32 a48, v120
  v_perm_b32 v121, v25, v24, s71
  v_accvgpr_write_b32 a176, v121
  v_perm_b32 v122, v27, v26, s70
  v_accvgpr_write_b32 a49, v122
  v_perm_b32 v123, v27, v26, s71
  v_accvgpr_write_b32 a177, v123
  v_perm_b32 v120, v29, v28, s70
  v_accvgpr_write_b32 a50, v120
  v_perm_b32 v121, v29, v28, s71
  v_accvgpr_write_b32 a178, v121
  v_perm_b32 v122, v31, v30, s70
  v_accvgpr_write_b32 a51, v122
  v_perm_b32 v123, v31, v30, s71
  v_accvgpr_write_b32 a179, v123
  v_perm_b32 v120, v33, v32, s70
  v_accvgpr_write_b32 a52, v120
  v_perm_b32 v121, v33, v32, s71
  v_accvgpr_write_b32 a180, v121
  v_perm_b32 v122, v35, v34, s70
  v_accvgpr_write_b32 a53, v122
  v_perm_b32 v123, v35, v34, s71
  v_accvgpr_write_b32 a181, v123
  v_perm_b32 v120, v37, v36, s70
  v_accvgpr_write_b32 a54, v120
  v_perm_b32 v121, v37, v36, s71
  v_accvgpr_write_b32 a182, v121
  v_perm_b32 v122, v39, v38, s70
  v_accvgpr_write_b32 a55, v122
  v_perm_b32 v123, v39, v38, s71
  v_accvgpr_write_b32 a183, v123
  v_perm_b32 v120, v41, v40, s70
  v_accvgpr_write_b32 a56, v120
  v_perm_b32 v121, v41, v40, s71
  v_accvgpr_write_b32 a184, v121
  v_perm_b32 v122, v43, v42, s70
  v_accvgpr_write_b32 a57, v122
  v_perm_b32 v123, v43, v42, s71
  v_accvgpr_write_b32 a185, v123
  v_perm_b32 v120, v45, v44, s70
  v_accvgpr_write_b32 a58, v120
  v_perm_b32 v121, v45, v44, s71
  v_accvgpr_write_b32 a186, v121
  v_perm_b32 v122, v47, v46, s70
  v_accvgpr_write_b32 a59, v122
  v_perm_b32 v123, v47, v46, s71
  v_accvgpr_write_b32 a187, v123
  v_perm_b32 v120, v49, v48, s70
  v_accvgpr_write_b32 a60, v120
  v_perm_b32 v121, v49, v48, s71
  v_accvgpr_write_b32 a188, v121
  v_perm_b32 v122, v51, v50, s70
  v_accvgpr_write_b32 a61, v122
  v_perm_b32 v123, v51, v50, s71
  v_accvgpr_write_b32 a189, v123
  v_perm_b32 v120, v53, v52, s70
  v_accvgpr_write_b32 a62, v120
  v_perm_b32 v121, v53, v52, s71
  v_accvgpr_write_b32 a190, v121
  v_perm_b32 v122, v55, v54, s70
  v_accvgpr_write_b32 a63, v122
  v_perm_b32 v123, v55, v54, s71
  v_accvgpr_write_b32 a191, v123
  v_perm_b32 v120, v57, v56, s70
  v_accvgpr_write_b32 a64, v120
  v_perm_b32 v121, v57, v56, s71
  v_accvgpr_write_b32 a192, v121
  v_perm_b32 v122, v59, v58, s70
  v_accvgpr_write_b32 a65, v122
  v_perm_b32 v123, v59, v58, s71
  v_accvgpr_write_b32 a193, v123
  v_perm_b32 v120, v61, v60, s70
  v_accvgpr_write_b32 a66, v120
  v_perm_b32 v121, v61, v60, s71
  v_accvgpr_write_b32 a194, v121
  v_perm_b32 v122, v63, v62, s70
  v_accvgpr_write_b32 a67, v122
  v_perm_b32 v123, v63, v62, s71
  v_accvgpr_write_b32 a195, v123
  v_perm_b32 v120, v65, v64, s70
  v_accvgpr_write_b32 a68, v120
  v_perm_b32 v121, v65, v64, s71
  v_accvgpr_write_b32 a196, v121
  v_perm_b32 v122, v67, v66, s70
  v_accvgpr_write_b32 a69, v122
  v_perm_b32 v123, v67, v66, s71
  v_accvgpr_write_b32 a197, v123
  v_perm_b32 v120, v69, v68, s70
  v_accvgpr_write_b32 a70, v120
  v_perm_b32 v121, v69, v68, s71
  v_accvgpr_write_b32 a198, v121
  v_perm_b32 v122, v71, v70, s70
  v_accvgpr_write_b32 a71, v122
  v_perm_b32 v123, v71, v70, s71
  v_accvgpr_write_b32 a199, v123
  s_mov_b32 s72, 3145728
  buffer_load_dword v24, v4, s[48:51], s72 offen
  s_mov_b32 s73, 3153920
  buffer_load_dword v25, v4, s[48:51], s73 offen
  s_mov_b32 s72, 3162112
  buffer_load_dword v26, v4, s[48:51], s72 offen
  s_mov_b32 s73, 3170304
  buffer_load_dword v27, v4, s[48:51], s73 offen
  s_mov_b32 s72, 3178496
  buffer_load_dword v28, v4, s[48:51], s72 offen
  s_mov_b32 s73, 3186688
  buffer_load_dword v29, v4, s[48:51], s73 offen
  s_mov_b32 s72, 3194880
  buffer_load_dword v30, v4, s[48:51], s72 offen
  s_mov_b32 s73, 3203072
  buffer_load_dword v31, v4, s[48:51], s73 offen
  s_mov_b32 s72, 3276800
  buffer_load_dword v32, v4, s[48:51], s72 offen
  s_mov_b32 s73, 3284992
  buffer_load_dword v33, v4, s[48:51], s73 offen
  s_mov_b32 s72, 3293184
  buffer_load_dword v34, v4, s[48:51], s72 offen
  s_mov_b32 s73, 3301376
  buffer_load_dword v35, v4, s[48:51], s73 offen
  s_mov_b32 s72, 3309568
  buffer_load_dword v36, v4, s[48:51], s72 offen
  s_mov_b32 s73, 3317760
  buffer_load_dword v37, v4, s[48:51], s73 offen
  s_mov_b32 s72, 3325952
  buffer_load_dword v38, v4, s[48:51], s72 offen
  s_mov_b32 s73, 3334144
  buffer_load_dword v39, v4, s[48:51], s73 offen
  s_mov_b32 s72, 3407872
  buffer_load_dword v40, v4, s[48:51], s72 offen
  s_mov_b32 s73, 3416064
  buffer_load_dword v41, v4, s[48:51], s73 offen
  s_mov_b32 s72, 3424256
  buffer_load_dword v42, v4, s[48:51], s72 offen
  s_mov_b32 s73, 3432448
  buffer_load_dword v43, v4, s[48:51], s73 offen
  s_mov_b32 s72, 3440640
  buffer_load_dword v44, v4, s[48:51], s72 offen
  s_mov_b32 s73, 3448832
  buffer_load_dword v45, v4, s[48:51], s73 offen
  s_mov_b32 s72, 3457024
  buffer_load_dword v46, v4, s[48:51], s72 offen
  s_mov_b32 s73, 3465216
  buffer_load_dword v47, v4, s[48:51], s73 offen
  s_mov_b32 s72, 3538944
  buffer_load_dword v48, v4, s[48:51], s72 offen
  s_mov_b32 s73, 3547136
  buffer_load_dword v49, v4, s[48:51], s73 offen
  s_mov_b32 s72, 3555328
  buffer_load_dword v50, v4, s[48:51], s72 offen
  s_mov_b32 s73, 3563520
  buffer_load_dword v51, v4, s[48:51], s73 offen
  s_mov_b32 s72, 3571712
  buffer_load_dword v52, v4, s[48:51], s72 offen
  s_mov_b32 s73, 3579904
  buffer_load_dword v53, v4, s[48:51], s73 offen
  s_mov_b32 s72, 3588096
  buffer_load_dword v54, v4, s[48:51], s72 offen
  s_mov_b32 s73, 3596288
  buffer_load_dword v55, v4, s[48:51], s73 offen
  s_mov_b32 s72, 3670016
  buffer_load_dword v56, v4, s[48:51], s72 offen
  s_mov_b32 s73, 3678208
  buffer_load_dword v57, v4, s[48:51], s73 offen
  s_mov_b32 s72, 3686400
  buffer_load_dword v58, v4, s[48:51], s72 offen
  s_mov_b32 s73, 3694592
  buffer_load_dword v59, v4, s[48:51], s73 offen
  s_mov_b32 s72, 3702784
  buffer_load_dword v60, v4, s[48:51], s72 offen
  s_mov_b32 s73, 3710976
  buffer_load_dword v61, v4, s[48:51], s73 offen
  s_mov_b32 s72, 3719168
  buffer_load_dword v62, v4, s[48:51], s72 offen
  s_mov_b32 s73, 3727360
  buffer_load_dword v63, v4, s[48:51], s73 offen
  s_mov_b32 s72, 3801088
  buffer_load_dword v64, v4, s[48:51], s72 offen
  s_mov_b32 s73, 3809280
  buffer_load_dword v65, v4, s[48:51], s73 offen
  s_mov_b32 s72, 3817472
  buffer_load_dword v66, v4, s[48:51], s72 offen
  s_mov_b32 s73, 3825664
  buffer_load_dword v67, v4, s[48:51], s73 offen
  s_mov_b32 s72, 3833856
  buffer_load_dword v68, v4, s[48:51], s72 offen
  s_mov_b32 s73, 3842048
  buffer_load_dword v69, v4, s[48:51], s73 offen
  s_mov_b32 s72, 3850240
  buffer_load_dword v70, v4, s[48:51], s72 offen
  s_mov_b32 s73, 3858432
  buffer_load_dword v71, v4, s[48:51], s73 offen
  s_waitcnt vmcnt(48)
  v_perm_b32 v120, v73, v72, s70
  v_accvgpr_write_b32 a72, v120
  v_perm_b32 v121, v73, v72, s71
  v_accvgpr_write_b32 a200, v121
  v_perm_b32 v122, v75, v74, s70
  v_accvgpr_write_b32 a73, v122
  v_perm_b32 v123, v75, v74, s71
  v_accvgpr_write_b32 a201, v123
  v_perm_b32 v120, v77, v76, s70
  v_accvgpr_write_b32 a74, v120
  v_perm_b32 v121, v77, v76, s71
  v_accvgpr_write_b32 a202, v121
  v_perm_b32 v122, v79, v78, s70
  v_accvgpr_write_b32 a75, v122
  v_perm_b32 v123, v79, v78, s71
  v_accvgpr_write_b32 a203, v123
  v_perm_b32 v120, v81, v80, s70
  v_accvgpr_write_b32 a76, v120
  v_perm_b32 v121, v81, v80, s71
  v_accvgpr_write_b32 a204, v121
  v_perm_b32 v122, v83, v82, s70
  v_accvgpr_write_b32 a77, v122
  v_perm_b32 v123, v83, v82, s71
  v_accvgpr_write_b32 a205, v123
  v_perm_b32 v120, v85, v84, s70
  v_accvgpr_write_b32 a78, v120
  v_perm_b32 v121, v85, v84, s71
  v_accvgpr_write_b32 a206, v121
  v_perm_b32 v122, v87, v86, s70
  v_accvgpr_write_b32 a79, v122
  v_perm_b32 v123, v87, v86, s71
  v_accvgpr_write_b32 a207, v123
  v_perm_b32 v120, v89, v88, s70
  v_accvgpr_write_b32 a80, v120
  v_perm_b32 v121, v89, v88, s71
  v_accvgpr_write_b32 a208, v121
  v_perm_b32 v122, v91, v90, s70
  v_accvgpr_write_b32 a81, v122
  v_perm_b32 v123, v91, v90, s71
  v_accvgpr_write_b32 a209, v123
  v_perm_b32 v120, v93, v92, s70
  v_accvgpr_write_b32 a82, v120
  v_perm_b32 v121, v93, v92, s71
  v_accvgpr_write_b32 a210, v121
  v_perm_b32 v122, v95, v94, s70
  v_accvgpr_write_b32 a83, v122
  v_perm_b32 v123, v95, v94, s71
  v_accvgpr_write_b32 a211, v123
  v_perm_b32 v120, v97, v96, s70
  v_accvgpr_write_b32 a84, v120
  v_perm_b32 v121, v97, v96, s71
  v_accvgpr_write_b32 a212, v121
  v_perm_b32 v122, v99, v98, s70
  v_accvgpr_write_b32 a85, v122
  v_perm_b32 v123, v99, v98, s71
  v_accvgpr_write_b32 a213, v123
  v_perm_b32 v120, v101, v100, s70
  v_accvgpr_write_b32 a86, v120
  v_perm_b32 v121, v101, v100, s71
  v_accvgpr_write_b32 a214, v121
  v_perm_b32 v122, v103, v102, s70
  v_accvgpr_write_b32 a87, v122
  v_perm_b32 v123, v103, v102, s71
  v_accvgpr_write_b32 a215, v123
  v_perm_b32 v120, v105, v104, s70
  v_accvgpr_write_b32 a88, v120
  v_perm_b32 v121, v105, v104, s71
  v_accvgpr_write_b32 a216, v121
  v_perm_b32 v122, v107, v106, s70
  v_accvgpr_write_b32 a89, v122
  v_perm_b32 v123, v107, v106, s71
  v_accvgpr_write_b32 a217, v123
  v_perm_b32 v120, v109, v108, s70
  v_accvgpr_write_b32 a90, v120
  v_perm_b32 v121, v109, v108, s71
  v_accvgpr_write_b32 a218, v121
  v_perm_b32 v122, v111, v110, s70
  v_accvgpr_write_b32 a91, v122
  v_perm_b32 v123, v111, v110, s71
  v_accvgpr_write_b32 a219, v123
  v_perm_b32 v120, v113, v112, s70
  v_accvgpr_write_b32 a92, v120
  v_perm_b32 v121, v113, v112, s71
  v_accvgpr_write_b32 a220, v121
  v_perm_b32 v122, v115, v114, s70
  v_accvgpr_write_b32 a93, v122
  v_perm_b32 v123, v115, v114, s71
  v_accvgpr_write_b32 a221, v123
  v_perm_b32 v120, v117, v116, s70
  v_accvgpr_write_b32 a94, v120
  v_perm_b32 v121, v117, v116, s71
  v_accvgpr_write_b32 a222, v121
  v_perm_b32 v122, v119, v118, s70
  v_accvgpr_write_b32 a95, v122
  v_perm_b32 v123, v119, v118, s71
  v_accvgpr_write_b32 a223, v123
  s_mov_b32 s72, 3932160
  buffer_load_dword v72, v4, s[48:51], s72 offen
  s_mov_b32 s73, 3940352
  buffer_load_dword v73, v4, s[48:51], s73 offen
  s_mov_b32 s72, 3948544
  buffer_load_dword v74, v4, s[48:51], s72 offen
  s_mov_b32 s73, 3956736
  buffer_load_dword v75, v4, s[48:51], s73 offen
  s_mov_b32 s72, 3964928
  buffer_load_dword v76, v4, s[48:51], s72 offen
  s_mov_b32 s73, 3973120
  buffer_load_dword v77, v4, s[48:51], s73 offen
  s_mov_b32 s72, 3981312
  buffer_load_dword v78, v4, s[48:51], s72 offen
  s_mov_b32 s73, 3989504
  buffer_load_dword v79, v4, s[48:51], s73 offen
  s_mov_b32 s72, 4063232
  buffer_load_dword v80, v4, s[48:51], s72 offen
  s_mov_b32 s73, 4071424
  buffer_load_dword v81, v4, s[48:51], s73 offen
  s_mov_b32 s72, 4079616
  buffer_load_dword v82, v4, s[48:51], s72 offen
  s_mov_b32 s73, 4087808
  buffer_load_dword v83, v4, s[48:51], s73 offen
  s_mov_b32 s72, 4096000
  buffer_load_dword v84, v4, s[48:51], s72 offen
  s_mov_b32 s73, 4104192
  buffer_load_dword v85, v4, s[48:51], s73 offen
  s_mov_b32 s72, 4112384
  buffer_load_dword v86, v4, s[48:51], s72 offen
  s_mov_b32 s73, 4120576
  buffer_load_dword v87, v4, s[48:51], s73 offen
  s_waitcnt vmcnt(16)
  v_perm_b32 v120, v25, v24, s70
  v_accvgpr_write_b32 a96, v120
  v_perm_b32 v121, v25, v24, s71
  v_accvgpr_write_b32 a224, v121
  v_perm_b32 v122, v27, v26, s70
  v_accvgpr_write_b32 a97, v122
  v_perm_b32 v123, v27, v26, s71
  v_accvgpr_write_b32 a225, v123
  v_perm_b32 v120, v29, v28, s70
  v_accvgpr_write_b32 a98, v120
  v_perm_b32 v121, v29, v28, s71
  v_accvgpr_write_b32 a226, v121
  v_perm_b32 v122, v31, v30, s70
  v_accvgpr_write_b32 a99, v122
  v_perm_b32 v123, v31, v30, s71
  v_accvgpr_write_b32 a227, v123
  v_perm_b32 v120, v33, v32, s70
  v_accvgpr_write_b32 a100, v120
  v_perm_b32 v121, v33, v32, s71
  v_accvgpr_write_b32 a228, v121
  v_perm_b32 v122, v35, v34, s70
  v_accvgpr_write_b32 a101, v122
  v_perm_b32 v123, v35, v34, s71
  v_accvgpr_write_b32 a229, v123
  v_perm_b32 v120, v37, v36, s70
  v_accvgpr_write_b32 a102, v120
  v_perm_b32 v121, v37, v36, s71
  v_accvgpr_write_b32 a230, v121
  v_perm_b32 v122, v39, v38, s70
  v_accvgpr_write_b32 a103, v122
  v_perm_b32 v123, v39, v38, s71
  v_accvgpr_write_b32 a231, v123
  v_perm_b32 v120, v41, v40, s70
  v_accvgpr_write_b32 a104, v120
  v_perm_b32 v121, v41, v40, s71
  v_accvgpr_write_b32 a232, v121
  v_perm_b32 v122, v43, v42, s70
  v_accvgpr_write_b32 a105, v122
  v_perm_b32 v123, v43, v42, s71
  v_accvgpr_write_b32 a233, v123
  v_perm_b32 v120, v45, v44, s70
  v_accvgpr_write_b32 a106, v120
  v_perm_b32 v121, v45, v44, s71
  v_accvgpr_write_b32 a234, v121
  v_perm_b32 v122, v47, v46, s70
  v_accvgpr_write_b32 a107, v122
  v_perm_b32 v123, v47, v46, s71
  v_accvgpr_write_b32 a235, v123
  v_perm_b32 v120, v49, v48, s70
  v_accvgpr_write_b32 a108, v120
  v_perm_b32 v121, v49, v48, s71
  v_accvgpr_write_b32 a236, v121
  v_perm_b32 v122, v51, v50, s70
  v_accvgpr_write_b32 a109, v122
  v_perm_b32 v123, v51, v50, s71
  v_accvgpr_write_b32 a237, v123
  v_perm_b32 v120, v53, v52, s70
  v_accvgpr_write_b32 a110, v120
  v_perm_b32 v121, v53, v52, s71
  v_accvgpr_write_b32 a238, v121
  v_perm_b32 v122, v55, v54, s70
  v_accvgpr_write_b32 a111, v122
  v_perm_b32 v123, v55, v54, s71
  v_accvgpr_write_b32 a239, v123
  v_perm_b32 v120, v57, v56, s70
  v_accvgpr_write_b32 a112, v120
  v_perm_b32 v121, v57, v56, s71
  v_accvgpr_write_b32 a240, v121
  v_perm_b32 v122, v59, v58, s70
  v_accvgpr_write_b32 a113, v122
  v_perm_b32 v123, v59, v58, s71
  v_accvgpr_write_b32 a241, v123
  v_perm_b32 v120, v61, v60, s70
  v_accvgpr_write_b32 a114, v120
  v_perm_b32 v121, v61, v60, s71
  v_accvgpr_write_b32 a242, v121
  v_perm_b32 v122, v63, v62, s70
  v_accvgpr_write_b32 a115, v122
  v_perm_b32 v123, v63, v62, s71
  v_accvgpr_write_b32 a243, v123
  v_perm_b32 v120, v65, v64, s70
  v_accvgpr_write_b32 a116, v120
  v_perm_b32 v121, v65, v64, s71
  v_accvgpr_write_b32 a244, v121
  v_perm_b32 v122, v67, v66, s70
  v_accvgpr_write_b32 a117, v122
  v_perm_b32 v123, v67, v66, s71
  v_accvgpr_write_b32 a245, v123
  v_perm_b32 v120, v69, v68, s70
  v_accvgpr_write_b32 a118, v120
  v_perm_b32 v121, v69, v68, s71
  v_accvgpr_write_b32 a246, v121
  v_perm_b32 v122, v71, v70, s70
  v_accvgpr_write_b32 a119, v122
  v_perm_b32 v123, v71, v70, s71
  v_accvgpr_write_b32 a247, v123
  s_waitcnt vmcnt(0)
  v_perm_b32 v120, v73, v72, s70
  v_accvgpr_write_b32 a120, v120
  v_perm_b32 v121, v73, v72, s71
  v_accvgpr_write_b32 a248, v121
  v_perm_b32 v122, v75, v74, s70
  v_accvgpr_write_b32 a121, v122
  v_perm_b32 v123, v75, v74, s71
  v_accvgpr_write_b32 a249, v123
  v_perm_b32 v120, v77, v76, s70
  v_accvgpr_write_b32 a122, v120
  v_perm_b32 v121, v77, v76, s71
  v_accvgpr_write_b32 a250, v121
  v_perm_b32 v122, v79, v78, s70
  v_accvgpr_write_b32 a123, v122
  v_perm_b32 v123, v79, v78, s71
  v_accvgpr_write_b32 a251, v123
  v_perm_b32 v120, v81, v80, s70
  v_accvgpr_write_b32 a124, v120
  v_perm_b32 v121, v81, v80, s71
  v_accvgpr_write_b32 a252, v121
  v_perm_b32 v122, v83, v82, s70
  v_accvgpr_write_b32 a125, v122
  v_perm_b32 v123, v83, v82, s71
  v_accvgpr_write_b32 a253, v123
  v_perm_b32 v120, v85, v84, s70
  v_accvgpr_write_b32 a126, v120
  v_perm_b32 v121, v85, v84, s71
  v_accvgpr_write_b32 a254, v121
  v_perm_b32 v122, v87, v86, s70
  v_accvgpr_write_b32 a127, v122
  v_perm_b32 v123, v87, v86, s71
  v_accvgpr_write_b32 a255, v123
  s_mov_b32 s72, 0
  buffer_load_dword v24, v5, s[52:55], s72 offen
  s_mov_b32 s73, 8192
  buffer_load_dword v25, v5, s[52:55], s73 offen
  s_mov_b32 s72, 16384
  buffer_load_dword v26, v5, s[52:55], s72 offen
  s_mov_b32 s73, 24576
  buffer_load_dword v27, v5, s[52:55], s73 offen
  s_mov_b32 s72, 32768
  buffer_load_dword v28, v5, s[52:55], s72 offen
  s_mov_b32 s73, 40960
  buffer_load_dword v29, v5, s[52:55], s73 offen
  s_mov_b32 s72, 49152
  buffer_load_dword v30, v5, s[52:55], s72 offen
  s_mov_b32 s73, 57344
  buffer_load_dword v31, v5, s[52:55], s73 offen
  s_mov_b32 s72, 131072
  buffer_load_dword v32, v5, s[52:55], s72 offen
  s_mov_b32 s73, 139264
  buffer_load_dword v33, v5, s[52:55], s73 offen
  s_mov_b32 s72, 147456
  buffer_load_dword v34, v5, s[52:55], s72 offen
  s_mov_b32 s73, 155648
  buffer_load_dword v35, v5, s[52:55], s73 offen
  s_mov_b32 s72, 163840
  buffer_load_dword v36, v5, s[52:55], s72 offen
  s_mov_b32 s73, 172032
  buffer_load_dword v37, v5, s[52:55], s73 offen
  s_mov_b32 s72, 180224
  buffer_load_dword v38, v5, s[52:55], s72 offen
  s_mov_b32 s73, 188416
  buffer_load_dword v39, v5, s[52:55], s73 offen
  s_mov_b32 s72, 262144
  buffer_load_dword v40, v5, s[52:55], s72 offen
  s_mov_b32 s73, 270336
  buffer_load_dword v41, v5, s[52:55], s73 offen
  s_mov_b32 s72, 278528
  buffer_load_dword v42, v5, s[52:55], s72 offen
  s_mov_b32 s73, 286720
  buffer_load_dword v43, v5, s[52:55], s73 offen
  s_mov_b32 s72, 294912
  buffer_load_dword v44, v5, s[52:55], s72 offen
  s_mov_b32 s73, 303104
  buffer_load_dword v45, v5, s[52:55], s73 offen
  s_mov_b32 s72, 311296
  buffer_load_dword v46, v5, s[52:55], s72 offen
  s_mov_b32 s73, 319488
  buffer_load_dword v47, v5, s[52:55], s73 offen
  s_mov_b32 s72, 393216
  buffer_load_dword v48, v5, s[52:55], s72 offen
  s_mov_b32 s73, 401408
  buffer_load_dword v49, v5, s[52:55], s73 offen
  s_mov_b32 s72, 409600
  buffer_load_dword v50, v5, s[52:55], s72 offen
  s_mov_b32 s73, 417792
  buffer_load_dword v51, v5, s[52:55], s73 offen
  s_mov_b32 s72, 425984
  buffer_load_dword v52, v5, s[52:55], s72 offen
  s_mov_b32 s73, 434176
  buffer_load_dword v53, v5, s[52:55], s73 offen
  s_mov_b32 s72, 442368
  buffer_load_dword v54, v5, s[52:55], s72 offen
  s_mov_b32 s73, 450560
  buffer_load_dword v55, v5, s[52:55], s73 offen
  s_mov_b32 s72, 524288
  buffer_load_dword v56, v5, s[52:55], s72 offen
  s_mov_b32 s73, 532480
  buffer_load_dword v57, v5, s[52:55], s73 offen
  s_mov_b32 s72, 540672
  buffer_load_dword v58, v5, s[52:55], s72 offen
  s_mov_b32 s73, 548864
  buffer_load_dword v59, v5, s[52:55], s73 offen
  s_mov_b32 s72, 557056
  buffer_load_dword v60, v5, s[52:55], s72 offen
  s_mov_b32 s73, 565248
  buffer_load_dword v61, v5, s[52:55], s73 offen
  s_mov_b32 s72, 573440
  buffer_load_dword v62, v5, s[52:55], s72 offen
  s_mov_b32 s73, 581632
  buffer_load_dword v63, v5, s[52:55], s73 offen
  s_mov_b32 s72, 655360
  buffer_load_dword v64, v5, s[52:55], s72 offen
  s_mov_b32 s73, 663552
  buffer_load_dword v65, v5, s[52:55], s73 offen
  s_mov_b32 s72, 671744
  buffer_load_dword v66, v5, s[52:55], s72 offen
  s_mov_b32 s73, 679936
  buffer_load_dword v67, v5, s[52:55], s73 offen
  s_mov_b32 s72, 688128
  buffer_load_dword v68, v5, s[52:55], s72 offen
  s_mov_b32 s73, 696320
  buffer_load_dword v69, v5, s[52:55], s73 offen
  s_mov_b32 s72, 704512
  buffer_load_dword v70, v5, s[52:55], s72 offen
  s_mov_b32 s73, 712704
  buffer_load_dword v71, v5, s[52:55], s73 offen
  s_mov_b32 s72, 786432
  buffer_load_dword v72, v5, s[52:55], s72 offen
  s_mov_b32 s73, 794624
  buffer_load_dword v73, v5, s[52:55], s73 offen
  s_mov_b32 s72, 802816
  buffer_load_dword v74, v5, s[52:55], s72 offen
  s_mov_b32 s73, 811008
  buffer_load_dword v75, v5, s[52:55], s73 offen
  s_mov_b32 s72, 819200
  buffer_load_dword v76, v5, s[52:55], s72 offen
  s_mov_b32 s73, 827392
  buffer_load_dword v77, v5, s[52:55], s73 offen
  s_mov_b32 s72, 835584
  buffer_load_dword v78, v5, s[52:55], s72 offen
  s_mov_b32 s73, 843776
  buffer_load_dword v79, v5, s[52:55], s73 offen
  s_mov_b32 s72, 917504
  buffer_load_dword v80, v5, s[52:55], s72 offen
  s_mov_b32 s73, 925696
  buffer_load_dword v81, v5, s[52:55], s73 offen
  s_mov_b32 s72, 933888
  buffer_load_dword v82, v5, s[52:55], s72 offen
  s_mov_b32 s73, 942080
  buffer_load_dword v83, v5, s[52:55], s73 offen
  s_mov_b32 s72, 950272
  buffer_load_dword v84, v5, s[52:55], s72 offen
  s_mov_b32 s73, 958464
  buffer_load_dword v85, v5, s[52:55], s73 offen
  s_mov_b32 s72, 966656
  buffer_load_dword v86, v5, s[52:55], s72 offen
  s_mov_b32 s73, 974848
  buffer_load_dword v87, v5, s[52:55], s73 offen
  s_mov_b32 s72, 1048576
  buffer_load_dword v88, v5, s[52:55], s72 offen
  s_mov_b32 s73, 1056768
  buffer_load_dword v89, v5, s[52:55], s73 offen
  s_mov_b32 s72, 1064960
  buffer_load_dword v90, v5, s[52:55], s72 offen
  s_mov_b32 s73, 1073152
  buffer_load_dword v91, v5, s[52:55], s73 offen
  s_mov_b32 s72, 1081344
  buffer_load_dword v92, v5, s[52:55], s72 offen
  s_mov_b32 s73, 1089536
  buffer_load_dword v93, v5, s[52:55], s73 offen
  s_mov_b32 s72, 1097728
  buffer_load_dword v94, v5, s[52:55], s72 offen
  s_mov_b32 s73, 1105920
  buffer_load_dword v95, v5, s[52:55], s73 offen
  s_mov_b32 s72, 1179648
  buffer_load_dword v96, v5, s[52:55], s72 offen
  s_mov_b32 s73, 1187840
  buffer_load_dword v97, v5, s[52:55], s73 offen
  s_mov_b32 s72, 1196032
  buffer_load_dword v98, v5, s[52:55], s72 offen
  s_mov_b32 s73, 1204224
  buffer_load_dword v99, v5, s[52:55], s73 offen
  s_mov_b32 s72, 1212416
  buffer_load_dword v100, v5, s[52:55], s72 offen
  s_mov_b32 s73, 1220608
  buffer_load_dword v101, v5, s[52:55], s73 offen
  s_mov_b32 s72, 1228800
  buffer_load_dword v102, v5, s[52:55], s72 offen
  s_mov_b32 s73, 1236992
  buffer_load_dword v103, v5, s[52:55], s73 offen
  s_mov_b32 s72, 1310720
  buffer_load_dword v104, v5, s[52:55], s72 offen
  s_mov_b32 s73, 1318912
  buffer_load_dword v105, v5, s[52:55], s73 offen
  s_mov_b32 s72, 1327104
  buffer_load_dword v106, v5, s[52:55], s72 offen
  s_mov_b32 s73, 1335296
  buffer_load_dword v107, v5, s[52:55], s73 offen
  s_mov_b32 s72, 1343488
  buffer_load_dword v108, v5, s[52:55], s72 offen
  s_mov_b32 s73, 1351680
  buffer_load_dword v109, v5, s[52:55], s73 offen
  s_mov_b32 s72, 1359872
  buffer_load_dword v110, v5, s[52:55], s72 offen
  s_mov_b32 s73, 1368064
  buffer_load_dword v111, v5, s[52:55], s73 offen
  s_mov_b32 s72, 1441792
  buffer_load_dword v112, v5, s[52:55], s72 offen
  s_mov_b32 s73, 1449984
  buffer_load_dword v113, v5, s[52:55], s73 offen
  s_mov_b32 s72, 1458176
  buffer_load_dword v114, v5, s[52:55], s72 offen
  s_mov_b32 s73, 1466368
  buffer_load_dword v115, v5, s[52:55], s73 offen
  s_mov_b32 s72, 1474560
  buffer_load_dword v116, v5, s[52:55], s72 offen
  s_mov_b32 s73, 1482752
  buffer_load_dword v117, v5, s[52:55], s73 offen
  s_mov_b32 s72, 1490944
  buffer_load_dword v118, v5, s[52:55], s72 offen
  s_mov_b32 s73, 1499136
  buffer_load_dword v119, v5, s[52:55], s73 offen
  s_waitcnt vmcnt(48)
  v_perm_b32 v128, v25, v24, v7
  v_perm_b32 v129, v27, v26, v7
  v_perm_b32 v130, v29, v28, v7
  v_perm_b32 v131, v31, v30, v7
  v_perm_b32 v132, v33, v32, v7
  v_perm_b32 v133, v35, v34, v7
  v_perm_b32 v134, v37, v36, v7
  v_perm_b32 v135, v39, v38, v7
  v_perm_b32 v136, v41, v40, v7
  v_perm_b32 v137, v43, v42, v7
  v_perm_b32 v138, v45, v44, v7
  v_perm_b32 v139, v47, v46, v7
  v_perm_b32 v140, v49, v48, v7
  v_perm_b32 v141, v51, v50, v7
  v_perm_b32 v142, v53, v52, v7
  v_perm_b32 v143, v55, v54, v7
  v_perm_b32 v144, v57, v56, v7
  v_perm_b32 v145, v59, v58, v7
  v_perm_b32 v146, v61, v60, v7
  v_perm_b32 v147, v63, v62, v7
  v_perm_b32 v148, v65, v64, v7
  v_perm_b32 v149, v67, v66, v7
  v_perm_b32 v150, v69, v68, v7
  v_perm_b32 v151, v71, v70, v7
  s_mov_b32 s72, 1572864
  buffer_load_dword v24, v5, s[52:55], s72 offen
  s_mov_b32 s73, 1581056
  buffer_load_dword v25, v5, s[52:55], s73 offen
  s_mov_b32 s72, 1589248
  buffer_load_dword v26, v5, s[52:55], s72 offen
  s_mov_b32 s73, 1597440
  buffer_load_dword v27, v5, s[52:55], s73 offen
  s_mov_b32 s72, 1605632
  buffer_load_dword v28, v5, s[52:55], s72 offen
  s_mov_b32 s73, 1613824
  buffer_load_dword v29, v5, s[52:55], s73 offen
  s_mov_b32 s72, 1622016
  buffer_load_dword v30, v5, s[52:55], s72 offen
  s_mov_b32 s73, 1630208
  buffer_load_dword v31, v5, s[52:55], s73 offen
  s_mov_b32 s72, 1703936
  buffer_load_dword v32, v5, s[52:55], s72 offen
  s_mov_b32 s73, 1712128
  buffer_load_dword v33, v5, s[52:55], s73 offen
  s_mov_b32 s72, 1720320
  buffer_load_dword v34, v5, s[52:55], s72 offen
  s_mov_b32 s73, 1728512
  buffer_load_dword v35, v5, s[52:55], s73 offen
  s_mov_b32 s72, 1736704
  buffer_load_dword v36, v5, s[52:55], s72 offen
  s_mov_b32 s73, 1744896
  buffer_load_dword v37, v5, s[52:55], s73 offen
  s_mov_b32 s72, 1753088
  buffer_load_dword v38, v5, s[52:55], s72 offen
  s_mov_b32 s73, 1761280
  buffer_load_dword v39, v5, s[52:55], s73 offen
  s_mov_b32 s72, 1835008
  buffer_load_dword v40, v5, s[52:55], s72 offen
  s_mov_b32 s73, 1843200
  buffer_load_dword v41, v5, s[52:55], s73 offen
  s_mov_b32 s72, 1851392
  buffer_load_dword v42, v5, s[52:55], s72 offen
  s_mov_b32 s73, 1859584
  buffer_load_dword v43, v5, s[52:55], s73 offen
  s_mov_b32 s72, 1867776
  buffer_load_dword v44, v5, s[52:55], s72 offen
  s_mov_b32 s73, 1875968
  buffer_load_dword v45, v5, s[52:55], s73 offen
  s_mov_b32 s72, 1884160
  buffer_load_dword v46, v5, s[52:55], s72 offen
  s_mov_b32 s73, 1892352
  buffer_load_dword v47, v5, s[52:55], s73 offen
  s_mov_b32 s72, 1966080
  buffer_load_dword v48, v5, s[52:55], s72 offen
  s_mov_b32 s73, 1974272
  buffer_load_dword v49, v5, s[52:55], s73 offen
  s_mov_b32 s72, 1982464
  buffer_load_dword v50, v5, s[52:55], s72 offen
  s_mov_b32 s73, 1990656
  buffer_load_dword v51, v5, s[52:55], s73 offen
  s_mov_b32 s72, 1998848
  buffer_load_dword v52, v5, s[52:55], s72 offen
  s_mov_b32 s73, 2007040
  buffer_load_dword v53, v5, s[52:55], s73 offen
  s_mov_b32 s72, 2015232
  buffer_load_dword v54, v5, s[52:55], s72 offen
  s_mov_b32 s73, 2023424
  buffer_load_dword v55, v5, s[52:55], s73 offen
  s_mov_b32 s72, 2097152
  buffer_load_dword v56, v5, s[52:55], s72 offen
  s_mov_b32 s73, 2105344
  buffer_load_dword v57, v5, s[52:55], s73 offen
  s_mov_b32 s72, 2113536
  buffer_load_dword v58, v5, s[52:55], s72 offen
  s_mov_b32 s73, 2121728
  buffer_load_dword v59, v5, s[52:55], s73 offen
  s_mov_b32 s72, 2129920
  buffer_load_dword v60, v5, s[52:55], s72 offen
  s_mov_b32 s73, 2138112
  buffer_load_dword v61, v5, s[52:55], s73 offen
  s_mov_b32 s72, 2146304
  buffer_load_dword v62, v5, s[52:55], s72 offen
  s_mov_b32 s73, 2154496
  buffer_load_dword v63, v5, s[52:55], s73 offen
  s_mov_b32 s72, 2228224
  buffer_load_dword v64, v5, s[52:55], s72 offen
  s_mov_b32 s73, 2236416
  buffer_load_dword v65, v5, s[52:55], s73 offen
  s_mov_b32 s72, 2244608
  buffer_load_dword v66, v5, s[52:55], s72 offen
  s_mov_b32 s73, 2252800
  buffer_load_dword v67, v5, s[52:55], s73 offen
  s_mov_b32 s72, 2260992
  buffer_load_dword v68, v5, s[52:55], s72 offen
  s_mov_b32 s73, 2269184
  buffer_load_dword v69, v5, s[52:55], s73 offen
  s_mov_b32 s72, 2277376
  buffer_load_dword v70, v5, s[52:55], s72 offen
  s_mov_b32 s73, 2285568
  buffer_load_dword v71, v5, s[52:55], s73 offen
  s_waitcnt vmcnt(48)
  v_perm_b32 v152, v73, v72, v7
  v_perm_b32 v153, v75, v74, v7
  v_perm_b32 v154, v77, v76, v7
  v_perm_b32 v155, v79, v78, v7
  v_perm_b32 v156, v81, v80, v7
  v_perm_b32 v157, v83, v82, v7
  v_perm_b32 v158, v85, v84, v7
  v_perm_b32 v159, v87, v86, v7
  v_perm_b32 v160, v89, v88, v7
  v_perm_b32 v161, v91, v90, v7
  v_perm_b32 v162, v93, v92, v7
  v_perm_b32 v163, v95, v94, v7
  v_perm_b32 v164, v97, v96, v7
  v_perm_b32 v165, v99, v98, v7
  v_perm_b32 v166, v101, v100, v7
  v_perm_b32 v167, v103, v102, v7
  v_perm_b32 v168, v105, v104, v7
  v_perm_b32 v169, v107, v106, v7
  v_perm_b32 v170, v109, v108, v7
  v_perm_b32 v171, v111, v110, v7
  v_perm_b32 v172, v113, v112, v7
  v_perm_b32 v173, v115, v114, v7
  v_perm_b32 v174, v117, v116, v7
  v_perm_b32 v175, v119, v118, v7
  s_mov_b32 s72, 2359296
  buffer_load_dword v72, v5, s[52:55], s72 offen
  s_mov_b32 s73, 2367488
  buffer_load_dword v73, v5, s[52:55], s73 offen
  s_mov_b32 s72, 2375680
  buffer_load_dword v74, v5, s[52:55], s72 offen
  s_mov_b32 s73, 2383872
  buffer_load_dword v75, v5, s[52:55], s73 offen
  s_mov_b32 s72, 2392064
  buffer_load_dword v76, v5, s[52:55], s72 offen
  s_mov_b32 s73, 2400256
  buffer_load_dword v77, v5, s[52:55], s73 offen
  s_mov_b32 s72, 2408448
  buffer_load_dword v78, v5, s[52:55], s72 offen
  s_mov_b32 s73, 2416640
  buffer_load_dword v79, v5, s[52:55], s73 offen
  s_mov_b32 s72, 2490368
  buffer_load_dword v80, v5, s[52:55], s72 offen
  s_mov_b32 s73, 2498560
  buffer_load_dword v81, v5, s[52:55], s73 offen
  s_mov_b32 s72, 2506752
  buffer_load_dword v82, v5, s[52:55], s72 offen
  s_mov_b32 s73, 2514944
  buffer_load_dword v83, v5, s[52:55], s73 offen
  s_mov_b32 s72, 2523136
  buffer_load_dword v84, v5, s[52:55], s72 offen
  s_mov_b32 s73, 2531328
  buffer_load_dword v85, v5, s[52:55], s73 offen
  s_mov_b32 s72, 2539520
  buffer_load_dword v86, v5, s[52:55], s72 offen
  s_mov_b32 s73, 2547712
  buffer_load_dword v87, v5, s[52:55], s73 offen
  s_mov_b32 s72, 2621440
  buffer_load_dword v88, v5, s[52:55], s72 offen
  s_mov_b32 s73, 2629632
  buffer_load_dword v89, v5, s[52:55], s73 offen
  s_mov_b32 s72, 2637824
  buffer_load_dword v90, v5, s[52:55], s72 offen
  s_mov_b32 s73, 2646016
  buffer_load_dword v91, v5, s[52:55], s73 offen
  s_mov_b32 s72, 2654208
  buffer_load_dword v92, v5, s[52:55], s72 offen
  s_mov_b32 s73, 2662400
  buffer_load_dword v93, v5, s[52:55], s73 offen
  s_mov_b32 s72, 2670592
  buffer_load_dword v94, v5, s[52:55], s72 offen
  s_mov_b32 s73, 2678784
  buffer_load_dword v95, v5, s[52:55], s73 offen
  s_mov_b32 s72, 2752512
  buffer_load_dword v96, v5, s[52:55], s72 offen
  s_mov_b32 s73, 2760704
  buffer_load_dword v97, v5, s[52:55], s73 offen
  s_mov_b32 s72, 2768896
  buffer_load_dword v98, v5, s[52:55], s72 offen
  s_mov_b32 s73, 2777088
  buffer_load_dword v99, v5, s[52:55], s73 offen
  s_mov_b32 s72, 2785280
  buffer_load_dword v100, v5, s[52:55], s72 offen
  s_mov_b32 s73, 2793472
  buffer_load_dword v101, v5, s[52:55], s73 offen
  s_mov_b32 s72, 2801664
  buffer_load_dword v102, v5, s[52:55], s72 offen
  s_mov_b32 s73, 2809856
  buffer_load_dword v103, v5, s[52:55], s73 offen
  s_mov_b32 s72, 2883584
  buffer_load_dword v104, v5, s[52:55], s72 offen
  s_mov_b32 s73, 2891776
  buffer_load_dword v105, v5, s[52:55], s73 offen
  s_mov_b32 s72, 2899968
  buffer_load_dword v106, v5, s[52:55], s72 offen
  s_mov_b32 s73, 2908160
  buffer_load_dword v107, v5, s[52:55], s73 offen
  s_mov_b32 s72, 2916352
  buffer_load_dword v108, v5, s[52:55], s72 offen
  s_mov_b32 s73, 2924544
  buffer_load_dword v109, v5, s[52:55], s73 offen
  s_mov_b32 s72, 2932736
  buffer_load_dword v110, v5, s[52:55], s72 offen
  s_mov_b32 s73, 2940928
  buffer_load_dword v111, v5, s[52:55], s73 offen
  s_mov_b32 s72, 3014656
  buffer_load_dword v112, v5, s[52:55], s72 offen
  s_mov_b32 s73, 3022848
  buffer_load_dword v113, v5, s[52:55], s73 offen
  s_mov_b32 s72, 3031040
  buffer_load_dword v114, v5, s[52:55], s72 offen
  s_mov_b32 s73, 3039232
  buffer_load_dword v115, v5, s[52:55], s73 offen
  s_mov_b32 s72, 3047424
  buffer_load_dword v116, v5, s[52:55], s72 offen
  s_mov_b32 s73, 3055616
  buffer_load_dword v117, v5, s[52:55], s73 offen
  s_mov_b32 s72, 3063808
  buffer_load_dword v118, v5, s[52:55], s72 offen
  s_mov_b32 s73, 3072000
  buffer_load_dword v119, v5, s[52:55], s73 offen
  s_waitcnt vmcnt(48)
  v_perm_b32 v176, v25, v24, v7
  v_perm_b32 v177, v27, v26, v7
  v_perm_b32 v178, v29, v28, v7
  v_perm_b32 v179, v31, v30, v7
  v_perm_b32 v180, v33, v32, v7
  v_perm_b32 v181, v35, v34, v7
  v_perm_b32 v182, v37, v36, v7
  v_perm_b32 v183, v39, v38, v7
  v_perm_b32 v184, v41, v40, v7
  v_perm_b32 v185, v43, v42, v7
  v_perm_b32 v186, v45, v44, v7
  v_perm_b32 v187, v47, v46, v7
  v_perm_b32 v188, v49, v48, v7
  v_perm_b32 v189, v51, v50, v7
  v_perm_b32 v190, v53, v52, v7
  v_perm_b32 v191, v55, v54, v7
  v_perm_b32 v192, v57, v56, v7
  v_perm_b32 v193, v59, v58, v7
  v_perm_b32 v194, v61, v60, v7
  v_perm_b32 v195, v63, v62, v7
  v_perm_b32 v196, v65, v64, v7
  v_perm_b32 v197, v67, v66, v7
  v_perm_b32 v198, v69, v68, v7
  v_perm_b32 v199, v71, v70, v7
  s_mov_b32 s72, 3145728
  buffer_load_dword v24, v5, s[52:55], s72 offen
  s_mov_b32 s73, 3153920
  buffer_load_dword v25, v5, s[52:55], s73 offen
  s_mov_b32 s72, 3162112
  buffer_load_dword v26, v5, s[52:55], s72 offen
  s_mov_b32 s73, 3170304
  buffer_load_dword v27, v5, s[52:55], s73 offen
  s_mov_b32 s72, 3178496
  buffer_load_dword v28, v5, s[52:55], s72 offen
  s_mov_b32 s73, 3186688
  buffer_load_dword v29, v5, s[52:55], s73 offen
  s_mov_b32 s72, 3194880
  buffer_load_dword v30, v5, s[52:55], s72 offen
  s_mov_b32 s73, 3203072
  buffer_load_dword v31, v5, s[52:55], s73 offen
  s_mov_b32 s72, 3276800
  buffer_load_dword v32, v5, s[52:55], s72 offen
  s_mov_b32 s73, 3284992
  buffer_load_dword v33, v5, s[52:55], s73 offen
  s_mov_b32 s72, 3293184
  buffer_load_dword v34, v5, s[52:55], s72 offen
  s_mov_b32 s73, 3301376
  buffer_load_dword v35, v5, s[52:55], s73 offen
  s_mov_b32 s72, 3309568
  buffer_load_dword v36, v5, s[52:55], s72 offen
  s_mov_b32 s73, 3317760
  buffer_load_dword v37, v5, s[52:55], s73 offen
  s_mov_b32 s72, 3325952
  buffer_load_dword v38, v5, s[52:55], s72 offen
  s_mov_b32 s73, 3334144
  buffer_load_dword v39, v5, s[52:55], s73 offen
  s_mov_b32 s72, 3407872
  buffer_load_dword v40, v5, s[52:55], s72 offen
  s_mov_b32 s73, 3416064
  buffer_load_dword v41, v5, s[52:55], s73 offen
  s_mov_b32 s72, 3424256
  buffer_load_dword v42, v5, s[52:55], s72 offen
  s_mov_b32 s73, 3432448
  buffer_load_dword v43, v5, s[52:55], s73 offen
  s_mov_b32 s72, 3440640
  buffer_load_dword v44, v5, s[52:55], s72 offen
  s_mov_b32 s73, 3448832
  buffer_load_dword v45, v5, s[52:55], s73 offen
  s_mov_b32 s72, 3457024
  buffer_load_dword v46, v5, s[52:55], s72 offen
  s_mov_b32 s73, 3465216
  buffer_load_dword v47, v5, s[52:55], s73 offen
  s_mov_b32 s72, 3538944
  buffer_load_dword v48, v5, s[52:55], s72 offen
  s_mov_b32 s73, 3547136
  buffer_load_dword v49, v5, s[52:55], s73 offen
  s_mov_b32 s72, 3555328
  buffer_load_dword v50, v5, s[52:55], s72 offen
  s_mov_b32 s73, 3563520
  buffer_load_dword v51, v5, s[52:55], s73 offen
  s_mov_b32 s72, 3571712
  buffer_load_dword v52, v5, s[52:55], s72 offen
  s_mov_b32 s73, 3579904
  buffer_load_dword v53, v5, s[52:55], s73 offen
  s_mov_b32 s72, 3588096
  buffer_load_dword v54, v5, s[52:55], s72 offen
  s_mov_b32 s73, 3596288
  buffer_load_dword v55, v5, s[52:55], s73 offen
  s_mov_b32 s72, 3670016
  buffer_load_dword v56, v5, s[52:55], s72 offen
  s_mov_b32 s73, 3678208
  buffer_load_dword v57, v5, s[52:55], s73 offen
  s_mov_b32 s72, 3686400
  buffer_load_dword v58, v5, s[52:55], s72 offen
  s_mov_b32 s73, 3694592
  buffer_load_dword v59, v5, s[52:55], s73 offen
  s_mov_b32 s72, 3702784
  buffer_load_dword v60, v5, s[52:55], s72 offen
  s_mov_b32 s73, 3710976
  buffer_load_dword v61, v5, s[52:55], s73 offen
  s_mov_b32 s72, 3719168
  buffer_load_dword v62, v5, s[52:55], s72 offen
  s_mov_b32 s73, 3727360
  buffer_load_dword v63, v5, s[52:55], s73 offen
  s_mov_b32 s72, 3801088
  buffer_load_dword v64, v5, s[52:55], s72 offen
  s_mov_b32 s73, 3809280
  buffer_load_dword v65, v5, s[52:55], s73 offen
  s_mov_b32 s72, 3817472
  buffer_load_dword v66, v5, s[52:55], s72 offen
  s_mov_b32 s73, 3825664
  buffer_load_dword v67, v5, s[52:55], s73 offen
  s_mov_b32 s72, 3833856
  buffer_load_dword v68, v5, s[52:55], s72 offen
  s_mov_b32 s73, 3842048
  buffer_load_dword v69, v5, s[52:55], s73 offen
  s_mov_b32 s72, 3850240
  buffer_load_dword v70, v5, s[52:55], s72 offen
  s_mov_b32 s73, 3858432
  buffer_load_dword v71, v5, s[52:55], s73 offen
  s_waitcnt vmcnt(48)
  v_perm_b32 v200, v73, v72, v7
  v_perm_b32 v201, v75, v74, v7
  v_perm_b32 v202, v77, v76, v7
  v_perm_b32 v203, v79, v78, v7
  v_perm_b32 v204, v81, v80, v7
  v_perm_b32 v205, v83, v82, v7
  v_perm_b32 v206, v85, v84, v7
  v_perm_b32 v207, v87, v86, v7
  v_perm_b32 v208, v89, v88, v7
  v_perm_b32 v209, v91, v90, v7
  v_perm_b32 v210, v93, v92, v7
  v_perm_b32 v211, v95, v94, v7
  v_perm_b32 v212, v97, v96, v7
  v_perm_b32 v213, v99, v98, v7
  v_perm_b32 v214, v101, v100, v7
  v_perm_b32 v215, v103, v102, v7
  v_perm_b32 v216, v105, v104, v7
  v_perm_b32 v217, v107, v106, v7
  v_perm_b32 v218, v109, v108, v7
  v_perm_b32 v219, v111, v110, v7
  v_perm_b32 v220, v113, v112, v7
  v_perm_b32 v221, v115, v114, v7
  v_perm_b32 v222, v117, v116, v7
  v_perm_b32 v223, v119, v118, v7
  s_mov_b32 s72, 3932160
  buffer_load_dword v72, v5, s[52:55], s72 offen
  s_mov_b32 s73, 3940352
  buffer_load_dword v73, v5, s[52:55], s73 offen
  s_mov_b32 s72, 3948544
  buffer_load_dword v74, v5, s[52:55], s72 offen
  s_mov_b32 s73, 3956736
  buffer_load_dword v75, v5, s[52:55], s73 offen
  s_mov_b32 s72, 3964928
  buffer_load_dword v76, v5, s[52:55], s72 offen
  s_mov_b32 s73, 3973120
  buffer_load_dword v77, v5, s[52:55], s73 offen
  s_mov_b32 s72, 3981312
  buffer_load_dword v78, v5, s[52:55], s72 offen
  s_mov_b32 s73, 3989504
  buffer_load_dword v79, v5, s[52:55], s73 offen
  s_mov_b32 s72, 4063232
  buffer_load_dword v80, v5, s[52:55], s72 offen
  s_mov_b32 s73, 4071424
  buffer_load_dword v81, v5, s[52:55], s73 offen
  s_mov_b32 s72, 4079616
  buffer_load_dword v82, v5, s[52:55], s72 offen
  s_mov_b32 s73, 4087808
  buffer_load_dword v83, v5, s[52:55], s73 offen
  s_mov_b32 s72, 4096000
  buffer_load_dword v84, v5, s[52:55], s72 offen
  s_mov_b32 s73, 4104192
  buffer_load_dword v85, v5, s[52:55], s73 offen
  s_mov_b32 s72, 4112384
  buffer_load_dword v86, v5, s[52:55], s72 offen
  s_mov_b32 s73, 4120576
  buffer_load_dword v87, v5, s[52:55], s73 offen
  s_waitcnt vmcnt(16)
  v_perm_b32 v224, v25, v24, v7
  v_perm_b32 v225, v27, v26, v7
  v_perm_b32 v226, v29, v28, v7
  v_perm_b32 v227, v31, v30, v7
  v_perm_b32 v228, v33, v32, v7
  v_perm_b32 v229, v35, v34, v7
  v_perm_b32 v230, v37, v36, v7
  v_perm_b32 v231, v39, v38, v7
  v_perm_b32 v232, v41, v40, v7
  v_perm_b32 v233, v43, v42, v7
  v_perm_b32 v234, v45, v44, v7
  v_perm_b32 v235, v47, v46, v7
  v_perm_b32 v236, v49, v48, v7
  v_perm_b32 v237, v51, v50, v7
  v_perm_b32 v238, v53, v52, v7
  v_perm_b32 v239, v55, v54, v7
  v_perm_b32 v240, v57, v56, v7
  v_perm_b32 v241, v59, v58, v7
  v_perm_b32 v242, v61, v60, v7
  v_perm_b32 v243, v63, v62, v7
  v_perm_b32 v244, v65, v64, v7
  v_perm_b32 v245, v67, v66, v7
  v_perm_b32 v246, v69, v68, v7
  v_perm_b32 v247, v71, v70, v7
  s_waitcnt vmcnt(0)
  v_perm_b32 v248, v73, v72, v7
  v_perm_b32 v249, v75, v74, v7
  v_perm_b32 v250, v77, v76, v7
  v_perm_b32 v251, v79, v78, v7
  v_perm_b32 v252, v81, v80, v7
  v_perm_b32 v253, v83, v82, v7
  v_perm_b32 v254, v85, v84, v7
  v_perm_b32 v255, v87, v86, v7
  s_mov_b32 s60, s40
  s_mov_b32 s61, s41
  s_mov_b32 s62, 256
  s_mov_b32 s63, 0x00020000
iw_16:
  buffer_load_dword v24, off, s[60:63], 0 offset:192 sc1
  s_waitcnt vmcnt(0)
  v_readfirstlane_b32 s72, v24
  s_nop 0
  s_cmp_ge_u32 s72, 208
  s_nop 1
  s_cbranch_scc1 id_17
  s_sub_u32 s69, s69, 1
  s_cbranch_scc0 iw_16
  s_branch mega_exit
id_17:
  s_lshl_b32 s72, s66, 13
  v_lshlrev_b32 v4, 4, v1
  v_add_u32 v4, s72, v4
  s_lshl_b32 s72, s66, 3
  v_and_b32 v10, 31, v1
  v_xor_b32 v10, s72, v10
  v_lshlrev_b32 v5, 9, v1
  v_lshl_add_u32 v5, v10, 4, v5
  v_lshlrev_b32 v6, 4, v1
  v_and_b32 v12, 31, v1
  v_lshlrev_b32 v12, 2, v12
  v_add_u32 v12, 14704640, v12
  s_lshl_b32 s72, s64, 11
  s_add_u32 s72, s72, s65
  s_lshl_b32 s72, s72, 15
  v_add_u32 v10, s72, v6
  v_and_b32 v9, 1, v3
  v_lshlrev_b32 v9, 12, v9
  v_lshl_add_u32 v9, v2, 4, v9
  v_lshrrev_b32 v13, 5, v1
  v_lshl_add_u32 v9, v13, 8, v9
  v_add_u32 v9, s72, v9
  s_lshl_b32 s72, s64, 9
  s_lshl_b32 s73, s65, 4
  s_add_u32 s72, s72, s73
  s_lshl_b32 s73, s66, 2
  s_add_u32 s72, s72, s73
  s_add_u32 s72, s72, 14680064
  v_mov_b32 v11, s72
  s_lshl_b32 s80, s64, 21
  s_mov_b32 s81, s64
  s_mov_b32 s82, s80
  s_mov_b32 s85, 0
  v_mov_b32 v7, v5
  s_lshl_b32 s78, s66, 12
  s_add_u32 s78, s78, 134217728
  s_lshl_b32 s79, s66, 10
  s_add_u32 s79, s79, 134234112
  s_lshl_b32 s91, s65, 10
  s_add_u32 s91, s91, s80
  v_lshrrev_b32 v13, 5, v1
  v_lshlrev_b32 v13, 4, v13
  v_xor_b32 v6, v13, v6
  s_mov_b32 s84, s78
  s_mov_b32 s86, s79
  v_mov_b32 v14, 0
  s_nop 0
  s_branch kv_top_in
kv_top:
  s_and_b32 s72, s67, 1
  s_lshl_b32 s72, s72, 15
  v_add_u32 v8, s72, v6
  s_xor_b32 s72, s72, 32768
  v_add_u32 v7, s72, v5
  s_add_u32 s85, s67, 1
  s_min_u32 s85, s85, 63
  s_lshl_b32 s82, s85, 15
  s_add_u32 s82, s82, s80
  s_lshl_b32 s85, s85, 7
  s_cmp_lt_u32 s66, 2
  s_waitcnt lgkmcnt(0)
  s_barrier
  s_cbranch_scc0 kv_v
  v_xor_b32 v13, 0, v8
  ds_read_b128 v[96:99], v13 offset:0
  v_xor_b32 v13, 32, v8
  ds_read_b128 v[100:103], v13 offset:1024
  v_xor_b32 v13, 64, v8
  ds_read_b128 v[104:107], v13 offset:2048
  s_waitcnt lgkmcnt(2)
  v_mfma_f32_32x32x16_bf16 v[48:63], v[128:131], v[96:99], 0
  buffer_load_dword v14, v12, s[44:47], s85 offen sc1
  v_mfma_f32_32x32x16_bf16 v[16:31], a[0:3], v[96:99], 0
  buffer_store_dwordx4 v[112:115], v10, s[44:47], s84 offen offset:0 sc1
  v_mfma_f32_32x32x16_bf16 v[32:47], a[128:131], v[96:99], 0
  v_xor_b32 v13, 96, v8
  ds_read_b128 v[96:99], v13 offset:3072
  s_waitcnt lgkmcnt(2)
  v_mfma_f32_32x32x16_bf16 v[48:63], v[132:135], v[100:103], v[48:63]
  v_mfma_f32_32x32x16_bf16 v[16:31], a[4:7], v[100:103], v[16:31]
  buffer_store_dwordx4 v[116:119], v10, s[44:47], s84 offen offset:1024 sc1
  v_mfma_f32_32x32x16_bf16 v[32:47], a[132:135], v[100:103], v[32:47]
  v_xor_b32 v13, 128, v8
  ds_read_b128 v[100:103], v13 offset:4096
  s_waitcnt lgkmcnt(2)
  v_mfma_f32_32x32x16_bf16 v[48:63], v[136:139], v[104:107], v[48:63]
  v_mfma_f32_32x32x16_bf16 v[16:31], a[8:11], v[104:107], v[16:31]
  buffer_store_dwordx4 v[120:123], v10, s[44:47], s84 offen offset:2048 sc1
  v_mfma_f32_32x32x16_bf16 v[32:47], a[136:139], v[104:107], v[32:47]
  v_xor_b32 v13, 160, v8
  ds_read_b128 v[104:107], v13 offset:5120
  s_waitcnt lgkmcnt(2)
  v_mfma_f32_32x32x16_bf16 v[48:63], v[140:143], v[96:99], v[48:63]
  v_mfma_f32_32x32x16_bf16 v[16:31], a[12:15], v[96:99], v[16:31]
  buffer_store_dwordx4 v[124:127], v10, s[44:47], s84 offen offset:3072 sc1
  v_mfma_f32_32x32x16_bf16 v[32:47], a[140:143], v[96:99], v[32:47]
  v_xor_b32 v13, 192, v8
  ds_read_b128 v[96:99], v13 offset:6144
  s_waitcnt lgkmcnt(2)
  v_mfma_f32_32x32x16_bf16 v[48:63], v[144:147], v[100:103], v[48:63]
  v_mfma_f32_32x32x16_bf16 v[16:31], a[16:19], v[100:103], v[16:31]
  buffer_store_dwordx4 v[0:3], v9, s[44:47], s86 offen offset:0 sc1
  v_mfma_f32_32x32x16_bf16 v[32:47], a[144:147], v[100:103], v[32:47]
  v_xor_b32 v13, 224, v8
  ds_read_b128 v[100:103], v13 offset:7168
  s_waitcnt lgkmcnt(2)
  v_mfma_f32_32x32x16_bf16 v[48:63], v[148:151], v[104:107], v[48:63]
  v_mfma_f32_32x32x16_bf16 v[16:31], a[20:23], v[104:107], v[16:31]
  buffer_store_dwordx4 v[108:111], v9, s[44:47], s86 offen offset:512 sc1
  v_mfma_f32_32x32x16_bf16 v[32:47], a[148:151], v[104:107], v[32:47]
  v_xor_b32 v13, 256, v8
  ds_read_b128 v[104:107], v13 offset:8192
  s_waitcnt lgkmcnt(2)
  v_mfma_f32_32x32x16_bf16 v[48:63], v[152:155], v[96:99], v[48:63]
  s_lshl_b32 s84, s67, 20
  s_add_u32 s86, s84, s79
  s_add_u32 s84, s84, s78
  v_mfma_f32_32x32x16_bf16 v[16:31], a[24:27], v[96:99], v[16:31]
  v_mfma_f32_32x32x16_bf16 v[32:47], a[152:155], v[96:99], v[32:47]
  v_xor_b32 v13, 288, v8
  ds_read_b128 v[96:99], v13 offset:9216
  s_waitcnt lgkmcnt(2)
  v_mfma_f32_32x32x16_bf16 v[48:63], v[156:159], v[100:103], v[48:63]
  v_mfma_f32_32x32x16_bf16 v[16:31], a[28:31], v[100:103], v[16:31]
  v_mfma_f32_32x32x16_bf16 v[32:47], a[156:159], v[100:103], v[32:47]
  v_xor_b32 v13, 320, v8
  ds_read_b128 v[100:103], v13 offset:10240
  s_waitcnt lgkmcnt(2)
  v_mfma_f32_32x32x16_bf16 v[48:63], v[160:163], v[104:107], v[48:63]
  v_mfma_f32_32x32x16_bf16 v[16:31], a[32:35], v[104:107], v[16:31]
  v_mfma_f32_32x32x16_bf16 v[32:47], a[160:163], v[104:107], v[32:47]
  v_xor_b32 v13, 352, v8
  ds_read_b128 v[104:107], v13 offset:11264
  s_waitcnt lgkmcnt(2)
  v_mfma_f32_32x32x16_bf16 v[48:63], v[164:167], v[96:99], v[48:63]
  v_mfma_f32_32x32x16_bf16 v[16:31], a[36:39], v[96:99], v[16:31]
  v_mfma_f32_32x32x16_bf16 v[32:47], a[164:167], v[96:99], v[32:47]
  v_xor_b32 v13, 384, v8
  ds_read_b128 v[96:99], v13 offset:12288
  s_waitcnt lgkmcnt(2)
  v_mfma_f32_32x32x16_bf16 v[48:63], v[168:171], v[100:103], v[48:63]
  s_waitcnt vmcnt(6)
  v_cmp_gt_u32 vcc, s81, v14
  v_mfma_f32_32x32x16_bf16 v[16:31], a[40:43], v[100:103], v[16:31]
  s_cmp_eq_u64 vcc, 0
  s_cselect_b32 s83, 1, 0
  v_mfma_f32_32x32x16_bf16 v[32:47], a[168:171], v[100:103], v[32:47]
  s_cmp_eq_u32 s83, 1
  s_cbranch_scc0 c_18
  s_add_u32 s90, s82, 0
  buffer_load_dwordx4 v[64:67], v4, s[44:47], s90 offen offset:0
  buffer_load_dwordx4 v[68:71], v4, s[44:47], s90 offen offset:1024
c_18:
  v_xor_b32 v13, 416, v8
  ds_read_b128 v[100:103], v13 offset:13312
  s_waitcnt lgkmcnt(2)
  v_mfma_f32_32x32x16_bf16 v[48:63], v[172:175], v[104:107], v[48:63]
  v_mfma_f32_32x32x16_bf16 v[16:31], a[44:47], v[104:107], v[16:31]
  v_mfma_f32_32x32x16_bf16 v[32:47], a[172:175], v[104:107], v[32:47]
  v_xor_b32 v13, 448, v8
  ds_read_b128 v[104:107], v13 offset:14336
  s_waitcnt lgkmcnt(2)
  v_mfma_f32_32x32x16_bf16 v[48:63], v[176:179], v[96:99], v[48:63]
  v_mfma_f32_32x32x16_bf16 v[16:31], a[48:51], v[96:99], v[16:31]
  s_cmp_eq_u32 s83, 1
  s_cbranch_scc0 c_19
  s_add_u32 s90, s82, 2048
  buffer_load_dwordx4 v[72:75], v4, s[44:47], s90 offen offset:0
  buffer_load_dwordx4 v[76:79], v4, s[44:47], s90 offen offset:1024
c_19:
  v_mfma_f32_32x32x16_bf16 v[32:47], a[176:179], v[96:99], v[32:47]
  v_xor_b32 v13, 480, v8
  ds_read_b128 v[96:99], v13 offset:15360
  s_waitcnt lgkmcnt(2)
  v_mfma_f32_32x32x16_bf16 v[48:63], v[180:183], v[100:103], v[48:63]
  v_mfma_f32_32x32x16_bf16 v[16:31], a[52:55], v[100:103], v[16:31]
  v_mfma_f32_32x32x16_bf16 v[32:47], a[180:183], v[100:103], v[32:47]
  v_xor_b32 v13, 0, v8
  ds_read_b128 v[100:103], v13 offset:16384
  s_waitcnt lgkmcnt(2)
  v_mfma_f32_32x32x16_bf16 v[48:63], v[184:187], v[104:107], v[48:63]
  s_cmp_eq_u32 s83, 1
  s_cbranch_scc0 c_20
  s_add_u32 s90, s82, 4096
  buffer_load_dwordx4 v[80:83], v4, s[44:47], s90 offen offset:0
  buffer_load_dwordx4 v[84:87], v4, s[44:47], s90 offen offset:1024
c_20:
  v_mfma_f32_32x32x16_bf16 v[16:31], a[56:59], v[104:107], v[16:31]
  v_mfma_f32_32x32x16_bf16 v[32:47], a[184:187], v[104:107], v[32:47]
  v_xor_b32 v13, 32, v8
  ds_read_b128 v[104:107], v13 offset:17408
  s_waitcnt lgkmcnt(2)
  v_mfma_f32_32x32x16_bf16 v[48:63], v[188:191], v[96:99], v[48:63]
  v_mfma_f32_32x32x16_bf16 v[16:31], a[60:63], v[96:99], v[16:31]
  v_mfma_f32_32x32x16_bf16 v[32:47], a[188:191], v[96:99], v[32:47]
  s_cmp_eq_u32 s83, 1
  s_cbranch_scc0 c_21
  s_add_u32 s90, s82, 6144
  buffer_load_dwordx4 v[88:91], v4, s[44:47], s90 offen offset:0
  buffer_load_dwordx4 v[92:95], v4, s[44:47], s90 offen offset:1024
c_21:
  v_xor_b32 v13, 64, v8
  ds_read_b128 v[96:99], v13 offset:18432
  s_waitcnt lgkmcnt(2)
  v_mfma_f32_32x32x16_bf16 v[48:63], v[192:195], v[100:103], v[48:63]
  v_mfma_f32_32x32x16_bf16 v[16:31], a[64:67], v[100:103], v[16:31]
  v_mfma_f32_32x32x16_bf16 v[32:47], a[192:195], v[100:103], v[32:47]
  v_xor_b32 v13, 96, v8
  ds_read_b128 v[100:103], v13 offset:19456
  s_waitcnt lgkmcnt(2)
  v_mfma_f32_32x32x16_bf16 v[48:63], v[196:199], v[104:107], v[48:63]
  v_mfma_f32_32x32x16_bf16 v[16:31], a[68:71], v[104:107], v[16:31]
  v_mfma_f32_32x32x16_bf16 v[32:47], a[196:199], v[104:107], v[32:47]
  v_xor_b32 v13, 128, v8
  ds_read_b128 v[104:107], v13 offset:20480
  s_waitcnt lgkmcnt(2)
  v_mfma_f32_32x32x16_bf16 v[48:63], v[200:203], v[96:99], v[48:63]
  v_mfma_f32_32x32x16_bf16 v[16:31], a[72:75], v[96:99], v[16:31]
  v_mfma_f32_32x32x16_bf16 v[32:47], a[200:203], v[96:99], v[32:47]
  s_waitcnt vmcnt(8)
  s_cmp_eq_u32 s83, 1
  s_cbranch_scc1 pw_22
  s_waitcnt vmcnt(0)
pw_22:
  v_mov_b32 v15, s67
  s_mov_b64 exec, 1
  buffer_store_dword v15, v11, s[44:47], 0 offen sc1
  s_mov_b64 exec, -1
  v_xor_b32 v13, 160, v8
  ds_read_b128 v[96:99], v13 offset:21504
  s_waitcnt lgkmcnt(2)
  v_mfma_f32_32x32x16_bf16 v[48:63], v[204:207], v[100:103], v[48:63]
  v_mfma_f32_32x32x16_bf16 v[16:31], a[76:79], v[100:103], v[16:31]
  v_mfma_f32_32x32x16_bf16 v[32:47], a[204:207], v[100:103], v[32:47]
  v_xor_b32 v13, 192, v8
  ds_read_b128 v[100:103], v13 offset:22528
  s_waitcnt lgkmcnt(2)
  v_mfma_f32_32x32x16_bf16 v[48:63], v[208:211], v[104:107], v[48:63]
  v_mfma_f32_32x32x16_bf16 v[16:31], a[80:83], v[104:107], v[16:31]
  v_mfma_f32_32x32x16_bf16 v[32:47], a[208:211], v[104:107], v[32:47]
  v_xor_b32 v13, 224, v8
  ds_read_b128 v[104:107], v13 offset:23552
  s_waitcnt lgkmcnt(2)
  v_mfma_f32_32x32x16_bf16 v[48:63], v[212:215], v[96:99], v[48:63]
  v_mfma_f32_32x32x16_bf16 v[16:31], a[84:87], v[96:99], v[16:31]
  v_mfma_f32_32x32x16_bf16 v[32:47], a[212:215], v[96:99], v[32:47]
  v_xor_b32 v13, 256, v8
  ds_read_b128 v[96:99], v13 offset:24576
  s_waitcnt lgkmcnt(2)
  v_mfma_f32_32x32x16_bf16 v[48:63], v[216:219], v[100:103], v[48:63]
  v_mfma_f32_32x32x16_bf16 v[16:31], a[88:91], v[100:103], v[16:31]
  v_mfma_f32_32x32x16_bf16 v[32:47], a[216:219], v[100:103], v[32:47]
  v_xor_b32 v13, 288, v8
  ds_read_b128 v[100:103], v13 offset:25600
  s_waitcnt lgkmcnt(2)
  v_mfma_f32_32x32x16_bf16 v[48:63], v[220:223], v[104:107], v[48:63]
  v_mfma_f32_32x32x16_bf16 v[16:31], a[92:95], v[104:107], v[16:31]
  v_mfma_f32_32x32x16_bf16 v[32:47], a[220:223], v[104:107], v[32:47]
  v_xor_b32 v13, 320, v8
  ds_read_b128 v[104:107], v13 offset:26624
  s_waitcnt lgkmcnt(2)
  v_mfma_f32_32x32x16_bf16 v[48:63], v[224:227], v[96:99], v[48:63]
  v_mfma_f32_32x32x16_bf16 v[16:31], a[96:99], v[96:99], v[16:31]
  v_mfma_f32_32x32x16_bf16 v[32:47], a[224:227], v[96:99], v[32:47]
  v_xor_b32 v13, 352, v8
  ds_read_b128 v[96:99], v13 offset:27648
  s_waitcnt lgkmcnt(2)
  v_mfma_f32_32x32x16_bf16 v[48:63], v[228:231], v[100:103], v[48:63]
  v_mfma_f32_32x32x16_bf16 v[16:31], a[100:103], v[100:103], v[16:31]
  s_waitcnt vmcnt(1)
  v_mfma_f32_32x32x16_bf16 v[32:47], a[228:231], v[100:103], v[32:47]
  v_xor_b32 v13, 0, v7
  ds_write_b128 v13, v[64:67]
  v_xor_b32 v13, 384, v8
  ds_read_b128 v[100:103], v13 offset:28672
  s_waitcnt lgkmcnt(3)
  v_mfma_f32_32x32x16_bf16 v[48:63], v[232:235], v[104:107], v[48:63]
  v_mfma_f32_32x32x16_bf16 v[16:31], a[104:107], v[104:107], v[16:31]
  v_xor_b32 v13, 16, v7
  ds_write_b128 v13, v[68:71]
  v_mfma_f32_32x32x16_bf16 v[32:47], a[232:235], v[104:107], v[32:47]
  v_xor_b32 v13, 416, v8
  ds_read_b128 v[104:107], v13 offset:29696
  s_waitcnt lgkmcnt(4)
  v_mfma_f32_32x32x16_bf16 v[48:63], v[236:239], v[96:99], v[48:63]
  v_xor_b32 v13, 32, v7
  ds_write_b128 v13, v[72:75]
  v_mfma_f32_32x32x16_bf16 v[16:31], a[108:111], v[96:99], v[16:31]
  v_mfma_f32_32x32x16_bf16 v[32:47], a[236:239], v[96:99], v[32:47]
  v_xor_b32 v13, 48, v7
  ds_write_b128 v13, v[76:79]
  v_xor_b32 v13, 448, v8
  ds_read_b128 v[96:99], v13 offset:30720
  s_waitcnt lgkmcnt(5)
  v_mfma_f32_32x32x16_bf16 v[48:63], v[240:243], v[100:103], v[48:63]
  v_mfma_f32_32x32x16_bf16 v[16:31], a[112:115], v[100:103], v[16:31]
  v_xor_b32 v13, 64, v7
  ds_write_b128 v13, v[80:83]
  v_mfma_f32_32x32x16_bf16 v[32:47], a[240:243], v[100:103], v[32:47]
  v_xor_b32 v13, 480, v8
  ds_read_b128 v[100:103], v13 offset:31744
  s_waitcnt lgkmcnt(5)
  v_mfma_f32_32x32x16_bf16 v[48:63], v[244:247], v[104:107], v[48:63]
  v_xor_b32 v13, 80, v7
  ds_write_b128 v13, v[84:87]
  v_mfma_f32_32x32x16_bf16 v[16:31], a[116:119], v[104:107], v[16:31]
  v_mfma_f32_32x32x16_bf16 v[32:47], a[244:247], v[104:107], v[32:47]
  v_xor_b32 v13, 96, v7
  ds_write_b128 v13, v[88:91]
  s_waitcnt lgkmcnt(4)
  v_mfma_f32_32x32x16_bf16 v[48:63], v[248:251], v[96:99], v[48:63]
  v_mfma_f32_32x32x16_bf16 v[16:31], a[120:123], v[96:99], v[16:31]
  v_xor_b32 v13, 112, v7
  ds_write_b128 v13, v[92:95]
  v_mfma_f32_32x32x16_bf16 v[32:47], a[248:251], v[96:99], v[32:47]
  s_waitcnt lgkmcnt(3)
  v_mfma_f32_32x32x16_bf16 v[48:63], v[252:255], v[100:103], v[48:63]
  v_mfma_f32_32x32x16_bf16 v[16:31], a[124:127], v[100:103], v[16:31]
  v_mfma_f32_32x32x16_bf16 v[32:47], a[252:255], v[100:103], v[32:47]
  s_nop 9
  v_cvt_pk_bf16_f32 v0, v48, v49
  v_cvt_pk_bf16_f32 v1, v50, v51
  v_cvt_pk_bf16_f32 v2, v52, v53
  v_cvt_pk_bf16_f32 v3, v54, v55
  v_cvt_pk_bf16_f32 v108, v56, v57
  v_cvt_pk_bf16_f32 v109, v58, v59
  v_cvt_pk_bf16_f32 v110, v60, v61
  v_cvt_pk_bf16_f32 v111, v62, v63
  v_cvt_pk_bf16_f32 v112, v16, v32
  v_cvt_pk_bf16_f32 v113, v17, v33
  v_cvt_pk_bf16_f32 v114, v18, v34
  v_cvt_pk_bf16_f32 v115, v19, v35
  v_cvt_pk_bf16_f32 v116, v20, v36
  v_cvt_pk_bf16_f32 v117, v21, v37
  v_cvt_pk_bf16_f32 v118, v22, v38
  v_cvt_pk_bf16_f32 v119, v23, v39
  v_cvt_pk_bf16_f32 v120, v24, v40
  v_cvt_pk_bf16_f32 v121, v25, v41
  v_cvt_pk_bf16_f32 v122, v26, v42
  v_cvt_pk_bf16_f32 v123, v27, v43
  v_cvt_pk_bf16_f32 v124, v28, v44
  v_cvt_pk_bf16_f32 v125, v29, v45
  v_cvt_pk_bf16_f32 v126, v30, v46
  v_cvt_pk_bf16_f32 v127, v31, v47
  s_nop 0
  s_branch kv_j
kv_v:
  v_xor_b32 v13, 0, v8
  ds_read_b128 v[96:99], v13 offset:0
  v_xor_b32 v13, 32, v8
  ds_read_b128 v[100:103], v13 offset:1024
  v_xor_b32 v13, 64, v8
  ds_read_b128 v[104:107], v13 offset:2048
  s_waitcnt lgkmcnt(2)
  v_mfma_f32_32x32x16_bf16 v[48:63], v[128:131], v[96:99], 0
  buffer_load_dword v14, v12, s[44:47], s85 offen sc1
  v_mfma_f32_32x32x16_bf16 v[16:31], v[96:99], a[0:3], 0
  buffer_store_dwordx4 v[112:115], v10, s[44:47], s84 offen offset:0 sc1
  v_mfma_f32_32x32x16_bf16 v[32:47], v[96:99], a[128:131], 0
  v_xor_b32 v13, 96, v8
  ds_read_b128 v[96:99], v13 offset:3072
  s_waitcnt lgkmcnt(2)
  v_mfma_f32_32x32x16_bf16 v[48:63], v[132:135], v[100:103], v[48:63]
  v_mfma_f32_32x32x16_bf16 v[16:31], v[100:103], a[4:7], v[16:31]
  buffer_store_dwordx4 v[116:119], v10, s[44:47], s84 offen offset:1024 sc1
  v_mfma_f32_32x32x16_bf16 v[32:47], v[100:103], a[132:135], v[32:47]
  v_xor_b32 v13, 128, v8
  ds_read_b128 v[100:103], v13 offset:4096
  s_waitcnt lgkmcnt(2)
  v_mfma_f32_32x32x16_bf16 v[48:63], v[136:139], v[104:107], v[48:63]
  v_mfma_f32_32x32x16_bf16 v[16:31], v[104:107], a[8:11], v[16:31]
  buffer_store_dwordx4 v[120:123], v10, s[44:47], s84 offen offset:2048 sc1
  v_mfma_f32_32x32x16_bf16 v[32:47], v[104:107], a[136:139], v[32:47]
  v_xor_b32 v13, 160, v8
  ds_read_b128 v[104:107], v13 offset:5120
  s_waitcnt lgkmcnt(2)
  v_mfma_f32_32x32x16_bf16 v[48:63], v[140:143], v[96:99], v[48:63]
  v_mfma_f32_32x32x16_bf16 v[16:31], v[96:99], a[12:15], v[16:31]
  buffer_store_dwordx4 v[124:127], v10, s[44:47], s84 offen offset:3072 sc1
  v_mfma_f32_32x32x16_bf16 v[32:47], v[96:99], a[140:143], v[32:47]
  v_xor_b32 v13, 192, v8
  ds_read_b128 v[96:99], v13 offset:6144
  s_waitcnt lgkmcnt(2)
  v_mfma_f32_32x32x16_bf16 v[48:63], v[144:147], v[100:103], v[48:63]
  v_mfma_f32_32x32x16_bf16 v[16:31], v[100:103], a[16:19], v[16:31]
  buffer_store_dwordx4 v[0:3], v9, s[44:47], s86 offen offset:0 sc1
  v_mfma_f32_32x32x16_bf16 v[32:47], v[100:103], a[144:147], v[32:47]
  v_xor_b32 v13, 224, v8
  ds_read_b128 v[100:103], v13 offset:7168
  s_waitcnt lgkmcnt(2)
  v_mfma_f32_32x32x16_bf16 v[48:63], v[148:151], v[104:107], v[48:63]
  v_mfma_f32_32x32x16_bf16 v[16:31], v[104:107], a[20:23], v[16:31]
  buffer_store_dwordx4 v[108:111], v9, s[44:47], s86 offen offset:512 sc1
  v_mfma_f32_32x32x16_bf16 v[32:47], v[104:107], a[148:151], v[32:47]
  v_xor_b32 v13, 256, v8
  ds_read_b128 v[104:107], v13 offset:8192
  s_waitcnt lgkmcnt(2)
  v_mfma_f32_32x32x16_bf16 v[48:63], v[152:155], v[96:99], v[48:63]
  s_lshl_b32 s84, s67, 20
  s_add_u32 s86, s84, s79
  s_add_u32 s84, s84, s78
  v_mfma_f32_32x32x16_bf16 v[16:31], v[96:99], a[24:27], v[16:31]
  v_mfma_f32_32x32x16_bf16 v[32:47], v[96:99], a[152:155], v[32:47]
  v_xor_b32 v13, 288, v8
  ds_read_b128 v[96:99], v13 offset:9216
  s_waitcnt lgkmcnt(2)
  v_mfma_f32_32x32x16_bf16 v[48:63], v[156:159], v[100:103], v[48:63]
  v_mfma_f32_32x32x16_bf16 v[16:31], v[100:103], a[28:31], v[16:31]
  v_mfma_f32_32x32x16_bf16 v[32:47], v[100:103], a[156:159], v[32:47]
  v_xor_b32 v13, 320, v8
  ds_read_b128 v[100:103], v13 offset:10240
  s_waitcnt lgkmcnt(2)
  v_mfma_f32_32x32x16_bf16 v[48:63], v[160:163], v[104:107], v[48:63]
  v_mfma_f32_32x32x16_bf16 v[16:31], v[104:107], a[32:35], v[16:31]
  v_mfma_f32_32x32x16_bf16 v[32:47], v[104:107], a[160:163], v[32:47]
  v_xor_b32 v13, 352, v8
  ds_read_b128 v[104:107], v13 offset:11264
  s_waitcnt lgkmcnt(2)
  v_mfma_f32_32x32x16_bf16 v[48:63], v[164:167], v[96:99], v[48:63]
  v_mfma_f32_32x32x16_bf16 v[16:31], v[96:99], a[36:39], v[16:31]
  v_mfma_f32_32x32x16_bf16 v[32:47], v[96:99], a[164:167], v[32:47]
  v_xor_b32 v13, 384, v8
  ds_read_b128 v[96:99], v13 offset:12288
  s_waitcnt lgkmcnt(2)
  v_mfma_f32_32x32x16_bf16 v[48:63], v[168:171], v[100:103], v[48:63]
  s_waitcnt vmcnt(6)
  v_cmp_gt_u32 vcc, s81, v14
  v_mfma_f32_32x32x16_bf16 v[16:31], v[100:103], a[40:43], v[16:31]
  s_cmp_eq_u64 vcc, 0
  s_cselect_b32 s83, 1, 0
  v_mfma_f32_32x32x16_bf16 v[32:47], v[100:103], a[168:171], v[32:47]
  s_cmp_eq_u32 s83, 1
  s_cbranch_scc0 c_23
  s_add_u32 s90, s82, 0
  buffer_load_dwordx4 v[64:67], v4, s[44:47], s90 offen offset:0
  buffer_load_dwordx4 v[68:71], v4, s[44:47], s90 offen offset:1024
c_23:
  v_xor_b32 v13, 416, v8
  ds_read_b128 v[100:103], v13 offset:13312
  s_waitcnt lgkmcnt(2)
  v_mfma_f32_32x32x16_bf16 v[48:63], v[172:175], v[104:107], v[48:63]
  v_mfma_f32_32x32x16_bf16 v[16:31], v[104:107], a[44:47], v[16:31]
  v_mfma_f32_32x32x16_bf16 v[32:47], v[104:107], a[172:175], v[32:47]
  v_xor_b32 v13, 448, v8
  ds_read_b128 v[104:107], v13 offset:14336
  s_waitcnt lgkmcnt(2)
  v_mfma_f32_32x32x16_bf16 v[48:63], v[176:179], v[96:99], v[48:63]
  v_mfma_f32_32x32x16_bf16 v[16:31], v[96:99], a[48:51], v[16:31]
  s_cmp_eq_u32 s83, 1
  s_cbranch_scc0 c_24
  s_add_u32 s90, s82, 2048
  buffer_load_dwordx4 v[72:75], v4, s[44:47], s90 offen offset:0
  buffer_load_dwordx4 v[76:79], v4, s[44:47], s90 offen offset:1024
c_24:
  v_mfma_f32_32x32x16_bf16 v[32:47], v[96:99], a[176:179], v[32:47]
  v_xor_b32 v13, 480, v8
  ds_read_b128 v[96:99], v13 offset:15360
  s_waitcnt lgkmcnt(2)
  v_mfma_f32_32x32x16_bf16 v[48:63], v[180:183], v[100:103], v[48:63]
  v_mfma_f32_32x32x16_bf16 v[16:31], v[100:103], a[52:55], v[16:31]
  v_mfma_f32_32x32x16_bf16 v[32:47], v[100:103], a[180:183], v[32:47]
  v_xor_b32 v13, 0, v8
  ds_read_b128 v[100:103], v13 offset:16384
  s_waitcnt lgkmcnt(2)
  v_mfma_f32_32x32x16_bf16 v[48:63], v[184:187], v[104:107], v[48:63]
  s_cmp_eq_u32 s83, 1
  s_cbranch_scc0 c_25
  s_add_u32 s90, s82, 4096
  buffer_load_dwordx4 v[80:83], v4, s[44:47], s90 offen offset:0
  buffer_load_dwordx4 v[84:87], v4, s[44:47], s90 offen offset:1024
c_25:
  v_mfma_f32_32x32x16_bf16 v[16:31], v[104:107], a[56:59], v[16:31]
  v_mfma_f32_32x32x16_bf16 v[32:47], v[104:107], a[184:187], v[32:47]
  v_xor_b32 v13, 32, v8
  ds_read_b128 v[104:107], v13 offset:17408
  s_waitcnt lgkmcnt(2)
  v_mfma_f32_32x32x16_bf16 v[48:63], v[188:191], v[96:99], v[48:63]
  v_mfma_f32_32x32x16_bf16 v[16:31], v[96:99], a[60:63], v[16:31]
  v_mfma_f32_32x32x16_bf16 v[32:47], v[96:99], a[188:191], v[32:47]
  s_cmp_eq_u32 s83, 1
  s_cbranch_scc0 c_26
  s_add_u32 s90, s82, 6144
  buffer_load_dwordx4 v[88:91], v4, s[44:47], s90 offen offset:0
  buffer_load_dwordx4 v[92:95], v4, s[44:47], s90 offen offset:1024
c_26:
  v_xor_b32 v13, 64, v8
  ds_read_b128 v[96:99], v13 offset:18432
  s_waitcnt lgkmcnt(2)
  v_mfma_f32_32x32x16_bf16 v[48:63], v[192:195], v[100:103], v[48:63]
  v_mfma_f32_32x32x16_bf16 v[16:31], v[100:103], a[64:67], v[16:31]
  v_mfma_f32_32x32x16_bf16 v[32:47], v[100:103], a[192:195], v[32:47]
  v_xor_b32 v13, 96, v8
  ds_read_b128 v[100:103], v13 offset:19456
  s_waitcnt lgkmcnt(2)
  v_mfma_f32_32x32x16_bf16 v[48:63], v[196:199], v[104:107], v[48:63]
  v_mfma_f32_32x32x16_bf16 v[16:31], v[104:107], a[68:71], v[16:31]
  v_mfma_f32_32x32x16_bf16 v[32:47], v[104:107], a[196:199], v[32:47]
  v_xor_b32 v13, 128, v8
  ds_read_b128 v[104:107], v13 offset:20480
  s_waitcnt lgkmcnt(2)
  v_mfma_f32_32x32x16_bf16 v[48:63], v[200:203], v[96:99], v[48:63]
  v_mfma_f32_32x32x16_bf16 v[16:31], v[96:99], a[72:75], v[16:31]
  v_mfma_f32_32x32x16_bf16 v[32:47], v[96:99], a[200:203], v[32:47]
  s_waitcnt vmcnt(8)
  s_cmp_eq_u32 s83, 1
  s_cbranch_scc1 pw_27
  s_waitcnt vmcnt(0)
pw_27:
  v_mov_b32 v15, s67
  s_mov_b64 exec, 1
  buffer_store_dword v15, v11, s[44:47], 0 offen sc1
  s_mov_b64 exec, -1
  v_xor_b32 v13, 160, v8
  ds_read_b128 v[96:99], v13 offset:21504
  s_waitcnt lgkmcnt(2)
  v_mfma_f32_32x32x16_bf16 v[48:63], v[204:207], v[100:103], v[48:63]
  v_mfma_f32_32x32x16_bf16 v[16:31], v[100:103], a[76:79], v[16:31]
  v_mfma_f32_32x32x16_bf16 v[32:47], v[100:103], a[204:207], v[32:47]
  v_xor_b32 v13, 192, v8
  ds_read_b128 v[100:103], v13 offset:22528
  s_waitcnt lgkmcnt(2)
  v_mfma_f32_32x32x16_bf16 v[48:63], v[208:211], v[104:107], v[48:63]
  v_mfma_f32_32x32x16_bf16 v[16:31], v[104:107], a[80:83], v[16:31]
  v_mfma_f32_32x32x16_bf16 v[32:47], v[104:107], a[208:211], v[32:47]
  v_xor_b32 v13, 224, v8
  ds_read_b128 v[104:107], v13 offset:23552
  s_waitcnt lgkmcnt(2)
  v_mfma_f32_32x32x16_bf16 v[48:63], v[212:215], v[96:99], v[48:63]
  v_mfma_f32_32x32x16_bf16 v[16:31], v[96:99], a[84:87], v[16:31]
  v_mfma_f32_32x32x16_bf16 v[32:47], v[96:99], a[212:215], v[32:47]
  v_xor_b32 v13, 256, v8
  ds_read_b128 v[96:99], v13 offset:24576
  s_waitcnt lgkmcnt(2)
  v_mfma_f32_32x32x16_bf16 v[48:63], v[216:219], v[100:103], v[48:63]
  v_mfma_f32_32x32x16_bf16 v[16:31], v[100:103], a[88:91], v[16:31]
  v_mfma_f32_32x32x16_bf16 v[32:47], v[100:103], a[216:219], v[32:47]
  v_xor_b32 v13, 288, v8
  ds_read_b128 v[100:103], v13 offset:25600
  s_waitcnt lgkmcnt(2)
  v_mfma_f32_32x32x16_bf16 v[48:63], v[220:223], v[104:107], v[48:63]
  v_mfma_f32_32x32x16_bf16 v[16:31], v[104:107], a[92:95], v[16:31]
  v_mfma_f32_32x32x16_bf16 v[32:47], v[104:107], a[220:223], v[32:47]
  v_xor_b32 v13, 320, v8
  ds_read_b128 v[104:107], v13 offset:26624
  s_waitcnt lgkmcnt(2)
  v_mfma_f32_32x32x16_bf16 v[48:63], v[224:227], v[96:99], v[48:63]
  v_mfma_f32_32x32x16_bf16 v[16:31], v[96:99], a[96:99], v[16:31]
  v_mfma_f32_32x32x16_bf16 v[32:47], v[96:99], a[224:227], v[32:47]
  v_xor_b32 v13, 352, v8
  ds_read_b128 v[96:99], v13 offset:27648
  s_waitcnt lgkmcnt(2)
  v_mfma_f32_32x32x16_bf16 v[48:63], v[228:231], v[100:103], v[48:63]
  v_mfma_f32_32x32x16_bf16 v[16:31], v[100:103], a[100:103], v[16:31]
  s_waitcnt vmcnt(1)
  v_mfma_f32_32x32x16_bf16 v[32:47], v[100:103], a[228:231], v[32:47]
  v_xor_b32 v13, 0, v7
  ds_write_b128 v13, v[64:67]
  v_xor_b32 v13, 384, v8
  ds_read_b128 v[100:103], v13 offset:28672
  s_waitcnt lgkmcnt(3)
  v_mfma_f32_32x32x16_bf16 v[48:63], v[232:235], v[104:107], v[48:63]
  v_mfma_f32_32x32x16_bf16 v[16:31], v[104:107], a[104:107], v[16:31]
  v_xor_b32 v13, 16, v7
  ds_write_b128 v13, v[68:71]
  v_mfma_f32_32x32x16_bf16 v[32:47], v[104:107], a[232:235], v[32:47]
  v_xor_b32 v13, 416, v8
  ds_read_b128 v[104:107], v13 offset:29696
  s_waitcnt lgkmcnt(4)
  v_mfma_f32_32x32x16_bf16 v[48:63], v[236:239], v[96:99], v[48:63]
  v_xor_b32 v13, 32, v7
  ds_write_b128 v13, v[72:75]
  v_mfma_f32_32x32x16_bf16 v[16:31], v[96:99], a[108:111], v[16:31]
  v_mfma_f32_32x32x16_bf16 v[32:47], v[96:99], a[236:239], v[32:47]
  v_xor_b32 v13, 48, v7
  ds_write_b128 v13, v[76:79]
  v_xor_b32 v13, 448, v8
  ds_read_b128 v[96:99], v13 offset:30720
  s_waitcnt lgkmcnt(5)
  v_mfma_f32_32x32x16_bf16 v[48:63], v[240:243], v[100:103], v[48:63]
  v_mfma_f32_32x32x16_bf16 v[16:31], v[100:103], a[112:115], v[16:31]
  v_xor_b32 v13, 64, v7
  ds_write_b128 v13, v[80:83]
  v_mfma_f32_32x32x16_bf16 v[32:47], v[100:103], a[240:243], v[32:47]
  v_xor_b32 v13, 480, v8
  ds_read_b128 v[100:103], v13 offset:31744
  s_waitcnt lgkmcnt(5)
  v_mfma_f32_32x32x16_bf16 v[48:63], v[244:247], v[104:107], v[48:63]
  v_xor_b32 v13, 80, v7
  ds_write_b128 v13, v[84:87]
  v_mfma_f32_32x32x16_bf16 v[16:31], v[104:107], a[116:119], v[16:31]
  v_mfma_f32_32x32x16_bf16 v[32:47], v[104:107], a[244:247], v[32:47]
  v_xor_b32 v13, 96, v7
  ds_write_b128 v13, v[88:91]
  s_waitcnt lgkmcnt(4)
  v_mfma_f32_32x32x16_bf16 v[48:63], v[248:251], v[96:99], v[48:63]
  v_mfma_f32_32x32x16_bf16 v[16:31], v[96:99], a[120:123], v[16:31]
  v_xor_b32 v13, 112, v7
  ds_write_b128 v13, v[92:95]
  v_mfma_f32_32x32x16_bf16 v[32:47], v[96:99], a[248:251], v[32:47]
  s_waitcnt lgkmcnt(3)
  v_mfma_f32_32x32x16_bf16 v[48:63], v[252:255], v[100:103], v[48:63]
  v_mfma_f32_32x32x16_bf16 v[16:31], v[100:103], a[124:127], v[16:31]
  v_mfma_f32_32x32x16_bf16 v[32:47], v[100:103], a[252:255], v[32:47]
  s_nop 9
  v_cvt_pk_bf16_f32 v0, v48, v49
  v_cvt_pk_bf16_f32 v1, v50, v51
  v_cvt_pk_bf16_f32 v2, v52, v53
  v_cvt_pk_bf16_f32 v3, v54, v55
  v_cvt_pk_bf16_f32 v108, v56, v57
  v_cvt_pk_bf16_f32 v109, v58, v59
  v_cvt_pk_bf16_f32 v110, v60, v61
  v_cvt_pk_bf16_f32 v111, v62, v63
  v_cvt_pk_bf16_f32 v112, v16, v17
  v_cvt_pk_bf16_f32 v113, v18, v19
  v_cvt_pk_bf16_f32 v114, v24, v25
  v_cvt_pk_bf16_f32 v115, v26, v27
  v_cvt_pk_bf16_f32 v116, v20, v21
  v_cvt_pk_bf16_f32 v117, v22, v23
  v_cvt_pk_bf16_f32 v118, v28, v29
  v_cvt_pk_bf16_f32 v119, v30, v31
  v_cvt_pk_bf16_f32 v120, v32, v33
  v_cvt_pk_bf16_f32 v121, v34, v35
  v_cvt_pk_bf16_f32 v122, v40, v41
  v_cvt_pk_bf16_f32 v123, v42, v43
  v_cvt_pk_bf16_f32 v124, v36, v37
  v_cvt_pk_bf16_f32 v125, v38, v39
  v_cvt_pk_bf16_f32 v126, v44, v45
  v_cvt_pk_bf16_f32 v127, v46, v47
  s_nop 1
kv_j:
  s_add_u32 s67, s67, 1
  s_cmp_eq_u32 s83, 1
  s_cselect_b32 s72, s67, 64
  s_cmp_lt_u32 s72, 64
  s_cbranch_scc1 kv_top
  buffer_store_dwordx4 v[112:115], v10, s[44:47], s84 offen offset:0 sc1
  buffer_store_dwordx4 v[116:119], v10, s[44:47], s84 offen offset:1024 sc1
  buffer_store_dwordx4 v[120:123], v10, s[44:47], s84 offen offset:2048 sc1
  buffer_store_dwordx4 v[124:127], v10, s[44:47], s84 offen offset:3072 sc1
  buffer_store_dwordx4 v[0:3], v9, s[44:47], s86 offen offset:0 sc1
  buffer_store_dwordx4 v[108:111], v9, s[44:47], s86 offen offset:512 sc1
  s_waitcnt vmcnt(0)
  v_mov_b32 v15, s67
  s_mov_b64 exec, 1
  buffer_store_dword v15, v11, s[44:47], 0 offen sc1
  s_mov_b64 exec, -1
  s_cmp_ge_u32 s67, 64
  s_cbranch_scc1 mega_end
kv_top_in:
pf_28:
  buffer_load_dword v15, v12, s[44:47], s85 offen sc1
  s_waitcnt vmcnt(0)
  v_cmp_gt_u32 vcc, s81, v15
  s_nop 0
  s_cbranch_vccz pd_29
  s_nop 2
pr_30:
  s_sub_u32 s69, s69, 1
  s_cbranch_scc0 pf_28
  s_branch mega_exit
pd_29:
  s_add_u32 s90, s82, 4096
  buffer_load_dwordx4 v[64:67], v4, s[44:47], s82 offen offset:0
  buffer_load_dwordx4 v[68:71], v4, s[44:47], s82 offen offset:1024
  buffer_load_dwordx4 v[72:75], v4, s[44:47], s82 offen offset:2048
  buffer_load_dwordx4 v[76:79], v4, s[44:47], s82 offen offset:3072
  buffer_load_dwordx4 v[80:83], v4, s[44:47], s90 offen offset:0
  buffer_load_dwordx4 v[84:87], v4, s[44:47], s90 offen offset:1024
  buffer_load_dwordx4 v[88:91], v4, s[44:47], s90 offen offset:2048
  buffer_load_dwordx4 v[92:95], v4, s[44:47], s90 offen offset:3072
  s_waitcnt vmcnt(0)
  v_xor_b32 v13, 0, v7
  ds_write_b128 v13, v[64:67]
  v_xor_b32 v13, 16, v7
  ds_write_b128 v13, v[68:71]
  v_xor_b32 v13, 32, v7
  ds_write_b128 v13, v[72:75]
  v_xor_b32 v13, 48, v7
  ds_write_b128 v13, v[76:79]
  v_xor_b32 v13, 64, v7
  ds_write_b128 v13, v[80:83]
  v_xor_b32 v13, 80, v7
  ds_write_b128 v13, v[84:87]
  v_xor_b32 v13, 96, v7
  ds_write_b128 v13, v[88:91]
  v_xor_b32 v13, 112, v7
  ds_write_b128 v13, v[92:95]
  s_branch kv_top
  s_branch mega_end
role_q:
  s_cmp_eq_u32 s64, 0
  s_cselect_b32 s72, s16, s42
  s_cselect_b32 s73, s17, s43
  s_mov_b32 s56, s72
  s_mov_b32 s57, s73
  s_mov_b32 s58, 2097152
  s_mov_b32 s59, 0x00020000
  s_cmp_eq_u32 s64, 0
  s_cselect_b32 s58, 2097152, s46
  s_mul_i32 s91, s64, 4194304
  s_cmp_lt_u32 s65, 16
  s_cbranch_scc1 a_comp
  s_lshl_b32 s79, s64, 4
  s_add_u32 s79, s79, s65
  s_sub_u32 s79, s79, 16
  s_sub_u32 s80, s65, 16
  s_lshl_b32 s80, s80, 2
  s_add_u32 s80, s80, s66
  v_lshlrev_b32 v16, 4, v1
  s_lshl_b32 s72, s64, 22
  s_add_u32 s72, s72, 17825792
  v_add_u32 v13, s72, v16
  s_lshl_b32 s72, s64, 9
  s_add_u32 s72, s72, 14682112
  v_min_u32 v15, 31, v1
  v_lshlrev_b32 v15, 3, v15
  v_add_u32 v15, s72, v15
  s_lshl_b32 s72, s64, 13
  s_add_u32 s72, s72, 14688256
  v_mov_b32 v14, s72
  s_mov_b32 s94, 0x3f80
  s_mov_b32 s95, 0x3f800000
  s_lshl_b32 s81, s64, 21
  s_mov_b32 s48, s16
  s_mov_b32 s49, s17
  s_mov_b32 s50, 2097152
  s_mov_b32 s51, 0x00020000
  s_mov_b32 s60, s18
  s_mov_b32 s61, s19
  s_mov_b32 s62, 8192
  s_mov_b32 s63, 0x00020000
  s_lshl_b32 s79, s79, 2
  s_add_u32 s79, s79, s66
  s_lshl_b32 s72, s79, 10
  buffer_load_dwordx4 v[64:67], v16, s[48:51], s72 offen
  s_add_u32 s72, s72, 212992
  s_min_u32 s72, s72, 2096128
  buffer_load_dwordx4 v[68:71], v16, s[48:51], s72 offen
  s_add_u32 s72, s72, 212992
  s_min_u32 s72, s72, 2096128
  buffer_load_dwordx4 v[72:75], v16, s[48:51], s72 offen
  s_add_u32 s72, s72, 212992
  s_min_u32 s72, s72, 2096128
  buffer_load_dwordx4 v[76:79], v16, s[48:51], s72 offen
  s_add_u32 s72, s72, 212992
  s_min_u32 s72, s72, 2096128
  buffer_load_dwordx4 v[80:83], v16, s[48:51], s72 offen
  s_add_u32 s72, s72, 212992
  s_min_u32 s72, s72, 2096128
  buffer_load_dwordx4 v[84:87], v16, s[48:51], s72 offen
  s_add_u32 s72, s72, 212992
  s_min_u32 s72, s72, 2096128
  buffer_load_dwordx4 v[88:91], v16, s[48:51], s72 offen
  s_add_u32 s72, s72, 212992
  s_min_u32 s72, s72, 2096128
  buffer_load_dwordx4 v[92:95], v16, s[48:51], s72 offen
  s_add_u32 s72, s72, 212992
  s_min_u32 s72, s72, 2096128
  buffer_load_dwordx4 v[96:99], v16, s[48:51], s72 offen
  s_add_u32 s72, s72, 212992
  s_min_u32 s72, s72, 2096128
  buffer_load_dwordx4 v[100:103], v16, s[48:51], s72 offen
  s_add_u32 s72, s72, 212992
  s_min_u32 s72, s72, 2096128
  s_lshl_b32 s72, s79, 6
  v_add_u32 v20, s72, v1
  v_and_b32 v21, 0xfe0, v20
  v_and_b32 v22, 15, v20
  v_lshl_add_u32 v21, v22, 1, v21
  v_bfe_u32 v22, v20, 4, 1
  v_add_u32 v21, v21, v22
  v_lshlrev_b32 v21, 1, v21
  buffer_load_ushort v23, v21, s[60:63], 0 offen
  v_lshrrev_b32 v21, 12, v20
  v_lshlrev_b32 v21, 15, v21
  v_and_b32 v20, 0xfff, v20
  v_lshl_add_u32 v21, v20, 1, v21
  s_mov_b32 s73, 14745600
  v_mov_b32 v24, 0
  v_mov_b32 v28, -1
  v_mov_b32 v25, 0
  v_mov_b32 v29, -1
  v_mov_b32 v26, 0
  v_mov_b32 v30, -1
  v_mov_b32 v27, 0
  v_mov_b32 v31, -1
  s_lshl_b32 s72, s79, 10
  s_add_u32 s74, s72, 14680064
  s_cmp_lt_u32 s79, 64
  s_cbranch_scc0 ib_31
  buffer_store_dwordx4 v[24:27], v16, s[44:47], s74 offen sc1
  s_nop 1
ib_31:
  s_cmp_lt_u32 s79, 24
  s_cselect_b32 s74, 0, 8192
  s_add_u32 s74, s74, 14753792
  s_add_u32 s74, s74, s72
  s_cmp_lt_u32 s79, 48
  s_cbranch_scc0 ib_32
  buffer_store_dwordx4 v[28:31], v16, s[44:47], s74 offen sc1
  s_nop 1
ib_32:
  s_add_u32 s74, s79, 0
  s_lshr_b32 s75, s74, 8
  s_lshl_b32 s75, s75, 19
  s_and_b32 s76, s74, 255
  s_lshl_b32 s76, s76, 10
  s_add_u32 s75, s75, s76
  s_add_u32 s75, s75, 14811136
  s_cmp_lt_u32 s74, 1024
  s_cbranch_scc0 ib_33
  buffer_store_dwordx4 v[24:27], v16, s[44:47], s75 offen sc1
  s_nop 1
ib_33:
  s_add_u32 s74, s79, 208
  s_lshr_b32 s75, s74, 8
  s_lshl_b32 s75, s75, 19
  s_and_b32 s76, s74, 255
  s_lshl_b32 s76, s76, 10
  s_add_u32 s75, s75, s76
  s_add_u32 s75, s75, 14811136
  s_cmp_lt_u32 s74, 1024
  s_cbranch_scc0 ib_34
  buffer_store_dwordx4 v[24:27], v16, s[44:47], s75 offen sc1
  s_nop 1
ib_34:
  s_add_u32 s74, s79, 416
  s_lshr_b32 s75, s74, 8
  s_lshl_b32 s75, s75, 19
  s_and_b32 s76, s74, 255
  s_lshl_b32 s76, s76, 10
  s_add_u32 s75, s75, s76
  s_add_u32 s75, s75, 14811136
  s_cmp_lt_u32 s74, 1024
  s_cbranch_scc0 ib_35
  buffer_store_dwordx4 v[24:27], v16, s[44:47], s75 offen sc1
  s_nop 1
ib_35:
  s_add_u32 s74, s79, 624
  s_lshr_b32 s75, s74, 8
  s_lshl_b32 s75, s75, 19
  s_and_b32 s76, s74, 255
  s_lshl_b32 s76, s76, 10
  s_add_u32 s75, s75, s76
  s_add_u32 s75, s75, 14811136
  s_cmp_lt_u32 s74, 1024
  s_cbranch_scc0 ib_36
  buffer_store_dwordx4 v[24:27], v16, s[44:47], s75 offen sc1
  s_nop 1
ib_36:
  s_add_u32 s74, s79, 832
  s_lshr_b32 s75, s74, 8
  s_lshl_b32 s75, s75, 19
  s_and_b32 s76, s74, 255
  s_lshl_b32 s76, s76, 10
  s_add_u32 s75, s75, s76
  s_add_u32 s75, s75, 14811136
  s_cmp_lt_u32 s74, 1024
  s_cbranch_scc0 ib_37
  buffer_store_dwordx4 v[24:27], v16, s[44:47], s75 offen sc1
  s_nop 1
ib_37:
  s_waitcnt vmcnt(0)
  v_min_u32 v23, 0xfffe, v23
  s_cmp_lt_u32 s79, 128
  s_cbranch_scc0 ib_38
  buffer_store_short v23, v21, s[44:47], s73 offen sc1
ib_38:
  v_lshlrev_b32 v28, 16, v64
  v_and_b32 v29, 0xffff0000, v64
  v_lshlrev_b32 v30, 16, v65
  v_and_b32 v31, 0xffff0000, v65
  v_lshlrev_b32 v32, 16, v66
  v_and_b32 v33, 0xffff0000, v66
  v_lshlrev_b32 v34, 16, v67
  v_and_b32 v35, 0xffff0000, v67
  v_add_f32 v40, v28, v29
  v_add_f32 v40, v40, v30
  v_add_f32 v40, v40, v31
  v_add_f32 v40, v40, v32
  v_add_f32 v40, v40, v33
  v_add_f32 v40, v40, v34
  v_add_f32 v40, v40, v35
  s_nop 1
  v_add_f32_dpp v40, v40, v40 row_ror:8 row_mask:0xf bank_mask:0xf
  s_nop 1
  v_add_f32_dpp v40, v40, v40 row_ror:4 row_mask:0xf bank_mask:0xf
  s_nop 1
  v_add_f32_dpp v40, v40, v40 row_ror:2 row_mask:0xf bank_mask:0xf
  s_nop 1
  v_add_f32_dpp v40, v40, v40 row_ror:1 row_mask:0xf bank_mask:0xf
  v_mov_b32 v41, v40
  s_nop 1
  v_permlane16_swap_b32 v40, v41
  v_add_f32 v40, v40, v41
  v_mov_b32 v41, v40
  s_nop 1
  v_permlane32_swap_b32 v40, v41
  v_add_f32 v40, v40, v41
  v_mul_f32 v40, 0x3b000000, v40
  v_sub_f32 v44, v28, v40
  v_sub_f32 v45, v29, v40
  v_sub_f32 v46, v30, v40
  v_sub_f32 v47, v31, v40
  v_sub_f32 v48, v32, v40
  v_sub_f32 v49, v33, v40
  v_sub_f32 v50, v34, v40
  v_sub_f32 v51, v35, v40
  v_mul_f32 v43, v44, v44
  v_fmac_f32 v43, v45, v45
  v_fmac_f32 v43, v46, v46
  v_fmac_f32 v43, v47, v47
  v_fmac_f32 v43, v48, v48
  v_fmac_f32 v43, v49, v49
  v_fmac_f32 v43, v50, v50
  v_fmac_f32 v43, v51, v51
  v_cvt_pk_bf16_f32 v42, v40, v40
  v_and_b32 v42, 0xffff0000, v42
  v_add_f32_dpp v43, v43, v43 row_ror:8 row_mask:0xf bank_mask:0xf
  s_nop 1
  v_add_f32_dpp v43, v43, v43 row_ror:4 row_mask:0xf bank_mask:0xf
  s_nop 1
  v_add_f32_dpp v43, v43, v43 row_ror:2 row_mask:0xf bank_mask:0xf
  s_nop 1
  v_add_f32_dpp v43, v43, v43 row_ror:1 row_mask:0xf bank_mask:0xf
  v_mov_b32 v41, v43
  s_nop 1
  v_permlane16_swap_b32 v43, v41
  v_add_f32 v43, v43, v41
  v_mov_b32 v41, v43
  s_nop 1
  v_permlane32_swap_b32 v43, v41
  v_add_f32 v43, v43, v41
  v_sub_f32 v44, v28, v42
  v_sub_f32 v45, v29, v42
  v_sub_f32 v46, v30, v42
  v_sub_f32 v47, v31, v42
  v_sub_f32 v48, v32, v42
  v_sub_f32 v49, v33, v42
  v_sub_f32 v50, v34, v42
  v_sub_f32 v51, v35, v42
  v_mul_f32 v43, 0x3b000000, v43
  v_cvt_pk_bf16_f32 v43, v43, v43
  v_and_b32 v43, 0xffff0000, v43
  v_add_f32 v43, 0x3727c5ac, v43
  v_cvt_pk_bf16_f32 v43, v43, v43
  v_and_b32 v43, 0xffff0000, v43
  v_sqrt_f32 v43, v43
  s_nop 0
  v_cvt_pk_bf16_f32 v43, v43, v43
  v_and_b32 v43, 0xffff0000, v43
  v_rcp_f32 v43, v43
  v_cvt_pk_bf16_f32 v36, v44, v45
  v_cvt_pk_bf16_f32 v37, v46, v47
  v_cvt_pk_bf16_f32 v38, v48, v49
  v_cvt_pk_bf16_f32 v39, v50, v51
  v_lshlrev_b32 v44, 16, v36
  v_and_b32 v45, 0xffff0000, v36
  v_lshlrev_b32 v46, 16, v37
  v_and_b32 v47, 0xffff0000, v37
  v_lshlrev_b32 v48, 16, v38
  v_and_b32 v49, 0xffff0000, v38
  v_lshlrev_b32 v50, 16, v39
  v_and_b32 v51, 0xffff0000, v39
  v_mul_f32 v44, v44, v43
  v_mul_f32 v45, v45, v43
  v_mul_f32 v46, v46, v43
  v_mul_f32 v47, v47, v43
  v_mul_f32 v48, v48, v43
  v_mul_f32 v49, v49, v43
  v_mul_f32 v50, v50, v43
  v_mul_f32 v51, v51, v43
  v_cvt_pk_bf16_f32 v36, v44, v45
  v_cvt_pk_bf16_f32 v37, v46, v47
  v_cvt_pk_bf16_f32 v38, v48, v49
  v_cvt_pk_bf16_f32 v39, v50, v51
  s_cmp_lt_u32 s72, 2097152
  s_cbranch_scc0 ib_39
  buffer_store_dwordx4 v[36:39], v16, s[44:47], s72 offen sc1
  s_nop 1
ib_39:
  s_add_u32 s72, s72, 212992
  v_lshlrev_b32 v28, 16, v68
  v_and_b32 v29, 0xffff0000, v68
  v_lshlrev_b32 v30, 16, v69
  v_and_b32 v31, 0xffff0000, v69
  v_lshlrev_b32 v32, 16, v70
  v_and_b32 v33, 0xffff0000, v70
  v_lshlrev_b32 v34, 16, v71
  v_and_b32 v35, 0xffff0000, v71
  v_add_f32 v40, v28, v29
  v_add_f32 v40, v40, v30
  v_add_f32 v40, v40, v31
  v_add_f32 v40, v40, v32
  v_add_f32 v40, v40, v33
  v_add_f32 v40, v40, v34
  v_add_f32 v40, v40, v35
  s_nop 1
  v_add_f32_dpp v40, v40, v40 row_ror:8 row_mask:0xf bank_mask:0xf
  s_nop 1
  v_add_f32_dpp v40, v40, v40 row_ror:4 row_mask:0xf bank_mask:0xf
  s_nop 1
  v_add_f32_dpp v40, v40, v40 row_ror:2 row_mask:0xf bank_mask:0xf
  s_nop 1
  v_add_f32_dpp v40, v40, v40 row_ror:1 row_mask:0xf bank_mask:0xf
  v_mov_b32 v41, v40
  s_nop 1
  v_permlane16_swap_b32 v40, v41
  v_add_f32 v40, v40, v41
  v_mov_b32 v41, v40
  s_nop 1
  v_permlane32_swap_b32 v40, v41
  v_add_f32 v40, v40, v41
  v_mul_f32 v40, 0x3b000000, v40
  v_sub_f32 v44, v28, v40
  v_sub_f32 v45, v29, v40
  v_sub_f32 v46, v30, v40
  v_sub_f32 v47, v31, v40
  v_sub_f32 v48, v32, v40
  v_sub_f32 v49, v33, v40
  v_sub_f32 v50, v34, v40
  v_sub_f32 v51, v35, v40
  v_mul_f32 v43, v44, v44
  v_fmac_f32 v43, v45, v45
  v_fmac_f32 v43, v46, v46
  v_fmac_f32 v43, v47, v47
  v_fmac_f32 v43, v48, v48
  v_fmac_f32 v43, v49, v49
  v_fmac_f32 v43, v50, v50
  v_fmac_f32 v43, v51, v51
  v_cvt_pk_bf16_f32 v42, v40, v40
  v_and_b32 v42, 0xffff0000, v42
  v_add_f32_dpp v43, v43, v43 row_ror:8 row_mask:0xf bank_mask:0xf
  s_nop 1
  v_add_f32_dpp v43, v43, v43 row_ror:4 row_mask:0xf bank_mask:0xf
  s_nop 1
  v_add_f32_dpp v43, v43, v43 row_ror:2 row_mask:0xf bank_mask:0xf
  s_nop 1
  v_add_f32_dpp v43, v43, v43 row_ror:1 row_mask:0xf bank_mask:0xf
  v_mov_b32 v41, v43
  s_nop 1
  v_permlane16_swap_b32 v43, v41
  v_add_f32 v43, v43, v41
  v_mov_b32 v41, v43
  s_nop 1
  v_permlane32_swap_b32 v43, v41
  v_add_f32 v43, v43, v41
  v_sub_f32 v44, v28, v42
  v_sub_f32 v45, v29, v42
  v_sub_f32 v46, v30, v42
  v_sub_f32 v47, v31, v42
  v_sub_f32 v48, v32, v42
  v_sub_f32 v49, v33, v42
  v_sub_f32 v50, v34, v42
  v_sub_f32 v51, v35, v42
  v_mul_f32 v43, 0x3b000000, v43
  v_cvt_pk_bf16_f32 v43, v43, v43
  v_and_b32 v43, 0xffff0000, v43
  v_add_f32 v43, 0x3727c5ac, v43
  v_cvt_pk_bf16_f32 v43, v43, v43
  v_and_b32 v43, 0xffff0000, v43
  v_sqrt_f32 v43, v43
  s_nop 0
  v_cvt_pk_bf16_f32 v43, v43, v43
  v_and_b32 v43, 0xffff0000, v43
  v_rcp_f32 v43, v43
  v_cvt_pk_bf16_f32 v36, v44, v45
  v_cvt_pk_bf16_f32 v37, v46, v47
  v_cvt_pk_bf16_f32 v38, v48, v49
  v_cvt_pk_bf16_f32 v39, v50, v51
  v_lshlrev_b32 v44, 16, v36
  v_and_b32 v45, 0xffff0000, v36
  v_lshlrev_b32 v46, 16, v37
  v_and_b32 v47, 0xffff0000, v37
  v_lshlrev_b32 v48, 16, v38
  v_and_b32 v49, 0xffff0000, v38
  v_lshlrev_b32 v50, 16, v39
  v_and_b32 v51, 0xffff0000, v39
  v_mul_f32 v44, v44, v43
  v_mul_f32 v45, v45, v43
  v_mul_f32 v46, v46, v43
  v_mul_f32 v47, v47, v43
  v_mul_f32 v48, v48, v43
  v_mul_f32 v49, v49, v43
  v_mul_f32 v50, v50, v43
  v_mul_f32 v51, v51, v43
  v_cvt_pk_bf16_f32 v36, v44, v45
  v_cvt_pk_bf16_f32 v37, v46, v47
  v_cvt_pk_bf16_f32 v38, v48, v49
  v_cvt_pk_bf16_f32 v39, v50, v51
  s_cmp_lt_u32 s72, 2097152
  s_cbranch_scc0 ib_40
  buffer_store_dwordx4 v[36:39], v16, s[44:47], s72 offen sc1
  s_nop 1
ib_40:
  s_add_u32 s72, s72, 212992
  v_lshlrev_b32 v28, 16, v72
  v_and_b32 v29, 0xffff0000, v72
  v_lshlrev_b32 v30, 16, v73
  v_and_b32 v31, 0xffff0000, v73
  v_lshlrev_b32 v32, 16, v74
  v_and_b32 v33, 0xffff0000, v74
  v_lshlrev_b32 v34, 16, v75
  v_and_b32 v35, 0xffff0000, v75
  v_add_f32 v40, v28, v29
  v_add_f32 v40, v40, v30
  v_add_f32 v40, v40, v31
  v_add_f32 v40, v40, v32
  v_add_f32 v40, v40, v33
  v_add_f32 v40, v40, v34
  v_add_f32 v40, v40, v35
  s_nop 1
  v_add_f32_dpp v40, v40, v40 row_ror:8 row_mask:0xf bank_mask:0xf
  s_nop 1
  v_add_f32_dpp v40, v40, v40 row_ror:4 row_mask:0xf bank_mask:0xf
  s_nop 1
  v_add_f32_dpp v40, v40, v40 row_ror:2 row_mask:0xf bank_mask:0xf
  s_nop 1
  v_add_f32_dpp v40, v40, v40 row_ror:1 row_mask:0xf bank_mask:0xf
  v_mov_b32 v41, v40
  s_nop 1
  v_permlane16_swap_b32 v40, v41
  v_add_f32 v40, v40, v41
  v_mov_b32 v41, v40
  s_nop 1
  v_permlane32_swap_b32 v40, v41
  v_add_f32 v40, v40, v41
  v_mul_f32 v40, 0x3b000000, v40
  v_sub_f32 v44, v28, v40
  v_sub_f32 v45, v29, v40
  v_sub_f32 v46, v30, v40
  v_sub_f32 v47, v31, v40
  v_sub_f32 v48, v32, v40
  v_sub_f32 v49, v33, v40
  v_sub_f32 v50, v34, v40
  v_sub_f32 v51, v35, v40
  v_mul_f32 v43, v44, v44
  v_fmac_f32 v43, v45, v45
  v_fmac_f32 v43, v46, v46
  v_fmac_f32 v43, v47, v47
  v_fmac_f32 v43, v48, v48
  v_fmac_f32 v43, v49, v49
  v_fmac_f32 v43, v50, v50
  v_fmac_f32 v43, v51, v51
  v_cvt_pk_bf16_f32 v42, v40, v40
  v_and_b32 v42, 0xffff0000, v42
  v_add_f32_dpp v43, v43, v43 row_ror:8 row_mask:0xf bank_mask:0xf
  s_nop 1
  v_add_f32_dpp v43, v43, v43 row_ror:4 row_mask:0xf bank_mask:0xf
  s_nop 1
  v_add_f32_dpp v43, v43, v43 row_ror:2 row_mask:0xf bank_mask:0xf
  s_nop 1
  v_add_f32_dpp v43, v43, v43 row_ror:1 row_mask:0xf bank_mask:0xf
  v_mov_b32 v41, v43
  s_nop 1
  v_permlane16_swap_b32 v43, v41
  v_add_f32 v43, v43, v41
  v_mov_b32 v41, v43
  s_nop 1
  v_permlane32_swap_b32 v43, v41
  v_add_f32 v43, v43, v41
  v_sub_f32 v44, v28, v42
  v_sub_f32 v45, v29, v42
  v_sub_f32 v46, v30, v42
  v_sub_f32 v47, v31, v42
  v_sub_f32 v48, v32, v42
  v_sub_f32 v49, v33, v42
  v_sub_f32 v50, v34, v42
  v_sub_f32 v51, v35, v42
  v_mul_f32 v43, 0x3b000000, v43
  v_cvt_pk_bf16_f32 v43, v43, v43
  v_and_b32 v43, 0xffff0000, v43
  v_add_f32 v43, 0x3727c5ac, v43
  v_cvt_pk_bf16_f32 v43, v43, v43
  v_and_b32 v43, 0xffff0000, v43
  v_sqrt_f32 v43, v43
  s_nop 0
  v_cvt_pk_bf16_f32 v43, v43, v43
  v_and_b32 v43, 0xffff0000, v43
  v_rcp_f32 v43, v43
  v_cvt_pk_bf16_f32 v36, v44, v45
  v_cvt_pk_bf16_f32 v37, v46, v47
  v_cvt_pk_bf16_f32 v38, v48, v49
  v_cvt_pk_bf16_f32 v39, v50, v51
  v_lshlrev_b32 v44, 16, v36
  v_and_b32 v45, 0xffff0000, v36
  v_lshlrev_b32 v46, 16, v37
  v_and_b32 v47, 0xffff0000, v37
  v_lshlrev_b32 v48, 16, v38
  v_and_b32 v49, 0xffff0000, v38
  v_lshlrev_b32 v50, 16, v39
  v_and_b32 v51, 0xffff0000, v39
  v_mul_f32 v44, v44, v43
  v_mul_f32 v45, v45, v43
  v_mul_f32 v46, v46, v43
  v_mul_f32 v47, v47, v43
  v_mul_f32 v48, v48, v43
  v_mul_f32 v49, v49, v43
  v_mul_f32 v50, v50, v43
  v_mul_f32 v51, v51, v43
  v_cvt_pk_bf16_f32 v36, v44, v45
  v_cvt_pk_bf16_f32 v37, v46, v47
  v_cvt_pk_bf16_f32 v38, v48, v49
  v_cvt_pk_bf16_f32 v39, v50, v51
  s_cmp_lt_u32 s72, 2097152
  s_cbranch_scc0 ib_41
  buffer_store_dwordx4 v[36:39], v16, s[44:47], s72 offen sc1
  s_nop 1
ib_41:
  s_add_u32 s72, s72, 212992
  v_lshlrev_b32 v28, 16, v76
  v_and_b32 v29, 0xffff0000, v76
  v_lshlrev_b32 v30, 16, v77
  v_and_b32 v31, 0xffff0000, v77
  v_lshlrev_b32 v32, 16, v78
  v_and_b32 v33, 0xffff0000, v78
  v_lshlrev_b32 v34, 16, v79
  v_and_b32 v35, 0xffff0000, v79
  v_add_f32 v40, v28, v29
  v_add_f32 v40, v40, v30
  v_add_f32 v40, v40, v31
  v_add_f32 v40, v40, v32
  v_add_f32 v40, v40, v33
  v_add_f32 v40, v40, v34
  v_add_f32 v40, v40, v35
  s_nop 1
  v_add_f32_dpp v40, v40, v40 row_ror:8 row_mask:0xf bank_mask:0xf
  s_nop 1
  v_add_f32_dpp v40, v40, v40 row_ror:4 row_mask:0xf bank_mask:0xf
  s_nop 1
  v_add_f32_dpp v40, v40, v40 row_ror:2 row_mask:0xf bank_mask:0xf
  s_nop 1
  v_add_f32_dpp v40, v40, v40 row_ror:1 row_mask:0xf bank_mask:0xf
  v_mov_b32 v41, v40
  s_nop 1
  v_permlane16_swap_b32 v40, v41
  v_add_f32 v40, v40, v41
  v_mov_b32 v41, v40
  s_nop 1
  v_permlane32_swap_b32 v40, v41
  v_add_f32 v40, v40, v41
  v_mul_f32 v40, 0x3b000000, v40
  v_sub_f32 v44, v28, v40
  v_sub_f32 v45, v29, v40
  v_sub_f32 v46, v30, v40
  v_sub_f32 v47, v31, v40
  v_sub_f32 v48, v32, v40
  v_sub_f32 v49, v33, v40
  v_sub_f32 v50, v34, v40
  v_sub_f32 v51, v35, v40
  v_mul_f32 v43, v44, v44
  v_fmac_f32 v43, v45, v45
  v_fmac_f32 v43, v46, v46
  v_fmac_f32 v43, v47, v47
  v_fmac_f32 v43, v48, v48
  v_fmac_f32 v43, v49, v49
  v_fmac_f32 v43, v50, v50
  v_fmac_f32 v43, v51, v51
  v_cvt_pk_bf16_f32 v42, v40, v40
  v_and_b32 v42, 0xffff0000, v42
  v_add_f32_dpp v43, v43, v43 row_ror:8 row_mask:0xf bank_mask:0xf
  s_nop 1
  v_add_f32_dpp v43, v43, v43 row_ror:4 row_mask:0xf bank_mask:0xf
  s_nop 1
  v_add_f32_dpp v43, v43, v43 row_ror:2 row_mask:0xf bank_mask:0xf
  s_nop 1
  v_add_f32_dpp v43, v43, v43 row_ror:1 row_mask:0xf bank_mask:0xf
  v_mov_b32 v41, v43
  s_nop 1
  v_permlane16_swap_b32 v43, v41
  v_add_f32 v43, v43, v41
  v_mov_b32 v41, v43
  s_nop 1
  v_permlane32_swap_b32 v43, v41
  v_add_f32 v43, v43, v41
  v_sub_f32 v44, v28, v42
  v_sub_f32 v45, v29, v42
  v_sub_f32 v46, v30, v42
  v_sub_f32 v47, v31, v42
  v_sub_f32 v48, v32, v42
  v_sub_f32 v49, v33, v42
  v_sub_f32 v50, v34, v42
  v_sub_f32 v51, v35, v42
  v_mul_f32 v43, 0x3b000000, v43
  v_cvt_pk_bf16_f32 v43, v43, v43
  v_and_b32 v43, 0xffff0000, v43
  v_add_f32 v43, 0x3727c5ac, v43
  v_cvt_pk_bf16_f32 v43, v43, v43
  v_and_b32 v43, 0xffff0000, v43
  v_sqrt_f32 v43, v43
  s_nop 0
  v_cvt_pk_bf16_f32 v43, v43, v43
  v_and_b32 v43, 0xffff0000, v43
  v_rcp_f32 v43, v43
  v_cvt_pk_bf16_f32 v36, v44, v45
  v_cvt_pk_bf16_f32 v37, v46, v47
  v_cvt_pk_bf16_f32 v38, v48, v49
  v_cvt_pk_bf16_f32 v39, v50, v51
  v_lshlrev_b32 v44, 16, v36
  v_and_b32 v45, 0xffff0000, v36
  v_lshlrev_b32 v46, 16, v37
  v_and_b32 v47, 0xffff0000, v37
  v_lshlrev_b32 v48, 16, v38
  v_and_b32 v49, 0xffff0000, v38
  v_lshlrev_b32 v50, 16, v39
  v_and_b32 v51, 0xffff0000, v39
  v_mul_f32 v44, v44, v43
  v_mul_f32 v45, v45, v43
  v_mul_f32 v46, v46, v43
  v_mul_f32 v47, v47, v43
  v_mul_f32 v48, v48, v43
  v_mul_f32 v49, v49, v43
  v_mul_f32 v50, v50, v43
  v_mul_f32 v51, v51, v43
  v_cvt_pk_bf16_f32 v36, v44, v45
  v_cvt_pk_bf16_f32 v37, v46, v47
  v_cvt_pk_bf16_f32 v38, v48, v49
  v_cvt_pk_bf16_f32 v39, v50, v51
  s_cmp_lt_u32 s72, 2097152
  s_cbranch_scc0 ib_42
  buffer_store_dwordx4 v[36:39], v16, s[44:47], s72 offen sc1
  s_nop 1
ib_42:
  s_add_u32 s72, s72, 212992
  v_lshlrev_b32 v28, 16, v80
  v_and_b32 v29, 0xffff0000, v80
  v_lshlrev_b32 v30, 16, v81
  v_and_b32 v31, 0xffff0000, v81
  v_lshlrev_b32 v32, 16, v82
  v_and_b32 v33, 0xffff0000, v82
  v_lshlrev_b32 v34, 16, v83
  v_and_b32 v35, 0xffff0000, v83
  v_add_f32 v40, v28, v29
  v_add_f32 v40, v40, v30
  v_add_f32 v40, v40, v31
  v_add_f32 v40, v40, v32
  v_add_f32 v40, v40, v33
  v_add_f32 v40, v40, v34
  v_add_f32 v40, v40, v35
  s_nop 1
  v_add_f32_dpp v40, v40, v40 row_ror:8 row_mask:0xf bank_mask:0xf
  s_nop 1
  v_add_f32_dpp v40, v40, v40 row_ror:4 row_mask:0xf bank_mask:0xf
  s_nop 1
  v_add_f32_dpp v40, v40, v40 row_ror:2 row_mask:0xf bank_mask:0xf
  s_nop 1
  v_add_f32_dpp v40, v40, v40 row_ror:1 row_mask:0xf bank_mask:0xf
  v_mov_b32 v41, v40
  s_nop 1
  v_permlane16_swap_b32 v40, v41
  v_add_f32 v40, v40, v41
  v_mov_b32 v41, v40
  s_nop 1
  v_permlane32_swap_b32 v40, v41
  v_add_f32 v40, v40, v41
  v_mul_f32 v40, 0x3b000000, v40
  v_sub_f32 v44, v28, v40
  v_sub_f32 v45, v29, v40
  v_sub_f32 v46, v30, v40
  v_sub_f32 v47, v31, v40
  v_sub_f32 v48, v32, v40
  v_sub_f32 v49, v33, v40
  v_sub_f32 v50, v34, v40
  v_sub_f32 v51, v35, v40
  v_mul_f32 v43, v44, v44
  v_fmac_f32 v43, v45, v45
  v_fmac_f32 v43, v46, v46
  v_fmac_f32 v43, v47, v47
  v_fmac_f32 v43, v48, v48
  v_fmac_f32 v43, v49, v49
  v_fmac_f32 v43, v50, v50
  v_fmac_f32 v43, v51, v51
  v_cvt_pk_bf16_f32 v42, v40, v40
  v_and_b32 v42, 0xffff0000, v42
  v_add_f32_dpp v43, v43, v43 row_ror:8 row_mask:0xf bank_mask:0xf
  s_nop 1
  v_add_f32_dpp v43, v43, v43 row_ror:4 row_mask:0xf bank_mask:0xf
  s_nop 1
  v_add_f32_dpp v43, v43, v43 row_ror:2 row_mask:0xf bank_mask:0xf
  s_nop 1
  v_add_f32_dpp v43, v43, v43 row_ror:1 row_mask:0xf bank_mask:0xf
  v_mov_b32 v41, v43
  s_nop 1
  v_permlane16_swap_b32 v43, v41
  v_add_f32 v43, v43, v41
  v_mov_b32 v41, v43
  s_nop 1
  v_permlane32_swap_b32 v43, v41
  v_add_f32 v43, v43, v41
  v_sub_f32 v44, v28, v42
  v_sub_f32 v45, v29, v42
  v_sub_f32 v46, v30, v42
  v_sub_f32 v47, v31, v42
  v_sub_f32 v48, v32, v42
  v_sub_f32 v49, v33, v42
  v_sub_f32 v50, v34, v42
  v_sub_f32 v51, v35, v42
  v_mul_f32 v43, 0x3b000000, v43
  v_cvt_pk_bf16_f32 v43, v43, v43
  v_and_b32 v43, 0xffff0000, v43
  v_add_f32 v43, 0x3727c5ac, v43
  v_cvt_pk_bf16_f32 v43, v43, v43
  v_and_b32 v43, 0xffff0000, v43
  v_sqrt_f32 v43, v43
  s_nop 0
  v_cvt_pk_bf16_f32 v43, v43, v43
  v_and_b32 v43, 0xffff0000, v43
  v_rcp_f32 v43, v43
  v_cvt_pk_bf16_f32 v36, v44, v45
  v_cvt_pk_bf16_f32 v37, v46, v47
  v_cvt_pk_bf16_f32 v38, v48, v49
  v_cvt_pk_bf16_f32 v39, v50, v51
  v_lshlrev_b32 v44, 16, v36
  v_and_b32 v45, 0xffff0000, v36
  v_lshlrev_b32 v46, 16, v37
  v_and_b32 v47, 0xffff0000, v37
  v_lshlrev_b32 v48, 16, v38
  v_and_b32 v49, 0xffff0000, v38
  v_lshlrev_b32 v50, 16, v39
  v_and_b32 v51, 0xffff0000, v39
  v_mul_f32 v44, v44, v43
  v_mul_f32 v45, v45, v43
  v_mul_f32 v46, v46, v43
  v_mul_f32 v47, v47, v43
  v_mul_f32 v48, v48, v43
  v_mul_f32 v49, v49, v43
  v_mul_f32 v50, v50, v43
  v_mul_f32 v51, v51, v43
  v_cvt_pk_bf16_f32 v36, v44, v45
  v_cvt_pk_bf16_f32 v37, v46, v47
  v_cvt_pk_bf16_f32 v38, v48, v49
  v_cvt_pk_bf16_f32 v39, v50, v51
  s_cmp_lt_u32 s72, 2097152
  s_cbranch_scc0 ib_43
  buffer_store_dwordx4 v[36:39], v16, s[44:47], s72 offen sc1
  s_nop 1
ib_43:
  s_add_u32 s72, s72, 212992
  v_lshlrev_b32 v28, 16, v84
  v_and_b32 v29, 0xffff0000, v84
  v_lshlrev_b32 v30, 16, v85
  v_and_b32 v31, 0xffff0000, v85
  v_lshlrev_b32 v32, 16, v86
  v_and_b32 v33, 0xffff0000, v86
  v_lshlrev_b32 v34, 16, v87
  v_and_b32 v35, 0xffff0000, v87
  v_add_f32 v40, v28, v29
  v_add_f32 v40, v40, v30
  v_add_f32 v40, v40, v31
  v_add_f32 v40, v40, v32
  v_add_f32 v40, v40, v33
  v_add_f32 v40, v40, v34
  v_add_f32 v40, v40, v35
  s_nop 1
  v_add_f32_dpp v40, v40, v40 row_ror:8 row_mask:0xf bank_mask:0xf
  s_nop 1
  v_add_f32_dpp v40, v40, v40 row_ror:4 row_mask:0xf bank_mask:0xf
  s_nop 1
  v_add_f32_dpp v40, v40, v40 row_ror:2 row_mask:0xf bank_mask:0xf
  s_nop 1
  v_add_f32_dpp v40, v40, v40 row_ror:1 row_mask:0xf bank_mask:0xf
  v_mov_b32 v41, v40
  s_nop 1
  v_permlane16_swap_b32 v40, v41
  v_add_f32 v40, v40, v41
  v_mov_b32 v41, v40
  s_nop 1
  v_permlane32_swap_b32 v40, v41
  v_add_f32 v40, v40, v41
  v_mul_f32 v40, 0x3b000000, v40
  v_sub_f32 v44, v28, v40
  v_sub_f32 v45, v29, v40
  v_sub_f32 v46, v30, v40
  v_sub_f32 v47, v31, v40
  v_sub_f32 v48, v32, v40
  v_sub_f32 v49, v33, v40
  v_sub_f32 v50, v34, v40
  v_sub_f32 v51, v35, v40
  v_mul_f32 v43, v44, v44
  v_fmac_f32 v43, v45, v45
  v_fmac_f32 v43, v46, v46
  v_fmac_f32 v43, v47, v47
  v_fmac_f32 v43, v48, v48
  v_fmac_f32 v43, v49, v49
  v_fmac_f32 v43, v50, v50
  v_fmac_f32 v43, v51, v51
  v_cvt_pk_bf16_f32 v42, v40, v40
  v_and_b32 v42, 0xffff0000, v42
  v_add_f32_dpp v43, v43, v43 row_ror:8 row_mask:0xf bank_mask:0xf
  s_nop 1
  v_add_f32_dpp v43, v43, v43 row_ror:4 row_mask:0xf bank_mask:0xf
  s_nop 1
  v_add_f32_dpp v43, v43, v43 row_ror:2 row_mask:0xf bank_mask:0xf
  s_nop 1
  v_add_f32_dpp v43, v43, v43 row_ror:1 row_mask:0xf bank_mask:0xf
  v_mov_b32 v41, v43
  s_nop 1
  v_permlane16_swap_b32 v43, v41
  v_add_f32 v43, v43, v41
  v_mov_b32 v41, v43
  s_nop 1
  v_permlane32_swap_b32 v43, v41
  v_add_f32 v43, v43, v41
  v_sub_f32 v44, v28, v42
  v_sub_f32 v45, v29, v42
  v_sub_f32 v46, v30, v42
  v_sub_f32 v47, v31, v42
  v_sub_f32 v48, v32, v42
  v_sub_f32 v49, v33, v42
  v_sub_f32 v50, v34, v42
  v_sub_f32 v51, v35, v42
  v_mul_f32 v43, 0x3b000000, v43
  v_cvt_pk_bf16_f32 v43, v43, v43
  v_and_b32 v43, 0xffff0000, v43
  v_add_f32 v43, 0x3727c5ac, v43
  v_cvt_pk_bf16_f32 v43, v43, v43
  v_and_b32 v43, 0xffff0000, v43
  v_sqrt_f32 v43, v43
  s_nop 0
  v_cvt_pk_bf16_f32 v43, v43, v43
  v_and_b32 v43, 0xffff0000, v43
  v_rcp_f32 v43, v43
  v_cvt_pk_bf16_f32 v36, v44, v45
  v_cvt_pk_bf16_f32 v37, v46, v47
  v_cvt_pk_bf16_f32 v38, v48, v49
  v_cvt_pk_bf16_f32 v39, v50, v51
  v_lshlrev_b32 v44, 16, v36
  v_and_b32 v45, 0xffff0000, v36
  v_lshlrev_b32 v46, 16, v37
  v_and_b32 v47, 0xffff0000, v37
  v_lshlrev_b32 v48, 16, v38
  v_and_b32 v49, 0xffff0000, v38
  v_lshlrev_b32 v50, 16, v39
  v_and_b32 v51, 0xffff0000, v39
  v_mul_f32 v44, v44, v43
  v_mul_f32 v45, v45, v43
  v_mul_f32 v46, v46, v43
  v_mul_f32 v47, v47, v43
  v_mul_f32 v48, v48, v43
  v_mul_f32 v49, v49, v43
  v_mul_f32 v50, v50, v43
  v_mul_f32 v51, v51, v43
  v_cvt_pk_bf16_f32 v36, v44, v45
  v_cvt_pk_bf16_f32 v37, v46, v47
  v_cvt_pk_bf16_f32 v38, v48, v49
  v_cvt_pk_bf16_f32 v39, v50, v51
  s_cmp_lt_u32 s72, 2097152
  s_cbranch_scc0 ib_44
  buffer_store_dwordx4 v[36:39], v16, s[44:47], s72 offen sc1
  s_nop 1
ib_44:
  s_add_u32 s72, s72, 212992
  v_lshlrev_b32 v28, 16, v88
  v_and_b32 v29, 0xffff0000, v88
  v_lshlrev_b32 v30, 16, v89
  v_and_b32 v31, 0xffff0000, v89
  v_lshlrev_b32 v32, 16, v90
  v_and_b32 v33, 0xffff0000, v90
  v_lshlrev_b32 v34, 16, v91
  v_and_b32 v35, 0xffff0000, v91
  v_add_f32 v40, v28, v29
  v_add_f32 v40, v40, v30
  v_add_f32 v40, v40, v31
  v_add_f32 v40, v40, v32
  v_add_f32 v40, v40, v33
  v_add_f32 v40, v40, v34
  v_add_f32 v40, v40, v35
  s_nop 1
  v_add_f32_dpp v40, v40, v40 row_ror:8 row_mask:0xf bank_mask:0xf
  s_nop 1
  v_add_f32_dpp v40, v40, v40 row_ror:4 row_mask:0xf bank_mask:0xf
  s_nop 1
  v_add_f32_dpp v40, v40, v40 row_ror:2 row_mask:0xf bank_mask:0xf
  s_nop 1
  v_add_f32_dpp v40, v40, v40 row_ror:1 row_mask:0xf bank_mask:0xf
  v_mov_b32 v41, v40
  s_nop 1
  v_permlane16_swap_b32 v40, v41
  v_add_f32 v40, v40, v41
  v_mov_b32 v41, v40
  s_nop 1
  v_permlane32_swap_b32 v40, v41
  v_add_f32 v40, v40, v41
  v_mul_f32 v40, 0x3b000000, v40
  v_sub_f32 v44, v28, v40
  v_sub_f32 v45, v29, v40
  v_sub_f32 v46, v30, v40
  v_sub_f32 v47, v31, v40
  v_sub_f32 v48, v32, v40
  v_sub_f32 v49, v33, v40
  v_sub_f32 v50, v34, v40
  v_sub_f32 v51, v35, v40
  v_mul_f32 v43, v44, v44
  v_fmac_f32 v43, v45, v45
  v_fmac_f32 v43, v46, v46
  v_fmac_f32 v43, v47, v47
  v_fmac_f32 v43, v48, v48
  v_fmac_f32 v43, v49, v49
  v_fmac_f32 v43, v50, v50
  v_fmac_f32 v43, v51, v51
  v_cvt_pk_bf16_f32 v42, v40, v40
  v_and_b32 v42, 0xffff0000, v42
  v_add_f32_dpp v43, v43, v43 row_ror:8 row_mask:0xf bank_mask:0xf
  s_nop 1
  v_add_f32_dpp v43, v43, v43 row_ror:4 row_mask:0xf bank_mask:0xf
  s_nop 1
  v_add_f32_dpp v43, v43, v43 row_ror:2 row_mask:0xf bank_mask:0xf
  s_nop 1
  v_add_f32_dpp v43, v43, v43 row_ror:1 row_mask:0xf bank_mask:0xf
  v_mov_b32 v41, v43
  s_nop 1
  v_permlane16_swap_b32 v43, v41
  v_add_f32 v43, v43, v41
  v_mov_b32 v41, v43
  s_nop 1
  v_permlane32_swap_b32 v43, v41
  v_add_f32 v43, v43, v41
  v_sub_f32 v44, v28, v42
  v_sub_f32 v45, v29, v42
  v_sub_f32 v46, v30, v42
  v_sub_f32 v47, v31, v42
  v_sub_f32 v48, v32, v42
  v_sub_f32 v49, v33, v42
  v_sub_f32 v50, v34, v42
  v_sub_f32 v51, v35, v42
  v_mul_f32 v43, 0x3b000000, v43
  v_cvt_pk_bf16_f32 v43, v43, v43
  v_and_b32 v43, 0xffff0000, v43
  v_add_f32 v43, 0x3727c5ac, v43
  v_cvt_pk_bf16_f32 v43, v43, v43
  v_and_b32 v43, 0xffff0000, v43
  v_sqrt_f32 v43, v43
  s_nop 0
  v_cvt_pk_bf16_f32 v43, v43, v43
  v_and_b32 v43, 0xffff0000, v43
  v_rcp_f32 v43, v43
  v_cvt_pk_bf16_f32 v36, v44, v45
  v_cvt_pk_bf16_f32 v37, v46, v47
  v_cvt_pk_bf16_f32 v38, v48, v49
  v_cvt_pk_bf16_f32 v39, v50, v51
  v_lshlrev_b32 v44, 16, v36
  v_and_b32 v45, 0xffff0000, v36
  v_lshlrev_b32 v46, 16, v37
  v_and_b32 v47, 0xffff0000, v37
  v_lshlrev_b32 v48, 16, v38
  v_and_b32 v49, 0xffff0000, v38
  v_lshlrev_b32 v50, 16, v39
  v_and_b32 v51, 0xffff0000, v39
  v_mul_f32 v44, v44, v43
  v_mul_f32 v45, v45, v43
  v_mul_f32 v46, v46, v43
  v_mul_f32 v47, v47, v43
  v_mul_f32 v48, v48, v43
  v_mul_f32 v49, v49, v43
  v_mul_f32 v50, v50, v43
  v_mul_f32 v51, v51, v43
  v_cvt_pk_bf16_f32 v36, v44, v45
  v_cvt_pk_bf16_f32 v37, v46, v47
  v_cvt_pk_bf16_f32 v38, v48, v49
  v_cvt_pk_bf16_f32 v39, v50, v51
  s_cmp_lt_u32 s72, 2097152
  s_cbranch_scc0 ib_45
  buffer_store_dwordx4 v[36:39], v16, s[44:47], s72 offen sc1
  s_nop 1
ib_45:
  s_add_u32 s72, s72, 212992
  v_lshlrev_b32 v28, 16, v92
  v_and_b32 v29, 0xffff0000, v92
  v_lshlrev_b32 v30, 16, v93
  v_and_b32 v31, 0xffff0000, v93
  v_lshlrev_b32 v32, 16, v94
  v_and_b32 v33, 0xffff0000, v94
  v_lshlrev_b32 v34, 16, v95
  v_and_b32 v35, 0xffff0000, v95
  v_add_f32 v40, v28, v29
  v_add_f32 v40, v40, v30
  v_add_f32 v40, v40, v31
  v_add_f32 v40, v40, v32
  v_add_f32 v40, v40, v33
  v_add_f32 v40, v40, v34
  v_add_f32 v40, v40, v35
  s_nop 1
  v_add_f32_dpp v40, v40, v40 row_ror:8 row_mask:0xf bank_mask:0xf
  s_nop 1
  v_add_f32_dpp v40, v40, v40 row_ror:4 row_mask:0xf bank_mask:0xf
  s_nop 1
  v_add_f32_dpp v40, v40, v40 row_ror:2 row_mask:0xf bank_mask:0xf
  s_nop 1
  v_add_f32_dpp v40, v40, v40 row_ror:1 row_mask:0xf bank_mask:0xf
  v_mov_b32 v41, v40
  s_nop 1
  v_permlane16_swap_b32 v40, v41
  v_add_f32 v40, v40, v41
  v_mov_b32 v41, v40
  s_nop 1
  v_permlane32_swap_b32 v40, v41
  v_add_f32 v40, v40, v41
  v_mul_f32 v40, 0x3b000000, v40
  v_sub_f32 v44, v28, v40
  v_sub_f32 v45, v29, v40
  v_sub_f32 v46, v30, v40
  v_sub_f32 v47, v31, v40
  v_sub_f32 v48, v32, v40
  v_sub_f32 v49, v33, v40
  v_sub_f32 v50, v34, v40
  v_sub_f32 v51, v35, v40
  v_mul_f32 v43, v44, v44
  v_fmac_f32 v43, v45, v45
  v_fmac_f32 v43, v46, v46
  v_fmac_f32 v43, v47, v47
  v_fmac_f32 v43, v48, v48
  v_fmac_f32 v43, v49, v49
  v_fmac_f32 v43, v50, v50
  v_fmac_f32 v43, v51, v51
  v_cvt_pk_bf16_f32 v42, v40, v40
  v_and_b32 v42, 0xffff0000, v42
  v_add_f32_dpp v43, v43, v43 row_ror:8 row_mask:0xf bank_mask:0xf
  s_nop 1
  v_add_f32_dpp v43, v43, v43 row_ror:4 row_mask:0xf bank_mask:0xf
  s_nop 1
  v_add_f32_dpp v43, v43, v43 row_ror:2 row_mask:0xf bank_mask:0xf
  s_nop 1
  v_add_f32_dpp v43, v43, v43 row_ror:1 row_mask:0xf bank_mask:0xf
  v_mov_b32 v41, v43
  s_nop 1
  v_permlane16_swap_b32 v43, v41
  v_add_f32 v43, v43, v41
  v_mov_b32 v41, v43
  s_nop 1
  v_permlane32_swap_b32 v43, v41
  v_add_f32 v43, v43, v41
  v_sub_f32 v44, v28, v42
  v_sub_f32 v45, v29, v42
  v_sub_f32 v46, v30, v42
  v_sub_f32 v47, v31, v42
  v_sub_f32 v48, v32, v42
  v_sub_f32 v49, v33, v42
  v_sub_f32 v50, v34, v42
  v_sub_f32 v51, v35, v42
  v_mul_f32 v43, 0x3b000000, v43
  v_cvt_pk_bf16_f32 v43, v43, v43
  v_and_b32 v43, 0xffff0000, v43
  v_add_f32 v43, 0x3727c5ac, v43
  v_cvt_pk_bf16_f32 v43, v43, v43
  v_and_b32 v43, 0xffff0000, v43
  v_sqrt_f32 v43, v43
  s_nop 0
  v_cvt_pk_bf16_f32 v43, v43, v43
  v_and_b32 v43, 0xffff0000, v43
  v_rcp_f32 v43, v43
  v_cvt_pk_bf16_f32 v36, v44, v45
  v_cvt_pk_bf16_f32 v37, v46, v47
  v_cvt_pk_bf16_f32 v38, v48, v49
  v_cvt_pk_bf16_f32 v39, v50, v51
  v_lshlrev_b32 v44, 16, v36
  v_and_b32 v45, 0xffff0000, v36
  v_lshlrev_b32 v46, 16, v37
  v_and_b32 v47, 0xffff0000, v37
  v_lshlrev_b32 v48, 16, v38
  v_and_b32 v49, 0xffff0000, v38
  v_lshlrev_b32 v50, 16, v39
  v_and_b32 v51, 0xffff0000, v39
  v_mul_f32 v44, v44, v43
  v_mul_f32 v45, v45, v43
  v_mul_f32 v46, v46, v43
  v_mul_f32 v47, v47, v43
  v_mul_f32 v48, v48, v43
  v_mul_f32 v49, v49, v43
  v_mul_f32 v50, v50, v43
  v_mul_f32 v51, v51, v43
  v_cvt_pk_bf16_f32 v36, v44, v45
  v_cvt_pk_bf16_f32 v37, v46, v47
  v_cvt_pk_bf16_f32 v38, v48, v49
  v_cvt_pk_bf16_f32 v39, v50, v51
  s_cmp_lt_u32 s72, 2097152
  s_cbranch_scc0 ib_46
  buffer_store_dwordx4 v[36:39], v16, s[44:47], s72 offen sc1
  s_nop 1
ib_46:
  s_add_u32 s72, s72, 212992
  v_lshlrev_b32 v28, 16, v96
  v_and_b32 v29, 0xffff0000, v96
  v_lshlrev_b32 v30, 16, v97
  v_and_b32 v31, 0xffff0000, v97
  v_lshlrev_b32 v32, 16, v98
  v_and_b32 v33, 0xffff0000, v98
  v_lshlrev_b32 v34, 16, v99
  v_and_b32 v35, 0xffff0000, v99
  v_add_f32 v40, v28, v29
  v_add_f32 v40, v40, v30
  v_add_f32 v40, v40, v31
  v_add_f32 v40, v40, v32
  v_add_f32 v40, v40, v33
  v_add_f32 v40, v40, v34
  v_add_f32 v40, v40, v35
  s_nop 1
  v_add_f32_dpp v40, v40, v40 row_ror:8 row_mask:0xf bank_mask:0xf
  s_nop 1
  v_add_f32_dpp v40, v40, v40 row_ror:4 row_mask:0xf bank_mask:0xf
  s_nop 1
  v_add_f32_dpp v40, v40, v40 row_ror:2 row_mask:0xf bank_mask:0xf
  s_nop 1
  v_add_f32_dpp v40, v40, v40 row_ror:1 row_mask:0xf bank_mask:0xf
  v_mov_b32 v41, v40
  s_nop 1
  v_permlane16_swap_b32 v40, v41
  v_add_f32 v40, v40, v41
  v_mov_b32 v41, v40
  s_nop 1
  v_permlane32_swap_b32 v40, v41
  v_add_f32 v40, v40, v41
  v_mul_f32 v40, 0x3b000000, v40
  v_sub_f32 v44, v28, v40
  v_sub_f32 v45, v29, v40
  v_sub_f32 v46, v30, v40
  v_sub_f32 v47, v31, v40
  v_sub_f32 v48, v32, v40
  v_sub_f32 v49, v33, v40
  v_sub_f32 v50, v34, v40
  v_sub_f32 v51, v35, v40
  v_mul_f32 v43, v44, v44
  v_fmac_f32 v43, v45, v45
  v_fmac_f32 v43, v46, v46
  v_fmac_f32 v43, v47, v47
  v_fmac_f32 v43, v48, v48
  v_fmac_f32 v43, v49, v49
  v_fmac_f32 v43, v50, v50
  v_fmac_f32 v43, v51, v51
  v_cvt_pk_bf16_f32 v42, v40, v40
  v_and_b32 v42, 0xffff0000, v42
  v_add_f32_dpp v43, v43, v43 row_ror:8 row_mask:0xf bank_mask:0xf
  s_nop 1
  v_add_f32_dpp v43, v43, v43 row_ror:4 row_mask:0xf bank_mask:0xf
  s_nop 1
  v_add_f32_dpp v43, v43, v43 row_ror:2 row_mask:0xf bank_mask:0xf
  s_nop 1
  v_add_f32_dpp v43, v43, v43 row_ror:1 row_mask:0xf bank_mask:0xf
  v_mov_b32 v41, v43
  s_nop 1
  v_permlane16_swap_b32 v43, v41
  v_add_f32 v43, v43, v41
  v_mov_b32 v41, v43
  s_nop 1
  v_permlane32_swap_b32 v43, v41
  v_add_f32 v43, v43, v41
  v_sub_f32 v44, v28, v42
  v_sub_f32 v45, v29, v42
  v_sub_f32 v46, v30, v42
  v_sub_f32 v47, v31, v42
  v_sub_f32 v48, v32, v42
  v_sub_f32 v49, v33, v42
  v_sub_f32 v50, v34, v42
  v_sub_f32 v51, v35, v42
  v_mul_f32 v43, 0x3b000000, v43
  v_cvt_pk_bf16_f32 v43, v43, v43
  v_and_b32 v43, 0xffff0000, v43
  v_add_f32 v43, 0x3727c5ac, v43
  v_cvt_pk_bf16_f32 v43, v43, v43
  v_and_b32 v43, 0xffff0000, v43
  v_sqrt_f32 v43, v43
  s_nop 0
  v_cvt_pk_bf16_f32 v43, v43, v43
  v_and_b32 v43, 0xffff0000, v43
  v_rcp_f32 v43, v43
  v_cvt_pk_bf16_f32 v36, v44, v45
  v_cvt_pk_bf16_f32 v37, v46, v47
  v_cvt_pk_bf16_f32 v38, v48, v49
  v_cvt_pk_bf16_f32 v39, v50, v51
  v_lshlrev_b32 v44, 16, v36
  v_and_b32 v45, 0xffff0000, v36
  v_lshlrev_b32 v46, 16, v37
  v_and_b32 v47, 0xffff0000, v37
  v_lshlrev_b32 v48, 16, v38
  v_and_b32 v49, 0xffff0000, v38
  v_lshlrev_b32 v50, 16, v39
  v_and_b32 v51, 0xffff0000, v39
  v_mul_f32 v44, v44, v43
  v_mul_f32 v45, v45, v43
  v_mul_f32 v46, v46, v43
  v_mul_f32 v47, v47, v43
  v_mul_f32 v48, v48, v43
  v_mul_f32 v49, v49, v43
  v_mul_f32 v50, v50, v43
  v_mul_f32 v51, v51, v43
  v_cvt_pk_bf16_f32 v36, v44, v45
  v_cvt_pk_bf16_f32 v37, v46, v47
  v_cvt_pk_bf16_f32 v38, v48, v49
  v_cvt_pk_bf16_f32 v39, v50, v51
  s_cmp_lt_u32 s72, 2097152
  s_cbranch_scc0 ib_47
  buffer_store_dwordx4 v[36:39], v16, s[44:47], s72 offen sc1
  s_nop 1
ib_47:
  s_add_u32 s72, s72, 212992
  v_lshlrev_b32 v28, 16, v100
  v_and_b32 v29, 0xffff0000, v100
  v_lshlrev_b32 v30, 16, v101
  v_and_b32 v31, 0xffff0000, v101
  v_lshlrev_b32 v32, 16, v102
  v_and_b32 v33, 0xffff0000, v102
  v_lshlrev_b32 v34, 16, v103
  v_and_b32 v35, 0xffff0000, v103
  v_add_f32 v40, v28, v29
  v_add_f32 v40, v40, v30
  v_add_f32 v40, v40, v31
  v_add_f32 v40, v40, v32
  v_add_f32 v40, v40, v33
  v_add_f32 v40, v40, v34
  v_add_f32 v40, v40, v35
  s_nop 1
  v_add_f32_dpp v40, v40, v40 row_ror:8 row_mask:0xf bank_mask:0xf
  s_nop 1
  v_add_f32_dpp v40, v40, v40 row_ror:4 row_mask:0xf bank_mask:0xf
  s_nop 1
  v_add_f32_dpp v40, v40, v40 row_ror:2 row_mask:0xf bank_mask:0xf
  s_nop 1
  v_add_f32_dpp v40, v40, v40 row_ror:1 row_mask:0xf bank_mask:0xf
  v_mov_b32 v41, v40
  s_nop 1
  v_permlane16_swap_b32 v40, v41
  v_add_f32 v40, v40, v41
  v_mov_b32 v41, v40
  s_nop 1
  v_permlane32_swap_b32 v40, v41
  v_add_f32 v40, v40, v41
  v_mul_f32 v40, 0x3b000000, v40
  v_sub_f32 v44, v28, v40
  v_sub_f32 v45, v29, v40
  v_sub_f32 v46, v30, v40
  v_sub_f32 v47, v31, v40
  v_sub_f32 v48, v32, v40
  v_sub_f32 v49, v33, v40
  v_sub_f32 v50, v34, v40
  v_sub_f32 v51, v35, v40
  v_mul_f32 v43, v44, v44
  v_fmac_f32 v43, v45, v45
  v_fmac_f32 v43, v46, v46
  v_fmac_f32 v43, v47, v47
  v_fmac_f32 v43, v48, v48
  v_fmac_f32 v43, v49, v49
  v_fmac_f32 v43, v50, v50
  v_fmac_f32 v43, v51, v51
  v_cvt_pk_bf16_f32 v42, v40, v40
  v_and_b32 v42, 0xffff0000, v42
  v_add_f32_dpp v43, v43, v43 row_ror:8 row_mask:0xf bank_mask:0xf
  s_nop 1
  v_add_f32_dpp v43, v43, v43 row_ror:4 row_mask:0xf bank_mask:0xf
  s_nop 1
  v_add_f32_dpp v43, v43, v43 row_ror:2 row_mask:0xf bank_mask:0xf
  s_nop 1
  v_add_f32_dpp v43, v43, v43 row_ror:1 row_mask:0xf bank_mask:0xf
  v_mov_b32 v41, v43
  s_nop 1
  v_permlane16_swap_b32 v43, v41
  v_add_f32 v43, v43, v41
  v_mov_b32 v41, v43
  s_nop 1
  v_permlane32_swap_b32 v43, v41
  v_add_f32 v43, v43, v41
  v_sub_f32 v44, v28, v42
  v_sub_f32 v45, v29, v42
  v_sub_f32 v46, v30, v42
  v_sub_f32 v47, v31, v42
  v_sub_f32 v48, v32, v42
  v_sub_f32 v49, v33, v42
  v_sub_f32 v50, v34, v42
  v_sub_f32 v51, v35, v42
  v_mul_f32 v43, 0x3b000000, v43
  v_cvt_pk_bf16_f32 v43, v43, v43
  v_and_b32 v43, 0xffff0000, v43
  v_add_f32 v43, 0x3727c5ac, v43
  v_cvt_pk_bf16_f32 v43, v43, v43
  v_and_b32 v43, 0xffff0000, v43
  v_sqrt_f32 v43, v43
  s_nop 0
  v_cvt_pk_bf16_f32 v43, v43, v43
  v_and_b32 v43, 0xffff0000, v43
  v_rcp_f32 v43, v43
  v_cvt_pk_bf16_f32 v36, v44, v45
  v_cvt_pk_bf16_f32 v37, v46, v47
  v_cvt_pk_bf16_f32 v38, v48, v49
  v_cvt_pk_bf16_f32 v39, v50, v51
  v_lshlrev_b32 v44, 16, v36
  v_and_b32 v45, 0xffff0000, v36
  v_lshlrev_b32 v46, 16, v37
  v_and_b32 v47, 0xffff0000, v37
  v_lshlrev_b32 v48, 16, v38
  v_and_b32 v49, 0xffff0000, v38
  v_lshlrev_b32 v50, 16, v39
  v_and_b32 v51, 0xffff0000, v39
  v_mul_f32 v44, v44, v43
  v_mul_f32 v45, v45, v43
  v_mul_f32 v46, v46, v43
  v_mul_f32 v47, v47, v43
  v_mul_f32 v48, v48, v43
  v_mul_f32 v49, v49, v43
  v_mul_f32 v50, v50, v43
  v_mul_f32 v51, v51, v43
  v_cvt_pk_bf16_f32 v36, v44, v45
  v_cvt_pk_bf16_f32 v37, v46, v47
  v_cvt_pk_bf16_f32 v38, v48, v49
  v_cvt_pk_bf16_f32 v39, v50, v51
  s_cmp_lt_u32 s72, 2097152
  s_cbranch_scc0 ib_48
  buffer_store_dwordx4 v[36:39], v16, s[44:47], s72 offen sc1
  s_nop 1
ib_48:
  s_add_u32 s72, s72, 212992
  s_mov_b32 s60, s40
  s_mov_b32 s61, s41
  s_mov_b32 s62, 256
  s_mov_b32 s63, 0x00020000
  s_waitcnt vmcnt(0)
  v_mov_b32 v24, 1
  s_mov_b64 exec, 1
  buffer_atomic_add v24, off, s[60:63], 0 offset:192 sc1
  s_mov_b64 exec, -1
  s_mov_b32 s60, s40
  s_mov_b32 s61, s41
  s_mov_b32 s62, 256
  s_mov_b32 s63, 0x00020000
iw_49:
  buffer_load_dword v24, off, s[60:63], 0 offset:192 sc1
  s_waitcnt vmcnt(0)
  v_readfirstlane_b32 s72, v24
  s_nop 0
  s_cmp_ge_u32 s72, 208
  s_nop 1
  s_cbranch_scc1 id_50
  s_sub_u32 s69, s69, 1
  s_cbranch_scc0 iw_49
  s_branch mega_exit
id_50:
ar_top:
  s_lshr_b32 s82, s80, 5
  s_add_u32 s93, s82, 1
  s_and_b32 s82, s82, 3
  s_mul_i32 s82, s82, 524288
  s_and_b32 s83, s80, 31
  s_lshl_b32 s83, s83, 10
  s_add_u32 s82, s82, s83
  s_lshl_b32 s87, s80, 10
  s_lshr_b32 s72, s83, 6
  s_lshl_b32 s73, s64, 9
  s_add_u32 s72, s72, s73
  s_add_u32 s72, s72, 14680064
  buffer_load_dwordx4 v[24:27], off, s[44:47], s72 sc1
  s_add_u32 s74, s93, 1
  s_lshl_b32 s72, s93, 20
  s_lshl_b32 s73, s83, 5
  s_add_u32 s72, s72, s73
  s_lshl_b32 s73, s64, 26
  s_add_u32 s72, s72, s73
  s_add_u32 s72, s72, 134217728
  v_lshlrev_b32 v28, 6, v1
  s_waitcnt vmcnt(0)
  v_min3_u32 v24, v24, v25, v26
  v_min_u32 v24, v24, v27
  v_cmp_gt_u32 vcc, s74, v24
  s_nop 0
  s_cbranch_vccnz wm_51
  buffer_load_dword v29, v28, s[44:47], s72 offen
  s_add_i32 s72, s72, 4096
  buffer_load_dword v30, v28, s[44:47], s72 offen
  s_add_i32 s72, s72, 12288
  buffer_load_dword v31, v28, s[44:47], s72 offen
  s_add_i32 s72, s72, 4096
  buffer_load_dword v32, v28, s[44:47], s72 offen
  s_add_i32 s72, s72, -12288
  buffer_load_dword v33, v28, s[44:47], s72 offen
  s_add_i32 s72, s72, 4096
  buffer_load_dword v34, v28, s[44:47], s72 offen
wm_51:
pf_52:
  buffer_load_dwordx2 v[24:25], v15, s[44:47], 0 offen sc1
  s_waitcnt vmcnt(0)
  v_min_u32 v24, v24, v25
  v_cmp_gt_u32 vcc, s93, v24
  s_nop 0
  s_cbranch_vccz pd_53
  s_nop 2
pr_54:
  s_sub_u32 s69, s69, 1
  s_cbranch_scc0 pf_52
  s_branch mega_exit
pd_53:
  buffer_load_dwordx4 v[64:67], v13, s[44:47], s82 offen sc1
  s_add_u32 s82, s82, 32768
  buffer_load_dwordx4 v[68:71], v13, s[44:47], s82 offen sc1
  s_add_u32 s82, s82, 32768
  buffer_load_dwordx4 v[72:75], v13, s[44:47], s82 offen sc1
  s_add_u32 s82, s82, 32768
  buffer_load_dwordx4 v[76:79], v13, s[44:47], s82 offen sc1
  s_add_u32 s82, s82, 32768
  buffer_load_dwordx4 v[80:83], v13, s[44:47], s82 offen sc1
  s_add_u32 s82, s82, 32768
  buffer_load_dwordx4 v[84:87], v13, s[44:47], s82 offen sc1
  s_add_u32 s82, s82, 32768
  buffer_load_dwordx4 v[88:91], v13, s[44:47], s82 offen sc1
  s_add_u32 s82, s82, 32768
  buffer_load_dwordx4 v[92:95], v13, s[44:47], s82 offen sc1
  s_add_u32 s82, s82, 32768
  buffer_load_dwordx4 v[96:99], v13, s[44:47], s82 offen sc1
  s_add_u32 s82, s82, 32768
  buffer_load_dwordx4 v[100:103], v13, s[44:47], s82 offen sc1
  s_add_u32 s82, s82, 32768
  buffer_load_dwordx4 v[104:107], v13, s[44:47], s82 offen sc1
  s_add_u32 s82, s82, 32768
  buffer_load_dwordx4 v[108:111], v13, s[44:47], s82 offen sc1
  s_add_u32 s82, s82, 32768
  buffer_load_dwordx4 v[112:115], v13, s[44:47], s82 offen sc1
  s_add_u32 s82, s82, 32768
  buffer_load_dwordx4 v[116:119], v13, s[44:47], s82 offen sc1
  s_add_u32 s82, s82, 32768
  buffer_load_dwordx4 v[120:123], v13, s[44:47], s82 offen sc1
  s_add_u32 s82, s82, 32768
  buffer_load_dwordx4 v[124:127], v13, s[44:47], s82 offen sc1
  s_add_u32 s72, s87, s91
  buffer_load_dwordx4 v[20:23], v16, s[56:59], s72 offen
  s_waitcnt vmcnt(16)
  v_dot2_f32_bf16 v28, v64, s94, 0
  v_dot2_f32_bf16 v29, v64, s95, 0
  v_dot2_f32_bf16 v30, v65, s94, 0
  v_dot2_f32_bf16 v31, v65, s95, 0
  v_dot2_f32_bf16 v32, v66, s94, 0
  v_dot2_f32_bf16 v33, v66, s95, 0
  v_dot2_f32_bf16 v34, v67, s94, 0
  v_dot2_f32_bf16 v35, v67, s95, 0
  s_waitcnt vmcnt(15)
  v_dot2_f32_bf16 v28, v68, s94, v28
  v_dot2_f32_bf16 v29, v68, s95, v29
  v_dot2_f32_bf16 v30, v69, s94, v30
  v_dot2_f32_bf16 v31, v69, s95, v31
  v_dot2_f32_bf16 v32, v70, s94, v32
  v_dot2_f32_bf16 v33, v70, s95, v33
  v_dot2_f32_bf16 v34, v71, s94, v34
  v_dot2_f32_bf16 v35, v71, s95, v35
  s_waitcnt vmcnt(14)
  v_dot2_f32_bf16 v28, v72, s94, v28
  v_dot2_f32_bf16 v29, v72, s95, v29
  v_dot2_f32_bf16 v30, v73, s94, v30
  v_dot2_f32_bf16 v31, v73, s95, v31
  v_dot2_f32_bf16 v32, v74, s94, v32
  v_dot2_f32_bf16 v33, v74, s95, v33
  v_dot2_f32_bf16 v34, v75, s94, v34
  v_dot2_f32_bf16 v35, v75, s95, v35
  s_waitcnt vmcnt(13)
  v_dot2_f32_bf16 v28, v76, s94, v28
  v_dot2_f32_bf16 v29, v76, s95, v29
  v_dot2_f32_bf16 v30, v77, s94, v30
  v_dot2_f32_bf16 v31, v77, s95, v31
  v_dot2_f32_bf16 v32, v78, s94, v32
  v_dot2_f32_bf16 v33, v78, s95, v33
  v_dot2_f32_bf16 v34, v79, s94, v34
  v_dot2_f32_bf16 v35, v79, s95, v35
  s_waitcnt vmcnt(12)
  v_dot2_f32_bf16 v28, v80, s94, v28
  v_dot2_f32_bf16 v29, v80, s95, v29
  v_dot2_f32_bf16 v30, v81, s94, v30
  v_dot2_f32_bf16 v31, v81, s95, v31
  v_dot2_f32_bf16 v32, v82, s94, v32
  v_dot2_f32_bf16 v33, v82, s95, v33
  v_dot2_f32_bf16 v34, v83, s94, v34
  v_dot2_f32_bf16 v35, v83, s95, v35
  s_waitcnt vmcnt(11)
  v_dot2_f32_bf16 v28, v84, s94, v28
  v_dot2_f32_bf16 v29, v84, s95, v29
  v_dot2_f32_bf16 v30, v85, s94, v30
  v_dot2_f32_bf16 v31, v85, s95, v31
  v_dot2_f32_bf16 v32, v86, s94, v32
  v_dot2_f32_bf16 v33, v86, s95, v33
  v_dot2_f32_bf16 v34, v87, s94, v34
  v_dot2_f32_bf16 v35, v87, s95, v35
  s_waitcnt vmcnt(10)
  v_dot2_f32_bf16 v28, v88, s94, v28
  v_dot2_f32_bf16 v29, v88, s95, v29
  v_dot2_f32_bf16 v30, v89, s94, v30
  v_dot2_f32_bf16 v31, v89, s95, v31
  v_dot2_f32_bf16 v32, v90, s94, v32
  v_dot2_f32_bf16 v33, v90, s95, v33
  v_dot2_f32_bf16 v34, v91, s94, v34
  v_dot2_f32_bf16 v35, v91, s95, v35
  s_waitcnt vmcnt(9)
  v_dot2_f32_bf16 v28, v92, s94, v28
  v_dot2_f32_bf16 v29, v92, s95, v29
  v_dot2_f32_bf16 v30, v93, s94, v30
  v_dot2_f32_bf16 v31, v93, s95, v31
  v_dot2_f32_bf16 v32, v94, s94, v32
  v_dot2_f32_bf16 v33, v94, s95, v33
  v_dot2_f32_bf16 v34, v95, s94, v34
  v_dot2_f32_bf16 v35, v95, s95, v35
  s_waitcnt vmcnt(8)
  v_dot2_f32_bf16 v28, v96, s94, v28
  v_dot2_f32_bf16 v29, v96, s95, v29
  v_dot2_f32_bf16 v30, v97, s94, v30
  v_dot2_f32_bf16 v31, v97, s95, v31
  v_dot2_f32_bf16 v32, v98, s94, v32
  v_dot2_f32_bf16 v33, v98, s95, v33
  v_dot2_f32_bf16 v34, v99, s94, v34
  v_dot2_f32_bf16 v35, v99, s95, v35
  s_waitcnt vmcnt(7)
  v_dot2_f32_bf16 v28, v100, s94, v28
  v_dot2_f32_bf16 v29, v100, s95, v29
  v_dot2_f32_bf16 v30, v101, s94, v30
  v_dot2_f32_bf16 v31, v101, s95, v31
  v_dot2_f32_bf16 v32, v102, s94, v32
  v_dot2_f32_bf16 v33, v102, s95, v33
  v_dot2_f32_bf16 v34, v103, s94, v34
  v_dot2_f32_bf16 v35, v103, s95, v35
  s_waitcnt vmcnt(6)
  v_dot2_f32_bf16 v28, v104, s94, v28
  v_dot2_f32_bf16 v29, v104, s95, v29
  v_dot2_f32_bf16 v30, v105, s94, v30
  v_dot2_f32_bf16 v31, v105, s95, v31
  v_dot2_f32_bf16 v32, v106, s94, v32
  v_dot2_f32_bf16 v33, v106, s95, v33
  v_dot2_f32_bf16 v34, v107, s94, v34
  v_dot2_f32_bf16 v35, v107, s95, v35
  s_waitcnt vmcnt(5)
  v_dot2_f32_bf16 v28, v108, s94, v28
  v_dot2_f32_bf16 v29, v108, s95, v29
  v_dot2_f32_bf16 v30, v109, s94, v30
  v_dot2_f32_bf16 v31, v109, s95, v31
  v_dot2_f32_bf16 v32, v110, s94, v32
  v_dot2_f32_bf16 v33, v110, s95, v33
  v_dot2_f32_bf16 v34, v111, s94, v34
  v_dot2_f32_bf16 v35, v111, s95, v35
  s_waitcnt vmcnt(4)
  v_dot2_f32_bf16 v28, v112, s94, v28
  v_dot2_f32_bf16 v29, v112, s95, v29
  v_dot2_f32_bf16 v30, v113, s94, v30
  v_dot2_f32_bf16 v31, v113, s95, v31
  v_dot2_f32_bf16 v32, v114, s94, v32
  v_dot2_f32_bf16 v33, v114, s95, v33
  v_dot2_f32_bf16 v34, v115, s94, v34
  v_dot2_f32_bf16 v35, v115, s95, v35
  s_waitcnt vmcnt(3)
  v_dot2_f32_bf16 v28, v116, s94, v28
  v_dot2_f32_bf16 v29, v116, s95, v29
  v_dot2_f32_bf16 v30, v117, s94, v30
  v_dot2_f32_bf16 v31, v117, s95, v31
  v_dot2_f32_bf16 v32, v118, s94, v32
  v_dot2_f32_bf16 v33, v118, s95, v33
  v_dot2_f32_bf16 v34, v119, s94, v34
  v_dot2_f32_bf16 v35, v119, s95, v35
  s_waitcnt vmcnt(2)
  v_dot2_f32_bf16 v28, v120, s94, v28
  v_dot2_f32_bf16 v29, v120, s95, v29
  v_dot2_f32_bf16 v30, v121, s94, v30
  v_dot2_f32_bf16 v31, v121, s95, v31
  v_dot2_f32_bf16 v32, v122, s94, v32
  v_dot2_f32_bf16 v33, v122, s95, v33
  v_dot2_f32_bf16 v34, v123, s94, v34
  v_dot2_f32_bf16 v35, v123, s95, v35
  s_waitcnt vmcnt(1)
  v_dot2_f32_bf16 v28, v124, s94, v28
  v_dot2_f32_bf16 v29, v124, s95, v29
  v_dot2_f32_bf16 v30, v125, s94, v30
  v_dot2_f32_bf16 v31, v125, s95, v31
  v_dot2_f32_bf16 v32, v126, s94, v32
  v_dot2_f32_bf16 v33, v126, s95, v33
  v_dot2_f32_bf16 v34, v127, s94, v34
  v_dot2_f32_bf16 v35, v127, s95, v35
  v_cvt_pk_bf16_f32 v24, v28, v29
  v_cvt_pk_bf16_f32 v25, v30, v31
  v_cvt_pk_bf16_f32 v26, v32, v33
  v_cvt_pk_bf16_f32 v27, v34, v35
  s_waitcnt vmcnt(0)
  v_lshlrev_b32 v28, 16, v24
  v_and_b32 v29, 0xffff0000, v24
  v_lshlrev_b32 v30, 16, v25
  v_and_b32 v31, 0xffff0000, v25
  v_lshlrev_b32 v32, 16, v26
  v_and_b32 v33, 0xffff0000, v26
  v_lshlrev_b32 v34, 16, v27
  v_and_b32 v35, 0xffff0000, v27
  v_lshlrev_b32 v36, 16, v20
  v_and_b32 v37, 0xffff0000, v20
  v_lshlrev_b32 v38, 16, v21
  v_and_b32 v39, 0xffff0000, v21
  v_lshlrev_b32 v40, 16, v22
  v_and_b32 v41, 0xffff0000, v22
  v_lshlrev_b32 v42, 16, v23
  v_and_b32 v43, 0xffff0000, v23
  v_add_f32 v28, v28, v36
  v_add_f32 v29, v29, v37
  v_add_f32 v30, v30, v38
  v_add_f32 v31, v31, v39
  v_add_f32 v32, v32, v40
  v_add_f32 v33, v33, v41
  v_add_f32 v34, v34, v42
  v_add_f32 v35, v35, v43
  v_cvt_pk_bf16_f32 v24, v28, v29
  v_cvt_pk_bf16_f32 v25, v30, v31
  v_cvt_pk_bf16_f32 v26, v32, v33
  v_cvt_pk_bf16_f32 v27, v34, v35
  s_add_u32 s72, s87, s81
  s_add_u32 s73, s72, 10485760
  s_add_u32 s72, s72, 6291456
  buffer_store_dwordx4 v[24:27], v16, s[44:47], s72 offen sc1
  v_lshlrev_b32 v28, 16, v24
  v_and_b32 v29, 0xffff0000, v24
  v_lshlrev_b32 v30, 16, v25
  v_and_b32 v31, 0xffff0000, v25
  v_lshlrev_b32 v32, 16, v26
  v_and_b32 v33, 0xffff0000, v26
  v_lshlrev_b32 v34, 16, v27
  v_and_b32 v35, 0xffff0000, v27
  v_add_f32 v40, v28, v29
  v_add_f32 v40, v40, v30
  v_add_f32 v40, v40, v31
  v_add_f32 v40, v40, v32
  v_add_f32 v40, v40, v33
  v_add_f32 v40, v40, v34
  v_add_f32 v40, v40, v35
  s_nop 1
  v_add_f32_dpp v40, v40, v40 row_ror:8 row_mask:0xf bank_mask:0xf
  s_nop 1
  v_add_f32_dpp v40, v40, v40 row_ror:4 row_mask:0xf bank_mask:0xf
  s_nop 1
  v_add_f32_dpp v40, v40, v40 row_ror:2 row_mask:0xf bank_mask:0xf
  s_nop 1
  v_add_f32_dpp v40, v40, v40 row_ror:1 row_mask:0xf bank_mask:0xf
  v_mov_b32 v41, v40
  s_nop 1
  v_permlane16_swap_b32 v40, v41
  v_add_f32 v40, v40, v41
  v_mov_b32 v41, v40
  s_nop 1
  v_permlane32_swap_b32 v40, v41
  v_add_f32 v40, v40, v41
  v_mul_f32 v40, 0x3b000000, v40
  v_sub_f32 v44, v28, v40
  v_sub_f32 v45, v29, v40
  v_sub_f32 v46, v30, v40
  v_sub_f32 v47, v31, v40
  v_sub_f32 v48, v32, v40
  v_sub_f32 v49, v33, v40
  v_sub_f32 v50, v34, v40
  v_sub_f32 v51, v35, v40
  v_mul_f32 v43, v44, v44
  v_fmac_f32 v43, v45, v45
  v_fmac_f32 v43, v46, v46
  v_fmac_f32 v43, v47, v47
  v_fmac_f32 v43, v48, v48
  v_fmac_f32 v43, v49, v49
  v_fmac_f32 v43, v50, v50
  v_fmac_f32 v43, v51, v51
  v_cvt_pk_bf16_f32 v42, v40, v40
  v_and_b32 v42, 0xffff0000, v42
  v_add_f32_dpp v43, v43, v43 row_ror:8 row_mask:0xf bank_mask:0xf
  s_nop 1
  v_add_f32_dpp v43, v43, v43 row_ror:4 row_mask:0xf bank_mask:0xf
  s_nop 1
  v_add_f32_dpp v43, v43, v43 row_ror:2 row_mask:0xf bank_mask:0xf
  s_nop 1
  v_add_f32_dpp v43, v43, v43 row_ror:1 row_mask:0xf bank_mask:0xf
  v_mov_b32 v41, v43
  s_nop 1
  v_permlane16_swap_b32 v43, v41
  v_add_f32 v43, v43, v41
  v_mov_b32 v41, v43
  s_nop 1
  v_permlane32_swap_b32 v43, v41
  v_add_f32 v43, v43, v41
  v_sub_f32 v44, v28, v42
  v_sub_f32 v45, v29, v42
  v_sub_f32 v46, v30, v42
  v_sub_f32 v47, v31, v42
  v_sub_f32 v48, v32, v42
  v_sub_f32 v49, v33, v42
  v_sub_f32 v50, v34, v42
  v_sub_f32 v51, v35, v42
  v_mul_f32 v43, 0x3b000000, v43
  v_cvt_pk_bf16_f32 v43, v43, v43
  v_and_b32 v43, 0xffff0000, v43
  v_add_f32 v43, 0x3727c5ac, v43
  v_cvt_pk_bf16_f32 v43, v43, v43
  v_and_b32 v43, 0xffff0000, v43
  v_sqrt_f32 v43, v43
  s_nop 0
  v_cvt_pk_bf16_f32 v43, v43, v43
  v_and_b32 v43, 0xffff0000, v43
  v_rcp_f32 v43, v43
  v_cvt_pk_bf16_f32 v36, v44, v45
  v_cvt_pk_bf16_f32 v37, v46, v47
  v_cvt_pk_bf16_f32 v38, v48, v49
  v_cvt_pk_bf16_f32 v39, v50, v51
  v_lshlrev_b32 v44, 16, v36
  v_and_b32 v45, 0xffff0000, v36
  v_lshlrev_b32 v46, 16, v37
  v_and_b32 v47, 0xffff0000, v37
  v_lshlrev_b32 v48, 16, v38
  v_and_b32 v49, 0xffff0000, v38
  v_lshlrev_b32 v50, 16, v39
  v_and_b32 v51, 0xffff0000, v39
  v_mul_f32 v44, v44, v43
  v_mul_f32 v45, v45, v43
  v_mul_f32 v46, v46, v43
  v_mul_f32 v47, v47, v43
  v_mul_f32 v48, v48, v43
  v_mul_f32 v49, v49, v43
  v_mul_f32 v50, v50, v43
  v_mul_f32 v51, v51, v43
  v_cvt_pk_bf16_f32 v36, v44, v45
  v_cvt_pk_bf16_f32 v37, v46, v47
  v_cvt_pk_bf16_f32 v38, v48, v49
  v_cvt_pk_bf16_f32 v39, v50, v51
  buffer_store_dwordx4 v[36:39], v16, s[44:47], s73 offen sc1
  s_nop 1
re_55:
  s_lshl_b32 s72, s80, 2
  v_mov_b32 v28, 1
  s_waitcnt vmcnt(0)
  buffer_store_dword v28, v14, s[44:47], s72 offen sc1
  s_add_u32 s80, s80, 64
  s_cmp_lt_u32 s80, 2048
  s_cbranch_scc1 ar_top
  s_branch mega_end
a_comp:
  s_mov_b32 s52, s26
  s_mov_b32 s53, s27
  s_mov_b32 s54, 4194304
  s_mov_b32 s55, 0x00020000
  s_lshl_b32 s72, s65, 18
  s_lshl_b32 s73, s66, 8
  s_add_u32 s72, s72, s73
  v_lshrrev_b32 v6, 5, v1
  v_lshlrev_b32 v5, 13, v6
  v_and_b32 v6, 31, v1
  v_lshl_add_u32 v5, v6, 3, v5
  v_add_u32 v5, s72, v5
  s_mov_b32 s72, 0
  buffer_load_dwordx2 v[24:25], v5, s[52:55], s72 offen
  s_mov_b32 s73, 1024
  buffer_load_dwordx2 v[26:27], v5, s[52:55], s73 offen
  s_mov_b32 s72, 2048
  buffer_load_dwordx2 v[28:29], v5, s[52:55], s72 offen
  s_mov_b32 s73, 3072
  buffer_load_dwordx2 v[30:31], v5, s[52:55], s73 offen
  s_mov_b32 s72, 4096
  buffer_load_dwordx2 v[32:33], v5, s[52:55], s72 offen
  s_mov_b32 s73, 5120
  buffer_load_dwordx2 v[34:35], v5, s[52:55], s73 offen
  s_mov_b32 s72, 6144
  buffer_load_dwordx2 v[36:37], v5, s[52:55], s72 offen
  s_mov_b32 s73, 7168
  buffer_load_dwordx2 v[38:39], v5, s[52:55], s73 offen
  s_mov_b32 s72, 16384
  buffer_load_dwordx2 v[40:41], v5, s[52:55], s72 offen
  s_mov_b32 s73, 17408
  buffer_load_dwordx2 v[42:43], v5, s[52:55], s73 offen
  s_mov_b32 s72, 18432
  buffer_load_dwordx2 v[44:45], v5, s[52:55], s72 offen
  s_mov_b32 s73, 19456
  buffer_load_dwordx2 v[46:47], v5, s[52:55], s73 offen
  s_mov_b32 s72, 20480
  buffer_load_dwordx2 v[48:49], v5, s[52:55], s72 offen
  s_mov_b32 s73, 21504
  buffer_load_dwordx2 v[50:51], v5, s[52:55], s73 offen
  s_mov_b32 s72, 22528
  buffer_load_dwordx2 v[52:53], v5, s[52:55], s72 offen
  s_mov_b32 s73, 23552
  buffer_load_dwordx2 v[54:55], v5, s[52:55], s73 offen
  s_mov_b32 s72, 32768
  buffer_load_dwordx2 v[56:57], v5, s[52:55], s72 offen
  s_mov_b32 s73, 33792
  buffer_load_dwordx2 v[58:59], v5, s[52:55], s73 offen
  s_mov_b32 s72, 34816
  buffer_load_dwordx2 v[60:61], v5, s[52:55], s72 offen
  s_mov_b32 s73, 35840
  buffer_load_dwordx2 v[62:63], v5, s[52:55], s73 offen
  s_mov_b32 s72, 36864
  buffer_load_dwordx2 v[64:65], v5, s[52:55], s72 offen
  s_mov_b32 s73, 37888
  buffer_load_dwordx2 v[66:67], v5, s[52:55], s73 offen
  s_mov_b32 s72, 38912
  buffer_load_dwordx2 v[68:69], v5, s[52:55], s72 offen
  s_mov_b32 s73, 39936
  buffer_load_dwordx2 v[70:71], v5, s[52:55], s73 offen
  s_mov_b32 s72, 49152
  buffer_load_dwordx2 v[72:73], v5, s[52:55], s72 offen
  s_mov_b32 s73, 50176
  buffer_load_dwordx2 v[74:75], v5, s[52:55], s73 offen
  s_mov_b32 s72, 51200
  buffer_load_dwordx2 v[76:77], v5, s[52:55], s72 offen
  s_mov_b32 s73, 52224
  buffer_load_dwordx2 v[78:79], v5, s[52:55], s73 offen
  s_mov_b32 s72, 53248
  buffer_load_dwordx2 v[80:81], v5, s[52:55], s72 offen
  s_mov_b32 s73, 54272
  buffer_load_dwordx2 v[82:83], v5, s[52:55], s73 offen
  s_mov_b32 s72, 55296
  buffer_load_dwordx2 v[84:85], v5, s[52:55], s72 offen
  s_mov_b32 s73, 56320
  buffer_load_dwordx2 v[86:87], v5, s[52:55], s73 offen
  s_mov_b32 s72, 65536
  buffer_load_dwordx2 v[88:89], v5, s[52:55], s72 offen
  s_mov_b32 s73, 66560
  buffer_load_dwordx2 v[90:91], v5, s[52:55], s73 offen
  s_mov_b32 s72, 67584
  buffer_load_dwordx2 v[92:93], v5, s[52:55], s72 offen
  s_mov_b32 s73, 68608
  buffer_load_dwordx2 v[94:95], v5, s[52:55], s73 offen
  s_mov_b32 s72, 69632
  buffer_load_dwordx2 v[96:97], v5, s[52:55], s72 offen
  s_mov_b32 s73, 70656
  buffer_load_dwordx2 v[98:99], v5, s[52:55], s73 offen
  s_mov_b32 s72, 71680
  buffer_load_dwordx2 v[100:101], v5, s[52:55], s72 offen
  s_mov_b32 s73, 72704
  buffer_load_dwordx2 v[102:103], v5, s[52:55], s73 offen
  s_mov_b32 s72, 81920
  buffer_load_dwordx2 v[104:105], v5, s[52:55], s72 offen
  s_mov_b32 s73, 82944
  buffer_load_dwordx2 v[106:107], v5, s[52:55], s73 offen
  s_mov_b32 s72, 83968
  buffer_load_dwordx2 v[108:109], v5, s[52:55], s72 offen
  s_mov_b32 s73, 84992
  buffer_load_dwordx2 v[110:111], v5, s[52:55], s73 offen
  s_mov_b32 s72, 86016
  buffer_load_dwordx2 v[112:113], v5, s[52:55], s72 offen
  s_mov_b32 s73, 87040
  buffer_load_dwordx2 v[114:115], v5, s[52:55], s73 offen
  s_mov_b32 s72, 88064
  buffer_load_dwordx2 v[116:117], v5, s[52:55], s72 offen
  s_mov_b32 s73, 89088
  buffer_load_dwordx2 v[118:119], v5, s[52:55], s73 offen
  s_mov_b32 s72, 98304
  buffer_load_dwordx2 v[120:121], v5, s[52:55], s72 offen
  s_mov_b32 s73, 99328
  buffer_load_dwordx2 v[122:123], v5, s[52:55], s73 offen
  s_mov_b32 s72, 100352
  buffer_load_dwordx2 v[124:125], v5, s[52:55], s72 offen
  s_mov_b32 s73, 101376
  buffer_load_dwordx2 v[126:127], v5, s[52:55], s73 offen
  s_mov_b32 s72, 102400
  buffer_load_dwordx2 v[128:129], v5, s[52:55], s72 offen
  s_mov_b32 s73, 103424
  buffer_load_dwordx2 v[130:131], v5, s[52:55], s73 offen
  s_mov_b32 s72, 104448
  buffer_load_dwordx2 v[132:133], v5, s[52:55], s72 offen
  s_mov_b32 s73, 105472
  buffer_load_dwordx2 v[134:135], v5, s[52:55], s73 offen
  s_mov_b32 s72, 114688
  buffer_load_dwordx2 v[136:137], v5, s[52:55], s72 offen
  s_mov_b32 s73, 115712
  buffer_load_dwordx2 v[138:139], v5, s[52:55], s73 offen
  s_mov_b32 s72, 116736
  buffer_load_dwordx2 v[140:141], v5, s[52:55], s72 offen
  s_mov_b32 s73, 117760
  buffer_load_dwordx2 v[142:143], v5, s[52:55], s73 offen
  s_mov_b32 s72, 118784
  buffer_load_dwordx2 v[144:145], v5, s[52:55], s72 offen
  s_mov_b32 s73, 119808
  buffer_load_dwordx2 v[146:147], v5, s[52:55], s73 offen
  s_mov_b32 s72, 120832
  buffer_load_dwordx2 v[148:149], v5, s[52:55], s72 offen
  s_mov_b32 s73, 121856
  buffer_load_dwordx2 v[150:151], v5, s[52:55], s73 offen
  s_waitcnt vmcnt(32)
  v_perm_b32 v152, v26, v24, s70
  v_accvgpr_write_b32 a0, v152
  v_perm_b32 v153, v26, v24, s71
  v_accvgpr_write_b32 a64, v153
  v_perm_b32 v154, v27, v25, s70
  v_accvgpr_write_b32 a128, v154
  v_perm_b32 v155, v27, v25, s71
  v_accvgpr_write_b32 a192, v155
  v_perm_b32 v152, v30, v28, s70
  v_accvgpr_write_b32 a1, v152
  v_perm_b32 v153, v30, v28, s71
  v_accvgpr_write_b32 a65, v153
  v_perm_b32 v154, v31, v29, s70
  v_accvgpr_write_b32 a129, v154
  v_perm_b32 v155, v31, v29, s71
  v_accvgpr_write_b32 a193, v155
  v_perm_b32 v152, v34, v32, s70
  v_accvgpr_write_b32 a2, v152
  v_perm_b32 v153, v34, v32, s71
  v_accvgpr_write_b32 a66, v153
  v_perm_b32 v154, v35, v33, s70
  v_accvgpr_write_b32 a130, v154
  v_perm_b32 v155, v35, v33, s71
  v_accvgpr_write_b32 a194, v155
  v_perm_b32 v152, v38, v36, s70
  v_accvgpr_write_b32 a3, v152
  v_perm_b32 v153, v38, v36, s71
  v_accvgpr_write_b32 a67, v153
  v_perm_b32 v154, v39, v37, s70
  v_accvgpr_write_b32 a131, v154
  v_perm_b32 v155, v39, v37, s71
  v_accvgpr_write_b32 a195, v155
  v_perm_b32 v152, v42, v40, s70
  v_accvgpr_write_b32 a4, v152
  v_perm_b32 v153, v42, v40, s71
  v_accvgpr_write_b32 a68, v153
  v_perm_b32 v154, v43, v41, s70
  v_accvgpr_write_b32 a132, v154
  v_perm_b32 v155, v43, v41, s71
  v_accvgpr_write_b32 a196, v155
  v_perm_b32 v152, v46, v44, s70
  v_accvgpr_write_b32 a5, v152
  v_perm_b32 v153, v46, v44, s71
  v_accvgpr_write_b32 a69, v153
  v_perm_b32 v154, v47, v45, s70
  v_accvgpr_write_b32 a133, v154
  v_perm_b32 v155, v47, v45, s71
  v_accvgpr_write_b32 a197, v155
  v_perm_b32 v152, v50, v48, s70
  v_accvgpr_write_b32 a6, v152
  v_perm_b32 v153, v50, v48, s71
  v_accvgpr_write_b32 a70, v153
  v_perm_b32 v154, v51, v49, s70
  v_accvgpr_write_b32 a134, v154
  v_perm_b32 v155, v51, v49, s71
  v_accvgpr_write_b32 a198, v155
  v_perm_b32 v152, v54, v52, s70
  v_accvgpr_write_b32 a7, v152
  v_perm_b32 v153, v54, v52, s71
  v_accvgpr_write_b32 a71, v153
  v_perm_b32 v154, v55, v53, s70
  v_accvgpr_write_b32 a135, v154
  v_perm_b32 v155, v55, v53, s71
  v_accvgpr_write_b32 a199, v155
  v_perm_b32 v152, v58, v56, s70
  v_accvgpr_write_b32 a8, v152
  v_perm_b32 v153, v58, v56, s71
  v_accvgpr_write_b32 a72, v153
  v_perm_b32 v154, v59, v57, s70
  v_accvgpr_write_b32 a136, v154
  v_perm_b32 v155, v59, v57, s71
  v_accvgpr_write_b32 a200, v155
  v_perm_b32 v152, v62, v60, s70
  v_accvgpr_write_b32 a9, v152
  v_perm_b32 v153, v62, v60, s71
  v_accvgpr_write_b32 a73, v153
  v_perm_b32 v154, v63, v61, s70
  v_accvgpr_write_b32 a137, v154
  v_perm_b32 v155, v63, v61, s71
  v_accvgpr_write_b32 a201, v155
  v_perm_b32 v152, v66, v64, s70
  v_accvgpr_write_b32 a10, v152
  v_perm_b32 v153, v66, v64, s71
  v_accvgpr_write_b32 a74, v153
  v_perm_b32 v154, v67, v65, s70
  v_accvgpr_write_b32 a138, v154
  v_perm_b32 v155, v67, v65, s71
  v_accvgpr_write_b32 a202, v155
  v_perm_b32 v152, v70, v68, s70
  v_accvgpr_write_b32 a11, v152
  v_perm_b32 v153, v70, v68, s71
  v_accvgpr_write_b32 a75, v153
  v_perm_b32 v154, v71, v69, s70
  v_accvgpr_write_b32 a139, v154
  v_perm_b32 v155, v71, v69, s71
  v_accvgpr_write_b32 a203, v155
  v_perm_b32 v152, v74, v72, s70
  v_accvgpr_write_b32 a12, v152
  v_perm_b32 v153, v74, v72, s71
  v_accvgpr_write_b32 a76, v153
  v_perm_b32 v154, v75, v73, s70
  v_accvgpr_write_b32 a140, v154
  v_perm_b32 v155, v75, v73, s71
  v_accvgpr_write_b32 a204, v155
  v_perm_b32 v152, v78, v76, s70
  v_accvgpr_write_b32 a13, v152
  v_perm_b32 v153, v78, v76, s71
  v_accvgpr_write_b32 a77, v153
  v_perm_b32 v154, v79, v77, s70
  v_accvgpr_write_b32 a141, v154
  v_perm_b32 v155, v79, v77, s71
  v_accvgpr_write_b32 a205, v155
  v_perm_b32 v152, v82, v80, s70
  v_accvgpr_write_b32 a14, v152
  v_perm_b32 v153, v82, v80, s71
  v_accvgpr_write_b32 a78, v153
  v_perm_b32 v154, v83, v81, s70
  v_accvgpr_write_b32 a142, v154
  v_perm_b32 v155, v83, v81, s71
  v_accvgpr_write_b32 a206, v155
  v_perm_b32 v152, v86, v84, s70
  v_accvgpr_write_b32 a15, v152
  v_perm_b32 v153, v86, v84, s71
  v_accvgpr_write_b32 a79, v153
  v_perm_b32 v154, v87, v85, s70
  v_accvgpr_write_b32 a143, v154
  v_perm_b32 v155, v87, v85, s71
  v_accvgpr_write_b32 a207, v155
  s_mov_b32 s72, 131072
  buffer_load_dwordx2 v[24:25], v5, s[52:55], s72 offen
  s_mov_b32 s73, 132096
  buffer_load_dwordx2 v[26:27], v5, s[52:55], s73 offen
  s_mov_b32 s72, 133120
  buffer_load_dwordx2 v[28:29], v5, s[52:55], s72 offen
  s_mov_b32 s73, 134144
  buffer_load_dwordx2 v[30:31], v5, s[52:55], s73 offen
  s_mov_b32 s72, 135168
  buffer_load_dwordx2 v[32:33], v5, s[52:55], s72 offen
  s_mov_b32 s73, 136192
  buffer_load_dwordx2 v[34:35], v5, s[52:55], s73 offen
  s_mov_b32 s72, 137216
  buffer_load_dwordx2 v[36:37], v5, s[52:55], s72 offen
  s_mov_b32 s73, 138240
  buffer_load_dwordx2 v[38:39], v5, s[52:55], s73 offen
  s_mov_b32 s72, 147456
  buffer_load_dwordx2 v[40:41], v5, s[52:55], s72 offen
  s_mov_b32 s73, 148480
  buffer_load_dwordx2 v[42:43], v5, s[52:55], s73 offen
  s_mov_b32 s72, 149504
  buffer_load_dwordx2 v[44:45], v5, s[52:55], s72 offen
  s_mov_b32 s73, 150528
  buffer_load_dwordx2 v[46:47], v5, s[52:55], s73 offen
  s_mov_b32 s72, 151552
  buffer_load_dwordx2 v[48:49], v5, s[52:55], s72 offen
  s_mov_b32 s73, 152576
  buffer_load_dwordx2 v[50:51], v5, s[52:55], s73 offen
  s_mov_b32 s72, 153600
  buffer_load_dwordx2 v[52:53], v5, s[52:55], s72 offen
  s_mov_b32 s73, 154624
  buffer_load_dwordx2 v[54:55], v5, s[52:55], s73 offen
  s_mov_b32 s72, 163840
  buffer_load_dwordx2 v[56:57], v5, s[52:55], s72 offen
  s_mov_b32 s73, 164864
  buffer_load_dwordx2 v[58:59], v5, s[52:55], s73 offen
  s_mov_b32 s72, 165888
  buffer_load_dwordx2 v[60:61], v5, s[52:55], s72 offen
  s_mov_b32 s73, 166912
  buffer_load_dwordx2 v[62:63], v5, s[52:55], s73 offen
  s_mov_b32 s72, 167936
  buffer_load_dwordx2 v[64:65], v5, s[52:55], s72 offen
  s_mov_b32 s73, 168960
  buffer_load_dwordx2 v[66:67], v5, s[52:55], s73 offen
  s_mov_b32 s72, 169984
  buffer_load_dwordx2 v[68:69], v5, s[52:55], s72 offen
  s_mov_b32 s73, 171008
  buffer_load_dwordx2 v[70:71], v5, s[52:55], s73 offen
  s_mov_b32 s72, 180224
  buffer_load_dwordx2 v[72:73], v5, s[52:55], s72 offen
  s_mov_b32 s73, 181248
  buffer_load_dwordx2 v[74:75], v5, s[52:55], s73 offen
  s_mov_b32 s72, 182272
  buffer_load_dwordx2 v[76:77], v5, s[52:55], s72 offen
  s_mov_b32 s73, 183296
  buffer_load_dwordx2 v[78:79], v5, s[52:55], s73 offen
  s_mov_b32 s72, 184320
  buffer_load_dwordx2 v[80:81], v5, s[52:55], s72 offen
  s_mov_b32 s73, 185344
  buffer_load_dwordx2 v[82:83], v5, s[52:55], s73 offen
  s_mov_b32 s72, 186368
  buffer_load_dwordx2 v[84:85], v5, s[52:55], s72 offen
  s_mov_b32 s73, 187392
  buffer_load_dwordx2 v[86:87], v5, s[52:55], s73 offen
  s_waitcnt vmcnt(32)
  v_perm_b32 v152, v90, v88, s70
  v_accvgpr_write_b32 a16, v152
  v_perm_b32 v153, v90, v88, s71
  v_accvgpr_write_b32 a80, v153
  v_perm_b32 v154, v91, v89, s70
  v_accvgpr_write_b32 a144, v154
  v_perm_b32 v155, v91, v89, s71
  v_accvgpr_write_b32 a208, v155
  v_perm_b32 v152, v94, v92, s70
  v_accvgpr_write_b32 a17, v152
  v_perm_b32 v153, v94, v92, s71
  v_accvgpr_write_b32 a81, v153
  v_perm_b32 v154, v95, v93, s70
  v_accvgpr_write_b32 a145, v154
  v_perm_b32 v155, v95, v93, s71
  v_accvgpr_write_b32 a209, v155
  v_perm_b32 v152, v98, v96, s70
  v_accvgpr_write_b32 a18, v152
  v_perm_b32 v153, v98, v96, s71
  v_accvgpr_write_b32 a82, v153
  v_perm_b32 v154, v99, v97, s70
  v_accvgpr_write_b32 a146, v154
  v_perm_b32 v155, v99, v97, s71
  v_accvgpr_write_b32 a210, v155
  v_perm_b32 v152, v102, v100, s70
  v_accvgpr_write_b32 a19, v152
  v_perm_b32 v153, v102, v100, s71
  v_accvgpr_write_b32 a83, v153
  v_perm_b32 v154, v103, v101, s70
  v_accvgpr_write_b32 a147, v154
  v_perm_b32 v155, v103, v101, s71
  v_accvgpr_write_b32 a211, v155
  v_perm_b32 v152, v106, v104, s70
  v_accvgpr_write_b32 a20, v152
  v_perm_b32 v153, v106, v104, s71
  v_accvgpr_write_b32 a84, v153
  v_perm_b32 v154, v107, v105, s70
  v_accvgpr_write_b32 a148, v154
  v_perm_b32 v155, v107, v105, s71
  v_accvgpr_write_b32 a212, v155
  v_perm_b32 v152, v110, v108, s70
  v_accvgpr_write_b32 a21, v152
  v_perm_b32 v153, v110, v108, s71
  v_accvgpr_write_b32 a85, v153
  v_perm_b32 v154, v111, v109, s70
  v_accvgpr_write_b32 a149, v154
  v_perm_b32 v155, v111, v109, s71
  v_accvgpr_write_b32 a213, v155
  v_perm_b32 v152, v114, v112, s70
  v_accvgpr_write_b32 a22, v152
  v_perm_b32 v153, v114, v112, s71
  v_accvgpr_write_b32 a86, v153
  v_perm_b32 v154, v115, v113, s70
  v_accvgpr_write_b32 a150, v154
  v_perm_b32 v155, v115, v113, s71
  v_accvgpr_write_b32 a214, v155
  v_perm_b32 v152, v118, v116, s70
  v_accvgpr_write_b32 a23, v152
  v_perm_b32 v153, v118, v116, s71
  v_accvgpr_write_b32 a87, v153
  v_perm_b32 v154, v119, v117, s70
  v_accvgpr_write_b32 a151, v154
  v_perm_b32 v155, v119, v117, s71
  v_accvgpr_write_b32 a215, v155
  v_perm_b32 v152, v122, v120, s70
  v_accvgpr_write_b32 a24, v152
  v_perm_b32 v153, v122, v120, s71
  v_accvgpr_write_b32 a88, v153
  v_perm_b32 v154, v123, v121, s70
  v_accvgpr_write_b32 a152, v154
  v_perm_b32 v155, v123, v121, s71
  v_accvgpr_write_b32 a216, v155
  v_perm_b32 v152, v126, v124, s70
  v_accvgpr_write_b32 a25, v152
  v_perm_b32 v153, v126, v124, s71
  v_accvgpr_write_b32 a89, v153
  v_perm_b32 v154, v127, v125, s70
  v_accvgpr_write_b32 a153, v154
  v_perm_b32 v155, v127, v125, s71
  v_accvgpr_write_b32 a217, v155
  v_perm_b32 v152, v130, v128, s70
  v_accvgpr_write_b32 a26, v152
  v_perm_b32 v153, v130, v128, s71
  v_accvgpr_write_b32 a90, v153
  v_perm_b32 v154, v131, v129, s70
  v_accvgpr_write_b32 a154, v154
  v_perm_b32 v155, v131, v129, s71
  v_accvgpr_write_b32 a218, v155
  v_perm_b32 v152, v134, v132, s70
  v_accvgpr_write_b32 a27, v152
  v_perm_b32 v153, v134, v132, s71
  v_accvgpr_write_b32 a91, v153
  v_perm_b32 v154, v135, v133, s70
  v_accvgpr_write_b32 a155, v154
  v_perm_b32 v155, v135, v133, s71
  v_accvgpr_write_b32 a219, v155
  v_perm_b32 v152, v138, v136, s70
  v_accvgpr_write_b32 a28, v152
  v_perm_b32 v153, v138, v136, s71
  v_accvgpr_write_b32 a92, v153
  v_perm_b32 v154, v139, v137, s70
  v_accvgpr_write_b32 a156, v154
  v_perm_b32 v155, v139, v137, s71
  v_accvgpr_write_b32 a220, v155
  v_perm_b32 v152, v142, v140, s70
  v_accvgpr_write_b32 a29, v152
  v_perm_b32 v153, v142, v140, s71
  v_accvgpr_write_b32 a93, v153
  v_perm_b32 v154, v143, v141, s70
  v_accvgpr_write_b32 a157, v154
  v_perm_b32 v155, v143, v141, s71
  v_accvgpr_write_b32 a221, v155
  v_perm_b32 v152, v146, v144, s70
  v_accvgpr_write_b32 a30, v152
  v_perm_b32 v153, v146, v144, s71
  v_accvgpr_write_b32 a94, v153
  v_perm_b32 v154, v147, v145, s70
  v_accvgpr_write_b32 a158, v154
  v_perm_b32 v155, v147, v145, s71
  v_accvgpr_write_b32 a222, v155
  v_perm_b32 v152, v150, v148, s70
  v_accvgpr_write_b32 a31, v152
  v_perm_b32 v153, v150, v148, s71
  v_accvgpr_write_b32 a95, v153
  v_perm_b32 v154, v151, v149, s70
  v_accvgpr_write_b32 a159, v154
  v_perm_b32 v155, v151, v149, s71
  v_accvgpr_write_b32 a223, v155
  s_mov_b32 s72, 196608
  buffer_load_dwordx2 v[88:89], v5, s[52:55], s72 offen
  s_mov_b32 s73, 197632
  buffer_load_dwordx2 v[90:91], v5, s[52:55], s73 offen
  s_mov_b32 s72, 198656
  buffer_load_dwordx2 v[92:93], v5, s[52:55], s72 offen
  s_mov_b32 s73, 199680
  buffer_load_dwordx2 v[94:95], v5, s[52:55], s73 offen
  s_mov_b32 s72, 200704
  buffer_load_dwordx2 v[96:97], v5, s[52:55], s72 offen
  s_mov_b32 s73, 201728
  buffer_load_dwordx2 v[98:99], v5, s[52:55], s73 offen
  s_mov_b32 s72, 202752
  buffer_load_dwordx2 v[100:101], v5, s[52:55], s72 offen
  s_mov_b32 s73, 203776
  buffer_load_dwordx2 v[102:103], v5, s[52:55], s73 offen
  s_mov_b32 s72, 212992
  buffer_load_dwordx2 v[104:105], v5, s[52:55], s72 offen
  s_mov_b32 s73, 214016
  buffer_load_dwordx2 v[106:107], v5, s[52:55], s73 offen
  s_mov_b32 s72, 215040
  buffer_load_dwordx2 v[108:109], v5, s[52:55], s72 offen
  s_mov_b32 s73, 216064
  buffer_load_dwordx2 v[110:111], v5, s[52:55], s73 offen
  s_mov_b32 s72, 217088
  buffer_load_dwordx2 v[112:113], v5, s[52:55], s72 offen
  s_mov_b32 s73, 218112
  buffer_load_dwordx2 v[114:115], v5, s[52:55], s73 offen
  s_mov_b32 s72, 219136
  buffer_load_dwordx2 v[116:117], v5, s[52:55], s72 offen
  s_mov_b32 s73, 220160
  buffer_load_dwordx2 v[118:119], v5, s[52:55], s73 offen
  s_mov_b32 s72, 229376
  buffer_load_dwordx2 v[120:121], v5, s[52:55], s72 offen
  s_mov_b32 s73, 230400
  buffer_load_dwordx2 v[122:123], v5, s[52:55], s73 offen
  s_mov_b32 s72, 231424
  buffer_load_dwordx2 v[124:125], v5, s[52:55], s72 offen
  s_mov_b32 s73, 232448
  buffer_load_dwordx2 v[126:127], v5, s[52:55], s73 offen
  s_mov_b32 s72, 233472
  buffer_load_dwordx2 v[128:129], v5, s[52:55], s72 offen
  s_mov_b32 s73, 234496
  buffer_load_dwordx2 v[130:131], v5, s[52:55], s73 offen
  s_mov_b32 s72, 235520
  buffer_load_dwordx2 v[132:133], v5, s[52:55], s72 offen
  s_mov_b32 s73, 236544
  buffer_load_dwordx2 v[134:135], v5, s[52:55], s73 offen
  s_mov_b32 s72, 245760
  buffer_load_dwordx2 v[136:137], v5, s[52:55], s72 offen
  s_mov_b32 s73, 246784
  buffer_load_dwordx2 v[138:139], v5, s[52:55], s73 offen
  s_mov_b32 s72, 247808
  buffer_load_dwordx2 v[140:141], v5, s[52:55], s72 offen
  s_mov_b32 s73, 248832
  buffer_load_dwordx2 v[142:143], v5, s[52:55], s73 offen
  s_mov_b32 s72, 249856
  buffer_load_dwordx2 v[144:145], v5, s[52:55], s72 offen
  s_mov_b32 s73, 250880
  buffer_load_dwordx2 v[146:147], v5, s[52:55], s73 offen
  s_mov_b32 s72, 251904
  buffer_load_dwordx2 v[148:149], v5, s[52:55], s72 offen
  s_mov_b32 s73, 252928
  buffer_load_dwordx2 v[150:151], v5, s[52:55], s73 offen
  s_waitcnt vmcnt(32)
  v_perm_b32 v152, v26, v24, s70
  v_accvgpr_write_b32 a32, v152
  v_perm_b32 v153, v26, v24, s71
  v_accvgpr_write_b32 a96, v153
  v_perm_b32 v154, v27, v25, s70
  v_accvgpr_write_b32 a160, v154
  v_perm_b32 v155, v27, v25, s71
  v_accvgpr_write_b32 a224, v155
  v_perm_b32 v152, v30, v28, s70
  v_accvgpr_write_b32 a33, v152
  v_perm_b32 v153, v30, v28, s71
  v_accvgpr_write_b32 a97, v153
  v_perm_b32 v154, v31, v29, s70
  v_accvgpr_write_b32 a161, v154
  v_perm_b32 v155, v31, v29, s71
  v_accvgpr_write_b32 a225, v155
  v_perm_b32 v152, v34, v32, s70
  v_accvgpr_write_b32 a34, v152
  v_perm_b32 v153, v34, v32, s71
  v_accvgpr_write_b32 a98, v153
  v_perm_b32 v154, v35, v33, s70
  v_accvgpr_write_b32 a162, v154
  v_perm_b32 v155, v35, v33, s71
  v_accvgpr_write_b32 a226, v155
  v_perm_b32 v152, v38, v36, s70
  v_accvgpr_write_b32 a35, v152
  v_perm_b32 v153, v38, v36, s71
  v_accvgpr_write_b32 a99, v153
  v_perm_b32 v154, v39, v37, s70
  v_accvgpr_write_b32 a163, v154
  v_perm_b32 v155, v39, v37, s71
  v_accvgpr_write_b32 a227, v155
  v_perm_b32 v152, v42, v40, s70
  v_accvgpr_write_b32 a36, v152
  v_perm_b32 v153, v42, v40, s71
  v_accvgpr_write_b32 a100, v153
  v_perm_b32 v154, v43, v41, s70
  v_accvgpr_write_b32 a164, v154
  v_perm_b32 v155, v43, v41, s71
  v_accvgpr_write_b32 a228, v155
  v_perm_b32 v152, v46, v44, s70
  v_accvgpr_write_b32 a37, v152
  v_perm_b32 v153, v46, v44, s71
  v_accvgpr_write_b32 a101, v153
  v_perm_b32 v154, v47, v45, s70
  v_accvgpr_write_b32 a165, v154
  v_perm_b32 v155, v47, v45, s71
  v_accvgpr_write_b32 a229, v155
  v_perm_b32 v152, v50, v48, s70
  v_accvgpr_write_b32 a38, v152
  v_perm_b32 v153, v50, v48, s71
  v_accvgpr_write_b32 a102, v153
  v_perm_b32 v154, v51, v49, s70
  v_accvgpr_write_b32 a166, v154
  v_perm_b32 v155, v51, v49, s71
  v_accvgpr_write_b32 a230, v155
  v_perm_b32 v152, v54, v52, s70
  v_accvgpr_write_b32 a39, v152
  v_perm_b32 v153, v54, v52, s71
  v_accvgpr_write_b32 a103, v153
  v_perm_b32 v154, v55, v53, s70
  v_accvgpr_write_b32 a167, v154
  v_perm_b32 v155, v55, v53, s71
  v_accvgpr_write_b32 a231, v155
  v_perm_b32 v152, v58, v56, s70
  v_accvgpr_write_b32 a40, v152
  v_perm_b32 v153, v58, v56, s71
  v_accvgpr_write_b32 a104, v153
  v_perm_b32 v154, v59, v57, s70
  v_accvgpr_write_b32 a168, v154
  v_perm_b32 v155, v59, v57, s71
  v_accvgpr_write_b32 a232, v155
  v_perm_b32 v152, v62, v60, s70
  v_accvgpr_write_b32 a41, v152
  v_perm_b32 v153, v62, v60, s71
  v_accvgpr_write_b32 a105, v153
  v_perm_b32 v154, v63, v61, s70
  v_accvgpr_write_b32 a169, v154
  v_perm_b32 v155, v63, v61, s71
  v_accvgpr_write_b32 a233, v155
  v_perm_b32 v152, v66, v64, s70
  v_accvgpr_write_b32 a42, v152
  v_perm_b32 v153, v66, v64, s71
  v_accvgpr_write_b32 a106, v153
  v_perm_b32 v154, v67, v65, s70
  v_accvgpr_write_b32 a170, v154
  v_perm_b32 v155, v67, v65, s71
  v_accvgpr_write_b32 a234, v155
  v_perm_b32 v152, v70, v68, s70
  v_accvgpr_write_b32 a43, v152
  v_perm_b32 v153, v70, v68, s71
  v_accvgpr_write_b32 a107, v153
  v_perm_b32 v154, v71, v69, s70
  v_accvgpr_write_b32 a171, v154
  v_perm_b32 v155, v71, v69, s71
  v_accvgpr_write_b32 a235, v155
  v_perm_b32 v152, v74, v72, s70
  v_accvgpr_write_b32 a44, v152
  v_perm_b32 v153, v74, v72, s71
  v_accvgpr_write_b32 a108, v153
  v_perm_b32 v154, v75, v73, s70
  v_accvgpr_write_b32 a172, v154
  v_perm_b32 v155, v75, v73, s71
  v_accvgpr_write_b32 a236, v155
  v_perm_b32 v152, v78, v76, s70
  v_accvgpr_write_b32 a45, v152
  v_perm_b32 v153, v78, v76, s71
  v_accvgpr_write_b32 a109, v153
  v_perm_b32 v154, v79, v77, s70
  v_accvgpr_write_b32 a173, v154
  v_perm_b32 v155, v79, v77, s71
  v_accvgpr_write_b32 a237, v155
  v_perm_b32 v152, v82, v80, s70
  v_accvgpr_write_b32 a46, v152
  v_perm_b32 v153, v82, v80, s71
  v_accvgpr_write_b32 a110, v153
  v_perm_b32 v154, v83, v81, s70
  v_accvgpr_write_b32 a174, v154
  v_perm_b32 v155, v83, v81, s71
  v_accvgpr_write_b32 a238, v155
  v_perm_b32 v152, v86, v84, s70
  v_accvgpr_write_b32 a47, v152
  v_perm_b32 v153, v86, v84, s71
  v_accvgpr_write_b32 a111, v153
  v_perm_b32 v154, v87, v85, s70
  v_accvgpr_write_b32 a175, v154
  v_perm_b32 v155, v87, v85, s71
  v_accvgpr_write_b32 a239, v155
  s_waitcnt vmcnt(0)
  v_perm_b32 v152, v90, v88, s70
  v_accvgpr_write_b32 a48, v152
  v_perm_b32 v153, v90, v88, s71
  v_accvgpr_write_b32 a112, v153
  v_perm_b32 v154, v91, v89, s70
  v_accvgpr_write_b32 a176, v154
  v_perm_b32 v155, v91, v89, s71
  v_accvgpr_write_b32 a240, v155
  v_perm_b32 v152, v94, v92, s70
  v_accvgpr_write_b32 a49, v152
  v_perm_b32 v153, v94, v92, s71
  v_accvgpr_write_b32 a113, v153
  v_perm_b32 v154, v95, v93, s70
  v_accvgpr_write_b32 a177, v154
  v_perm_b32 v155, v95, v93, s71
  v_accvgpr_write_b32 a241, v155
  v_perm_b32 v152, v98, v96, s70
  v_accvgpr_write_b32 a50, v152
  v_perm_b32 v153, v98, v96, s71
  v_accvgpr_write_b32 a114, v153
  v_perm_b32 v154, v99, v97, s70
  v_accvgpr_write_b32 a178, v154
  v_perm_b32 v155, v99, v97, s71
  v_accvgpr_write_b32 a242, v155
  v_perm_b32 v152, v102, v100, s70
  v_accvgpr_write_b32 a51, v152
  v_perm_b32 v153, v102, v100, s71
  v_accvgpr_write_b32 a115, v153
  v_perm_b32 v154, v103, v101, s70
  v_accvgpr_write_b32 a179, v154
  v_perm_b32 v155, v103, v101, s71
  v_accvgpr_write_b32 a243, v155
  v_perm_b32 v152, v106, v104, s70
  v_accvgpr_write_b32 a52, v152
  v_perm_b32 v153, v106, v104, s71
  v_accvgpr_write_b32 a116, v153
  v_perm_b32 v154, v107, v105, s70
  v_accvgpr_write_b32 a180, v154
  v_perm_b32 v155, v107, v105, s71
  v_accvgpr_write_b32 a244, v155
  v_perm_b32 v152, v110, v108, s70
  v_accvgpr_write_b32 a53, v152
  v_perm_b32 v153, v110, v108, s71
  v_accvgpr_write_b32 a117, v153
  v_perm_b32 v154, v111, v109, s70
  v_accvgpr_write_b32 a181, v154
  v_perm_b32 v155, v111, v109, s71
  v_accvgpr_write_b32 a245, v155
  v_perm_b32 v152, v114, v112, s70
  v_accvgpr_write_b32 a54, v152
  v_perm_b32 v153, v114, v112, s71
  v_accvgpr_write_b32 a118, v153
  v_perm_b32 v154, v115, v113, s70
  v_accvgpr_write_b32 a182, v154
  v_perm_b32 v155, v115, v113, s71
  v_accvgpr_write_b32 a246, v155
  v_perm_b32 v152, v118, v116, s70
  v_accvgpr_write_b32 a55, v152
  v_perm_b32 v153, v118, v116, s71
  v_accvgpr_write_b32 a119, v153
  v_perm_b32 v154, v119, v117, s70
  v_accvgpr_write_b32 a183, v154
  v_perm_b32 v155, v119, v117, s71
  v_accvgpr_write_b32 a247, v155
  v_perm_b32 v152, v122, v120, s70
  v_accvgpr_write_b32 a56, v152
  v_perm_b32 v153, v122, v120, s71
  v_accvgpr_write_b32 a120, v153
  v_perm_b32 v154, v123, v121, s70
  v_accvgpr_write_b32 a184, v154
  v_perm_b32 v155, v123, v121, s71
  v_accvgpr_write_b32 a248, v155
  v_perm_b32 v152, v126, v124, s70
  v_accvgpr_write_b32 a57, v152
  v_perm_b32 v153, v126, v124, s71
  v_accvgpr_write_b32 a121, v153
  v_perm_b32 v154, v127, v125, s70
  v_accvgpr_write_b32 a185, v154
  v_perm_b32 v155, v127, v125, s71
  v_accvgpr_write_b32 a249, v155
  v_perm_b32 v152, v130, v128, s70
  v_accvgpr_write_b32 a58, v152
  v_perm_b32 v153, v130, v128, s71
  v_accvgpr_write_b32 a122, v153
  v_perm_b32 v154, v131, v129, s70
  v_accvgpr_write_b32 a186, v154
  v_perm_b32 v155, v131, v129, s71
  v_accvgpr_write_b32 a250, v155
  v_perm_b32 v152, v134, v132, s70
  v_accvgpr_write_b32 a59, v152
  v_perm_b32 v153, v134, v132, s71
  v_accvgpr_write_b32 a123, v153
  v_perm_b32 v154, v135, v133, s70
  v_accvgpr_write_b32 a187, v154
  v_perm_b32 v155, v135, v133, s71
  v_accvgpr_write_b32 a251, v155
  v_perm_b32 v152, v138, v136, s70
  v_accvgpr_write_b32 a60, v152
  v_perm_b32 v153, v138, v136, s71
  v_accvgpr_write_b32 a124, v153
  v_perm_b32 v154, v139, v137, s70
  v_accvgpr_write_b32 a188, v154
  v_perm_b32 v155, v139, v137, s71
  v_accvgpr_write_b32 a252, v155
  v_perm_b32 v152, v142, v140, s70
  v_accvgpr_write_b32 a61, v152
  v_perm_b32 v153, v142, v140, s71
  v_accvgpr_write_b32 a125, v153
  v_perm_b32 v154, v143, v141, s70
  v_accvgpr_write_b32 a189, v154
  v_perm_b32 v155, v143, v141, s71
  v_accvgpr_write_b32 a253, v155
  v_perm_b32 v152, v146, v144, s70
  v_accvgpr_write_b32 a62, v152
  v_perm_b32 v153, v146, v144, s71
  v_accvgpr_write_b32 a126, v153
  v_perm_b32 v154, v147, v145, s70
  v_accvgpr_write_b32 a190, v154
  v_perm_b32 v155, v147, v145, s71
  v_accvgpr_write_b32 a254, v155
  v_perm_b32 v152, v150, v148, s70
  v_accvgpr_write_b32 a63, v152
  v_perm_b32 v153, v150, v148, s71
  v_accvgpr_write_b32 a127, v153
  v_perm_b32 v154, v151, v149, s70
  v_accvgpr_write_b32 a191, v154
  v_perm_b32 v155, v151, v149, s71
  v_accvgpr_write_b32 a255, v155
  s_mov_b32 s60, s40
  s_mov_b32 s61, s41
  s_mov_b32 s62, 256
  s_mov_b32 s63, 0x00020000
  v_mov_b32 v33, 0
  s_nop 1
mw_56:
  buffer_load_dword v32, v33, s[60:63], 0 offen offset:68 sc1
  s_waitcnt vmcnt(0)
  v_readfirstlane_b32 s72, v32
  s_nop 0
  s_cmp_ge_u32 s72, 256
  s_nop 1
  s_cbranch_scc1 md_57
  s_sub_u32 s69, s69, 1
  s_cbranch_scc0 mw_56
  s_branch mega_exit
md_57:
  buffer_load_dwordx4 v[24:27], v33, s[60:63], 0 offen sc1
  buffer_load_dwordx4 v[28:31], v33, s[60:63], 0 offen offset:16 sc1
  s_waitcnt vmcnt(0)
  v_xor_b32 v24, 32, v24
  v_xor_b32 v25, 32, v25
  v_xor_b32 v26, 32, v26
  v_xor_b32 v27, 32, v27
  v_xor_b32 v28, 32, v28
  v_xor_b32 v29, 32, v29
  v_xor_b32 v30, 32, v30
  v_xor_b32 v31, 32, v31
  v_or3_b32 v24, v24, v25, v26
  v_or3_b32 v24, v24, v27, v28
  v_or3_b32 v24, v24, v29, v30
  v_or_b32 v24, v24, v31
  s_nop 0
  v_readfirstlane_b32 s68, v24
  s_mov_b32 s60, s40
  s_mov_b32 s61, s41
  s_mov_b32 s62, 256
  s_mov_b32 s63, 0x00020000
  s_nop 0
iw_58:
  buffer_load_dword v24, off, s[60:63], 0 offset:192 sc1
  s_waitcnt vmcnt(0)
  v_readfirstlane_b32 s72, v24
  s_nop 0
  s_cmp_ge_u32 s72, 208
  s_nop 1
  s_cbranch_scc1 id_59
  s_sub_u32 s69, s69, 1
  s_cbranch_scc0 iw_58
  s_branch mega_exit
id_59:
  s_lshl_b32 s72, s64, 22
  s_add_u32 s72, s72, 17825792
  s_lshl_b32 s73, s65, 15
  s_add_u32 s73, s73, s72
  s_lshl_b32 s74, s66, 8
  s_add_u32 s73, s73, s74
  v_lshrrev_b32 v14, 5, v1
  v_lshlrev_b32 v12, 12, v14
  v_and_b32 v15, 31, v1
  v_lshl_add_u32 v12, v15, 3, v12
  v_add_u32 v12, s73, v12
  s_lshl_b32 s72, s64, 9
  s_add_u32 s72, s72, 14682112
  s_lshl_b32 s73, s65, 4
  s_add_u32 s73, s73, s72
  s_lshl_b32 s74, s66, 2
  s_add_u32 s73, s73, s74
  v_mov_b32 v14, s73
  s_lshl_b32 s72, s64, 13
  s_add_u32 s72, s72, 14688256
  v_lshlrev_b32 v15, 2, v15
  v_add_u32 v15, s72, v15
  s_and_b32 s76, s66, 1
  s_lshr_b32 s77, s66, 1
  s_lshl_b32 s78, s65, 1
  s_add_u32 s78, s78, s77
  v_lshlrev_b32 v6, 9, v3
  v_lshl_add_u32 v6, v2, 4, v6
  v_lshlrev_b32 v22, 4, v1
  s_lshl_b32 s72, s64, 11
  s_add_u32 s72, s72, s78
  s_lshl_b32 s73, s72, 15
  v_add_u32 v9, s73, v6
  s_lshl_b32 s74, s76, 12
  s_add_u32 s73, s73, s74
  s_add_u32 s73, s73, 16384
  v_add_u32 v13, s73, v22
  s_lshl_b32 s73, s64, 25
  s_lshl_b32 s74, s78, 13
  s_add_u32 s73, s73, s74
  v_add_u32 v10, s73, v22
  v_lshlrev_b32 v23, 3, v1
  v_add_u32 v23, s73, v23
  s_lshl_b32 s72, s64, 9
  s_lshl_b32 s73, s78, 4
  s_add_u32 s73, s73, s72
  v_mov_b32 v11, s73
  s_lshl_b32 s73, s77, 13
  s_lshl_b32 s74, s76, 8
  s_add_u32 s73, s73, s74
  v_add_u32 v21, s73, v6
  s_lshl_b32 s73, s76, 4
  v_add_u32 v24, s73, v2
  v_lshlrev_b32 v25, 2, v3
  v_sub_u32 v24, v24, v25
  v_mov_b32 v25, 0xf149f2ca
  v_cmp_gt_i32 vcc, 0, v24
  s_nop 1
  v_cndmask_b32 v248, 0, v25, vcc
  v_cmp_gt_i32 vcc, 1, v24
  s_nop 1
  v_cndmask_b32 v249, 0, v25, vcc
  v_cmp_gt_i32 vcc, 2, v24
  s_nop 1
  v_cndmask_b32 v250, 0, v25, vcc
  v_cmp_gt_i32 vcc, 3, v24
  s_nop 1
  v_cndmask_b32 v251, 0, v25, vcc
  v_cmp_gt_i32 vcc, 16, v24
  s_nop 1
  v_cndmask_b32 v252, 0, v25, vcc
  v_cmp_gt_i32 vcc, 17, v24
  s_nop 1
  v_cndmask_b32 v253, 0, v25, vcc
  v_cmp_gt_i32 vcc, 18, v24
  s_nop 1
  v_cndmask_b32 v254, 0, v25, vcc
  v_cmp_gt_i32 vcc, 19, v24
  s_nop 1
  v_cndmask_b32 v255, 0, v25, vcc
  v_mov_b32 v244, 0x3f803f80
  v_mov_b32 v245, 0x3f803f80
  v_mov_b32 v246, 0x3f803f80
  v_mov_b32 v247, 0x3f803f80
  s_mov_b32 s75, 1040356334
  s_mov_b32 s76, -1
  s_mov_b32 s77, 0
  s_mov_b32 s81, 14680064
  s_mov_b32 s82, 14681088
pf_60:
  buffer_load_dwordx4 v[236:239], v11, s[44:47], s81 offen sc1
  s_waitcnt vmcnt(0)
  v_min3_u32 v236, v236, v237, v238
  v_min_u32 v236, v236, v239
  v_cmp_gt_u32 vcc, 1, v236
  s_nop 0
  s_cbranch_vccz pd_61
  s_nop 2
pr_62:
  s_sub_u32 s69, s69, 1
  s_cbranch_scc0 pf_60
  s_branch mega_exit
pd_61:
  s_lshl_b32 s78, s67, 20
  s_add_u32 s78, s78, 134217728
  s_add_u32 s79, s78, 4096
  s_add_u32 s80, s78, 8192
  s_add_u32 s84, s78, 12288
  buffer_load_dwordx4 v[24:27], v13, s[44:47], s78 offen offset:0
  buffer_load_dwordx4 v[28:31], v13, s[44:47], s78 offen offset:1024
  buffer_load_dwordx4 v[32:35], v13, s[44:47], s78 offen offset:2048
  buffer_load_dwordx4 v[36:39], v13, s[44:47], s78 offen offset:3072
  buffer_load_dwordx4 v[40:43], v9, s[44:47], s78 offen offset:0
  buffer_load_dwordx4 v[56:59], v9, s[44:47], s78 offen offset:256
  buffer_load_dwordx4 v[44:47], v9, s[44:47], s78 offen offset:2048
  buffer_load_dwordx4 v[60:63], v9, s[44:47], s78 offen offset:2304
  buffer_load_dwordx4 v[48:51], v9, s[44:47], s79 offen offset:0
  buffer_load_dwordx4 v[64:67], v9, s[44:47], s79 offen offset:256
  buffer_load_dwordx4 v[52:55], v9, s[44:47], s79 offen offset:2048
  buffer_load_dwordx4 v[68:71], v9, s[44:47], s79 offen offset:2304
  buffer_load_dwordx4 v[72:75], v9, s[44:47], s80 offen offset:0
  buffer_load_dwordx4 v[76:79], v9, s[44:47], s80 offen offset:2048
  buffer_load_dwordx4 v[80:83], v9, s[44:47], s80 offen offset:256
  buffer_load_dwordx4 v[84:87], v9, s[44:47], s80 offen offset:2304
  buffer_load_dwordx4 v[88:91], v9, s[44:47], s84 offen offset:0
  buffer_load_dwordx4 v[92:95], v9, s[44:47], s84 offen offset:2048
  buffer_load_dwordx4 v[96:99], v9, s[44:47], s84 offen offset:256
  buffer_load_dwordx4 v[100:103], v9, s[44:47], s84 offen offset:2304
  s_mov_b32 s92, 0
  s_mov_b32 s93, 1
  s_mov_b32 s74, s75
  s_and_b32 s88, s67, 3
  s_mul_i32 s88, s88, 524288
  s_add_u32 s89, s88, 8192
  s_add_u32 s90, s88, 16384
  s_add_u32 s91, s88, 24576
  s_cmp_lg_u32 s68, 0
  s_cbranch_scc1 a1_top_in
  s_branch a0_top_in
a0_top:
  s_waitcnt vmcnt(8)
a0_top_go:
  v_mfma_f32_16x16x32_bf16 v[128:131], v[40:43], v[24:27], v[248:251]
  buffer_store_dwordx2 v[192:193], v12, s[44:47], s88 offen offset:0
  v_mfma_f32_16x16x32_bf16 v[132:135], v[56:59], v[24:27], v[252:255]
  v_mfma_f32_16x16x32_bf16 v[136:139], v[104:107], v[24:27], 0
  buffer_store_dwordx2 v[194:195], v12, s[44:47], s88 offen offset:1024
  v_mfma_f32_16x16x32_bf16 v[128:131], v[44:47], v[28:31], v[128:131]
  v_mfma_f32_16x16x32_bf16 v[132:135], v[60:63], v[28:31], v[132:135]
  buffer_store_dwordx2 v[196:197], v12, s[44:47], s88 offen offset:2048
  v_mfma_f32_16x16x32_bf16 v[136:139], v[108:111], v[28:31], v[136:139]
  v_mfma_f32_16x16x32_bf16 v[128:131], v[48:51], v[32:35], v[128:131]
  buffer_store_dwordx2 v[198:199], v12, s[44:47], s88 offen offset:3072
  v_mfma_f32_16x16x32_bf16 v[132:135], v[64:67], v[32:35], v[132:135]
  v_mfma_f32_16x16x32_bf16 v[136:139], v[112:115], v[32:35], v[136:139]
  buffer_store_dwordx2 v[200:201], v12, s[44:47], s89 offen offset:0
  v_mfma_f32_16x16x32_bf16 v[128:131], v[52:55], v[36:39], v[128:131]
  v_mfma_f32_16x16x32_bf16 v[132:135], v[68:71], v[36:39], v[132:135]
  buffer_store_dwordx2 v[202:203], v12, s[44:47], s89 offen offset:1024
  v_mfma_f32_16x16x32_bf16 v[136:139], v[116:119], v[36:39], v[136:139]
  s_and_b32 s72, s67, 1
  s_lshl_b32 s72, s72, 14
  v_add_u32 v19, s72, v21
  v_add_u32 v20, s72, v22
  s_nop 0
  v_max3_f32 v224, v128, v129, v130
  v_max3_f32 v224, v224, v131, v132
  v_max3_f32 v224, v224, v133, v134
  v_max3_f32 v224, v224, v135, v136
  v_max3_f32 v224, v224, v137, v138
  v_max_f32 v224, v224, v139
  v_mov_b32 v225, v224
  s_nop 1
  v_permlane16_swap_b32 v224, v225
  v_max_f32 v224, v224, v225
  v_mov_b32 v225, v224
  s_nop 1
  v_permlane32_swap_b32 v224, v225
  v_max_f32 v224, v224, v225
  v_mul_f32 v224, 0xbe0293ee, v224
  v_pk_fma_f32 v[128:129], v[128:129], s[74:75], v[224:225] op_sel:[0,1,0] op_sel_hi:[1,1,0]
  v_pk_fma_f32 v[130:131], v[130:131], s[74:75], v[224:225] op_sel:[0,1,0] op_sel_hi:[1,1,0]
  v_pk_fma_f32 v[132:133], v[132:133], s[74:75], v[224:225] op_sel:[0,1,0] op_sel_hi:[1,1,0]
  v_pk_fma_f32 v[134:135], v[134:135], s[74:75], v[224:225] op_sel:[0,1,0] op_sel_hi:[1,1,0]
  v_pk_fma_f32 v[136:137], v[136:137], s[74:75], v[224:225] op_sel:[0,1,0] op_sel_hi:[1,1,0]
  v_pk_fma_f32 v[138:139], v[138:139], s[74:75], v[224:225] op_sel:[0,1,0] op_sel_hi:[1,1,0]
  v_exp_f32 v128, v128
  v_exp_f32 v129, v129
  v_exp_f32 v130, v130
  v_exp_f32 v131, v131
  v_exp_f32 v132, v132
  v_exp_f32 v133, v133
  v_exp_f32 v134, v134
  v_exp_f32 v135, v135
  v_exp_f32 v136, v136
  v_exp_f32 v137, v137
  v_exp_f32 v138, v138
  v_exp_f32 v139, v139
  v_cvt_pk_bf16_f32 v228, v128, v129
  v_cvt_pk_bf16_f32 v229, v130, v131
  v_cvt_pk_bf16_f32 v230, v132, v133
  v_cvt_pk_bf16_f32 v231, v134, v135
  v_cvt_pk_bf16_f32 v224, v136, v137
  v_cvt_pk_bf16_f32 v225, v138, v139
  v_cndmask_b32 v232, 0, v224, s[76:77]
  v_cndmask_b32 v234, v224, 0, s[76:77]
  v_cndmask_b32 v233, 0, v225, s[76:77]
  v_cndmask_b32 v235, v225, 0, s[76:77]
  s_waitcnt vmcnt(6)
  v_mfma_f32_16x16x32_bf16 v[176:179], v[244:247], v[228:231], 0
  buffer_store_dwordx2 v[204:205], v12, s[44:47], s89 offen offset:2048
  v_mfma_f32_16x16x32_bf16 v[144:147], v[72:75], v[228:231], 0
  s_nop 0
  v_mfma_f32_16x16x32_bf16 v[148:151], v[76:79], v[228:231], 0
  buffer_store_dwordx2 v[206:207], v12, s[44:47], s89 offen offset:3072
  v_mfma_f32_16x16x32_bf16 v[152:155], v[80:83], v[228:231], 0
  s_nop 0
  v_mfma_f32_16x16x32_bf16 v[156:159], v[84:87], v[228:231], 0
  buffer_store_dwordx2 v[208:209], v12, s[44:47], s90 offen offset:0
  v_mfma_f32_16x16x32_bf16 v[160:163], v[88:91], v[228:231], 0
  s_nop 0
  v_mfma_f32_16x16x32_bf16 v[164:167], v[92:95], v[228:231], 0
  buffer_store_dwordx2 v[210:211], v12, s[44:47], s90 offen offset:1024
  v_mfma_f32_16x16x32_bf16 v[168:171], v[96:99], v[228:231], 0
  v_mfma_f32_16x16x32_bf16 v[172:175], v[100:103], v[228:231], 0
  v_mfma_f32_16x16x16_bf16 v[176:179], v[244:245], v[232:233], v[176:179]
  s_add_u32 s92, s67, 1
  s_min_u32 s92, s92, 63
  v_mfma_f32_16x16x16_bf16 v[144:147], v[120:121], v[232:233], v[144:147]
  s_add_u32 s93, s92, 1
  s_mov_b32 s83, 0
  v_mfma_f32_16x16x16_bf16 v[148:151], v[120:121], v[234:235], v[148:151]
  v_mfma_f32_16x16x16_bf16 v[152:155], v[122:123], v[232:233], v[152:155]
  s_nop 0
  v_rcp_f32 v224, v176
  v_mfma_f32_16x16x16_bf16 v[156:159], v[122:123], v[234:235], v[156:159]
  v_mfma_f32_16x16x16_bf16 v[160:163], v[124:125], v[232:233], v[160:163]
  v_mfma_f32_16x16x16_bf16 v[164:167], v[124:125], v[234:235], v[164:167]
  v_pk_mul_f32 v[144:145], v[144:145], v[224:225] op_sel_hi:[1,0]
  v_pk_mul_f32 v[146:147], v[146:147], v[224:225] op_sel_hi:[1,0]
  v_pk_mul_f32 v[148:149], v[148:149], v[224:225] op_sel_hi:[1,0]
  v_mfma_f32_16x16x16_bf16 v[168:171], v[126:127], v[232:233], v[168:171]
  v_pk_mul_f32 v[150:151], v[150:151], v[224:225] op_sel_hi:[1,0]
  v_cvt_pk_bf16_f32 v128, v144, v148
  v_cvt_pk_bf16_f32 v129, v145, v149
  v_mfma_f32_16x16x16_bf16 v[172:175], v[126:127], v[234:235], v[172:175]
  v_cvt_pk_bf16_f32 v130, v146, v150
  v_cvt_pk_bf16_f32 v131, v147, v151
  ds_write_b128 v19, v[128:131] offset:0
  v_pk_mul_f32 v[152:153], v[152:153], v[224:225] op_sel_hi:[1,0]
  v_pk_mul_f32 v[154:155], v[154:155], v[224:225] op_sel_hi:[1,0]
  v_pk_mul_f32 v[156:157], v[156:157], v[224:225] op_sel_hi:[1,0]
  v_pk_mul_f32 v[158:159], v[158:159], v[224:225] op_sel_hi:[1,0]
  v_cvt_pk_bf16_f32 v132, v152, v156
  v_cvt_pk_bf16_f32 v133, v153, v157
  v_cvt_pk_bf16_f32 v134, v154, v158
  v_cvt_pk_bf16_f32 v135, v155, v159
  ds_write_b128 v19, v[132:135] offset:2048
  v_pk_mul_f32 v[160:161], v[160:161], v[224:225] op_sel_hi:[1,0]
  v_pk_mul_f32 v[162:163], v[162:163], v[224:225] op_sel_hi:[1,0]
  v_pk_mul_f32 v[164:165], v[164:165], v[224:225] op_sel_hi:[1,0]
  v_pk_mul_f32 v[166:167], v[166:167], v[224:225] op_sel_hi:[1,0]
  v_cvt_pk_bf16_f32 v136, v160, v164
  v_cvt_pk_bf16_f32 v137, v161, v165
  v_cvt_pk_bf16_f32 v138, v162, v166
  v_cvt_pk_bf16_f32 v139, v163, v167
  ds_write_b128 v19, v[136:139] offset:4096
  v_pk_mul_f32 v[168:169], v[168:169], v[224:225] op_sel_hi:[1,0]
  v_pk_mul_f32 v[170:171], v[170:171], v[224:225] op_sel_hi:[1,0]
  v_pk_mul_f32 v[172:173], v[172:173], v[224:225] op_sel_hi:[1,0]
  v_pk_mul_f32 v[174:175], v[174:175], v[224:225] op_sel_hi:[1,0]
  v_cvt_pk_bf16_f32 v140, v168, v172
  v_cvt_pk_bf16_f32 v141, v169, v173
  v_cvt_pk_bf16_f32 v142, v170, v174
  v_cvt_pk_bf16_f32 v143, v171, v175
  ds_write_b128 v19, v[140:143] offset:6144
  s_waitcnt lgkmcnt(0)
  s_barrier
  ds_read_b128 v[192:195], v20 offset:0
  ds_read_b128 v[196:199], v20 offset:1024
  ds_read_b128 v[200:203], v20 offset:2048
  ds_read_b128 v[204:207], v20 offset:3072
  ds_read_b128 v[208:211], v20 offset:4096
  s_waitcnt lgkmcnt(4)
  v_mfma_f32_32x32x16_bf16 v[128:143], v[192:195], a[0:3], 0
  buffer_store_dwordx2 v[212:213], v12, s[44:47], s90 offen offset:2048
  v_mfma_f32_32x32x16_bf16 v[144:159], v[192:195], a[64:67], 0
  buffer_load_dwordx4 v[236:239], v11, s[44:47], s82 offen sc1
  s_sub_u32 s86, s67, 4
  s_cselect_b32 s86, 0, s86
  s_cselect_b32 s87, 0, 1
  s_lshl_b32 s86, s86, 7
  buffer_load_dword v240, v15, s[44:47], s86 offen sc1
  v_mfma_f32_32x32x16_bf16 v[160:175], v[192:195], a[128:131], 0
  buffer_store_dwordx2 v[214:215], v12, s[44:47], s90 offen offset:3072
  v_mfma_f32_32x32x16_bf16 v[176:191], v[192:195], a[192:195], 0
  s_lshl_b32 s78, s92, 20
  s_add_u32 s78, s78, 134217728
  s_add_u32 s79, s78, 4096
  s_add_u32 s80, s78, 8192
  s_add_u32 s84, s78, 12288
  ds_read_b128 v[212:215], v20 offset:5120
  s_waitcnt lgkmcnt(4)
  v_mfma_f32_32x32x16_bf16 v[128:143], v[196:199], a[4:7], v[128:143]
  buffer_store_dwordx2 v[216:217], v12, s[44:47], s91 offen offset:0
  v_mfma_f32_32x32x16_bf16 v[144:159], v[196:199], a[68:71], v[144:159]
  s_lshl_b32 s72, s92, 18
  s_add_u32 s72, s72, 67371008
  s_add_u32 s73, s72, 4096
  v_mfma_f32_32x32x16_bf16 v[160:175], v[196:199], a[132:135], v[160:175]
  buffer_store_dwordx2 v[218:219], v12, s[44:47], s91 offen offset:1024
  v_mfma_f32_32x32x16_bf16 v[176:191], v[196:199], a[196:199], v[176:191]
  ds_read_b128 v[216:219], v20 offset:6144
  s_waitcnt lgkmcnt(4)
  v_mfma_f32_32x32x16_bf16 v[128:143], v[200:203], a[8:11], v[128:143]
  buffer_store_dwordx2 v[220:221], v12, s[44:47], s91 offen offset:2048
  v_mfma_f32_32x32x16_bf16 v[144:159], v[200:203], a[72:75], v[144:159]
  v_mfma_f32_32x32x16_bf16 v[160:175], v[200:203], a[136:139], v[160:175]
  buffer_store_dwordx2 v[222:223], v12, s[44:47], s91 offen offset:3072
  v_mfma_f32_32x32x16_bf16 v[176:191], v[200:203], a[200:203], v[176:191]
  ds_read_b128 v[220:223], v20 offset:7168
  s_waitcnt lgkmcnt(4)
  v_mfma_f32_32x32x16_bf16 v[128:143], v[204:207], a[12:15], v[128:143]
  buffer_load_dwordx4 v[24:27], v13, s[44:47], s78 offen offset:0
  v_mfma_f32_32x32x16_bf16 v[144:159], v[204:207], a[76:79], v[144:159]
  v_mfma_f32_32x32x16_bf16 v[160:175], v[204:207], a[140:143], v[160:175]
  buffer_load_dwordx4 v[28:31], v13, s[44:47], s78 offen offset:1024
  v_mfma_f32_32x32x16_bf16 v[176:191], v[204:207], a[204:207], v[176:191]
  ds_read_b128 v[192:195], v20 offset:8192
  s_waitcnt lgkmcnt(4)
  v_mfma_f32_32x32x16_bf16 v[128:143], v[208:211], a[16:19], v[128:143]
  buffer_load_dwordx4 v[32:35], v13, s[44:47], s78 offen offset:2048
  v_mfma_f32_32x32x16_bf16 v[144:159], v[208:211], a[80:83], v[144:159]
  v_mfma_f32_32x32x16_bf16 v[160:175], v[208:211], a[144:147], v[160:175]
  buffer_load_dwordx4 v[36:39], v13, s[44:47], s78 offen offset:3072
  v_mfma_f32_32x32x16_bf16 v[176:191], v[208:211], a[208:211], v[176:191]
  ds_read_b128 v[196:199], v20 offset:9216
  s_waitcnt lgkmcnt(4)
  v_mfma_f32_32x32x16_bf16 v[128:143], v[212:215], a[20:23], v[128:143]
  buffer_load_dwordx4 v[40:43], v9, s[44:47], s78 offen offset:0
  v_mfma_f32_32x32x16_bf16 v[144:159], v[212:215], a[84:87], v[144:159]
  v_mfma_f32_32x32x16_bf16 v[160:175], v[212:215], a[148:151], v[160:175]
  buffer_load_dwordx4 v[56:59], v9, s[44:47], s78 offen offset:256
  v_mfma_f32_32x32x16_bf16 v[176:191], v[212:215], a[212:215], v[176:191]
  ds_read_b128 v[200:203], v20 offset:10240
  s_waitcnt lgkmcnt(4)
  v_mfma_f32_32x32x16_bf16 v[128:143], v[216:219], a[24:27], v[128:143]
  buffer_load_dwordx4 v[44:47], v9, s[44:47], s78 offen offset:2048
  v_mfma_f32_32x32x16_bf16 v[144:159], v[216:219], a[88:91], v[144:159]
  s_waitcnt vmcnt(7)
  v_min3_u32 v236, v236, v237, v238
  v_min_u32 v236, v236, v239
  v_cmp_gt_u32 vcc, s93, v236
  v_mfma_f32_32x32x16_bf16 v[160:175], v[216:219], a[152:155], v[160:175]
  buffer_load_dwordx4 v[60:63], v9, s[44:47], s78 offen offset:2304
  s_cmp_eq_u64 vcc, 0
  s_cselect_b32 s83, 1, 0
  v_mov_b32 v241, s67
  s_mov_b64 exec, 1
  buffer_store_dword v241, v14, s[44:47], 0 offen
  s_mov_b64 exec, -1
  v_mfma_f32_32x32x16_bf16 v[176:191], v[216:219], a[216:219], v[176:191]
  s_cmp_eq_u32 s83, 1
  s_cbranch_scc0 c_63
  buffer_load_dwordx4 v[104:107], v10, s[44:47], s72 offen offset:0
  buffer_load_dwordx2 v[120:121], v23, s[44:47], s73 offen offset:0
c_63:
  ds_read_b128 v[204:207], v20 offset:11264
  s_waitcnt lgkmcnt(4)
  v_mfma_f32_32x32x16_bf16 v[128:143], v[220:223], a[28:31], v[128:143]
  buffer_load_dwordx4 v[48:51], v9, s[44:47], s79 offen offset:0
  v_mfma_f32_32x32x16_bf16 v[144:159], v[220:223], a[92:95], v[144:159]
  v_mfma_f32_32x32x16_bf16 v[160:175], v[220:223], a[156:159], v[160:175]
  buffer_load_dwordx4 v[64:67], v9, s[44:47], s79 offen offset:256
  v_mfma_f32_32x32x16_bf16 v[176:191], v[220:223], a[220:223], v[176:191]
  s_cmp_eq_u32 s83, 1
  s_cbranch_scc0 c_64
  buffer_load_dwordx4 v[108:111], v10, s[44:47], s72 offen offset:1024
  buffer_load_dwordx2 v[122:123], v23, s[44:47], s73 offen offset:1024
c_64:
  ds_read_b128 v[208:211], v20 offset:12288
  s_waitcnt lgkmcnt(4)
  v_mfma_f32_32x32x16_bf16 v[128:143], v[192:195], a[32:35], v[128:143]
  buffer_load_dwordx4 v[52:55], v9, s[44:47], s79 offen offset:2048
  v_mfma_f32_32x32x16_bf16 v[144:159], v[192:195], a[96:99], v[144:159]
  v_mfma_f32_32x32x16_bf16 v[160:175], v[192:195], a[160:163], v[160:175]
  buffer_load_dwordx4 v[68:71], v9, s[44:47], s79 offen offset:2304
  v_mfma_f32_32x32x16_bf16 v[176:191], v[192:195], a[224:227], v[176:191]
  s_cmp_eq_u32 s83, 1
  s_cbranch_scc0 c_65
  buffer_load_dwordx4 v[112:115], v10, s[44:47], s72 offen offset:2048
  buffer_load_dwordx2 v[124:125], v23, s[44:47], s73 offen offset:2048
c_65:
  ds_read_b128 v[212:215], v20 offset:13312
  s_waitcnt lgkmcnt(4)
  v_mfma_f32_32x32x16_bf16 v[128:143], v[196:199], a[36:39], v[128:143]
  v_mfma_f32_32x32x16_bf16 v[144:159], v[196:199], a[100:103], v[144:159]
  v_mfma_f32_32x32x16_bf16 v[160:175], v[196:199], a[164:167], v[160:175]
  v_mfma_f32_32x32x16_bf16 v[176:191], v[196:199], a[228:231], v[176:191]
  s_cmp_eq_u32 s83, 1
  s_cbranch_scc0 c_66
  buffer_load_dwordx4 v[116:119], v10, s[44:47], s72 offen offset:3072
  buffer_load_dwordx2 v[126:127], v23, s[44:47], s73 offen offset:3072
c_66:
  ds_read_b128 v[216:219], v20 offset:14336
  s_waitcnt lgkmcnt(4)
  v_mfma_f32_32x32x16_bf16 v[128:143], v[200:203], a[40:43], v[128:143]
  v_mfma_f32_32x32x16_bf16 v[144:159], v[200:203], a[104:107], v[144:159]
  buffer_load_dwordx4 v[72:75], v9, s[44:47], s80 offen offset:0
  v_mfma_f32_32x32x16_bf16 v[160:175], v[200:203], a[168:171], v[160:175]
  v_mfma_f32_32x32x16_bf16 v[176:191], v[200:203], a[232:235], v[176:191]
  buffer_load_dwordx4 v[76:79], v9, s[44:47], s80 offen offset:2048
  ds_read_b128 v[220:223], v20 offset:15360
  s_waitcnt lgkmcnt(4)
  v_mfma_f32_32x32x16_bf16 v[128:143], v[204:207], a[44:47], v[128:143]
  v_mfma_f32_32x32x16_bf16 v[144:159], v[204:207], a[108:111], v[144:159]
  buffer_load_dwordx4 v[80:83], v9, s[44:47], s80 offen offset:256
  v_mfma_f32_32x32x16_bf16 v[160:175], v[204:207], a[172:175], v[160:175]
  v_mfma_f32_32x32x16_bf16 v[176:191], v[204:207], a[236:239], v[176:191]
  buffer_load_dwordx4 v[84:87], v9, s[44:47], s80 offen offset:2304
  s_waitcnt lgkmcnt(3)
  v_mfma_f32_32x32x16_bf16 v[128:143], v[208:211], a[48:51], v[128:143]
  v_mfma_f32_32x32x16_bf16 v[144:159], v[208:211], a[112:115], v[144:159]
  buffer_load_dwordx4 v[88:91], v9, s[44:47], s84 offen offset:0
  v_mfma_f32_32x32x16_bf16 v[160:175], v[208:211], a[176:179], v[160:175]
  v_mfma_f32_32x32x16_bf16 v[176:191], v[208:211], a[240:243], v[176:191]
  buffer_load_dwordx4 v[92:95], v9, s[44:47], s84 offen offset:2048
  s_waitcnt lgkmcnt(2)
  v_mfma_f32_32x32x16_bf16 v[128:143], v[212:215], a[52:55], v[128:143]
  v_mfma_f32_32x32x16_bf16 v[144:159], v[212:215], a[116:119], v[144:159]
  buffer_load_dwordx4 v[96:99], v9, s[44:47], s84 offen offset:256
  v_mfma_f32_32x32x16_bf16 v[160:175], v[212:215], a[180:183], v[160:175]
  v_mfma_f32_32x32x16_bf16 v[176:191], v[212:215], a[244:247], v[176:191]
  buffer_load_dwordx4 v[100:103], v9, s[44:47], s84 offen offset:2304
  s_waitcnt lgkmcnt(1)
  v_mfma_f32_32x32x16_bf16 v[128:143], v[216:219], a[56:59], v[128:143]
  v_mfma_f32_32x32x16_bf16 v[144:159], v[216:219], a[120:123], v[144:159]
  v_mfma_f32_32x32x16_bf16 v[160:175], v[216:219], a[184:187], v[160:175]
  v_mfma_f32_32x32x16_bf16 v[176:191], v[216:219], a[248:251], v[176:191]
  s_waitcnt lgkmcnt(0)
  v_mfma_f32_32x32x16_bf16 v[128:143], v[220:223], a[60:63], v[128:143]
  v_mfma_f32_32x32x16_bf16 v[144:159], v[220:223], a[124:127], v[144:159]
  v_mfma_f32_32x32x16_bf16 v[160:175], v[220:223], a[188:191], v[160:175]
  s_and_b32 s88, s67, 3
  s_mul_i32 s88, s88, 524288
  s_add_u32 s89, s88, 8192
  s_add_u32 s90, s88, 16384
  s_add_u32 s91, s88, 24576
  v_mfma_f32_32x32x16_bf16 v[176:191], v[220:223], a[252:255], v[176:191]
  s_nop 4
  v_cvt_pk_bf16_f32 v192, v128, v144
  v_cvt_pk_bf16_f32 v194, v129, v145
  v_cvt_pk_bf16_f32 v196, v130, v146
  v_cvt_pk_bf16_f32 v198, v131, v147
  v_cvt_pk_bf16_f32 v200, v132, v148
  v_cvt_pk_bf16_f32 v202, v133, v149
  v_cvt_pk_bf16_f32 v204, v134, v150
  v_cvt_pk_bf16_f32 v206, v135, v151
  v_cvt_pk_bf16_f32 v208, v136, v152
  v_cvt_pk_bf16_f32 v210, v137, v153
  v_cvt_pk_bf16_f32 v212, v138, v154
  v_cvt_pk_bf16_f32 v214, v139, v155
  v_cvt_pk_bf16_f32 v216, v140, v156
  v_cvt_pk_bf16_f32 v218, v141, v157
  v_cmp_gt_u32 vcc, s87, v240
  s_nop 0
  s_cbranch_vccz bp_67
  s_nop 2
pf_68:
  buffer_load_dword v240, v15, s[44:47], s86 offen sc1
  s_waitcnt vmcnt(0)
  v_cmp_gt_u32 vcc, s87, v240
  s_nop 0
  s_cbranch_vccz pd_69
  s_nop 2
pr_70:
  s_sub_u32 s69, s69, 1
  s_cbranch_scc0 pf_68
  s_branch mega_exit
pd_69:
bp_67:
  v_cvt_pk_bf16_f32 v220, v142, v158
  v_cvt_pk_bf16_f32 v222, v143, v159
  v_cvt_pk_bf16_f32 v193, v160, v176
  v_cvt_pk_bf16_f32 v195, v161, v177
  v_cvt_pk_bf16_f32 v197, v162, v178
  v_cvt_pk_bf16_f32 v199, v163, v179
  v_cvt_pk_bf16_f32 v201, v164, v180
  v_cvt_pk_bf16_f32 v203, v165, v181
  v_cvt_pk_bf16_f32 v205, v166, v182
  v_cvt_pk_bf16_f32 v207, v167, v183
  v_cvt_pk_bf16_f32 v209, v168, v184
  v_cvt_pk_bf16_f32 v211, v169, v185
  v_cvt_pk_bf16_f32 v213, v170, v186
  v_cvt_pk_bf16_f32 v215, v171, v187
  v_cvt_pk_bf16_f32 v217, v172, v188
  v_cvt_pk_bf16_f32 v219, v173, v189
  v_cvt_pk_bf16_f32 v221, v174, v190
  v_cvt_pk_bf16_f32 v223, v175, v191
  s_add_u32 s67, s67, 1
  s_cmp_eq_u32 s83, 1
  s_cselect_b32 s72, s67, 64
  s_cmp_lt_u32 s72, 64
  s_cbranch_scc1 a0_top
  buffer_store_dwordx2 v[192:193], v12, s[44:47], s88 offen offset:0
  buffer_store_dwordx2 v[194:195], v12, s[44:47], s88 offen offset:1024
  buffer_store_dwordx2 v[196:197], v12, s[44:47], s88 offen offset:2048
  buffer_store_dwordx2 v[198:199], v12, s[44:47], s88 offen offset:3072
  buffer_store_dwordx2 v[200:201], v12, s[44:47], s89 offen offset:0
  buffer_store_dwordx2 v[202:203], v12, s[44:47], s89 offen offset:1024
  buffer_store_dwordx2 v[204:205], v12, s[44:47], s89 offen offset:2048
  buffer_store_dwordx2 v[206:207], v12, s[44:47], s89 offen offset:3072
  buffer_store_dwordx2 v[208:209], v12, s[44:47], s90 offen offset:0
  buffer_store_dwordx2 v[210:211], v12, s[44:47], s90 offen offset:1024
  buffer_store_dwordx2 v[212:213], v12, s[44:47], s90 offen offset:2048
  buffer_store_dwordx2 v[214:215], v12, s[44:47], s90 offen offset:3072
  buffer_store_dwordx2 v[216:217], v12, s[44:47], s91 offen offset:0
  buffer_store_dwordx2 v[218:219], v12, s[44:47], s91 offen offset:1024
  buffer_store_dwordx2 v[220:221], v12, s[44:47], s91 offen offset:2048
  buffer_store_dwordx2 v[222:223], v12, s[44:47], s91 offen offset:3072
  s_waitcnt vmcnt(0)
  v_mov_b32 v241, s67
  s_mov_b64 exec, 1
  buffer_store_dword v241, v14, s[44:47], 0 offen
  s_mov_b64 exec, -1
  s_cmp_ge_u32 s67, 64
  s_cbranch_scc1 mega_end
a0_top_in:
pf_71:
  buffer_load_dwordx4 v[236:239], v11, s[44:47], s82 offen sc1
  s_waitcnt vmcnt(0)
  v_min3_u32 v236, v236, v237, v238
  v_min_u32 v236, v236, v239
  v_cmp_gt_u32 vcc, s93, v236
  s_nop 0
  s_cbranch_vccz pd_72
  s_nop 2
pr_73:
  s_sub_u32 s69, s69, 1
  s_cbranch_scc0 pf_71
  s_branch mega_exit
pd_72:
  s_lshl_b32 s72, s92, 18
  s_add_u32 s72, s72, 67371008
  s_add_u32 s73, s72, 4096
  buffer_load_dwordx4 v[104:107], v10, s[44:47], s72 offen offset:0
  buffer_load_dwordx4 v[108:111], v10, s[44:47], s72 offen offset:1024
  buffer_load_dwordx4 v[112:115], v10, s[44:47], s72 offen offset:2048
  buffer_load_dwordx4 v[116:119], v10, s[44:47], s72 offen offset:3072
  buffer_load_dwordx2 v[120:121], v23, s[44:47], s73 offen offset:0
  buffer_load_dwordx2 v[122:123], v23, s[44:47], s73 offen offset:1024
  buffer_load_dwordx2 v[124:125], v23, s[44:47], s73 offen offset:2048
  buffer_load_dwordx2 v[126:127], v23, s[44:47], s73 offen offset:3072
  s_waitcnt vmcnt(0)
  s_branch a0_top_go
a1_top:
  s_waitcnt vmcnt(8)
a1_top_go:
  v_mfma_f32_16x16x32_bf16 v[128:131], v[40:43], v[24:27], v[248:251]
  buffer_store_dwordx2 v[192:193], v12, s[44:47], s88 offen offset:0 sc1
  v_mfma_f32_16x16x32_bf16 v[132:135], v[56:59], v[24:27], v[252:255]
  v_mfma_f32_16x16x32_bf16 v[136:139], v[104:107], v[24:27], 0
  buffer_store_dwordx2 v[194:195], v12, s[44:47], s88 offen offset:1024 sc1
  v_mfma_f32_16x16x32_bf16 v[128:131], v[44:47], v[28:31], v[128:131]
  v_mfma_f32_16x16x32_bf16 v[132:135], v[60:63], v[28:31], v[132:135]
  buffer_store_dwordx2 v[196:197], v12, s[44:47], s88 offen offset:2048 sc1
  v_mfma_f32_16x16x32_bf16 v[136:139], v[108:111], v[28:31], v[136:139]
  v_mfma_f32_16x16x32_bf16 v[128:131], v[48:51], v[32:35], v[128:131]
  buffer_store_dwordx2 v[198:199], v12, s[44:47], s88 offen offset:3072 sc1
  v_mfma_f32_16x16x32_bf16 v[132:135], v[64:67], v[32:35], v[132:135]
  v_mfma_f32_16x16x32_bf16 v[136:139], v[112:115], v[32:35], v[136:139]
  buffer_store_dwordx2 v[200:201], v12, s[44:47], s89 offen offset:0 sc1
  v_mfma_f32_16x16x32_bf16 v[128:131], v[52:55], v[36:39], v[128:131]
  v_mfma_f32_16x16x32_bf16 v[132:135], v[68:71], v[36:39], v[132:135]
  buffer_store_dwordx2 v[202:203], v12, s[44:47], s89 offen offset:1024 sc1
  v_mfma_f32_16x16x32_bf16 v[136:139], v[116:119], v[36:39], v[136:139]
  s_and_b32 s72, s67, 1
  s_lshl_b32 s72, s72, 14
  v_add_u32 v19, s72, v21
  v_add_u32 v20, s72, v22
  s_nop 0
  v_max3_f32 v224, v128, v129, v130
  v_max3_f32 v224, v224, v131, v132
  v_max3_f32 v224, v224, v133, v134
  v_max3_f32 v224, v224, v135, v136
  v_max3_f32 v224, v224, v137, v138
  v_max_f32 v224, v224, v139
  v_mov_b32 v225, v224
  s_nop 1
  v_permlane16_swap_b32 v224, v225
  v_max_f32 v224, v224, v225
  v_mov_b32 v225, v224
  s_nop 1
  v_permlane32_swap_b32 v224, v225
  v_max_f32 v224, v224, v225
  v_mul_f32 v224, 0xbe0293ee, v224
  v_pk_fma_f32 v[128:129], v[128:129], s[74:75], v[224:225] op_sel:[0,1,0] op_sel_hi:[1,1,0]
  v_pk_fma_f32 v[130:131], v[130:131], s[74:75], v[224:225] op_sel:[0,1,0] op_sel_hi:[1,1,0]
  v_pk_fma_f32 v[132:133], v[132:133], s[74:75], v[224:225] op_sel:[0,1,0] op_sel_hi:[1,1,0]
  v_pk_fma_f32 v[134:135], v[134:135], s[74:75], v[224:225] op_sel:[0,1,0] op_sel_hi:[1,1,0]
  v_pk_fma_f32 v[136:137], v[136:137], s[74:75], v[224:225] op_sel:[0,1,0] op_sel_hi:[1,1,0]
  v_pk_fma_f32 v[138:139], v[138:139], s[74:75], v[224:225] op_sel:[0,1,0] op_sel_hi:[1,1,0]
  v_exp_f32 v128, v128
  v_exp_f32 v129, v129
  v_exp_f32 v130, v130
  v_exp_f32 v131, v131
  v_exp_f32 v132, v132
  v_exp_f32 v133, v133
  v_exp_f32 v134, v134
  v_exp_f32 v135, v135
  v_exp_f32 v136, v136
  v_exp_f32 v137, v137
  v_exp_f32 v138, v138
  v_exp_f32 v139, v139
  v_cvt_pk_bf16_f32 v228, v128, v129
  v_cvt_pk_bf16_f32 v229, v130, v131
  v_cvt_pk_bf16_f32 v230, v132, v133
  v_cvt_pk_bf16_f32 v231, v134, v135
  v_cvt_pk_bf16_f32 v224, v136, v137
  v_cvt_pk_bf16_f32 v225, v138, v139
  v_cndmask_b32 v232, 0, v224, s[76:77]
  v_cndmask_b32 v234, v224, 0, s[76:77]
  v_cndmask_b32 v233, 0, v225, s[76:77]
  v_cndmask_b32 v235, v225, 0, s[76:77]
  s_waitcnt vmcnt(6)
  v_mfma_f32_16x16x32_bf16 v[176:179], v[244:247], v[228:231], 0
  buffer_store_dwordx2 v[204:205], v12, s[44:47], s89 offen offset:2048 sc1
  v_mfma_f32_16x16x32_bf16 v[144:147], v[72:75], v[228:231], 0
  s_nop 0
  v_mfma_f32_16x16x32_bf16 v[148:151], v[76:79], v[228:231], 0
  buffer_store_dwordx2 v[206:207], v12, s[44:47], s89 offen offset:3072 sc1
  v_mfma_f32_16x16x32_bf16 v[152:155], v[80:83], v[228:231], 0
  s_nop 0
  v_mfma_f32_16x16x32_bf16 v[156:159], v[84:87], v[228:231], 0
  buffer_store_dwordx2 v[208:209], v12, s[44:47], s90 offen offset:0 sc1
  v_mfma_f32_16x16x32_bf16 v[160:163], v[88:91], v[228:231], 0
  s_nop 0
  v_mfma_f32_16x16x32_bf16 v[164:167], v[92:95], v[228:231], 0
  buffer_store_dwordx2 v[210:211], v12, s[44:47], s90 offen offset:1024 sc1
  v_mfma_f32_16x16x32_bf16 v[168:171], v[96:99], v[228:231], 0
  v_mfma_f32_16x16x32_bf16 v[172:175], v[100:103], v[228:231], 0
  v_mfma_f32_16x16x16_bf16 v[176:179], v[244:245], v[232:233], v[176:179]
  s_add_u32 s92, s67, 1
  s_min_u32 s92, s92, 63
  v_mfma_f32_16x16x16_bf16 v[144:147], v[120:121], v[232:233], v[144:147]
  s_add_u32 s93, s92, 1
  s_mov_b32 s83, 0
  v_mfma_f32_16x16x16_bf16 v[148:151], v[120:121], v[234:235], v[148:151]
  v_mfma_f32_16x16x16_bf16 v[152:155], v[122:123], v[232:233], v[152:155]
  s_nop 0
  v_rcp_f32 v224, v176
  v_mfma_f32_16x16x16_bf16 v[156:159], v[122:123], v[234:235], v[156:159]
  v_mfma_f32_16x16x16_bf16 v[160:163], v[124:125], v[232:233], v[160:163]
  v_mfma_f32_16x16x16_bf16 v[164:167], v[124:125], v[234:235], v[164:167]
  v_pk_mul_f32 v[144:145], v[144:145], v[224:225] op_sel_hi:[1,0]
  v_pk_mul_f32 v[146:147], v[146:147], v[224:225] op_sel_hi:[1,0]
  v_pk_mul_f32 v[148:149], v[148:149], v[224:225] op_sel_hi:[1,0]
  v_mfma_f32_16x16x16_bf16 v[168:171], v[126:127], v[232:233], v[168:171]
  v_pk_mul_f32 v[150:151], v[150:151], v[224:225] op_sel_hi:[1,0]
  v_cvt_pk_bf16_f32 v128, v144, v148
  v_cvt_pk_bf16_f32 v129, v145, v149
  v_mfma_f32_16x16x16_bf16 v[172:175], v[126:127], v[234:235], v[172:175]
  v_cvt_pk_bf16_f32 v130, v146, v150
  v_cvt_pk_bf16_f32 v131, v147, v151
  ds_write_b128 v19, v[128:131] offset:0
  v_pk_mul_f32 v[152:153], v[152:153], v[224:225] op_sel_hi:[1,0]
  v_pk_mul_f32 v[154:155], v[154:155], v[224:225] op_sel_hi:[1,0]
  v_pk_mul_f32 v[156:157], v[156:157], v[224:225] op_sel_hi:[1,0]
  v_pk_mul_f32 v[158:159], v[158:159], v[224:225] op_sel_hi:[1,0]
  v_cvt_pk_bf16_f32 v132, v152, v156
  v_cvt_pk_bf16_f32 v133, v153, v157
  v_cvt_pk_bf16_f32 v134, v154, v158
  v_cvt_pk_bf16_f32 v135, v155, v159
  ds_write_b128 v19, v[132:135] offset:2048
  v_pk_mul_f32 v[160:161], v[160:161], v[224:225] op_sel_hi:[1,0]
  v_pk_mul_f32 v[162:163], v[162:163], v[224:225] op_sel_hi:[1,0]
  v_pk_mul_f32 v[164:165], v[164:165], v[224:225] op_sel_hi:[1,0]
  v_pk_mul_f32 v[166:167], v[166:167], v[224:225] op_sel_hi:[1,0]
  v_cvt_pk_bf16_f32 v136, v160, v164
  v_cvt_pk_bf16_f32 v137, v161, v165
  v_cvt_pk_bf16_f32 v138, v162, v166
  v_cvt_pk_bf16_f32 v139, v163, v167
  ds_write_b128 v19, v[136:139] offset:4096
  v_pk_mul_f32 v[168:169], v[168:169], v[224:225] op_sel_hi:[1,0]
  v_pk_mul_f32 v[170:171], v[170:171], v[224:225] op_sel_hi:[1,0]
  v_pk_mul_f32 v[172:173], v[172:173], v[224:225] op_sel_hi:[1,0]
  v_pk_mul_f32 v[174:175], v[174:175], v[224:225] op_sel_hi:[1,0]
  v_cvt_pk_bf16_f32 v140, v168, v172
  v_cvt_pk_bf16_f32 v141, v169, v173
  v_cvt_pk_bf16_f32 v142, v170, v174
  v_cvt_pk_bf16_f32 v143, v171, v175
  ds_write_b128 v19, v[140:143] offset:6144
  s_waitcnt lgkmcnt(0)
  s_barrier
  ds_read_b128 v[192:195], v20 offset:0
  ds_read_b128 v[196:199], v20 offset:1024
  ds_read_b128 v[200:203], v20 offset:2048
  ds_read_b128 v[204:207], v20 offset:3072
  ds_read_b128 v[208:211], v20 offset:4096
  s_waitcnt lgkmcnt(4)
  v_mfma_f32_32x32x16_bf16 v[128:143], v[192:195], a[0:3], 0
  buffer_store_dwordx2 v[212:213], v12, s[44:47], s90 offen offset:2048 sc1
  v_mfma_f32_32x32x16_bf16 v[144:159], v[192:195], a[64:67], 0
  buffer_load_dwordx4 v[236:239], v11, s[44:47], s82 offen sc1
  s_sub_u32 s86, s67, 4
  s_cselect_b32 s86, 0, s86
  s_cselect_b32 s87, 0, 1
  s_lshl_b32 s86, s86, 7
  buffer_load_dword v240, v15, s[44:47], s86 offen sc1
  v_mfma_f32_32x32x16_bf16 v[160:175], v[192:195], a[128:131], 0
  buffer_store_dwordx2 v[214:215], v12, s[44:47], s90 offen offset:3072 sc1
  v_mfma_f32_32x32x16_bf16 v[176:191], v[192:195], a[192:195], 0
  s_lshl_b32 s78, s92, 20
  s_add_u32 s78, s78, 134217728
  s_add_u32 s79, s78, 4096
  s_add_u32 s80, s78, 8192
  s_add_u32 s84, s78, 12288
  ds_read_b128 v[212:215], v20 offset:5120
  s_waitcnt lgkmcnt(4)
  v_mfma_f32_32x32x16_bf16 v[128:143], v[196:199], a[4:7], v[128:143]
  buffer_store_dwordx2 v[216:217], v12, s[44:47], s91 offen offset:0 sc1
  v_mfma_f32_32x32x16_bf16 v[144:159], v[196:199], a[68:71], v[144:159]
  s_lshl_b32 s72, s92, 18
  s_add_u32 s72, s72, 67371008
  s_add_u32 s73, s72, 4096
  v_mfma_f32_32x32x16_bf16 v[160:175], v[196:199], a[132:135], v[160:175]
  buffer_store_dwordx2 v[218:219], v12, s[44:47], s91 offen offset:1024 sc1
  v_mfma_f32_32x32x16_bf16 v[176:191], v[196:199], a[196:199], v[176:191]
  ds_read_b128 v[216:219], v20 offset:6144
  s_waitcnt lgkmcnt(4)
  v_mfma_f32_32x32x16_bf16 v[128:143], v[200:203], a[8:11], v[128:143]
  buffer_store_dwordx2 v[220:221], v12, s[44:47], s91 offen offset:2048 sc1
  v_mfma_f32_32x32x16_bf16 v[144:159], v[200:203], a[72:75], v[144:159]
  v_mfma_f32_32x32x16_bf16 v[160:175], v[200:203], a[136:139], v[160:175]
  buffer_store_dwordx2 v[222:223], v12, s[44:47], s91 offen offset:3072 sc1
  v_mfma_f32_32x32x16_bf16 v[176:191], v[200:203], a[200:203], v[176:191]
  ds_read_b128 v[220:223], v20 offset:7168
  s_waitcnt lgkmcnt(4)
  v_mfma_f32_32x32x16_bf16 v[128:143], v[204:207], a[12:15], v[128:143]
  buffer_load_dwordx4 v[24:27], v13, s[44:47], s78 offen offset:0
  v_mfma_f32_32x32x16_bf16 v[144:159], v[204:207], a[76:79], v[144:159]
  v_mfma_f32_32x32x16_bf16 v[160:175], v[204:207], a[140:143], v[160:175]
  buffer_load_dwordx4 v[28:31], v13, s[44:47], s78 offen offset:1024
  v_mfma_f32_32x32x16_bf16 v[176:191], v[204:207], a[204:207], v[176:191]
  ds_read_b128 v[192:195], v20 offset:8192
  s_waitcnt lgkmcnt(4)
  v_mfma_f32_32x32x16_bf16 v[128:143], v[208:211], a[16:19], v[128:143]
  buffer_load_dwordx4 v[32:35], v13, s[44:47], s78 offen offset:2048
  v_mfma_f32_32x32x16_bf16 v[144:159], v[208:211], a[80:83], v[144:159]
  v_mfma_f32_32x32x16_bf16 v[160:175], v[208:211], a[144:147], v[160:175]
  buffer_load_dwordx4 v[36:39], v13, s[44:47], s78 offen offset:3072
  v_mfma_f32_32x32x16_bf16 v[176:191], v[208:211], a[208:211], v[176:191]
  ds_read_b128 v[196:199], v20 offset:9216
  s_waitcnt lgkmcnt(4)
  v_mfma_f32_32x32x16_bf16 v[128:143], v[212:215], a[20:23], v[128:143]
  buffer_load_dwordx4 v[40:43], v9, s[44:47], s78 offen offset:0
  v_mfma_f32_32x32x16_bf16 v[144:159], v[212:215], a[84:87], v[144:159]
  v_mfma_f32_32x32x16_bf16 v[160:175], v[212:215], a[148:151], v[160:175]
  buffer_load_dwordx4 v[56:59], v9, s[44:47], s78 offen offset:256
  v_mfma_f32_32x32x16_bf16 v[176:191], v[212:215], a[212:215], v[176:191]
  ds_read_b128 v[200:203], v20 offset:10240
  s_waitcnt lgkmcnt(4)
  v_mfma_f32_32x32x16_bf16 v[128:143], v[216:219], a[24:27], v[128:143]
  buffer_load_dwordx4 v[44:47], v9, s[44:47], s78 offen offset:2048
  v_mfma_f32_32x32x16_bf16 v[144:159], v[216:219], a[88:91], v[144:159]
  s_waitcnt vmcnt(7)
  v_min3_u32 v236, v236, v237, v238
  v_min_u32 v236, v236, v239
  v_cmp_gt_u32 vcc, s93, v236
  v_mfma_f32_32x32x16_bf16 v[160:175], v[216:219], a[152:155], v[160:175]
  buffer_load_dwordx4 v[60:63], v9, s[44:47], s78 offen offset:2304
  s_cmp_eq_u64 vcc, 0
  s_cselect_b32 s83, 1, 0
  v_mov_b32 v241, s67
  s_mov_b64 exec, 1
  buffer_store_dword v241, v14, s[44:47], 0 offen sc1
  s_mov_b64 exec, -1
  v_mfma_f32_32x32x16_bf16 v[176:191], v[216:219], a[216:219], v[176:191]
  s_cmp_eq_u32 s83, 1
  s_cbranch_scc0 c_74
  buffer_load_dwordx4 v[104:107], v10, s[44:47], s72 offen offset:0
  buffer_load_dwordx2 v[120:121], v23, s[44:47], s73 offen offset:0
c_74:
  ds_read_b128 v[204:207], v20 offset:11264
  s_waitcnt lgkmcnt(4)
  v_mfma_f32_32x32x16_bf16 v[128:143], v[220:223], a[28:31], v[128:143]
  buffer_load_dwordx4 v[48:51], v9, s[44:47], s79 offen offset:0
  v_mfma_f32_32x32x16_bf16 v[144:159], v[220:223], a[92:95], v[144:159]
  v_mfma_f32_32x32x16_bf16 v[160:175], v[220:223], a[156:159], v[160:175]
  buffer_load_dwordx4 v[64:67], v9, s[44:47], s79 offen offset:256
  v_mfma_f32_32x32x16_bf16 v[176:191], v[220:223], a[220:223], v[176:191]
  s_cmp_eq_u32 s83, 1
  s_cbranch_scc0 c_75
  buffer_load_dwordx4 v[108:111], v10, s[44:47], s72 offen offset:1024
  buffer_load_dwordx2 v[122:123], v23, s[44:47], s73 offen offset:1024
c_75:
  ds_read_b128 v[208:211], v20 offset:12288
  s_waitcnt lgkmcnt(4)
  v_mfma_f32_32x32x16_bf16 v[128:143], v[192:195], a[32:35], v[128:143]
  buffer_load_dwordx4 v[52:55], v9, s[44:47], s79 offen offset:2048
  v_mfma_f32_32x32x16_bf16 v[144:159], v[192:195], a[96:99], v[144:159]
  v_mfma_f32_32x32x16_bf16 v[160:175], v[192:195], a[160:163], v[160:175]
  buffer_load_dwordx4 v[68:71], v9, s[44:47], s79 offen offset:2304
  v_mfma_f32_32x32x16_bf16 v[176:191], v[192:195], a[224:227], v[176:191]
  s_cmp_eq_u32 s83, 1
  s_cbranch_scc0 c_76
  buffer_load_dwordx4 v[112:115], v10, s[44:47], s72 offen offset:2048
  buffer_load_dwordx2 v[124:125], v23, s[44:47], s73 offen offset:2048
c_76:
  ds_read_b128 v[212:215], v20 offset:13312
  s_waitcnt lgkmcnt(4)
  v_mfma_f32_32x32x16_bf16 v[128:143], v[196:199], a[36:39], v[128:143]
  v_mfma_f32_32x32x16_bf16 v[144:159], v[196:199], a[100:103], v[144:159]
  v_mfma_f32_32x32x16_bf16 v[160:175], v[196:199], a[164:167], v[160:175]
  v_mfma_f32_32x32x16_bf16 v[176:191], v[196:199], a[228:231], v[176:191]
  s_cmp_eq_u32 s83, 1
  s_cbranch_scc0 c_77
  buffer_load_dwordx4 v[116:119], v10, s[44:47], s72 offen offset:3072
  buffer_load_dwordx2 v[126:127], v23, s[44:47], s73 offen offset:3072
c_77:
  ds_read_b128 v[216:219], v20 offset:14336
  s_waitcnt lgkmcnt(4)
  v_mfma_f32_32x32x16_bf16 v[128:143], v[200:203], a[40:43], v[128:143]
  v_mfma_f32_32x32x16_bf16 v[144:159], v[200:203], a[104:107], v[144:159]
  buffer_load_dwordx4 v[72:75], v9, s[44:47], s80 offen offset:0
  v_mfma_f32_32x32x16_bf16 v[160:175], v[200:203], a[168:171], v[160:175]
  v_mfma_f32_32x32x16_bf16 v[176:191], v[200:203], a[232:235], v[176:191]
  buffer_load_dwordx4 v[76:79], v9, s[44:47], s80 offen offset:2048
  ds_read_b128 v[220:223], v20 offset:15360
  s_waitcnt lgkmcnt(4)
  v_mfma_f32_32x32x16_bf16 v[128:143], v[204:207], a[44:47], v[128:143]
  v_mfma_f32_32x32x16_bf16 v[144:159], v[204:207], a[108:111], v[144:159]
  buffer_load_dwordx4 v[80:83], v9, s[44:47], s80 offen offset:256
  v_mfma_f32_32x32x16_bf16 v[160:175], v[204:207], a[172:175], v[160:175]
  v_mfma_f32_32x32x16_bf16 v[176:191], v[204:207], a[236:239], v[176:191]
  buffer_load_dwordx4 v[84:87], v9, s[44:47], s80 offen offset:2304
  s_waitcnt lgkmcnt(3)
  v_mfma_f32_32x32x16_bf16 v[128:143], v[208:211], a[48:51], v[128:143]
  v_mfma_f32_32x32x16_bf16 v[144:159], v[208:211], a[112:115], v[144:159]
  buffer_load_dwordx4 v[88:91], v9, s[44:47], s84 offen offset:0
  v_mfma_f32_32x32x16_bf16 v[160:175], v[208:211], a[176:179], v[160:175]
  v_mfma_f32_32x32x16_bf16 v[176:191], v[208:211], a[240:243], v[176:191]
  buffer_load_dwordx4 v[92:95], v9, s[44:47], s84 offen offset:2048
  s_waitcnt lgkmcnt(2)
  v_mfma_f32_32x32x16_bf16 v[128:143], v[212:215], a[52:55], v[128:143]
  v_mfma_f32_32x32x16_bf16 v[144:159], v[212:215], a[116:119], v[144:159]
  buffer_load_dwordx4 v[96:99], v9, s[44:47], s84 offen offset:256
  v_mfma_f32_32x32x16_bf16 v[160:175], v[212:215], a[180:183], v[160:175]
  v_mfma_f32_32x32x16_bf16 v[176:191], v[212:215], a[244:247], v[176:191]
  buffer_load_dwordx4 v[100:103], v9, s[44:47], s84 offen offset:2304
  s_waitcnt lgkmcnt(1)
  v_mfma_f32_32x32x16_bf16 v[128:143], v[216:219], a[56:59], v[128:143]
  v_mfma_f32_32x32x16_bf16 v[144:159], v[216:219], a[120:123], v[144:159]
  v_mfma_f32_32x32x16_bf16 v[160:175], v[216:219], a[184:187], v[160:175]
  v_mfma_f32_32x32x16_bf16 v[176:191], v[216:219], a[248:251], v[176:191]
  s_waitcnt lgkmcnt(0)
  v_mfma_f32_32x32x16_bf16 v[128:143], v[220:223], a[60:63], v[128:143]
  v_mfma_f32_32x32x16_bf16 v[144:159], v[220:223], a[124:127], v[144:159]
  v_mfma_f32_32x32x16_bf16 v[160:175], v[220:223], a[188:191], v[160:175]
  s_and_b32 s88, s67, 3
  s_mul_i32 s88, s88, 524288
  s_add_u32 s89, s88, 8192
  s_add_u32 s90, s88, 16384
  s_add_u32 s91, s88, 24576
  v_mfma_f32_32x32x16_bf16 v[176:191], v[220:223], a[252:255], v[176:191]
  s_nop 4
  v_cvt_pk_bf16_f32 v192, v128, v144
  v_cvt_pk_bf16_f32 v194, v129, v145
  v_cvt_pk_bf16_f32 v196, v130, v146
  v_cvt_pk_bf16_f32 v198, v131, v147
  v_cvt_pk_bf16_f32 v200, v132, v148
  v_cvt_pk_bf16_f32 v202, v133, v149
  v_cvt_pk_bf16_f32 v204, v134, v150
  v_cvt_pk_bf16_f32 v206, v135, v151
  v_cvt_pk_bf16_f32 v208, v136, v152
  v_cvt_pk_bf16_f32 v210, v137, v153
  v_cvt_pk_bf16_f32 v212, v138, v154
  v_cvt_pk_bf16_f32 v214, v139, v155
  v_cvt_pk_bf16_f32 v216, v140, v156
  v_cvt_pk_bf16_f32 v218, v141, v157
  v_cmp_gt_u32 vcc, s87, v240
  s_nop 0
  s_cbranch_vccz bp_78
  s_nop 2
pf_79:
  buffer_load_dword v240, v15, s[44:47], s86 offen sc1
  s_waitcnt vmcnt(0)
  v_cmp_gt_u32 vcc, s87, v240
  s_nop 0
  s_cbranch_vccz pd_80
  s_nop 2
pr_81:
  s_sub_u32 s69, s69, 1
  s_cbranch_scc0 pf_79
  s_branch mega_exit
pd_80:
bp_78:
  v_cvt_pk_bf16_f32 v220, v142, v158
  v_cvt_pk_bf16_f32 v222, v143, v159
  v_cvt_pk_bf16_f32 v193, v160, v176
  v_cvt_pk_bf16_f32 v195, v161, v177
  v_cvt_pk_bf16_f32 v197, v162, v178
  v_cvt_pk_bf16_f32 v199, v163, v179
  v_cvt_pk_bf16_f32 v201, v164, v180
  v_cvt_pk_bf16_f32 v203, v165, v181
  v_cvt_pk_bf16_f32 v205, v166, v182
  v_cvt_pk_bf16_f32 v207, v167, v183
  v_cvt_pk_bf16_f32 v209, v168, v184
  v_cvt_pk_bf16_f32 v211, v169, v185
  v_cvt_pk_bf16_f32 v213, v170, v186
  v_cvt_pk_bf16_f32 v215, v171, v187
  v_cvt_pk_bf16_f32 v217, v172, v188
  v_cvt_pk_bf16_f32 v219, v173, v189
  v_cvt_pk_bf16_f32 v221, v174, v190
  v_cvt_pk_bf16_f32 v223, v175, v191
  s_add_u32 s67, s67, 1
  s_cmp_eq_u32 s83, 1
  s_cselect_b32 s72, s67, 64
  s_cmp_lt_u32 s72, 64
  s_cbranch_scc1 a1_top
  buffer_store_dwordx2 v[192:193], v12, s[44:47], s88 offen offset:0 sc1
  buffer_store_dwordx2 v[194:195], v12, s[44:47], s88 offen offset:1024 sc1
  buffer_store_dwordx2 v[196:197], v12, s[44:47], s88 offen offset:2048 sc1
  buffer_store_dwordx2 v[198:199], v12, s[44:47], s88 offen offset:3072 sc1
  buffer_store_dwordx2 v[200:201], v12, s[44:47], s89 offen offset:0 sc1
  buffer_store_dwordx2 v[202:203], v12, s[44:47], s89 offen offset:1024 sc1
  buffer_store_dwordx2 v[204:205], v12, s[44:47], s89 offen offset:2048 sc1
  buffer_store_dwordx2 v[206:207], v12, s[44:47], s89 offen offset:3072 sc1
  buffer_store_dwordx2 v[208:209], v12, s[44:47], s90 offen offset:0 sc1
  buffer_store_dwordx2 v[210:211], v12, s[44:47], s90 offen offset:1024 sc1
  buffer_store_dwordx2 v[212:213], v12, s[44:47], s90 offen offset:2048 sc1
  buffer_store_dwordx2 v[214:215], v12, s[44:47], s90 offen offset:3072 sc1
  buffer_store_dwordx2 v[216:217], v12, s[44:47], s91 offen offset:0 sc1
  buffer_store_dwordx2 v[218:219], v12, s[44:47], s91 offen offset:1024 sc1
  buffer_store_dwordx2 v[220:221], v12, s[44:47], s91 offen offset:2048 sc1
  buffer_store_dwordx2 v[222:223], v12, s[44:47], s91 offen offset:3072 sc1
  s_waitcnt vmcnt(0)
  v_mov_b32 v241, s67
  s_mov_b64 exec, 1
  buffer_store_dword v241, v14, s[44:47], 0 offen sc1
  s_mov_b64 exec, -1
  s_cmp_ge_u32 s67, 64
  s_cbranch_scc1 mega_end
a1_top_in:
pf_82:
  buffer_load_dwordx4 v[236:239], v11, s[44:47], s82 offen sc1
  s_waitcnt vmcnt(0)
  v_min3_u32 v236, v236, v237, v238
  v_min_u32 v236, v236, v239
  v_cmp_gt_u32 vcc, s93, v236
  s_nop 0
  s_cbranch_vccz pd_83
  s_nop 2
pr_84:
  s_sub_u32 s69, s69, 1
  s_cbranch_scc0 pf_82
  s_branch mega_exit
pd_83:
  s_lshl_b32 s72, s92, 18
  s_add_u32 s72, s72, 67371008
  s_add_u32 s73, s72, 4096
  buffer_load_dwordx4 v[104:107], v10, s[44:47], s72 offen offset:0
  buffer_load_dwordx4 v[108:111], v10, s[44:47], s72 offen offset:1024
  buffer_load_dwordx4 v[112:115], v10, s[44:47], s72 offen offset:2048
  buffer_load_dwordx4 v[116:119], v10, s[44:47], s72 offen offset:3072
  buffer_load_dwordx2 v[120:121], v23, s[44:47], s73 offen offset:0
  buffer_load_dwordx2 v[122:123], v23, s[44:47], s73 offen offset:1024
  buffer_load_dwordx2 v[124:125], v23, s[44:47], s73 offen offset:2048
  buffer_load_dwordx2 v[126:127], v23, s[44:47], s73 offen offset:3072
  s_waitcnt vmcnt(0)
  s_branch a1_top_go
  s_branch mega_end
role_f:
  s_cmp_lt_u32 s65, 22
  s_cbranch_scc1 f_comp
  s_mov_b32 s52, s38
  s_mov_b32 s53, s39
  s_mov_b32 s54, 2097152
  s_mov_b32 s55, 0x00020000
  s_mul_i32 s79, s64, 10
  s_add_u32 s79, s79, s65
  s_add_u32 s79, s79, 10
  s_sub_u32 s80, s65, 22
  s_lshl_b32 s80, s80, 2
  s_add_u32 s80, s80, s66
  v_lshlrev_b32 v16, 4, v1
  s_lshl_b32 s72, s64, 22
  s_add_u32 s72, s72, 26214400
  v_add_u32 v13, s72, v16
  s_lshl_b32 s72, s64, 9
  s_add_u32 s72, s72, 14683136
  v_min_u32 v15, 43, v1
  v_lshlrev_b32 v15, 3, v15
  v_add_u32 v15, s72, v15
  s_lshl_b32 s72, s64, 13
  s_add_u32 s72, s72, 14704640
  v_mov_b32 v14, s72
  s_mov_b32 s94, 0x3f80
  s_mov_b32 s95, 0x3f800000
  s_lshl_b32 s81, s64, 21
  s_mov_b32 s48, s16
  s_mov_b32 s49, s17
  s_mov_b32 s50, 2097152
  s_mov_b32 s51, 0x00020000
  s_mov_b32 s60, s18
  s_mov_b32 s61, s19
  s_mov_b32 s62, 8192
  s_mov_b32 s63, 0x00020000
  s_lshl_b32 s79, s79, 2
  s_add_u32 s79, s79, s66
  s_lshl_b32 s72, s79, 10
  buffer_load_dwordx4 v[64:67], v16, s[48:51], s72 offen
  s_add_u32 s72, s72, 212992
  s_min_u32 s72, s72, 2096128
  buffer_load_dwordx4 v[68:71], v16, s[48:51], s72 offen
  s_add_u32 s72, s72, 212992
  s_min_u32 s72, s72, 2096128
  buffer_load_dwordx4 v[72:75], v16, s[48:51], s72 offen
  s_add_u32 s72, s72, 212992
  s_min_u32 s72, s72, 2096128
  buffer_load_dwordx4 v[76:79], v16, s[48:51], s72 offen
  s_add_u32 s72, s72, 212992
  s_min_u32 s72, s72, 2096128
  buffer_load_dwordx4 v[80:83], v16, s[48:51], s72 offen
  s_add_u32 s72, s72, 212992
  s_min_u32 s72, s72, 2096128
  buffer_load_dwordx4 v[84:87], v16, s[48:51], s72 offen
  s_add_u32 s72, s72, 212992
  s_min_u32 s72, s72, 2096128
  buffer_load_dwordx4 v[88:91], v16, s[48:51], s72 offen
  s_add_u32 s72, s72, 212992
  s_min_u32 s72, s72, 2096128
  buffer_load_dwordx4 v[92:95], v16, s[48:51], s72 offen
  s_add_u32 s72, s72, 212992
  s_min_u32 s72, s72, 2096128
  buffer_load_dwordx4 v[96:99], v16, s[48:51], s72 offen
  s_add_u32 s72, s72, 212992
  s_min_u32 s72, s72, 2096128
  buffer_load_dwordx4 v[100:103], v16, s[48:51], s72 offen
  s_add_u32 s72, s72, 212992
  s_min_u32 s72, s72, 2096128
  s_lshl_b32 s72, s79, 6
  v_add_u32 v20, s72, v1
  v_and_b32 v21, 0xfe0, v20
  v_and_b32 v22, 15, v20
  v_lshl_add_u32 v21, v22, 1, v21
  v_bfe_u32 v22, v20, 4, 1
  v_add_u32 v21, v21, v22
  v_lshlrev_b32 v21, 1, v21
  buffer_load_ushort v23, v21, s[60:63], 0 offen
  v_lshrrev_b32 v21, 12, v20
  v_lshlrev_b32 v21, 15, v21
  v_and_b32 v20, 0xfff, v20
  v_lshl_add_u32 v21, v20, 1, v21
  s_mov_b32 s73, 14745600
  v_mov_b32 v24, 0
  v_mov_b32 v28, -1
  v_mov_b32 v25, 0
  v_mov_b32 v29, -1
  v_mov_b32 v26, 0
  v_mov_b32 v30, -1
  v_mov_b32 v27, 0
  v_mov_b32 v31, -1
  s_lshl_b32 s72, s79, 10
  s_add_u32 s74, s72, 14680064
  s_cmp_lt_u32 s79, 64
  s_cbranch_scc0 ib_85
  buffer_store_dwordx4 v[24:27], v16, s[44:47], s74 offen sc1
  s_nop 1
ib_85:
  s_cmp_lt_u32 s79, 24
  s_cselect_b32 s74, 0, 8192
  s_add_u32 s74, s74, 14753792
  s_add_u32 s74, s74, s72
  s_cmp_lt_u32 s79, 48
  s_cbranch_scc0 ib_86
  buffer_store_dwordx4 v[28:31], v16, s[44:47], s74 offen sc1
  s_nop 1
ib_86:
  s_add_u32 s74, s79, 0
  s_lshr_b32 s75, s74, 8
  s_lshl_b32 s75, s75, 19
  s_and_b32 s76, s74, 255
  s_lshl_b32 s76, s76, 10
  s_add_u32 s75, s75, s76
  s_add_u32 s75, s75, 14811136
  s_cmp_lt_u32 s74, 1024
  s_cbranch_scc0 ib_87
  buffer_store_dwordx4 v[24:27], v16, s[44:47], s75 offen sc1
  s_nop 1
ib_87:
  s_add_u32 s74, s79, 208
  s_lshr_b32 s75, s74, 8
  s_lshl_b32 s75, s75, 19
  s_and_b32 s76, s74, 255
  s_lshl_b32 s76, s76, 10
  s_add_u32 s75, s75, s76
  s_add_u32 s75, s75, 14811136
  s_cmp_lt_u32 s74, 1024
  s_cbranch_scc0 ib_88
  buffer_store_dwordx4 v[24:27], v16, s[44:47], s75 offen sc1
  s_nop 1
ib_88:
  s_add_u32 s74, s79, 416
  s_lshr_b32 s75, s74, 8
  s_lshl_b32 s75, s75, 19
  s_and_b32 s76, s74, 255
  s_lshl_b32 s76, s76, 10
  s_add_u32 s75, s75, s76
  s_add_u32 s75, s75, 14811136
  s_cmp_lt_u32 s74, 1024
  s_cbranch_scc0 ib_89
  buffer_store_dwordx4 v[24:27], v16, s[44:47], s75 offen sc1
  s_nop 1
ib_89:
  s_add_u32 s74, s79, 624
  s_lshr_b32 s75, s74, 8
  s_lshl_b32 s75, s75, 19
  s_and_b32 s76, s74, 255
  s_lshl_b32 s76, s76, 10
  s_add_u32 s75, s75, s76
  s_add_u32 s75, s75, 14811136
  s_cmp_lt_u32 s74, 1024
  s_cbranch_scc0 ib_90
  buffer_store_dwordx4 v[24:27], v16, s[44:47], s75 offen sc1
  s_nop 1
ib_90:
  s_add_u32 s74, s79, 832
  s_lshr_b32 s75, s74, 8
  s_lshl_b32 s75, s75, 19
  s_and_b32 s76, s74, 255
  s_lshl_b32 s76, s76, 10
  s_add_u32 s75, s75, s76
  s_add_u32 s75, s75, 14811136
  s_cmp_lt_u32 s74, 1024
  s_cbranch_scc0 ib_91
  buffer_store_dwordx4 v[24:27], v16, s[44:47], s75 offen sc1
  s_nop 1
ib_91:
  s_waitcnt vmcnt(0)
  v_min_u32 v23, 0xfffe, v23
  s_cmp_lt_u32 s79, 128
  s_cbranch_scc0 ib_92
  buffer_store_short v23, v21, s[44:47], s73 offen sc1
ib_92:
  v_lshlrev_b32 v28, 16, v64
  v_and_b32 v29, 0xffff0000, v64
  v_lshlrev_b32 v30, 16, v65
  v_and_b32 v31, 0xffff0000, v65
  v_lshlrev_b32 v32, 16, v66
  v_and_b32 v33, 0xffff0000, v66
  v_lshlrev_b32 v34, 16, v67
  v_and_b32 v35, 0xffff0000, v67
  v_add_f32 v40, v28, v29
  v_add_f32 v40, v40, v30
  v_add_f32 v40, v40, v31
  v_add_f32 v40, v40, v32
  v_add_f32 v40, v40, v33
  v_add_f32 v40, v40, v34
  v_add_f32 v40, v40, v35
  s_nop 1
  v_add_f32_dpp v40, v40, v40 row_ror:8 row_mask:0xf bank_mask:0xf
  s_nop 1
  v_add_f32_dpp v40, v40, v40 row_ror:4 row_mask:0xf bank_mask:0xf
  s_nop 1
  v_add_f32_dpp v40, v40, v40 row_ror:2 row_mask:0xf bank_mask:0xf
  s_nop 1
  v_add_f32_dpp v40, v40, v40 row_ror:1 row_mask:0xf bank_mask:0xf
  v_mov_b32 v41, v40
  s_nop 1
  v_permlane16_swap_b32 v40, v41
  v_add_f32 v40, v40, v41
  v_mov_b32 v41, v40
  s_nop 1
  v_permlane32_swap_b32 v40, v41
  v_add_f32 v40, v40, v41
  v_mul_f32 v40, 0x3b000000, v40
  v_sub_f32 v44, v28, v40
  v_sub_f32 v45, v29, v40
  v_sub_f32 v46, v30, v40
  v_sub_f32 v47, v31, v40
  v_sub_f32 v48, v32, v40
  v_sub_f32 v49, v33, v40
  v_sub_f32 v50, v34, v40
  v_sub_f32 v51, v35, v40
  v_mul_f32 v43, v44, v44
  v_fmac_f32 v43, v45, v45
  v_fmac_f32 v43, v46, v46
  v_fmac_f32 v43, v47, v47
  v_fmac_f32 v43, v48, v48
  v_fmac_f32 v43, v49, v49
  v_fmac_f32 v43, v50, v50
  v_fmac_f32 v43, v51, v51
  v_cvt_pk_bf16_f32 v42, v40, v40
  v_and_b32 v42, 0xffff0000, v42
  v_add_f32_dpp v43, v43, v43 row_ror:8 row_mask:0xf bank_mask:0xf
  s_nop 1
  v_add_f32_dpp v43, v43, v43 row_ror:4 row_mask:0xf bank_mask:0xf
  s_nop 1
  v_add_f32_dpp v43, v43, v43 row_ror:2 row_mask:0xf bank_mask:0xf
  s_nop 1
  v_add_f32_dpp v43, v43, v43 row_ror:1 row_mask:0xf bank_mask:0xf
  v_mov_b32 v41, v43
  s_nop 1
  v_permlane16_swap_b32 v43, v41
  v_add_f32 v43, v43, v41
  v_mov_b32 v41, v43
  s_nop 1
  v_permlane32_swap_b32 v43, v41
  v_add_f32 v43, v43, v41
  v_sub_f32 v44, v28, v42
  v_sub_f32 v45, v29, v42
  v_sub_f32 v46, v30, v42
  v_sub_f32 v47, v31, v42
  v_sub_f32 v48, v32, v42
  v_sub_f32 v49, v33, v42
  v_sub_f32 v50, v34, v42
  v_sub_f32 v51, v35, v42
  v_mul_f32 v43, 0x3b000000, v43
  v_cvt_pk_bf16_f32 v43, v43, v43
  v_and_b32 v43, 0xffff0000, v43
  v_add_f32 v43, 0x3727c5ac, v43
  v_cvt_pk_bf16_f32 v43, v43, v43
  v_and_b32 v43, 0xffff0000, v43
  v_sqrt_f32 v43, v43
  s_nop 0
  v_cvt_pk_bf16_f32 v43, v43, v43
  v_and_b32 v43, 0xffff0000, v43
  v_rcp_f32 v43, v43
  v_cvt_pk_bf16_f32 v36, v44, v45
  v_cvt_pk_bf16_f32 v37, v46, v47
  v_cvt_pk_bf16_f32 v38, v48, v49
  v_cvt_pk_bf16_f32 v39, v50, v51
  v_lshlrev_b32 v44, 16, v36
  v_and_b32 v45, 0xffff0000, v36
  v_lshlrev_b32 v46, 16, v37
  v_and_b32 v47, 0xffff0000, v37
  v_lshlrev_b32 v48, 16, v38
  v_and_b32 v49, 0xffff0000, v38
  v_lshlrev_b32 v50, 16, v39
  v_and_b32 v51, 0xffff0000, v39
  v_mul_f32 v44, v44, v43
  v_mul_f32 v45, v45, v43
  v_mul_f32 v46, v46, v43
  v_mul_f32 v47, v47, v43
  v_mul_f32 v48, v48, v43
  v_mul_f32 v49, v49, v43
  v_mul_f32 v50, v50, v43
  v_mul_f32 v51, v51, v43
  v_cvt_pk_bf16_f32 v36, v44, v45
  v_cvt_pk_bf16_f32 v37, v46, v47
  v_cvt_pk_bf16_f32 v38, v48, v49
  v_cvt_pk_bf16_f32 v39, v50, v51
  s_cmp_lt_u32 s72, 2097152
  s_cbranch_scc0 ib_93
  buffer_store_dwordx4 v[36:39], v16, s[44:47], s72 offen sc1
  s_nop 1
ib_93:
  s_add_u32 s72, s72, 212992
  v_lshlrev_b32 v28, 16, v68
  v_and_b32 v29, 0xffff0000, v68
  v_lshlrev_b32 v30, 16, v69
  v_and_b32 v31, 0xffff0000, v69
  v_lshlrev_b32 v32, 16, v70
  v_and_b32 v33, 0xffff0000, v70
  v_lshlrev_b32 v34, 16, v71
  v_and_b32 v35, 0xffff0000, v71
  v_add_f32 v40, v28, v29
  v_add_f32 v40, v40, v30
  v_add_f32 v40, v40, v31
  v_add_f32 v40, v40, v32
  v_add_f32 v40, v40, v33
  v_add_f32 v40, v40, v34
  v_add_f32 v40, v40, v35
  s_nop 1
  v_add_f32_dpp v40, v40, v40 row_ror:8 row_mask:0xf bank_mask:0xf
  s_nop 1
  v_add_f32_dpp v40, v40, v40 row_ror:4 row_mask:0xf bank_mask:0xf
  s_nop 1
  v_add_f32_dpp v40, v40, v40 row_ror:2 row_mask:0xf bank_mask:0xf
  s_nop 1
  v_add_f32_dpp v40, v40, v40 row_ror:1 row_mask:0xf bank_mask:0xf
  v_mov_b32 v41, v40
  s_nop 1
  v_permlane16_swap_b32 v40, v41
  v_add_f32 v40, v40, v41
  v_mov_b32 v41, v40
  s_nop 1
  v_permlane32_swap_b32 v40, v41
  v_add_f32 v40, v40, v41
  v_mul_f32 v40, 0x3b000000, v40
  v_sub_f32 v44, v28, v40
  v_sub_f32 v45, v29, v40
  v_sub_f32 v46, v30, v40
  v_sub_f32 v47, v31, v40
  v_sub_f32 v48, v32, v40
  v_sub_f32 v49, v33, v40
  v_sub_f32 v50, v34, v40
  v_sub_f32 v51, v35, v40
  v_mul_f32 v43, v44, v44
  v_fmac_f32 v43, v45, v45
  v_fmac_f32 v43, v46, v46
  v_fmac_f32 v43, v47, v47
  v_fmac_f32 v43, v48, v48
  v_fmac_f32 v43, v49, v49
  v_fmac_f32 v43, v50, v50
  v_fmac_f32 v43, v51, v51
  v_cvt_pk_bf16_f32 v42, v40, v40
  v_and_b32 v42, 0xffff0000, v42
  v_add_f32_dpp v43, v43, v43 row_ror:8 row_mask:0xf bank_mask:0xf
  s_nop 1
  v_add_f32_dpp v43, v43, v43 row_ror:4 row_mask:0xf bank_mask:0xf
  s_nop 1
  v_add_f32_dpp v43, v43, v43 row_ror:2 row_mask:0xf bank_mask:0xf
  s_nop 1
  v_add_f32_dpp v43, v43, v43 row_ror:1 row_mask:0xf bank_mask:0xf
  v_mov_b32 v41, v43
  s_nop 1
  v_permlane16_swap_b32 v43, v41
  v_add_f32 v43, v43, v41
  v_mov_b32 v41, v43
  s_nop 1
  v_permlane32_swap_b32 v43, v41
  v_add_f32 v43, v43, v41
  v_sub_f32 v44, v28, v42
  v_sub_f32 v45, v29, v42
  v_sub_f32 v46, v30, v42
  v_sub_f32 v47, v31, v42
  v_sub_f32 v48, v32, v42
  v_sub_f32 v49, v33, v42
  v_sub_f32 v50, v34, v42
  v_sub_f32 v51, v35, v42
  v_mul_f32 v43, 0x3b000000, v43
  v_cvt_pk_bf16_f32 v43, v43, v43
  v_and_b32 v43, 0xffff0000, v43
  v_add_f32 v43, 0x3727c5ac, v43
  v_cvt_pk_bf16_f32 v43, v43, v43
  v_and_b32 v43, 0xffff0000, v43
  v_sqrt_f32 v43, v43
  s_nop 0
  v_cvt_pk_bf16_f32 v43, v43, v43
  v_and_b32 v43, 0xffff0000, v43
  v_rcp_f32 v43, v43
  v_cvt_pk_bf16_f32 v36, v44, v45
  v_cvt_pk_bf16_f32 v37, v46, v47
  v_cvt_pk_bf16_f32 v38, v48, v49
  v_cvt_pk_bf16_f32 v39, v50, v51
  v_lshlrev_b32 v44, 16, v36
  v_and_b32 v45, 0xffff0000, v36
  v_lshlrev_b32 v46, 16, v37
  v_and_b32 v47, 0xffff0000, v37
  v_lshlrev_b32 v48, 16, v38
  v_and_b32 v49, 0xffff0000, v38
  v_lshlrev_b32 v50, 16, v39
  v_and_b32 v51, 0xffff0000, v39
  v_mul_f32 v44, v44, v43
  v_mul_f32 v45, v45, v43
  v_mul_f32 v46, v46, v43
  v_mul_f32 v47, v47, v43
  v_mul_f32 v48, v48, v43
  v_mul_f32 v49, v49, v43
  v_mul_f32 v50, v50, v43
  v_mul_f32 v51, v51, v43
  v_cvt_pk_bf16_f32 v36, v44, v45
  v_cvt_pk_bf16_f32 v37, v46, v47
  v_cvt_pk_bf16_f32 v38, v48, v49
  v_cvt_pk_bf16_f32 v39, v50, v51
  s_cmp_lt_u32 s72, 2097152
  s_cbranch_scc0 ib_94
  buffer_store_dwordx4 v[36:39], v16, s[44:47], s72 offen sc1
  s_nop 1
ib_94:
  s_add_u32 s72, s72, 212992
  v_lshlrev_b32 v28, 16, v72
  v_and_b32 v29, 0xffff0000, v72
  v_lshlrev_b32 v30, 16, v73
  v_and_b32 v31, 0xffff0000, v73
  v_lshlrev_b32 v32, 16, v74
  v_and_b32 v33, 0xffff0000, v74
  v_lshlrev_b32 v34, 16, v75
  v_and_b32 v35, 0xffff0000, v75
  v_add_f32 v40, v28, v29
  v_add_f32 v40, v40, v30
  v_add_f32 v40, v40, v31
  v_add_f32 v40, v40, v32
  v_add_f32 v40, v40, v33
  v_add_f32 v40, v40, v34
  v_add_f32 v40, v40, v35
  s_nop 1
  v_add_f32_dpp v40, v40, v40 row_ror:8 row_mask:0xf bank_mask:0xf
  s_nop 1
  v_add_f32_dpp v40, v40, v40 row_ror:4 row_mask:0xf bank_mask:0xf
  s_nop 1
  v_add_f32_dpp v40, v40, v40 row_ror:2 row_mask:0xf bank_mask:0xf
  s_nop 1
  v_add_f32_dpp v40, v40, v40 row_ror:1 row_mask:0xf bank_mask:0xf
  v_mov_b32 v41, v40
  s_nop 1
  v_permlane16_swap_b32 v40, v41
  v_add_f32 v40, v40, v41
  v_mov_b32 v41, v40
  s_nop 1
  v_permlane32_swap_b32 v40, v41
  v_add_f32 v40, v40, v41
  v_mul_f32 v40, 0x3b000000, v40
  v_sub_f32 v44, v28, v40
  v_sub_f32 v45, v29, v40
  v_sub_f32 v46, v30, v40
  v_sub_f32 v47, v31, v40
  v_sub_f32 v48, v32, v40
  v_sub_f32 v49, v33, v40
  v_sub_f32 v50, v34, v40
  v_sub_f32 v51, v35, v40
  v_mul_f32 v43, v44, v44
  v_fmac_f32 v43, v45, v45
  v_fmac_f32 v43, v46, v46
  v_fmac_f32 v43, v47, v47
  v_fmac_f32 v43, v48, v48
  v_fmac_f32 v43, v49, v49
  v_fmac_f32 v43, v50, v50
  v_fmac_f32 v43, v51, v51
  v_cvt_pk_bf16_f32 v42, v40, v40
  v_and_b32 v42, 0xffff0000, v42
  v_add_f32_dpp v43, v43, v43 row_ror:8 row_mask:0xf bank_mask:0xf
  s_nop 1
  v_add_f32_dpp v43, v43, v43 row_ror:4 row_mask:0xf bank_mask:0xf
  s_nop 1
  v_add_f32_dpp v43, v43, v43 row_ror:2 row_mask:0xf bank_mask:0xf
  s_nop 1
  v_add_f32_dpp v43, v43, v43 row_ror:1 row_mask:0xf bank_mask:0xf
  v_mov_b32 v41, v43
  s_nop 1
  v_permlane16_swap_b32 v43, v41
  v_add_f32 v43, v43, v41
  v_mov_b32 v41, v43
  s_nop 1
  v_permlane32_swap_b32 v43, v41
  v_add_f32 v43, v43, v41
  v_sub_f32 v44, v28, v42
  v_sub_f32 v45, v29, v42
  v_sub_f32 v46, v30, v42
  v_sub_f32 v47, v31, v42
  v_sub_f32 v48, v32, v42
  v_sub_f32 v49, v33, v42
  v_sub_f32 v50, v34, v42
  v_sub_f32 v51, v35, v42
  v_mul_f32 v43, 0x3b000000, v43
  v_cvt_pk_bf16_f32 v43, v43, v43
  v_and_b32 v43, 0xffff0000, v43
  v_add_f32 v43, 0x3727c5ac, v43
  v_cvt_pk_bf16_f32 v43, v43, v43
  v_and_b32 v43, 0xffff0000, v43
  v_sqrt_f32 v43, v43
  s_nop 0
  v_cvt_pk_bf16_f32 v43, v43, v43
  v_and_b32 v43, 0xffff0000, v43
  v_rcp_f32 v43, v43
  v_cvt_pk_bf16_f32 v36, v44, v45
  v_cvt_pk_bf16_f32 v37, v46, v47
  v_cvt_pk_bf16_f32 v38, v48, v49
  v_cvt_pk_bf16_f32 v39, v50, v51
  v_lshlrev_b32 v44, 16, v36
  v_and_b32 v45, 0xffff0000, v36
  v_lshlrev_b32 v46, 16, v37
  v_and_b32 v47, 0xffff0000, v37
  v_lshlrev_b32 v48, 16, v38
  v_and_b32 v49, 0xffff0000, v38
  v_lshlrev_b32 v50, 16, v39
  v_and_b32 v51, 0xffff0000, v39
  v_mul_f32 v44, v44, v43
  v_mul_f32 v45, v45, v43
  v_mul_f32 v46, v46, v43
  v_mul_f32 v47, v47, v43
  v_mul_f32 v48, v48, v43
  v_mul_f32 v49, v49, v43
  v_mul_f32 v50, v50, v43
  v_mul_f32 v51, v51, v43
  v_cvt_pk_bf16_f32 v36, v44, v45
  v_cvt_pk_bf16_f32 v37, v46, v47
  v_cvt_pk_bf16_f32 v38, v48, v49
  v_cvt_pk_bf16_f32 v39, v50, v51
  s_cmp_lt_u32 s72, 2097152
  s_cbranch_scc0 ib_95
  buffer_store_dwordx4 v[36:39], v16, s[44:47], s72 offen sc1
  s_nop 1
ib_95:
  s_add_u32 s72, s72, 212992
  v_lshlrev_b32 v28, 16, v76
  v_and_b32 v29, 0xffff0000, v76
  v_lshlrev_b32 v30, 16, v77
  v_and_b32 v31, 0xffff0000, v77
  v_lshlrev_b32 v32, 16, v78
  v_and_b32 v33, 0xffff0000, v78
  v_lshlrev_b32 v34, 16, v79
  v_and_b32 v35, 0xffff0000, v79
  v_add_f32 v40, v28, v29
  v_add_f32 v40, v40, v30
  v_add_f32 v40, v40, v31
  v_add_f32 v40, v40, v32
  v_add_f32 v40, v40, v33
  v_add_f32 v40, v40, v34
  v_add_f32 v40, v40, v35
  s_nop 1
  v_add_f32_dpp v40, v40, v40 row_ror:8 row_mask:0xf bank_mask:0xf
  s_nop 1
  v_add_f32_dpp v40, v40, v40 row_ror:4 row_mask:0xf bank_mask:0xf
  s_nop 1
  v_add_f32_dpp v40, v40, v40 row_ror:2 row_mask:0xf bank_mask:0xf
  s_nop 1
  v_add_f32_dpp v40, v40, v40 row_ror:1 row_mask:0xf bank_mask:0xf
  v_mov_b32 v41, v40
  s_nop 1
  v_permlane16_swap_b32 v40, v41
  v_add_f32 v40, v40, v41
  v_mov_b32 v41, v40
  s_nop 1
  v_permlane32_swap_b32 v40, v41
  v_add_f32 v40, v40, v41
  v_mul_f32 v40, 0x3b000000, v40
  v_sub_f32 v44, v28, v40
  v_sub_f32 v45, v29, v40
  v_sub_f32 v46, v30, v40
  v_sub_f32 v47, v31, v40
  v_sub_f32 v48, v32, v40
  v_sub_f32 v49, v33, v40
  v_sub_f32 v50, v34, v40
  v_sub_f32 v51, v35, v40
  v_mul_f32 v43, v44, v44
  v_fmac_f32 v43, v45, v45
  v_fmac_f32 v43, v46, v46
  v_fmac_f32 v43, v47, v47
  v_fmac_f32 v43, v48, v48
  v_fmac_f32 v43, v49, v49
  v_fmac_f32 v43, v50, v50
  v_fmac_f32 v43, v51, v51
  v_cvt_pk_bf16_f32 v42, v40, v40
  v_and_b32 v42, 0xffff0000, v42
  v_add_f32_dpp v43, v43, v43 row_ror:8 row_mask:0xf bank_mask:0xf
  s_nop 1
  v_add_f32_dpp v43, v43, v43 row_ror:4 row_mask:0xf bank_mask:0xf
  s_nop 1
  v_add_f32_dpp v43, v43, v43 row_ror:2 row_mask:0xf bank_mask:0xf
  s_nop 1
  v_add_f32_dpp v43, v43, v43 row_ror:1 row_mask:0xf bank_mask:0xf
  v_mov_b32 v41, v43
  s_nop 1
  v_permlane16_swap_b32 v43, v41
  v_add_f32 v43, v43, v41
  v_mov_b32 v41, v43
  s_nop 1
  v_permlane32_swap_b32 v43, v41
  v_add_f32 v43, v43, v41
  v_sub_f32 v44, v28, v42
  v_sub_f32 v45, v29, v42
  v_sub_f32 v46, v30, v42
  v_sub_f32 v47, v31, v42
  v_sub_f32 v48, v32, v42
  v_sub_f32 v49, v33, v42
  v_sub_f32 v50, v34, v42
  v_sub_f32 v51, v35, v42
  v_mul_f32 v43, 0x3b000000, v43
  v_cvt_pk_bf16_f32 v43, v43, v43
  v_and_b32 v43, 0xffff0000, v43
  v_add_f32 v43, 0x3727c5ac, v43
  v_cvt_pk_bf16_f32 v43, v43, v43
  v_and_b32 v43, 0xffff0000, v43
  v_sqrt_f32 v43, v43
  s_nop 0
  v_cvt_pk_bf16_f32 v43, v43, v43
  v_and_b32 v43, 0xffff0000, v43
  v_rcp_f32 v43, v43
  v_cvt_pk_bf16_f32 v36, v44, v45
  v_cvt_pk_bf16_f32 v37, v46, v47
  v_cvt_pk_bf16_f32 v38, v48, v49
  v_cvt_pk_bf16_f32 v39, v50, v51
  v_lshlrev_b32 v44, 16, v36
  v_and_b32 v45, 0xffff0000, v36
  v_lshlrev_b32 v46, 16, v37
  v_and_b32 v47, 0xffff0000, v37
  v_lshlrev_b32 v48, 16, v38
  v_and_b32 v49, 0xffff0000, v38
  v_lshlrev_b32 v50, 16, v39
  v_and_b32 v51, 0xffff0000, v39
  v_mul_f32 v44, v44, v43
  v_mul_f32 v45, v45, v43
  v_mul_f32 v46, v46, v43
  v_mul_f32 v47, v47, v43
  v_mul_f32 v48, v48, v43
  v_mul_f32 v49, v49, v43
  v_mul_f32 v50, v50, v43
  v_mul_f32 v51, v51, v43
  v_cvt_pk_bf16_f32 v36, v44, v45
  v_cvt_pk_bf16_f32 v37, v46, v47
  v_cvt_pk_bf16_f32 v38, v48, v49
  v_cvt_pk_bf16_f32 v39, v50, v51
  s_cmp_lt_u32 s72, 2097152
  s_cbranch_scc0 ib_96
  buffer_store_dwordx4 v[36:39], v16, s[44:47], s72 offen sc1
  s_nop 1
ib_96:
  s_add_u32 s72, s72, 212992
  v_lshlrev_b32 v28, 16, v80
  v_and_b32 v29, 0xffff0000, v80
  v_lshlrev_b32 v30, 16, v81
  v_and_b32 v31, 0xffff0000, v81
  v_lshlrev_b32 v32, 16, v82
  v_and_b32 v33, 0xffff0000, v82
  v_lshlrev_b32 v34, 16, v83
  v_and_b32 v35, 0xffff0000, v83
  v_add_f32 v40, v28, v29
  v_add_f32 v40, v40, v30
  v_add_f32 v40, v40, v31
  v_add_f32 v40, v40, v32
  v_add_f32 v40, v40, v33
  v_add_f32 v40, v40, v34
  v_add_f32 v40, v40, v35
  s_nop 1
  v_add_f32_dpp v40, v40, v40 row_ror:8 row_mask:0xf bank_mask:0xf
  s_nop 1
  v_add_f32_dpp v40, v40, v40 row_ror:4 row_mask:0xf bank_mask:0xf
  s_nop 1
  v_add_f32_dpp v40, v40, v40 row_ror:2 row_mask:0xf bank_mask:0xf
  s_nop 1
  v_add_f32_dpp v40, v40, v40 row_ror:1 row_mask:0xf bank_mask:0xf
  v_mov_b32 v41, v40
  s_nop 1
  v_permlane16_swap_b32 v40, v41
  v_add_f32 v40, v40, v41
  v_mov_b32 v41, v40
  s_nop 1
  v_permlane32_swap_b32 v40, v41
  v_add_f32 v40, v40, v41
  v_mul_f32 v40, 0x3b000000, v40
  v_sub_f32 v44, v28, v40
  v_sub_f32 v45, v29, v40
  v_sub_f32 v46, v30, v40
  v_sub_f32 v47, v31, v40
  v_sub_f32 v48, v32, v40
  v_sub_f32 v49, v33, v40
  v_sub_f32 v50, v34, v40
  v_sub_f32 v51, v35, v40
  v_mul_f32 v43, v44, v44
  v_fmac_f32 v43, v45, v45
  v_fmac_f32 v43, v46, v46
  v_fmac_f32 v43, v47, v47
  v_fmac_f32 v43, v48, v48
  v_fmac_f32 v43, v49, v49
  v_fmac_f32 v43, v50, v50
  v_fmac_f32 v43, v51, v51
  v_cvt_pk_bf16_f32 v42, v40, v40
  v_and_b32 v42, 0xffff0000, v42
  v_add_f32_dpp v43, v43, v43 row_ror:8 row_mask:0xf bank_mask:0xf
  s_nop 1
  v_add_f32_dpp v43, v43, v43 row_ror:4 row_mask:0xf bank_mask:0xf
  s_nop 1
  v_add_f32_dpp v43, v43, v43 row_ror:2 row_mask:0xf bank_mask:0xf
  s_nop 1
  v_add_f32_dpp v43, v43, v43 row_ror:1 row_mask:0xf bank_mask:0xf
  v_mov_b32 v41, v43
  s_nop 1
  v_permlane16_swap_b32 v43, v41
  v_add_f32 v43, v43, v41
  v_mov_b32 v41, v43
  s_nop 1
  v_permlane32_swap_b32 v43, v41
  v_add_f32 v43, v43, v41
  v_sub_f32 v44, v28, v42
  v_sub_f32 v45, v29, v42
  v_sub_f32 v46, v30, v42
  v_sub_f32 v47, v31, v42
  v_sub_f32 v48, v32, v42
  v_sub_f32 v49, v33, v42
  v_sub_f32 v50, v34, v42
  v_sub_f32 v51, v35, v42
  v_mul_f32 v43, 0x3b000000, v43
  v_cvt_pk_bf16_f32 v43, v43, v43
  v_and_b32 v43, 0xffff0000, v43
  v_add_f32 v43, 0x3727c5ac, v43
  v_cvt_pk_bf16_f32 v43, v43, v43
  v_and_b32 v43, 0xffff0000, v43
  v_sqrt_f32 v43, v43
  s_nop 0
  v_cvt_pk_bf16_f32 v43, v43, v43
  v_and_b32 v43, 0xffff0000, v43
  v_rcp_f32 v43, v43
  v_cvt_pk_bf16_f32 v36, v44, v45
  v_cvt_pk_bf16_f32 v37, v46, v47
  v_cvt_pk_bf16_f32 v38, v48, v49
  v_cvt_pk_bf16_f32 v39, v50, v51
  v_lshlrev_b32 v44, 16, v36
  v_and_b32 v45, 0xffff0000, v36
  v_lshlrev_b32 v46, 16, v37
  v_and_b32 v47, 0xffff0000, v37
  v_lshlrev_b32 v48, 16, v38
  v_and_b32 v49, 0xffff0000, v38
  v_lshlrev_b32 v50, 16, v39
  v_and_b32 v51, 0xffff0000, v39
  v_mul_f32 v44, v44, v43
  v_mul_f32 v45, v45, v43
  v_mul_f32 v46, v46, v43
  v_mul_f32 v47, v47, v43
  v_mul_f32 v48, v48, v43
  v_mul_f32 v49, v49, v43
  v_mul_f32 v50, v50, v43
  v_mul_f32 v51, v51, v43
  v_cvt_pk_bf16_f32 v36, v44, v45
  v_cvt_pk_bf16_f32 v37, v46, v47
  v_cvt_pk_bf16_f32 v38, v48, v49
  v_cvt_pk_bf16_f32 v39, v50, v51
  s_cmp_lt_u32 s72, 2097152
  s_cbranch_scc0 ib_97
  buffer_store_dwordx4 v[36:39], v16, s[44:47], s72 offen sc1
  s_nop 1
ib_97:
  s_add_u32 s72, s72, 212992
  v_lshlrev_b32 v28, 16, v84
  v_and_b32 v29, 0xffff0000, v84
  v_lshlrev_b32 v30, 16, v85
  v_and_b32 v31, 0xffff0000, v85
  v_lshlrev_b32 v32, 16, v86
  v_and_b32 v33, 0xffff0000, v86
  v_lshlrev_b32 v34, 16, v87
  v_and_b32 v35, 0xffff0000, v87
  v_add_f32 v40, v28, v29
  v_add_f32 v40, v40, v30
  v_add_f32 v40, v40, v31
  v_add_f32 v40, v40, v32
  v_add_f32 v40, v40, v33
  v_add_f32 v40, v40, v34
  v_add_f32 v40, v40, v35
  s_nop 1
  v_add_f32_dpp v40, v40, v40 row_ror:8 row_mask:0xf bank_mask:0xf
  s_nop 1
  v_add_f32_dpp v40, v40, v40 row_ror:4 row_mask:0xf bank_mask:0xf
  s_nop 1
  v_add_f32_dpp v40, v40, v40 row_ror:2 row_mask:0xf bank_mask:0xf
  s_nop 1
  v_add_f32_dpp v40, v40, v40 row_ror:1 row_mask:0xf bank_mask:0xf
  v_mov_b32 v41, v40
  s_nop 1
  v_permlane16_swap_b32 v40, v41
  v_add_f32 v40, v40, v41
  v_mov_b32 v41, v40
  s_nop 1
  v_permlane32_swap_b32 v40, v41
  v_add_f32 v40, v40, v41
  v_mul_f32 v40, 0x3b000000, v40
  v_sub_f32 v44, v28, v40
  v_sub_f32 v45, v29, v40
  v_sub_f32 v46, v30, v40
  v_sub_f32 v47, v31, v40
  v_sub_f32 v48, v32, v40
  v_sub_f32 v49, v33, v40
  v_sub_f32 v50, v34, v40
  v_sub_f32 v51, v35, v40
  v_mul_f32 v43, v44, v44
  v_fmac_f32 v43, v45, v45
  v_fmac_f32 v43, v46, v46
  v_fmac_f32 v43, v47, v47
  v_fmac_f32 v43, v48, v48
  v_fmac_f32 v43, v49, v49
  v_fmac_f32 v43, v50, v50
  v_fmac_f32 v43, v51, v51
  v_cvt_pk_bf16_f32 v42, v40, v40
  v_and_b32 v42, 0xffff0000, v42
  v_add_f32_dpp v43, v43, v43 row_ror:8 row_mask:0xf bank_mask:0xf
  s_nop 1
  v_add_f32_dpp v43, v43, v43 row_ror:4 row_mask:0xf bank_mask:0xf
  s_nop 1
  v_add_f32_dpp v43, v43, v43 row_ror:2 row_mask:0xf bank_mask:0xf
  s_nop 1
  v_add_f32_dpp v43, v43, v43 row_ror:1 row_mask:0xf bank_mask:0xf
  v_mov_b32 v41, v43
  s_nop 1
  v_permlane16_swap_b32 v43, v41
  v_add_f32 v43, v43, v41
  v_mov_b32 v41, v43
  s_nop 1
  v_permlane32_swap_b32 v43, v41
  v_add_f32 v43, v43, v41
  v_sub_f32 v44, v28, v42
  v_sub_f32 v45, v29, v42
  v_sub_f32 v46, v30, v42
  v_sub_f32 v47, v31, v42
  v_sub_f32 v48, v32, v42
  v_sub_f32 v49, v33, v42
  v_sub_f32 v50, v34, v42
  v_sub_f32 v51, v35, v42
  v_mul_f32 v43, 0x3b000000, v43
  v_cvt_pk_bf16_f32 v43, v43, v43
  v_and_b32 v43, 0xffff0000, v43
  v_add_f32 v43, 0x3727c5ac, v43
  v_cvt_pk_bf16_f32 v43, v43, v43
  v_and_b32 v43, 0xffff0000, v43
  v_sqrt_f32 v43, v43
  s_nop 0
  v_cvt_pk_bf16_f32 v43, v43, v43
  v_and_b32 v43, 0xffff0000, v43
  v_rcp_f32 v43, v43
  v_cvt_pk_bf16_f32 v36, v44, v45
  v_cvt_pk_bf16_f32 v37, v46, v47
  v_cvt_pk_bf16_f32 v38, v48, v49
  v_cvt_pk_bf16_f32 v39, v50, v51
  v_lshlrev_b32 v44, 16, v36
  v_and_b32 v45, 0xffff0000, v36
  v_lshlrev_b32 v46, 16, v37
  v_and_b32 v47, 0xffff0000, v37
  v_lshlrev_b32 v48, 16, v38
  v_and_b32 v49, 0xffff0000, v38
  v_lshlrev_b32 v50, 16, v39
  v_and_b32 v51, 0xffff0000, v39
  v_mul_f32 v44, v44, v43
  v_mul_f32 v45, v45, v43
  v_mul_f32 v46, v46, v43
  v_mul_f32 v47, v47, v43
  v_mul_f32 v48, v48, v43
  v_mul_f32 v49, v49, v43
  v_mul_f32 v50, v50, v43
  v_mul_f32 v51, v51, v43
  v_cvt_pk_bf16_f32 v36, v44, v45
  v_cvt_pk_bf16_f32 v37, v46, v47
  v_cvt_pk_bf16_f32 v38, v48, v49
  v_cvt_pk_bf16_f32 v39, v50, v51
  s_cmp_lt_u32 s72, 2097152
  s_cbranch_scc0 ib_98
  buffer_store_dwordx4 v[36:39], v16, s[44:47], s72 offen sc1
  s_nop 1
ib_98:
  s_add_u32 s72, s72, 212992
  v_lshlrev_b32 v28, 16, v88
  v_and_b32 v29, 0xffff0000, v88
  v_lshlrev_b32 v30, 16, v89
  v_and_b32 v31, 0xffff0000, v89
  v_lshlrev_b32 v32, 16, v90
  v_and_b32 v33, 0xffff0000, v90
  v_lshlrev_b32 v34, 16, v91
  v_and_b32 v35, 0xffff0000, v91
  v_add_f32 v40, v28, v29
  v_add_f32 v40, v40, v30
  v_add_f32 v40, v40, v31
  v_add_f32 v40, v40, v32
  v_add_f32 v40, v40, v33
  v_add_f32 v40, v40, v34
  v_add_f32 v40, v40, v35
  s_nop 1
  v_add_f32_dpp v40, v40, v40 row_ror:8 row_mask:0xf bank_mask:0xf
  s_nop 1
  v_add_f32_dpp v40, v40, v40 row_ror:4 row_mask:0xf bank_mask:0xf
  s_nop 1
  v_add_f32_dpp v40, v40, v40 row_ror:2 row_mask:0xf bank_mask:0xf
  s_nop 1
  v_add_f32_dpp v40, v40, v40 row_ror:1 row_mask:0xf bank_mask:0xf
  v_mov_b32 v41, v40
  s_nop 1
  v_permlane16_swap_b32 v40, v41
  v_add_f32 v40, v40, v41
  v_mov_b32 v41, v40
  s_nop 1
  v_permlane32_swap_b32 v40, v41
  v_add_f32 v40, v40, v41
  v_mul_f32 v40, 0x3b000000, v40
  v_sub_f32 v44, v28, v40
  v_sub_f32 v45, v29, v40
  v_sub_f32 v46, v30, v40
  v_sub_f32 v47, v31, v40
  v_sub_f32 v48, v32, v40
  v_sub_f32 v49, v33, v40
  v_sub_f32 v50, v34, v40
  v_sub_f32 v51, v35, v40
  v_mul_f32 v43, v44, v44
  v_fmac_f32 v43, v45, v45
  v_fmac_f32 v43, v46, v46
  v_fmac_f32 v43, v47, v47
  v_fmac_f32 v43, v48, v48
  v_fmac_f32 v43, v49, v49
  v_fmac_f32 v43, v50, v50
  v_fmac_f32 v43, v51, v51
  v_cvt_pk_bf16_f32 v42, v40, v40
  v_and_b32 v42, 0xffff0000, v42
  v_add_f32_dpp v43, v43, v43 row_ror:8 row_mask:0xf bank_mask:0xf
  s_nop 1
  v_add_f32_dpp v43, v43, v43 row_ror:4 row_mask:0xf bank_mask:0xf
  s_nop 1
  v_add_f32_dpp v43, v43, v43 row_ror:2 row_mask:0xf bank_mask:0xf
  s_nop 1
  v_add_f32_dpp v43, v43, v43 row_ror:1 row_mask:0xf bank_mask:0xf
  v_mov_b32 v41, v43
  s_nop 1
  v_permlane16_swap_b32 v43, v41
  v_add_f32 v43, v43, v41
  v_mov_b32 v41, v43
  s_nop 1
  v_permlane32_swap_b32 v43, v41
  v_add_f32 v43, v43, v41
  v_sub_f32 v44, v28, v42
  v_sub_f32 v45, v29, v42
  v_sub_f32 v46, v30, v42
  v_sub_f32 v47, v31, v42
  v_sub_f32 v48, v32, v42
  v_sub_f32 v49, v33, v42
  v_sub_f32 v50, v34, v42
  v_sub_f32 v51, v35, v42
  v_mul_f32 v43, 0x3b000000, v43
  v_cvt_pk_bf16_f32 v43, v43, v43
  v_and_b32 v43, 0xffff0000, v43
  v_add_f32 v43, 0x3727c5ac, v43
  v_cvt_pk_bf16_f32 v43, v43, v43
  v_and_b32 v43, 0xffff0000, v43
  v_sqrt_f32 v43, v43
  s_nop 0
  v_cvt_pk_bf16_f32 v43, v43, v43
  v_and_b32 v43, 0xffff0000, v43
  v_rcp_f32 v43, v43
  v_cvt_pk_bf16_f32 v36, v44, v45
  v_cvt_pk_bf16_f32 v37, v46, v47
  v_cvt_pk_bf16_f32 v38, v48, v49
  v_cvt_pk_bf16_f32 v39, v50, v51
  v_lshlrev_b32 v44, 16, v36
  v_and_b32 v45, 0xffff0000, v36
  v_lshlrev_b32 v46, 16, v37
  v_and_b32 v47, 0xffff0000, v37
  v_lshlrev_b32 v48, 16, v38
  v_and_b32 v49, 0xffff0000, v38
  v_lshlrev_b32 v50, 16, v39
  v_and_b32 v51, 0xffff0000, v39
  v_mul_f32 v44, v44, v43
  v_mul_f32 v45, v45, v43
  v_mul_f32 v46, v46, v43
  v_mul_f32 v47, v47, v43
  v_mul_f32 v48, v48, v43
  v_mul_f32 v49, v49, v43
  v_mul_f32 v50, v50, v43
  v_mul_f32 v51, v51, v43
  v_cvt_pk_bf16_f32 v36, v44, v45
  v_cvt_pk_bf16_f32 v37, v46, v47
  v_cvt_pk_bf16_f32 v38, v48, v49
  v_cvt_pk_bf16_f32 v39, v50, v51
  s_cmp_lt_u32 s72, 2097152
  s_cbranch_scc0 ib_99
  buffer_store_dwordx4 v[36:39], v16, s[44:47], s72 offen sc1
  s_nop 1
ib_99:
  s_add_u32 s72, s72, 212992
  v_lshlrev_b32 v28, 16, v92
  v_and_b32 v29, 0xffff0000, v92
  v_lshlrev_b32 v30, 16, v93
  v_and_b32 v31, 0xffff0000, v93
  v_lshlrev_b32 v32, 16, v94
  v_and_b32 v33, 0xffff0000, v94
  v_lshlrev_b32 v34, 16, v95
  v_and_b32 v35, 0xffff0000, v95
  v_add_f32 v40, v28, v29
  v_add_f32 v40, v40, v30
  v_add_f32 v40, v40, v31
  v_add_f32 v40, v40, v32
  v_add_f32 v40, v40, v33
  v_add_f32 v40, v40, v34
  v_add_f32 v40, v40, v35
  s_nop 1
  v_add_f32_dpp v40, v40, v40 row_ror:8 row_mask:0xf bank_mask:0xf
  s_nop 1
  v_add_f32_dpp v40, v40, v40 row_ror:4 row_mask:0xf bank_mask:0xf
  s_nop 1
  v_add_f32_dpp v40, v40, v40 row_ror:2 row_mask:0xf bank_mask:0xf
  s_nop 1
  v_add_f32_dpp v40, v40, v40 row_ror:1 row_mask:0xf bank_mask:0xf
  v_mov_b32 v41, v40
  s_nop 1
  v_permlane16_swap_b32 v40, v41
  v_add_f32 v40, v40, v41
  v_mov_b32 v41, v40
  s_nop 1
  v_permlane32_swap_b32 v40, v41
  v_add_f32 v40, v40, v41
  v_mul_f32 v40, 0x3b000000, v40
  v_sub_f32 v44, v28, v40
  v_sub_f32 v45, v29, v40
  v_sub_f32 v46, v30, v40
  v_sub_f32 v47, v31, v40
  v_sub_f32 v48, v32, v40
  v_sub_f32 v49, v33, v40
  v_sub_f32 v50, v34, v40
  v_sub_f32 v51, v35, v40
  v_mul_f32 v43, v44, v44
  v_fmac_f32 v43, v45, v45
  v_fmac_f32 v43, v46, v46
  v_fmac_f32 v43, v47, v47
  v_fmac_f32 v43, v48, v48
  v_fmac_f32 v43, v49, v49
  v_fmac_f32 v43, v50, v50
  v_fmac_f32 v43, v51, v51
  v_cvt_pk_bf16_f32 v42, v40, v40
  v_and_b32 v42, 0xffff0000, v42
  v_add_f32_dpp v43, v43, v43 row_ror:8 row_mask:0xf bank_mask:0xf
  s_nop 1
  v_add_f32_dpp v43, v43, v43 row_ror:4 row_mask:0xf bank_mask:0xf
  s_nop 1
  v_add_f32_dpp v43, v43, v43 row_ror:2 row_mask:0xf bank_mask:0xf
  s_nop 1
  v_add_f32_dpp v43, v43, v43 row_ror:1 row_mask:0xf bank_mask:0xf
  v_mov_b32 v41, v43
  s_nop 1
  v_permlane16_swap_b32 v43, v41
  v_add_f32 v43, v43, v41
  v_mov_b32 v41, v43
  s_nop 1
  v_permlane32_swap_b32 v43, v41
  v_add_f32 v43, v43, v41
  v_sub_f32 v44, v28, v42
  v_sub_f32 v45, v29, v42
  v_sub_f32 v46, v30, v42
  v_sub_f32 v47, v31, v42
  v_sub_f32 v48, v32, v42
  v_sub_f32 v49, v33, v42
  v_sub_f32 v50, v34, v42
  v_sub_f32 v51, v35, v42
  v_mul_f32 v43, 0x3b000000, v43
  v_cvt_pk_bf16_f32 v43, v43, v43
  v_and_b32 v43, 0xffff0000, v43
  v_add_f32 v43, 0x3727c5ac, v43
  v_cvt_pk_bf16_f32 v43, v43, v43
  v_and_b32 v43, 0xffff0000, v43
  v_sqrt_f32 v43, v43
  s_nop 0
  v_cvt_pk_bf16_f32 v43, v43, v43
  v_and_b32 v43, 0xffff0000, v43
  v_rcp_f32 v43, v43
  v_cvt_pk_bf16_f32 v36, v44, v45
  v_cvt_pk_bf16_f32 v37, v46, v47
  v_cvt_pk_bf16_f32 v38, v48, v49
  v_cvt_pk_bf16_f32 v39, v50, v51
  v_lshlrev_b32 v44, 16, v36
  v_and_b32 v45, 0xffff0000, v36
  v_lshlrev_b32 v46, 16, v37
  v_and_b32 v47, 0xffff0000, v37
  v_lshlrev_b32 v48, 16, v38
  v_and_b32 v49, 0xffff0000, v38
  v_lshlrev_b32 v50, 16, v39
  v_and_b32 v51, 0xffff0000, v39
  v_mul_f32 v44, v44, v43
  v_mul_f32 v45, v45, v43
  v_mul_f32 v46, v46, v43
  v_mul_f32 v47, v47, v43
  v_mul_f32 v48, v48, v43
  v_mul_f32 v49, v49, v43
  v_mul_f32 v50, v50, v43
  v_mul_f32 v51, v51, v43
  v_cvt_pk_bf16_f32 v36, v44, v45
  v_cvt_pk_bf16_f32 v37, v46, v47
  v_cvt_pk_bf16_f32 v38, v48, v49
  v_cvt_pk_bf16_f32 v39, v50, v51
  s_cmp_lt_u32 s72, 2097152
  s_cbranch_scc0 ib_100
  buffer_store_dwordx4 v[36:39], v16, s[44:47], s72 offen sc1
  s_nop 1
ib_100:
  s_add_u32 s72, s72, 212992
  v_lshlrev_b32 v28, 16, v96
  v_and_b32 v29, 0xffff0000, v96
  v_lshlrev_b32 v30, 16, v97
  v_and_b32 v31, 0xffff0000, v97
  v_lshlrev_b32 v32, 16, v98
  v_and_b32 v33, 0xffff0000, v98
  v_lshlrev_b32 v34, 16, v99
  v_and_b32 v35, 0xffff0000, v99
  v_add_f32 v40, v28, v29
  v_add_f32 v40, v40, v30
  v_add_f32 v40, v40, v31
  v_add_f32 v40, v40, v32
  v_add_f32 v40, v40, v33
  v_add_f32 v40, v40, v34
  v_add_f32 v40, v40, v35
  s_nop 1
  v_add_f32_dpp v40, v40, v40 row_ror:8 row_mask:0xf bank_mask:0xf
  s_nop 1
  v_add_f32_dpp v40, v40, v40 row_ror:4 row_mask:0xf bank_mask:0xf
  s_nop 1
  v_add_f32_dpp v40, v40, v40 row_ror:2 row_mask:0xf bank_mask:0xf
  s_nop 1
  v_add_f32_dpp v40, v40, v40 row_ror:1 row_mask:0xf bank_mask:0xf
  v_mov_b32 v41, v40
  s_nop 1
  v_permlane16_swap_b32 v40, v41
  v_add_f32 v40, v40, v41
  v_mov_b32 v41, v40
  s_nop 1
  v_permlane32_swap_b32 v40, v41
  v_add_f32 v40, v40, v41
  v_mul_f32 v40, 0x3b000000, v40
  v_sub_f32 v44, v28, v40
  v_sub_f32 v45, v29, v40
  v_sub_f32 v46, v30, v40
  v_sub_f32 v47, v31, v40
  v_sub_f32 v48, v32, v40
  v_sub_f32 v49, v33, v40
  v_sub_f32 v50, v34, v40
  v_sub_f32 v51, v35, v40
  v_mul_f32 v43, v44, v44
  v_fmac_f32 v43, v45, v45
  v_fmac_f32 v43, v46, v46
  v_fmac_f32 v43, v47, v47
  v_fmac_f32 v43, v48, v48
  v_fmac_f32 v43, v49, v49
  v_fmac_f32 v43, v50, v50
  v_fmac_f32 v43, v51, v51
  v_cvt_pk_bf16_f32 v42, v40, v40
  v_and_b32 v42, 0xffff0000, v42
  v_add_f32_dpp v43, v43, v43 row_ror:8 row_mask:0xf bank_mask:0xf
  s_nop 1
  v_add_f32_dpp v43, v43, v43 row_ror:4 row_mask:0xf bank_mask:0xf
  s_nop 1
  v_add_f32_dpp v43, v43, v43 row_ror:2 row_mask:0xf bank_mask:0xf
  s_nop 1
  v_add_f32_dpp v43, v43, v43 row_ror:1 row_mask:0xf bank_mask:0xf
  v_mov_b32 v41, v43
  s_nop 1
  v_permlane16_swap_b32 v43, v41
  v_add_f32 v43, v43, v41
  v_mov_b32 v41, v43
  s_nop 1
  v_permlane32_swap_b32 v43, v41
  v_add_f32 v43, v43, v41
  v_sub_f32 v44, v28, v42
  v_sub_f32 v45, v29, v42
  v_sub_f32 v46, v30, v42
  v_sub_f32 v47, v31, v42
  v_sub_f32 v48, v32, v42
  v_sub_f32 v49, v33, v42
  v_sub_f32 v50, v34, v42
  v_sub_f32 v51, v35, v42
  v_mul_f32 v43, 0x3b000000, v43
  v_cvt_pk_bf16_f32 v43, v43, v43
  v_and_b32 v43, 0xffff0000, v43
  v_add_f32 v43, 0x3727c5ac, v43
  v_cvt_pk_bf16_f32 v43, v43, v43
  v_and_b32 v43, 0xffff0000, v43
  v_sqrt_f32 v43, v43
  s_nop 0
  v_cvt_pk_bf16_f32 v43, v43, v43
  v_and_b32 v43, 0xffff0000, v43
  v_rcp_f32 v43, v43
  v_cvt_pk_bf16_f32 v36, v44, v45
  v_cvt_pk_bf16_f32 v37, v46, v47
  v_cvt_pk_bf16_f32 v38, v48, v49
  v_cvt_pk_bf16_f32 v39, v50, v51
  v_lshlrev_b32 v44, 16, v36
  v_and_b32 v45, 0xffff0000, v36
  v_lshlrev_b32 v46, 16, v37
  v_and_b32 v47, 0xffff0000, v37
  v_lshlrev_b32 v48, 16, v38
  v_and_b32 v49, 0xffff0000, v38
  v_lshlrev_b32 v50, 16, v39
  v_and_b32 v51, 0xffff0000, v39
  v_mul_f32 v44, v44, v43
  v_mul_f32 v45, v45, v43
  v_mul_f32 v46, v46, v43
  v_mul_f32 v47, v47, v43
  v_mul_f32 v48, v48, v43
  v_mul_f32 v49, v49, v43
  v_mul_f32 v50, v50, v43
  v_mul_f32 v51, v51, v43
  v_cvt_pk_bf16_f32 v36, v44, v45
  v_cvt_pk_bf16_f32 v37, v46, v47
  v_cvt_pk_bf16_f32 v38, v48, v49
  v_cvt_pk_bf16_f32 v39, v50, v51
  s_cmp_lt_u32 s72, 2097152
  s_cbranch_scc0 ib_101
  buffer_store_dwordx4 v[36:39], v16, s[44:47], s72 offen sc1
  s_nop 1
ib_101:
  s_add_u32 s72, s72, 212992
  v_lshlrev_b32 v28, 16, v100
  v_and_b32 v29, 0xffff0000, v100
  v_lshlrev_b32 v30, 16, v101
  v_and_b32 v31, 0xffff0000, v101
  v_lshlrev_b32 v32, 16, v102
  v_and_b32 v33, 0xffff0000, v102
  v_lshlrev_b32 v34, 16, v103
  v_and_b32 v35, 0xffff0000, v103
  v_add_f32 v40, v28, v29
  v_add_f32 v40, v40, v30
  v_add_f32 v40, v40, v31
  v_add_f32 v40, v40, v32
  v_add_f32 v40, v40, v33
  v_add_f32 v40, v40, v34
  v_add_f32 v40, v40, v35
  s_nop 1
  v_add_f32_dpp v40, v40, v40 row_ror:8 row_mask:0xf bank_mask:0xf
  s_nop 1
  v_add_f32_dpp v40, v40, v40 row_ror:4 row_mask:0xf bank_mask:0xf
  s_nop 1
  v_add_f32_dpp v40, v40, v40 row_ror:2 row_mask:0xf bank_mask:0xf
  s_nop 1
  v_add_f32_dpp v40, v40, v40 row_ror:1 row_mask:0xf bank_mask:0xf
  v_mov_b32 v41, v40
  s_nop 1
  v_permlane16_swap_b32 v40, v41
  v_add_f32 v40, v40, v41
  v_mov_b32 v41, v40
  s_nop 1
  v_permlane32_swap_b32 v40, v41
  v_add_f32 v40, v40, v41
  v_mul_f32 v40, 0x3b000000, v40
  v_sub_f32 v44, v28, v40
  v_sub_f32 v45, v29, v40
  v_sub_f32 v46, v30, v40
  v_sub_f32 v47, v31, v40
  v_sub_f32 v48, v32, v40
  v_sub_f32 v49, v33, v40
  v_sub_f32 v50, v34, v40
  v_sub_f32 v51, v35, v40
  v_mul_f32 v43, v44, v44
  v_fmac_f32 v43, v45, v45
  v_fmac_f32 v43, v46, v46
  v_fmac_f32 v43, v47, v47
  v_fmac_f32 v43, v48, v48
  v_fmac_f32 v43, v49, v49
  v_fmac_f32 v43, v50, v50
  v_fmac_f32 v43, v51, v51
  v_cvt_pk_bf16_f32 v42, v40, v40
  v_and_b32 v42, 0xffff0000, v42
  v_add_f32_dpp v43, v43, v43 row_ror:8 row_mask:0xf bank_mask:0xf
  s_nop 1
  v_add_f32_dpp v43, v43, v43 row_ror:4 row_mask:0xf bank_mask:0xf
  s_nop 1
  v_add_f32_dpp v43, v43, v43 row_ror:2 row_mask:0xf bank_mask:0xf
  s_nop 1
  v_add_f32_dpp v43, v43, v43 row_ror:1 row_mask:0xf bank_mask:0xf
  v_mov_b32 v41, v43
  s_nop 1
  v_permlane16_swap_b32 v43, v41
  v_add_f32 v43, v43, v41
  v_mov_b32 v41, v43
  s_nop 1
  v_permlane32_swap_b32 v43, v41
  v_add_f32 v43, v43, v41
  v_sub_f32 v44, v28, v42
  v_sub_f32 v45, v29, v42
  v_sub_f32 v46, v30, v42
  v_sub_f32 v47, v31, v42
  v_sub_f32 v48, v32, v42
  v_sub_f32 v49, v33, v42
  v_sub_f32 v50, v34, v42
  v_sub_f32 v51, v35, v42
  v_mul_f32 v43, 0x3b000000, v43
  v_cvt_pk_bf16_f32 v43, v43, v43
  v_and_b32 v43, 0xffff0000, v43
  v_add_f32 v43, 0x3727c5ac, v43
  v_cvt_pk_bf16_f32 v43, v43, v43
  v_and_b32 v43, 0xffff0000, v43
  v_sqrt_f32 v43, v43
  s_nop 0
  v_cvt_pk_bf16_f32 v43, v43, v43
  v_and_b32 v43, 0xffff0000, v43
  v_rcp_f32 v43, v43
  v_cvt_pk_bf16_f32 v36, v44, v45
  v_cvt_pk_bf16_f32 v37, v46, v47
  v_cvt_pk_bf16_f32 v38, v48, v49
  v_cvt_pk_bf16_f32 v39, v50, v51
  v_lshlrev_b32 v44, 16, v36
  v_and_b32 v45, 0xffff0000, v36
  v_lshlrev_b32 v46, 16, v37
  v_and_b32 v47, 0xffff0000, v37
  v_lshlrev_b32 v48, 16, v38
  v_and_b32 v49, 0xffff0000, v38
  v_lshlrev_b32 v50, 16, v39
  v_and_b32 v51, 0xffff0000, v39
  v_mul_f32 v44, v44, v43
  v_mul_f32 v45, v45, v43
  v_mul_f32 v46, v46, v43
  v_mul_f32 v47, v47, v43
  v_mul_f32 v48, v48, v43
  v_mul_f32 v49, v49, v43
  v_mul_f32 v50, v50, v43
  v_mul_f32 v51, v51, v43
  v_cvt_pk_bf16_f32 v36, v44, v45
  v_cvt_pk_bf16_f32 v37, v46, v47
  v_cvt_pk_bf16_f32 v38, v48, v49
  v_cvt_pk_bf16_f32 v39, v50, v51
  s_cmp_lt_u32 s72, 2097152
  s_cbranch_scc0 ib_102
  buffer_store_dwordx4 v[36:39], v16, s[44:47], s72 offen sc1
  s_nop 1
ib_102:
  s_add_u32 s72, s72, 212992
  s_mov_b32 s60, s40
  s_mov_b32 s61, s41
  s_mov_b32 s62, 256
  s_mov_b32 s63, 0x00020000
  s_waitcnt vmcnt(0)
  v_mov_b32 v24, 1
  s_mov_b64 exec, 1
  buffer_atomic_add v24, off, s[60:63], 0 offset:192 sc1
  s_mov_b64 exec, -1
  s_mov_b32 s60, s40
  s_mov_b32 s61, s41
  s_mov_b32 s62, 256
  s_mov_b32 s63, 0x00020000
iw_103:
  buffer_load_dword v24, off, s[60:63], 0 offset:192 sc1
  s_waitcnt vmcnt(0)
  v_readfirstlane_b32 s72, v24
  s_nop 0
  s_cmp_ge_u32 s72, 208
  s_nop 1
  s_cbranch_scc1 id_104
  s_sub_u32 s69, s69, 1
  s_cbranch_scc0 iw_103
  s_branch mega_exit
id_104:
fr_top:
  s_lshr_b32 s82, s80, 5
  s_add_u32 s93, s82, 1
  s_and_b32 s82, s82, 3
  s_mul_i32 s82, s82, 720896
  s_and_b32 s83, s80, 31
  s_lshl_b32 s83, s83, 10
  s_add_u32 s82, s82, s83
  s_lshl_b32 s87, s80, 10
pf_105:
  buffer_load_dwordx2 v[24:25], v15, s[44:47], 0 offen sc1
  s_waitcnt vmcnt(0)
  v_min_u32 v24, v24, v25
  v_cmp_gt_u32 vcc, s93, v24
  s_nop 0
  s_cbranch_vccz pd_106
  s_nop 2
pr_107:
  s_sub_u32 s69, s69, 1
  s_cbranch_scc0 pf_105
  s_branch mega_exit
pd_106:
  buffer_load_dwordx4 v[64:67], v13, s[44:47], s82 offen sc1
  s_add_u32 s82, s82, 32768
  buffer_load_dwordx4 v[68:71], v13, s[44:47], s82 offen sc1
  s_add_u32 s82, s82, 32768
  buffer_load_dwordx4 v[72:75], v13, s[44:47], s82 offen sc1
  s_add_u32 s82, s82, 32768
  buffer_load_dwordx4 v[76:79], v13, s[44:47], s82 offen sc1
  s_add_u32 s82, s82, 32768
  buffer_load_dwordx4 v[80:83], v13, s[44:47], s82 offen sc1
  s_add_u32 s82, s82, 32768
  buffer_load_dwordx4 v[84:87], v13, s[44:47], s82 offen sc1
  s_add_u32 s82, s82, 32768
  buffer_load_dwordx4 v[88:91], v13, s[44:47], s82 offen sc1
  s_add_u32 s82, s82, 32768
  buffer_load_dwordx4 v[92:95], v13, s[44:47], s82 offen sc1
  s_add_u32 s82, s82, 32768
  buffer_load_dwordx4 v[96:99], v13, s[44:47], s82 offen sc1
  s_add_u32 s82, s82, 32768
  buffer_load_dwordx4 v[100:103], v13, s[44:47], s82 offen sc1
  s_add_u32 s82, s82, 32768
  buffer_load_dwordx4 v[104:107], v13, s[44:47], s82 offen sc1
  s_add_u32 s82, s82, 32768
  buffer_load_dwordx4 v[108:111], v13, s[44:47], s82 offen sc1
  s_add_u32 s82, s82, 32768
  buffer_load_dwordx4 v[112:115], v13, s[44:47], s82 offen sc1
  s_add_u32 s82, s82, 32768
  buffer_load_dwordx4 v[116:119], v13, s[44:47], s82 offen sc1
  s_add_u32 s82, s82, 32768
  buffer_load_dwordx4 v[120:123], v13, s[44:47], s82 offen sc1
  s_add_u32 s82, s82, 32768
  buffer_load_dwordx4 v[124:127], v13, s[44:47], s82 offen sc1
  s_add_u32 s82, s82, 32768
  buffer_load_dwordx4 v[128:131], v13, s[44:47], s82 offen sc1
  s_add_u32 s82, s82, 32768
  buffer_load_dwordx4 v[132:135], v13, s[44:47], s82 offen sc1
  s_add_u32 s82, s82, 32768
  buffer_load_dwordx4 v[136:139], v13, s[44:47], s82 offen sc1
  s_add_u32 s82, s82, 32768
  buffer_load_dwordx4 v[140:143], v13, s[44:47], s82 offen sc1
  s_add_u32 s82, s82, 32768
  buffer_load_dwordx4 v[144:147], v13, s[44:47], s82 offen sc1
  s_add_u32 s82, s82, 32768
  buffer_load_dwordx4 v[148:151], v13, s[44:47], s82 offen sc1
  s_add_u32 s72, s87, s81
  s_add_u32 s72, s72, 6291456
  buffer_load_dwordx4 v[20:23], v16, s[44:47], s72 offen
  s_waitcnt vmcnt(22)
  v_dot2_f32_bf16 v28, v64, s94, 0
  v_dot2_f32_bf16 v29, v64, s95, 0
  v_dot2_f32_bf16 v30, v65, s94, 0
  v_dot2_f32_bf16 v31, v65, s95, 0
  v_dot2_f32_bf16 v32, v66, s94, 0
  v_dot2_f32_bf16 v33, v66, s95, 0
  v_dot2_f32_bf16 v34, v67, s94, 0
  v_dot2_f32_bf16 v35, v67, s95, 0
  s_waitcnt vmcnt(21)
  v_dot2_f32_bf16 v28, v68, s94, v28
  v_dot2_f32_bf16 v29, v68, s95, v29
  v_dot2_f32_bf16 v30, v69, s94, v30
  v_dot2_f32_bf16 v31, v69, s95, v31
  v_dot2_f32_bf16 v32, v70, s94, v32
  v_dot2_f32_bf16 v33, v70, s95, v33
  v_dot2_f32_bf16 v34, v71, s94, v34
  v_dot2_f32_bf16 v35, v71, s95, v35
  s_waitcnt vmcnt(20)
  v_dot2_f32_bf16 v28, v72, s94, v28
  v_dot2_f32_bf16 v29, v72, s95, v29
  v_dot2_f32_bf16 v30, v73, s94, v30
  v_dot2_f32_bf16 v31, v73, s95, v31
  v_dot2_f32_bf16 v32, v74, s94, v32
  v_dot2_f32_bf16 v33, v74, s95, v33
  v_dot2_f32_bf16 v34, v75, s94, v34
  v_dot2_f32_bf16 v35, v75, s95, v35
  s_waitcnt vmcnt(19)
  v_dot2_f32_bf16 v28, v76, s94, v28
  v_dot2_f32_bf16 v29, v76, s95, v29
  v_dot2_f32_bf16 v30, v77, s94, v30
  v_dot2_f32_bf16 v31, v77, s95, v31
  v_dot2_f32_bf16 v32, v78, s94, v32
  v_dot2_f32_bf16 v33, v78, s95, v33
  v_dot2_f32_bf16 v34, v79, s94, v34
  v_dot2_f32_bf16 v35, v79, s95, v35
  s_waitcnt vmcnt(18)
  v_dot2_f32_bf16 v28, v80, s94, v28
  v_dot2_f32_bf16 v29, v80, s95, v29
  v_dot2_f32_bf16 v30, v81, s94, v30
  v_dot2_f32_bf16 v31, v81, s95, v31
  v_dot2_f32_bf16 v32, v82, s94, v32
  v_dot2_f32_bf16 v33, v82, s95, v33
  v_dot2_f32_bf16 v34, v83, s94, v34
  v_dot2_f32_bf16 v35, v83, s95, v35
  s_waitcnt vmcnt(17)
  v_dot2_f32_bf16 v28, v84, s94, v28
  v_dot2_f32_bf16 v29, v84, s95, v29
  v_dot2_f32_bf16 v30, v85, s94, v30
  v_dot2_f32_bf16 v31, v85, s95, v31
  v_dot2_f32_bf16 v32, v86, s94, v32
  v_dot2_f32_bf16 v33, v86, s95, v33
  v_dot2_f32_bf16 v34, v87, s94, v34
  v_dot2_f32_bf16 v35, v87, s95, v35
  s_waitcnt vmcnt(16)
  v_dot2_f32_bf16 v28, v88, s94, v28
  v_dot2_f32_bf16 v29, v88, s95, v29
  v_dot2_f32_bf16 v30, v89, s94, v30
  v_dot2_f32_bf16 v31, v89, s95, v31
  v_dot2_f32_bf16 v32, v90, s94, v32
  v_dot2_f32_bf16 v33, v90, s95, v33
  v_dot2_f32_bf16 v34, v91, s94, v34
  v_dot2_f32_bf16 v35, v91, s95, v35
  s_waitcnt vmcnt(15)
  v_dot2_f32_bf16 v28, v92, s94, v28
  v_dot2_f32_bf16 v29, v92, s95, v29
  v_dot2_f32_bf16 v30, v93, s94, v30
  v_dot2_f32_bf16 v31, v93, s95, v31
  v_dot2_f32_bf16 v32, v94, s94, v32
  v_dot2_f32_bf16 v33, v94, s95, v33
  v_dot2_f32_bf16 v34, v95, s94, v34
  v_dot2_f32_bf16 v35, v95, s95, v35
  s_waitcnt vmcnt(14)
  v_dot2_f32_bf16 v28, v96, s94, v28
  v_dot2_f32_bf16 v29, v96, s95, v29
  v_dot2_f32_bf16 v30, v97, s94, v30
  v_dot2_f32_bf16 v31, v97, s95, v31
  v_dot2_f32_bf16 v32, v98, s94, v32
  v_dot2_f32_bf16 v33, v98, s95, v33
  v_dot2_f32_bf16 v34, v99, s94, v34
  v_dot2_f32_bf16 v35, v99, s95, v35
  s_waitcnt vmcnt(13)
  v_dot2_f32_bf16 v28, v100, s94, v28
  v_dot2_f32_bf16 v29, v100, s95, v29
  v_dot2_f32_bf16 v30, v101, s94, v30
  v_dot2_f32_bf16 v31, v101, s95, v31
  v_dot2_f32_bf16 v32, v102, s94, v32
  v_dot2_f32_bf16 v33, v102, s95, v33
  v_dot2_f32_bf16 v34, v103, s94, v34
  v_dot2_f32_bf16 v35, v103, s95, v35
  s_waitcnt vmcnt(12)
  v_dot2_f32_bf16 v28, v104, s94, v28
  v_dot2_f32_bf16 v29, v104, s95, v29
  v_dot2_f32_bf16 v30, v105, s94, v30
  v_dot2_f32_bf16 v31, v105, s95, v31
  v_dot2_f32_bf16 v32, v106, s94, v32
  v_dot2_f32_bf16 v33, v106, s95, v33
  v_dot2_f32_bf16 v34, v107, s94, v34
  v_dot2_f32_bf16 v35, v107, s95, v35
  s_waitcnt vmcnt(11)
  v_dot2_f32_bf16 v28, v108, s94, v28
  v_dot2_f32_bf16 v29, v108, s95, v29
  v_dot2_f32_bf16 v30, v109, s94, v30
  v_dot2_f32_bf16 v31, v109, s95, v31
  v_dot2_f32_bf16 v32, v110, s94, v32
  v_dot2_f32_bf16 v33, v110, s95, v33
  v_dot2_f32_bf16 v34, v111, s94, v34
  v_dot2_f32_bf16 v35, v111, s95, v35
  s_waitcnt vmcnt(10)
  v_dot2_f32_bf16 v28, v112, s94, v28
  v_dot2_f32_bf16 v29, v112, s95, v29
  v_dot2_f32_bf16 v30, v113, s94, v30
  v_dot2_f32_bf16 v31, v113, s95, v31
  v_dot2_f32_bf16 v32, v114, s94, v32
  v_dot2_f32_bf16 v33, v114, s95, v33
  v_dot2_f32_bf16 v34, v115, s94, v34
  v_dot2_f32_bf16 v35, v115, s95, v35
  s_waitcnt vmcnt(9)
  v_dot2_f32_bf16 v28, v116, s94, v28
  v_dot2_f32_bf16 v29, v116, s95, v29
  v_dot2_f32_bf16 v30, v117, s94, v30
  v_dot2_f32_bf16 v31, v117, s95, v31
  v_dot2_f32_bf16 v32, v118, s94, v32
  v_dot2_f32_bf16 v33, v118, s95, v33
  v_dot2_f32_bf16 v34, v119, s94, v34
  v_dot2_f32_bf16 v35, v119, s95, v35
  s_waitcnt vmcnt(8)
  v_dot2_f32_bf16 v28, v120, s94, v28
  v_dot2_f32_bf16 v29, v120, s95, v29
  v_dot2_f32_bf16 v30, v121, s94, v30
  v_dot2_f32_bf16 v31, v121, s95, v31
  v_dot2_f32_bf16 v32, v122, s94, v32
  v_dot2_f32_bf16 v33, v122, s95, v33
  v_dot2_f32_bf16 v34, v123, s94, v34
  v_dot2_f32_bf16 v35, v123, s95, v35
  s_waitcnt vmcnt(7)
  v_dot2_f32_bf16 v28, v124, s94, v28
  v_dot2_f32_bf16 v29, v124, s95, v29
  v_dot2_f32_bf16 v30, v125, s94, v30
  v_dot2_f32_bf16 v31, v125, s95, v31
  v_dot2_f32_bf16 v32, v126, s94, v32
  v_dot2_f32_bf16 v33, v126, s95, v33
  v_dot2_f32_bf16 v34, v127, s94, v34
  v_dot2_f32_bf16 v35, v127, s95, v35
  s_waitcnt vmcnt(6)
  v_dot2_f32_bf16 v28, v128, s94, v28
  v_dot2_f32_bf16 v29, v128, s95, v29
  v_dot2_f32_bf16 v30, v129, s94, v30
  v_dot2_f32_bf16 v31, v129, s95, v31
  v_dot2_f32_bf16 v32, v130, s94, v32
  v_dot2_f32_bf16 v33, v130, s95, v33
  v_dot2_f32_bf16 v34, v131, s94, v34
  v_dot2_f32_bf16 v35, v131, s95, v35
  s_waitcnt vmcnt(5)
  v_dot2_f32_bf16 v28, v132, s94, v28
  v_dot2_f32_bf16 v29, v132, s95, v29
  v_dot2_f32_bf16 v30, v133, s94, v30
  v_dot2_f32_bf16 v31, v133, s95, v31
  v_dot2_f32_bf16 v32, v134, s94, v32
  v_dot2_f32_bf16 v33, v134, s95, v33
  v_dot2_f32_bf16 v34, v135, s94, v34
  v_dot2_f32_bf16 v35, v135, s95, v35
  s_waitcnt vmcnt(4)
  v_dot2_f32_bf16 v28, v136, s94, v28
  v_dot2_f32_bf16 v29, v136, s95, v29
  v_dot2_f32_bf16 v30, v137, s94, v30
  v_dot2_f32_bf16 v31, v137, s95, v31
  v_dot2_f32_bf16 v32, v138, s94, v32
  v_dot2_f32_bf16 v33, v138, s95, v33
  v_dot2_f32_bf16 v34, v139, s94, v34
  v_dot2_f32_bf16 v35, v139, s95, v35
  s_waitcnt vmcnt(3)
  v_dot2_f32_bf16 v28, v140, s94, v28
  v_dot2_f32_bf16 v29, v140, s95, v29
  v_dot2_f32_bf16 v30, v141, s94, v30
  v_dot2_f32_bf16 v31, v141, s95, v31
  v_dot2_f32_bf16 v32, v142, s94, v32
  v_dot2_f32_bf16 v33, v142, s95, v33
  v_dot2_f32_bf16 v34, v143, s94, v34
  v_dot2_f32_bf16 v35, v143, s95, v35
  s_waitcnt vmcnt(2)
  v_dot2_f32_bf16 v28, v144, s94, v28
  v_dot2_f32_bf16 v29, v144, s95, v29
  v_dot2_f32_bf16 v30, v145, s94, v30
  v_dot2_f32_bf16 v31, v145, s95, v31
  v_dot2_f32_bf16 v32, v146, s94, v32
  v_dot2_f32_bf16 v33, v146, s95, v33
  v_dot2_f32_bf16 v34, v147, s94, v34
  v_dot2_f32_bf16 v35, v147, s95, v35
  s_waitcnt vmcnt(1)
  v_dot2_f32_bf16 v28, v148, s94, v28
  v_dot2_f32_bf16 v29, v148, s95, v29
  v_dot2_f32_bf16 v30, v149, s94, v30
  v_dot2_f32_bf16 v31, v149, s95, v31
  v_dot2_f32_bf16 v32, v150, s94, v32
  v_dot2_f32_bf16 v33, v150, s95, v33
  v_dot2_f32_bf16 v34, v151, s94, v34
  v_dot2_f32_bf16 v35, v151, s95, v35
  v_cvt_pk_bf16_f32 v24, v28, v29
  v_cvt_pk_bf16_f32 v25, v30, v31
  v_cvt_pk_bf16_f32 v26, v32, v33
  v_cvt_pk_bf16_f32 v27, v34, v35
  s_waitcnt vmcnt(0)
  v_lshlrev_b32 v28, 16, v24
  v_and_b32 v29, 0xffff0000, v24
  v_lshlrev_b32 v30, 16, v25
  v_and_b32 v31, 0xffff0000, v25
  v_lshlrev_b32 v32, 16, v26
  v_and_b32 v33, 0xffff0000, v26
  v_lshlrev_b32 v34, 16, v27
  v_and_b32 v35, 0xffff0000, v27
  v_lshlrev_b32 v36, 16, v20
  v_and_b32 v37, 0xffff0000, v20
  v_lshlrev_b32 v38, 16, v21
  v_and_b32 v39, 0xffff0000, v21
  v_lshlrev_b32 v40, 16, v22
  v_and_b32 v41, 0xffff0000, v22
  v_lshlrev_b32 v42, 16, v23
  v_and_b32 v43, 0xffff0000, v23
  v_add_f32 v28, v28, v36
  v_add_f32 v29, v29, v37
  v_add_f32 v30, v30, v38
  v_add_f32 v31, v31, v39
  v_add_f32 v32, v32, v40
  v_add_f32 v33, v33, v41
  v_add_f32 v34, v34, v42
  v_add_f32 v35, v35, v43
  v_cvt_pk_bf16_f32 v24, v28, v29
  v_cvt_pk_bf16_f32 v25, v30, v31
  v_cvt_pk_bf16_f32 v26, v32, v33
  v_cvt_pk_bf16_f32 v27, v34, v35
  s_cmp_eq_u32 s64, 0
  s_cbranch_scc1 fo_109
  buffer_store_dwordx4 v[24:27], v16, s[52:55], s87 offen
  s_nop 0
  s_branch re_108
fo_109:
  s_add_u32 s72, s87, 4194304
  s_add_u32 s73, s87, 2097152
  buffer_store_dwordx4 v[24:27], v16, s[44:47], s72 offen sc1
  v_lshlrev_b32 v28, 16, v24
  v_and_b32 v29, 0xffff0000, v24
  v_lshlrev_b32 v30, 16, v25
  v_and_b32 v31, 0xffff0000, v25
  v_lshlrev_b32 v32, 16, v26
  v_and_b32 v33, 0xffff0000, v26
  v_lshlrev_b32 v34, 16, v27
  v_and_b32 v35, 0xffff0000, v27
  v_add_f32 v40, v28, v29
  v_add_f32 v40, v40, v30
  v_add_f32 v40, v40, v31
  v_add_f32 v40, v40, v32
  v_add_f32 v40, v40, v33
  v_add_f32 v40, v40, v34
  v_add_f32 v40, v40, v35
  s_nop 1
  v_add_f32_dpp v40, v40, v40 row_ror:8 row_mask:0xf bank_mask:0xf
  s_nop 1
  v_add_f32_dpp v40, v40, v40 row_ror:4 row_mask:0xf bank_mask:0xf
  s_nop 1
  v_add_f32_dpp v40, v40, v40 row_ror:2 row_mask:0xf bank_mask:0xf
  s_nop 1
  v_add_f32_dpp v40, v40, v40 row_ror:1 row_mask:0xf bank_mask:0xf
  v_mov_b32 v41, v40
  s_nop 1
  v_permlane16_swap_b32 v40, v41
  v_add_f32 v40, v40, v41
  v_mov_b32 v41, v40
  s_nop 1
  v_permlane32_swap_b32 v40, v41
  v_add_f32 v40, v40, v41
  v_mul_f32 v40, 0x3b000000, v40
  v_sub_f32 v44, v28, v40
  v_sub_f32 v45, v29, v40
  v_sub_f32 v46, v30, v40
  v_sub_f32 v47, v31, v40
  v_sub_f32 v48, v32, v40
  v_sub_f32 v49, v33, v40
  v_sub_f32 v50, v34, v40
  v_sub_f32 v51, v35, v40
  v_mul_f32 v43, v44, v44
  v_fmac_f32 v43, v45, v45
  v_fmac_f32 v43, v46, v46
  v_fmac_f32 v43, v47, v47
  v_fmac_f32 v43, v48, v48
  v_fmac_f32 v43, v49, v49
  v_fmac_f32 v43, v50, v50
  v_fmac_f32 v43, v51, v51
  v_cvt_pk_bf16_f32 v42, v40, v40
  v_and_b32 v42, 0xffff0000, v42
  v_add_f32_dpp v43, v43, v43 row_ror:8 row_mask:0xf bank_mask:0xf
  s_nop 1
  v_add_f32_dpp v43, v43, v43 row_ror:4 row_mask:0xf bank_mask:0xf
  s_nop 1
  v_add_f32_dpp v43, v43, v43 row_ror:2 row_mask:0xf bank_mask:0xf
  s_nop 1
  v_add_f32_dpp v43, v43, v43 row_ror:1 row_mask:0xf bank_mask:0xf
  v_mov_b32 v41, v43
  s_nop 1
  v_permlane16_swap_b32 v43, v41
  v_add_f32 v43, v43, v41
  v_mov_b32 v41, v43
  s_nop 1
  v_permlane32_swap_b32 v43, v41
  v_add_f32 v43, v43, v41
  v_sub_f32 v44, v28, v42
  v_sub_f32 v45, v29, v42
  v_sub_f32 v46, v30, v42
  v_sub_f32 v47, v31, v42
  v_sub_f32 v48, v32, v42
  v_sub_f32 v49, v33, v42
  v_sub_f32 v50, v34, v42
  v_sub_f32 v51, v35, v42
  v_mul_f32 v43, 0x3b000000, v43
  v_cvt_pk_bf16_f32 v43, v43, v43
  v_and_b32 v43, 0xffff0000, v43
  v_add_f32 v43, 0x3727c5ac, v43
  v_cvt_pk_bf16_f32 v43, v43, v43
  v_and_b32 v43, 0xffff0000, v43
  v_sqrt_f32 v43, v43
  s_nop 0
  v_cvt_pk_bf16_f32 v43, v43, v43
  v_and_b32 v43, 0xffff0000, v43
  v_rcp_f32 v43, v43
  v_cvt_pk_bf16_f32 v36, v44, v45
  v_cvt_pk_bf16_f32 v37, v46, v47
  v_cvt_pk_bf16_f32 v38, v48, v49
  v_cvt_pk_bf16_f32 v39, v50, v51
  v_lshlrev_b32 v44, 16, v36
  v_and_b32 v45, 0xffff0000, v36
  v_lshlrev_b32 v46, 16, v37
  v_and_b32 v47, 0xffff0000, v37
  v_lshlrev_b32 v48, 16, v38
  v_and_b32 v49, 0xffff0000, v38
  v_lshlrev_b32 v50, 16, v39
  v_and_b32 v51, 0xffff0000, v39
  v_mul_f32 v44, v44, v43
  v_mul_f32 v45, v45, v43
  v_mul_f32 v46, v46, v43
  v_mul_f32 v47, v47, v43
  v_mul_f32 v48, v48, v43
  v_mul_f32 v49, v49, v43
  v_mul_f32 v50, v50, v43
  v_mul_f32 v51, v51, v43
  v_cvt_pk_bf16_f32 v36, v44, v45
  v_cvt_pk_bf16_f32 v37, v46, v47
  v_cvt_pk_bf16_f32 v38, v48, v49
  v_cvt_pk_bf16_f32 v39, v50, v51
  buffer_store_dwordx4 v[36:39], v16, s[44:47], s73 offen sc1
  s_nop 1
re_108:
  s_lshl_b32 s72, s80, 2
  v_mov_b32 v28, 1
  s_waitcnt vmcnt(0)
  buffer_store_dword v28, v14, s[44:47], s72 offen sc1
  s_add_u32 s80, s80, 40
  s_cmp_lt_u32 s80, 2048
  s_cbranch_scc1 fr_top
  s_branch mega_end
f_comp:
  s_mov_b32 s48, s32
  s_mov_b32 s49, s33
  s_mov_b32 s50, 1409024
  s_mov_b32 s51, 0x00020000
  s_mov_b32 s52, s34
  s_mov_b32 s53, s35
  s_mov_b32 s54, 1409024
  s_mov_b32 s55, 0x00020000
  s_mov_b32 s56, s36
  s_mov_b32 s57, s37
  s_mov_b32 s58, 1409024
  s_mov_b32 s59, 0x00020000
  s_lshr_b32 s77, s66, 1
  s_and_b32 s76, s66, 1
  s_lshl_b32 s72, s65, 1
  s_add_u32 s72, s72, s77
  s_lshl_b32 s73, s72, 6
  s_cmp_lt_u32 s72, 43
  s_cselect_b32 s73, s73, 0x40000000
  v_mul_u32_u24 v4, 22016, v3
  v_lshl_add_u32 v4, v2, 2, v4
  v_add_u32 v4, s73, v4
  s_lshl_b32 s72, s65, 16
  s_lshl_b32 s73, s66, 8
  s_add_u32 s72, s72, s73
  v_lshrrev_b32 v6, 5, v1
  v_lshlrev_b32 v5, 13, v6
  v_and_b32 v6, 31, v1
  v_lshl_add_u32 v5, v6, 3, v5
  s_cmp_lt_u32 s65, 21
  s_cselect_b32 s73, s72, 0x40000000
  v_add_u32 v6, s73, v5
  v_add_u32 v5, s72, v5
  s_mov_b32 s72, 0
  buffer_load_dword v24, v4, s[48:51], s72 offen
  s_mov_b32 s73, 2752
  buffer_load_dword v25, v4, s[48:51], s73 offen
  s_mov_b32 s72, 5504
  buffer_load_dword v26, v4, s[48:51], s72 offen
  s_mov_b32 s73, 8256
  buffer_load_dword v27, v4, s[48:51], s73 offen
  s_mov_b32 s72, 11008
  buffer_load_dword v28, v4, s[48:51], s72 offen
  s_mov_b32 s73, 13760
  buffer_load_dword v29, v4, s[48:51], s73 offen
  s_mov_b32 s72, 16512
  buffer_load_dword v30, v4, s[48:51], s72 offen
  s_mov_b32 s73, 19264
  buffer_load_dword v31, v4, s[48:51], s73 offen
  s_mov_b32 s72, 88064
  buffer_load_dword v32, v4, s[48:51], s72 offen
  s_mov_b32 s73, 90816
  buffer_load_dword v33, v4, s[48:51], s73 offen
  s_mov_b32 s72, 93568
  buffer_load_dword v34, v4, s[48:51], s72 offen
  s_mov_b32 s73, 96320
  buffer_load_dword v35, v4, s[48:51], s73 offen
  s_mov_b32 s72, 99072
  buffer_load_dword v36, v4, s[48:51], s72 offen
  s_mov_b32 s73, 101824
  buffer_load_dword v37, v4, s[48:51], s73 offen
  s_mov_b32 s72, 104576
  buffer_load_dword v38, v4, s[48:51], s72 offen
  s_mov_b32 s73, 107328
  buffer_load_dword v39, v4, s[48:51], s73 offen
  s_mov_b32 s72, 176128
  buffer_load_dword v40, v4, s[48:51], s72 offen
  s_mov_b32 s73, 178880
  buffer_load_dword v41, v4, s[48:51], s73 offen
  s_mov_b32 s72, 181632
  buffer_load_dword v42, v4, s[48:51], s72 offen
  s_mov_b32 s73, 184384
  buffer_load_dword v43, v4, s[48:51], s73 offen
  s_mov_b32 s72, 187136
  buffer_load_dword v44, v4, s[48:51], s72 offen
  s_mov_b32 s73, 189888
  buffer_load_dword v45, v4, s[48:51], s73 offen
  s_mov_b32 s72, 192640
  buffer_load_dword v46, v4, s[48:51], s72 offen
  s_mov_b32 s73, 195392
  buffer_load_dword v47, v4, s[48:51], s73 offen
  s_mov_b32 s72, 264192
  buffer_load_dword v48, v4, s[48:51], s72 offen
  s_mov_b32 s73, 266944
  buffer_load_dword v49, v4, s[48:51], s73 offen
  s_mov_b32 s72, 269696
  buffer_load_dword v50, v4, s[48:51], s72 offen
  s_mov_b32 s73, 272448
  buffer_load_dword v51, v4, s[48:51], s73 offen
  s_mov_b32 s72, 275200
  buffer_load_dword v52, v4, s[48:51], s72 offen
  s_mov_b32 s73, 277952
  buffer_load_dword v53, v4, s[48:51], s73 offen
  s_mov_b32 s72, 280704
  buffer_load_dword v54, v4, s[48:51], s72 offen
  s_mov_b32 s73, 283456
  buffer_load_dword v55, v4, s[48:51], s73 offen
  s_mov_b32 s72, 352256
  buffer_load_dword v56, v4, s[48:51], s72 offen
  s_mov_b32 s73, 355008
  buffer_load_dword v57, v4, s[48:51], s73 offen
  s_mov_b32 s72, 357760
  buffer_load_dword v58, v4, s[48:51], s72 offen
  s_mov_b32 s73, 360512
  buffer_load_dword v59, v4, s[48:51], s73 offen
  s_mov_b32 s72, 363264
  buffer_load_dword v60, v4, s[48:51], s72 offen
  s_mov_b32 s73, 366016
  buffer_load_dword v61, v4, s[48:51], s73 offen
  s_mov_b32 s72, 368768
  buffer_load_dword v62, v4, s[48:51], s72 offen
  s_mov_b32 s73, 371520
  buffer_load_dword v63, v4, s[48:51], s73 offen
  s_mov_b32 s72, 440320
  buffer_load_dword v64, v4, s[48:51], s72 offen
  s_mov_b32 s73, 443072
  buffer_load_dword v65, v4, s[48:51], s73 offen
  s_mov_b32 s72, 445824
  buffer_load_dword v66, v4, s[48:51], s72 offen
  s_mov_b32 s73, 448576
  buffer_load_dword v67, v4, s[48:51], s73 offen
  s_mov_b32 s72, 451328
  buffer_load_dword v68, v4, s[48:51], s72 offen
  s_mov_b32 s73, 454080
  buffer_load_dword v69, v4, s[48:51], s73 offen
  s_mov_b32 s72, 456832
  buffer_load_dword v70, v4, s[48:51], s72 offen
  s_mov_b32 s73, 459584
  buffer_load_dword v71, v4, s[48:51], s73 offen
  s_mov_b32 s72, 528384
  buffer_load_dword v72, v4, s[48:51], s72 offen
  s_mov_b32 s73, 531136
  buffer_load_dword v73, v4, s[48:51], s73 offen
  s_mov_b32 s72, 533888
  buffer_load_dword v74, v4, s[48:51], s72 offen
  s_mov_b32 s73, 536640
  buffer_load_dword v75, v4, s[48:51], s73 offen
  s_mov_b32 s72, 539392
  buffer_load_dword v76, v4, s[48:51], s72 offen
  s_mov_b32 s73, 542144
  buffer_load_dword v77, v4, s[48:51], s73 offen
  s_mov_b32 s72, 544896
  buffer_load_dword v78, v4, s[48:51], s72 offen
  s_mov_b32 s73, 547648
  buffer_load_dword v79, v4, s[48:51], s73 offen
  s_mov_b32 s72, 616448
  buffer_load_dword v80, v4, s[48:51], s72 offen
  s_mov_b32 s73, 619200
  buffer_load_dword v81, v4, s[48:51], s73 offen
  s_mov_b32 s72, 621952
  buffer_load_dword v82, v4, s[48:51], s72 offen
  s_mov_b32 s73, 624704
  buffer_load_dword v83, v4, s[48:51], s73 offen
  s_mov_b32 s72, 627456
  buffer_load_dword v84, v4, s[48:51], s72 offen
  s_mov_b32 s73, 630208
  buffer_load_dword v85, v4, s[48:51], s73 offen
  s_mov_b32 s72, 632960
  buffer_load_dword v86, v4, s[48:51], s72 offen
  s_mov_b32 s73, 635712
  buffer_load_dword v87, v4, s[48:51], s73 offen
  s_mov_b32 s72, 704512
  buffer_load_dword v88, v4, s[48:51], s72 offen
  s_mov_b32 s73, 707264
  buffer_load_dword v89, v4, s[48:51], s73 offen
  s_mov_b32 s72, 710016
  buffer_load_dword v90, v4, s[48:51], s72 offen
  s_mov_b32 s73, 712768
  buffer_load_dword v91, v4, s[48:51], s73 offen
  s_mov_b32 s72, 715520
  buffer_load_dword v92, v4, s[48:51], s72 offen
  s_mov_b32 s73, 718272
  buffer_load_dword v93, v4, s[48:51], s73 offen
  s_mov_b32 s72, 721024
  buffer_load_dword v94, v4, s[48:51], s72 offen
  s_mov_b32 s73, 723776
  buffer_load_dword v95, v4, s[48:51], s73 offen
  s_mov_b32 s72, 792576
  buffer_load_dword v96, v4, s[48:51], s72 offen
  s_mov_b32 s73, 795328
  buffer_load_dword v97, v4, s[48:51], s73 offen
  s_mov_b32 s72, 798080
  buffer_load_dword v98, v4, s[48:51], s72 offen
  s_mov_b32 s73, 800832
  buffer_load_dword v99, v4, s[48:51], s73 offen
  s_mov_b32 s72, 803584
  buffer_load_dword v100, v4, s[48:51], s72 offen
  s_mov_b32 s73, 806336
  buffer_load_dword v101, v4, s[48:51], s73 offen
  s_mov_b32 s72, 809088
  buffer_load_dword v102, v4, s[48:51], s72 offen
  s_mov_b32 s73, 811840
  buffer_load_dword v103, v4, s[48:51], s73 offen
  s_mov_b32 s72, 880640
  buffer_load_dword v104, v4, s[48:51], s72 offen
  s_mov_b32 s73, 883392
  buffer_load_dword v105, v4, s[48:51], s73 offen
  s_mov_b32 s72, 886144
  buffer_load_dword v106, v4, s[48:51], s72 offen
  s_mov_b32 s73, 888896
  buffer_load_dword v107, v4, s[48:51], s73 offen
  s_mov_b32 s72, 891648
  buffer_load_dword v108, v4, s[48:51], s72 offen
  s_mov_b32 s73, 894400
  buffer_load_dword v109, v4, s[48:51], s73 offen
  s_mov_b32 s72, 897152
  buffer_load_dword v110, v4, s[48:51], s72 offen
  s_mov_b32 s73, 899904
  buffer_load_dword v111, v4, s[48:51], s73 offen
  s_mov_b32 s72, 968704
  buffer_load_dword v112, v4, s[48:51], s72 offen
  s_mov_b32 s73, 971456
  buffer_load_dword v113, v4, s[48:51], s73 offen
  s_mov_b32 s72, 974208
  buffer_load_dword v114, v4, s[48:51], s72 offen
  s_mov_b32 s73, 976960
  buffer_load_dword v115, v4, s[48:51], s73 offen
  s_mov_b32 s72, 979712
  buffer_load_dword v116, v4, s[48:51], s72 offen
  s_mov_b32 s73, 982464
  buffer_load_dword v117, v4, s[48:51], s73 offen
  s_mov_b32 s72, 985216
  buffer_load_dword v118, v4, s[48:51], s72 offen
  s_mov_b32 s73, 987968
  buffer_load_dword v119, v4, s[48:51], s73 offen
  s_waitcnt vmcnt(48)
  v_perm_b32 v120, v25, v24, s70
  v_accvgpr_write_b32 a0, v120
  v_perm_b32 v121, v25, v24, s71
  v_accvgpr_write_b32 a64, v121
  v_perm_b32 v122, v27, v26, s70
  v_accvgpr_write_b32 a1, v122
  v_perm_b32 v123, v27, v26, s71
  v_accvgpr_write_b32 a65, v123
  v_perm_b32 v120, v29, v28, s70
  v_accvgpr_write_b32 a2, v120
  v_perm_b32 v121, v29, v28, s71
  v_accvgpr_write_b32 a66, v121
  v_perm_b32 v122, v31, v30, s70
  v_accvgpr_write_b32 a3, v122
  v_perm_b32 v123, v31, v30, s71
  v_accvgpr_write_b32 a67, v123
  v_perm_b32 v120, v33, v32, s70
  v_accvgpr_write_b32 a4, v120
  v_perm_b32 v121, v33, v32, s71
  v_accvgpr_write_b32 a68, v121
  v_perm_b32 v122, v35, v34, s70
  v_accvgpr_write_b32 a5, v122
  v_perm_b32 v123, v35, v34, s71
  v_accvgpr_write_b32 a69, v123
  v_perm_b32 v120, v37, v36, s70
  v_accvgpr_write_b32 a6, v120
  v_perm_b32 v121, v37, v36, s71
  v_accvgpr_write_b32 a70, v121
  v_perm_b32 v122, v39, v38, s70
  v_accvgpr_write_b32 a7, v122
  v_perm_b32 v123, v39, v38, s71
  v_accvgpr_write_b32 a71, v123
  v_perm_b32 v120, v41, v40, s70
  v_accvgpr_write_b32 a8, v120
  v_perm_b32 v121, v41, v40, s71
  v_accvgpr_write_b32 a72, v121
  v_perm_b32 v122, v43, v42, s70
  v_accvgpr_write_b32 a9, v122
  v_perm_b32 v123, v43, v42, s71
  v_accvgpr_write_b32 a73, v123
  v_perm_b32 v120, v45, v44, s70
  v_accvgpr_write_b32 a10, v120
  v_perm_b32 v121, v45, v44, s71
  v_accvgpr_write_b32 a74, v121
  v_perm_b32 v122, v47, v46, s70
  v_accvgpr_write_b32 a11, v122
  v_perm_b32 v123, v47, v46, s71
  v_accvgpr_write_b32 a75, v123
  v_perm_b32 v120, v49, v48, s70
  v_accvgpr_write_b32 a12, v120
  v_perm_b32 v121, v49, v48, s71
  v_accvgpr_write_b32 a76, v121
  v_perm_b32 v122, v51, v50, s70
  v_accvgpr_write_b32 a13, v122
  v_perm_b32 v123, v51, v50, s71
  v_accvgpr_write_b32 a77, v123
  v_perm_b32 v120, v53, v52, s70
  v_accvgpr_write_b32 a14, v120
  v_perm_b32 v121, v53, v52, s71
  v_accvgpr_write_b32 a78, v121
  v_perm_b32 v122, v55, v54, s70
  v_accvgpr_write_b32 a15, v122
  v_perm_b32 v123, v55, v54, s71
  v_accvgpr_write_b32 a79, v123
  v_perm_b32 v120, v57, v56, s70
  v_accvgpr_write_b32 a16, v120
  v_perm_b32 v121, v57, v56, s71
  v_accvgpr_write_b32 a80, v121
  v_perm_b32 v122, v59, v58, s70
  v_accvgpr_write_b32 a17, v122
  v_perm_b32 v123, v59, v58, s71
  v_accvgpr_write_b32 a81, v123
  v_perm_b32 v120, v61, v60, s70
  v_accvgpr_write_b32 a18, v120
  v_perm_b32 v121, v61, v60, s71
  v_accvgpr_write_b32 a82, v121
  v_perm_b32 v122, v63, v62, s70
  v_accvgpr_write_b32 a19, v122
  v_perm_b32 v123, v63, v62, s71
  v_accvgpr_write_b32 a83, v123
  v_perm_b32 v120, v65, v64, s70
  v_accvgpr_write_b32 a20, v120
  v_perm_b32 v121, v65, v64, s71
  v_accvgpr_write_b32 a84, v121
  v_perm_b32 v122, v67, v66, s70
  v_accvgpr_write_b32 a21, v122
  v_perm_b32 v123, v67, v66, s71
  v_accvgpr_write_b32 a85, v123
  v_perm_b32 v120, v69, v68, s70
  v_accvgpr_write_b32 a22, v120
  v_perm_b32 v121, v69, v68, s71
  v_accvgpr_write_b32 a86, v121
  v_perm_b32 v122, v71, v70, s70
  v_accvgpr_write_b32 a23, v122
  v_perm_b32 v123, v71, v70, s71
  v_accvgpr_write_b32 a87, v123
  s_mov_b32 s72, 1056768
  buffer_load_dword v24, v4, s[48:51], s72 offen
  s_mov_b32 s73, 1059520
  buffer_load_dword v25, v4, s[48:51], s73 offen
  s_mov_b32 s72, 1062272
  buffer_load_dword v26, v4, s[48:51], s72 offen
  s_mov_b32 s73, 1065024
  buffer_load_dword v27, v4, s[48:51], s73 offen
  s_mov_b32 s72, 1067776
  buffer_load_dword v28, v4, s[48:51], s72 offen
  s_mov_b32 s73, 1070528
  buffer_load_dword v29, v4, s[48:51], s73 offen
  s_mov_b32 s72, 1073280
  buffer_load_dword v30, v4, s[48:51], s72 offen
  s_mov_b32 s73, 1076032
  buffer_load_dword v31, v4, s[48:51], s73 offen
  s_mov_b32 s72, 1144832
  buffer_load_dword v32, v4, s[48:51], s72 offen
  s_mov_b32 s73, 1147584
  buffer_load_dword v33, v4, s[48:51], s73 offen
  s_mov_b32 s72, 1150336
  buffer_load_dword v34, v4, s[48:51], s72 offen
  s_mov_b32 s73, 1153088
  buffer_load_dword v35, v4, s[48:51], s73 offen
  s_mov_b32 s72, 1155840
  buffer_load_dword v36, v4, s[48:51], s72 offen
  s_mov_b32 s73, 1158592
  buffer_load_dword v37, v4, s[48:51], s73 offen
  s_mov_b32 s72, 1161344
  buffer_load_dword v38, v4, s[48:51], s72 offen
  s_mov_b32 s73, 1164096
  buffer_load_dword v39, v4, s[48:51], s73 offen
  s_mov_b32 s72, 1232896
  buffer_load_dword v40, v4, s[48:51], s72 offen
  s_mov_b32 s73, 1235648
  buffer_load_dword v41, v4, s[48:51], s73 offen
  s_mov_b32 s72, 1238400
  buffer_load_dword v42, v4, s[48:51], s72 offen
  s_mov_b32 s73, 1241152
  buffer_load_dword v43, v4, s[48:51], s73 offen
  s_mov_b32 s72, 1243904
  buffer_load_dword v44, v4, s[48:51], s72 offen
  s_mov_b32 s73, 1246656
  buffer_load_dword v45, v4, s[48:51], s73 offen
  s_mov_b32 s72, 1249408
  buffer_load_dword v46, v4, s[48:51], s72 offen
  s_mov_b32 s73, 1252160
  buffer_load_dword v47, v4, s[48:51], s73 offen
  s_mov_b32 s72, 1320960
  buffer_load_dword v48, v4, s[48:51], s72 offen
  s_mov_b32 s73, 1323712
  buffer_load_dword v49, v4, s[48:51], s73 offen
  s_mov_b32 s72, 1326464
  buffer_load_dword v50, v4, s[48:51], s72 offen
  s_mov_b32 s73, 1329216
  buffer_load_dword v51, v4, s[48:51], s73 offen
  s_mov_b32 s72, 1331968
  buffer_load_dword v52, v4, s[48:51], s72 offen
  s_mov_b32 s73, 1334720
  buffer_load_dword v53, v4, s[48:51], s73 offen
  s_mov_b32 s72, 1337472
  buffer_load_dword v54, v4, s[48:51], s72 offen
  s_mov_b32 s73, 1340224
  buffer_load_dword v55, v4, s[48:51], s73 offen
  s_waitcnt vmcnt(32)
  v_perm_b32 v120, v73, v72, s70
  v_accvgpr_write_b32 a24, v120
  v_perm_b32 v121, v73, v72, s71
  v_accvgpr_write_b32 a88, v121
  v_perm_b32 v122, v75, v74, s70
  v_accvgpr_write_b32 a25, v122
  v_perm_b32 v123, v75, v74, s71
  v_accvgpr_write_b32 a89, v123
  v_perm_b32 v120, v77, v76, s70
  v_accvgpr_write_b32 a26, v120
  v_perm_b32 v121, v77, v76, s71
  v_accvgpr_write_b32 a90, v121
  v_perm_b32 v122, v79, v78, s70
  v_accvgpr_write_b32 a27, v122
  v_perm_b32 v123, v79, v78, s71
  v_accvgpr_write_b32 a91, v123
  v_perm_b32 v120, v81, v80, s70
  v_accvgpr_write_b32 a28, v120
  v_perm_b32 v121, v81, v80, s71
  v_accvgpr_write_b32 a92, v121
  v_perm_b32 v122, v83, v82, s70
  v_accvgpr_write_b32 a29, v122
  v_perm_b32 v123, v83, v82, s71
  v_accvgpr_write_b32 a93, v123
  v_perm_b32 v120, v85, v84, s70
  v_accvgpr_write_b32 a30, v120
  v_perm_b32 v121, v85, v84, s71
  v_accvgpr_write_b32 a94, v121
  v_perm_b32 v122, v87, v86, s70
  v_accvgpr_write_b32 a31, v122
  v_perm_b32 v123, v87, v86, s71
  v_accvgpr_write_b32 a95, v123
  v_perm_b32 v120, v89, v88, s70
  v_accvgpr_write_b32 a32, v120
  v_perm_b32 v121, v89, v88, s71
  v_accvgpr_write_b32 a96, v121
  v_perm_b32 v122, v91, v90, s70
  v_accvgpr_write_b32 a33, v122
  v_perm_b32 v123, v91, v90, s71
  v_accvgpr_write_b32 a97, v123
  v_perm_b32 v120, v93, v92, s70
  v_accvgpr_write_b32 a34, v120
  v_perm_b32 v121, v93, v92, s71
  v_accvgpr_write_b32 a98, v121
  v_perm_b32 v122, v95, v94, s70
  v_accvgpr_write_b32 a35, v122
  v_perm_b32 v123, v95, v94, s71
  v_accvgpr_write_b32 a99, v123
  v_perm_b32 v120, v97, v96, s70
  v_accvgpr_write_b32 a36, v120
  v_perm_b32 v121, v97, v96, s71
  v_accvgpr_write_b32 a100, v121
  v_perm_b32 v122, v99, v98, s70
  v_accvgpr_write_b32 a37, v122
  v_perm_b32 v123, v99, v98, s71
  v_accvgpr_write_b32 a101, v123
  v_perm_b32 v120, v101, v100, s70
  v_accvgpr_write_b32 a38, v120
  v_perm_b32 v121, v101, v100, s71
  v_accvgpr_write_b32 a102, v121
  v_perm_b32 v122, v103, v102, s70
  v_accvgpr_write_b32 a39, v122
  v_perm_b32 v123, v103, v102, s71
  v_accvgpr_write_b32 a103, v123
  v_perm_b32 v120, v105, v104, s70
  v_accvgpr_write_b32 a40, v120
  v_perm_b32 v121, v105, v104, s71
  v_accvgpr_write_b32 a104, v121
  v_perm_b32 v122, v107, v106, s70
  v_accvgpr_write_b32 a41, v122
  v_perm_b32 v123, v107, v106, s71
  v_accvgpr_write_b32 a105, v123
  v_perm_b32 v120, v109, v108, s70
  v_accvgpr_write_b32 a42, v120
  v_perm_b32 v121, v109, v108, s71
  v_accvgpr_write_b32 a106, v121
  v_perm_b32 v122, v111, v110, s70
  v_accvgpr_write_b32 a43, v122
  v_perm_b32 v123, v111, v110, s71
  v_accvgpr_write_b32 a107, v123
  v_perm_b32 v120, v113, v112, s70
  v_accvgpr_write_b32 a44, v120
  v_perm_b32 v121, v113, v112, s71
  v_accvgpr_write_b32 a108, v121
  v_perm_b32 v122, v115, v114, s70
  v_accvgpr_write_b32 a45, v122
  v_perm_b32 v123, v115, v114, s71
  v_accvgpr_write_b32 a109, v123
  v_perm_b32 v120, v117, v116, s70
  v_accvgpr_write_b32 a46, v120
  v_perm_b32 v121, v117, v116, s71
  v_accvgpr_write_b32 a110, v121
  v_perm_b32 v122, v119, v118, s70
  v_accvgpr_write_b32 a47, v122
  v_perm_b32 v123, v119, v118, s71
  v_accvgpr_write_b32 a111, v123
  s_waitcnt vmcnt(0)
  v_perm_b32 v120, v25, v24, s70
  v_accvgpr_write_b32 a48, v120
  v_perm_b32 v121, v25, v24, s71
  v_accvgpr_write_b32 a112, v121
  v_perm_b32 v122, v27, v26, s70
  v_accvgpr_write_b32 a49, v122
  v_perm_b32 v123, v27, v26, s71
  v_accvgpr_write_b32 a113, v123
  v_perm_b32 v120, v29, v28, s70
  v_accvgpr_write_b32 a50, v120
  v_perm_b32 v121, v29, v28, s71
  v_accvgpr_write_b32 a114, v121
  v_perm_b32 v122, v31, v30, s70
  v_accvgpr_write_b32 a51, v122
  v_perm_b32 v123, v31, v30, s71
  v_accvgpr_write_b32 a115, v123
  v_perm_b32 v120, v33, v32, s70
  v_accvgpr_write_b32 a52, v120
  v_perm_b32 v121, v33, v32, s71
  v_accvgpr_write_b32 a116, v121
  v_perm_b32 v122, v35, v34, s70
  v_accvgpr_write_b32 a53, v122
  v_perm_b32 v123, v35, v34, s71
  v_accvgpr_write_b32 a117, v123
  v_perm_b32 v120, v37, v36, s70
  v_accvgpr_write_b32 a54, v120
  v_perm_b32 v121, v37, v36, s71
  v_accvgpr_write_b32 a118, v121
  v_perm_b32 v122, v39, v38, s70
  v_accvgpr_write_b32 a55, v122
  v_perm_b32 v123, v39, v38, s71
  v_accvgpr_write_b32 a119, v123
  v_perm_b32 v120, v41, v40, s70
  v_accvgpr_write_b32 a56, v120
  v_perm_b32 v121, v41, v40, s71
  v_accvgpr_write_b32 a120, v121
  v_perm_b32 v122, v43, v42, s70
  v_accvgpr_write_b32 a57, v122
  v_perm_b32 v123, v43, v42, s71
  v_accvgpr_write_b32 a121, v123
  v_perm_b32 v120, v45, v44, s70
  v_accvgpr_write_b32 a58, v120
  v_perm_b32 v121, v45, v44, s71
  v_accvgpr_write_b32 a122, v121
  v_perm_b32 v122, v47, v46, s70
  v_accvgpr_write_b32 a59, v122
  v_perm_b32 v123, v47, v46, s71
  v_accvgpr_write_b32 a123, v123
  v_perm_b32 v120, v49, v48, s70
  v_accvgpr_write_b32 a60, v120
  v_perm_b32 v121, v49, v48, s71
  v_accvgpr_write_b32 a124, v121
  v_perm_b32 v122, v51, v50, s70
  v_accvgpr_write_b32 a61, v122
  v_perm_b32 v123, v51, v50, s71
  v_accvgpr_write_b32 a125, v123
  v_perm_b32 v120, v53, v52, s70
  v_accvgpr_write_b32 a62, v120
  v_perm_b32 v121, v53, v52, s71
  v_accvgpr_write_b32 a126, v121
  v_perm_b32 v122, v55, v54, s70
  v_accvgpr_write_b32 a63, v122
  v_perm_b32 v123, v55, v54, s71
  v_accvgpr_write_b32 a127, v123
  s_mov_b32 s72, 0
  buffer_load_dword v24, v4, s[52:55], s72 offen
  s_mov_b32 s73, 2752
  buffer_load_dword v25, v4, s[52:55], s73 offen
  s_mov_b32 s72, 5504
  buffer_load_dword v26, v4, s[52:55], s72 offen
  s_mov_b32 s73, 8256
  buffer_load_dword v27, v4, s[52:55], s73 offen
  s_mov_b32 s72, 11008
  buffer_load_dword v28, v4, s[52:55], s72 offen
  s_mov_b32 s73, 13760
  buffer_load_dword v29, v4, s[52:55], s73 offen
  s_mov_b32 s72, 16512
  buffer_load_dword v30, v4, s[52:55], s72 offen
  s_mov_b32 s73, 19264
  buffer_load_dword v31, v4, s[52:55], s73 offen
  s_mov_b32 s72, 88064
  buffer_load_dword v32, v4, s[52:55], s72 offen
  s_mov_b32 s73, 90816
  buffer_load_dword v33, v4, s[52:55], s73 offen
  s_mov_b32 s72, 93568
  buffer_load_dword v34, v4, s[52:55], s72 offen
  s_mov_b32 s73, 96320
  buffer_load_dword v35, v4, s[52:55], s73 offen
  s_mov_b32 s72, 99072
  buffer_load_dword v36, v4, s[52:55], s72 offen
  s_mov_b32 s73, 101824
  buffer_load_dword v37, v4, s[52:55], s73 offen
  s_mov_b32 s72, 104576
  buffer_load_dword v38, v4, s[52:55], s72 offen
  s_mov_b32 s73, 107328
  buffer_load_dword v39, v4, s[52:55], s73 offen
  s_mov_b32 s72, 176128
  buffer_load_dword v40, v4, s[52:55], s72 offen
  s_mov_b32 s73, 178880
  buffer_load_dword v41, v4, s[52:55], s73 offen
  s_mov_b32 s72, 181632
  buffer_load_dword v42, v4, s[52:55], s72 offen
  s_mov_b32 s73, 184384
  buffer_load_dword v43, v4, s[52:55], s73 offen
  s_mov_b32 s72, 187136
  buffer_load_dword v44, v4, s[52:55], s72 offen
  s_mov_b32 s73, 189888
  buffer_load_dword v45, v4, s[52:55], s73 offen
  s_mov_b32 s72, 192640
  buffer_load_dword v46, v4, s[52:55], s72 offen
  s_mov_b32 s73, 195392
  buffer_load_dword v47, v4, s[52:55], s73 offen
  s_mov_b32 s72, 264192
  buffer_load_dword v48, v4, s[52:55], s72 offen
  s_mov_b32 s73, 266944
  buffer_load_dword v49, v4, s[52:55], s73 offen
  s_mov_b32 s72, 269696
  buffer_load_dword v50, v4, s[52:55], s72 offen
  s_mov_b32 s73, 272448
  buffer_load_dword v51, v4, s[52:55], s73 offen
  s_mov_b32 s72, 275200
  buffer_load_dword v52, v4, s[52:55], s72 offen
  s_mov_b32 s73, 277952
  buffer_load_dword v53, v4, s[52:55], s73 offen
  s_mov_b32 s72, 280704
  buffer_load_dword v54, v4, s[52:55], s72 offen
  s_mov_b32 s73, 283456
  buffer_load_dword v55, v4, s[52:55], s73 offen
  s_mov_b32 s72, 352256
  buffer_load_dword v56, v4, s[52:55], s72 offen
  s_mov_b32 s73, 355008
  buffer_load_dword v57, v4, s[52:55], s73 offen
  s_mov_b32 s72, 357760
  buffer_load_dword v58, v4, s[52:55], s72 offen
  s_mov_b32 s73, 360512
  buffer_load_dword v59, v4, s[52:55], s73 offen
  s_mov_b32 s72, 363264
  buffer_load_dword v60, v4, s[52:55], s72 offen
  s_mov_b32 s73, 366016
  buffer_load_dword v61, v4, s[52:55], s73 offen
  s_mov_b32 s72, 368768
  buffer_load_dword v62, v4, s[52:55], s72 offen
  s_mov_b32 s73, 371520
  buffer_load_dword v63, v4, s[52:55], s73 offen
  s_mov_b32 s72, 440320
  buffer_load_dword v64, v4, s[52:55], s72 offen
  s_mov_b32 s73, 443072
  buffer_load_dword v65, v4, s[52:55], s73 offen
  s_mov_b32 s72, 445824
  buffer_load_dword v66, v4, s[52:55], s72 offen
  s_mov_b32 s73, 448576
  buffer_load_dword v67, v4, s[52:55], s73 offen
  s_mov_b32 s72, 451328
  buffer_load_dword v68, v4, s[52:55], s72 offen
  s_mov_b32 s73, 454080
  buffer_load_dword v69, v4, s[52:55], s73 offen
  s_mov_b32 s72, 456832
  buffer_load_dword v70, v4, s[52:55], s72 offen
  s_mov_b32 s73, 459584
  buffer_load_dword v71, v4, s[52:55], s73 offen
  s_mov_b32 s72, 528384
  buffer_load_dword v72, v4, s[52:55], s72 offen
  s_mov_b32 s73, 531136
  buffer_load_dword v73, v4, s[52:55], s73 offen
  s_mov_b32 s72, 533888
  buffer_load_dword v74, v4, s[52:55], s72 offen
  s_mov_b32 s73, 536640
  buffer_load_dword v75, v4, s[52:55], s73 offen
  s_mov_b32 s72, 539392
  buffer_load_dword v76, v4, s[52:55], s72 offen
  s_mov_b32 s73, 542144
  buffer_load_dword v77, v4, s[52:55], s73 offen
  s_mov_b32 s72, 544896
  buffer_load_dword v78, v4, s[52:55], s72 offen
  s_mov_b32 s73, 547648
  buffer_load_dword v79, v4, s[52:55], s73 offen
  s_mov_b32 s72, 616448
  buffer_load_dword v80, v4, s[52:55], s72 offen
  s_mov_b32 s73, 619200
  buffer_load_dword v81, v4, s[52:55], s73 offen
  s_mov_b32 s72, 621952
  buffer_load_dword v82, v4, s[52:55], s72 offen
  s_mov_b32 s73, 624704
  buffer_load_dword v83, v4, s[52:55], s73 offen
  s_mov_b32 s72, 627456
  buffer_load_dword v84, v4, s[52:55], s72 offen
  s_mov_b32 s73, 630208
  buffer_load_dword v85, v4, s[52:55], s73 offen
  s_mov_b32 s72, 632960
  buffer_load_dword v86, v4, s[52:55], s72 offen
  s_mov_b32 s73, 635712
  buffer_load_dword v87, v4, s[52:55], s73 offen
  s_mov_b32 s72, 704512
  buffer_load_dword v88, v4, s[52:55], s72 offen
  s_mov_b32 s73, 707264
  buffer_load_dword v89, v4, s[52:55], s73 offen
  s_mov_b32 s72, 710016
  buffer_load_dword v90, v4, s[52:55], s72 offen
  s_mov_b32 s73, 712768
  buffer_load_dword v91, v4, s[52:55], s73 offen
  s_mov_b32 s72, 715520
  buffer_load_dword v92, v4, s[52:55], s72 offen
  s_mov_b32 s73, 718272
  buffer_load_dword v93, v4, s[52:55], s73 offen
  s_mov_b32 s72, 721024
  buffer_load_dword v94, v4, s[52:55], s72 offen
  s_mov_b32 s73, 723776
  buffer_load_dword v95, v4, s[52:55], s73 offen
  s_mov_b32 s72, 792576
  buffer_load_dword v96, v4, s[52:55], s72 offen
  s_mov_b32 s73, 795328
  buffer_load_dword v97, v4, s[52:55], s73 offen
  s_mov_b32 s72, 798080
  buffer_load_dword v98, v4, s[52:55], s72 offen
  s_mov_b32 s73, 800832
  buffer_load_dword v99, v4, s[52:55], s73 offen
  s_mov_b32 s72, 803584
  buffer_load_dword v100, v4, s[52:55], s72 offen
  s_mov_b32 s73, 806336
  buffer_load_dword v101, v4, s[52:55], s73 offen
  s_mov_b32 s72, 809088
  buffer_load_dword v102, v4, s[52:55], s72 offen
  s_mov_b32 s73, 811840
  buffer_load_dword v103, v4, s[52:55], s73 offen
  s_mov_b32 s72, 880640
  buffer_load_dword v104, v4, s[52:55], s72 offen
  s_mov_b32 s73, 883392
  buffer_load_dword v105, v4, s[52:55], s73 offen
  s_mov_b32 s72, 886144
  buffer_load_dword v106, v4, s[52:55], s72 offen
  s_mov_b32 s73, 888896
  buffer_load_dword v107, v4, s[52:55], s73 offen
  s_mov_b32 s72, 891648
  buffer_load_dword v108, v4, s[52:55], s72 offen
  s_mov_b32 s73, 894400
  buffer_load_dword v109, v4, s[52:55], s73 offen
  s_mov_b32 s72, 897152
  buffer_load_dword v110, v4, s[52:55], s72 offen
  s_mov_b32 s73, 899904
  buffer_load_dword v111, v4, s[52:55], s73 offen
  s_mov_b32 s72, 968704
  buffer_load_dword v112, v4, s[52:55], s72 offen
  s_mov_b32 s73, 971456
  buffer_load_dword v113, v4, s[52:55], s73 offen
  s_mov_b32 s72, 974208
  buffer_load_dword v114, v4, s[52:55], s72 offen
  s_mov_b32 s73, 976960
  buffer_load_dword v115, v4, s[52:55], s73 offen
  s_mov_b32 s72, 979712
  buffer_load_dword v116, v4, s[52:55], s72 offen
  s_mov_b32 s73, 982464
  buffer_load_dword v117, v4, s[52:55], s73 offen
  s_mov_b32 s72, 985216
  buffer_load_dword v118, v4, s[52:55], s72 offen
  s_mov_b32 s73, 987968
  buffer_load_dword v119, v4, s[52:55], s73 offen
  s_waitcnt vmcnt(48)
  v_perm_b32 v120, v25, v24, s70
  v_accvgpr_write_b32 a128, v120
  v_perm_b32 v121, v25, v24, s71
  v_accvgpr_write_b32 a192, v121
  v_perm_b32 v122, v27, v26, s70
  v_accvgpr_write_b32 a129, v122
  v_perm_b32 v123, v27, v26, s71
  v_accvgpr_write_b32 a193, v123
  v_perm_b32 v120, v29, v28, s70
  v_accvgpr_write_b32 a130, v120
  v_perm_b32 v121, v29, v28, s71
  v_accvgpr_write_b32 a194, v121
  v_perm_b32 v122, v31, v30, s70
  v_accvgpr_write_b32 a131, v122
  v_perm_b32 v123, v31, v30, s71
  v_accvgpr_write_b32 a195, v123
  v_perm_b32 v120, v33, v32, s70
  v_accvgpr_write_b32 a132, v120
  v_perm_b32 v121, v33, v32, s71
  v_accvgpr_write_b32 a196, v121
  v_perm_b32 v122, v35, v34, s70
  v_accvgpr_write_b32 a133, v122
  v_perm_b32 v123, v35, v34, s71
  v_accvgpr_write_b32 a197, v123
  v_perm_b32 v120, v37, v36, s70
  v_accvgpr_write_b32 a134, v120
  v_perm_b32 v121, v37, v36, s71
  v_accvgpr_write_b32 a198, v121
  v_perm_b32 v122, v39, v38, s70
  v_accvgpr_write_b32 a135, v122
  v_perm_b32 v123, v39, v38, s71
  v_accvgpr_write_b32 a199, v123
  v_perm_b32 v120, v41, v40, s70
  v_accvgpr_write_b32 a136, v120
  v_perm_b32 v121, v41, v40, s71
  v_accvgpr_write_b32 a200, v121
  v_perm_b32 v122, v43, v42, s70
  v_accvgpr_write_b32 a137, v122
  v_perm_b32 v123, v43, v42, s71
  v_accvgpr_write_b32 a201, v123
  v_perm_b32 v120, v45, v44, s70
  v_accvgpr_write_b32 a138, v120
  v_perm_b32 v121, v45, v44, s71
  v_accvgpr_write_b32 a202, v121
  v_perm_b32 v122, v47, v46, s70
  v_accvgpr_write_b32 a139, v122
  v_perm_b32 v123, v47, v46, s71
  v_accvgpr_write_b32 a203, v123
  v_perm_b32 v120, v49, v48, s70
  v_accvgpr_write_b32 a140, v120
  v_perm_b32 v121, v49, v48, s71
  v_accvgpr_write_b32 a204, v121
  v_perm_b32 v122, v51, v50, s70
  v_accvgpr_write_b32 a141, v122
  v_perm_b32 v123, v51, v50, s71
  v_accvgpr_write_b32 a205, v123
  v_perm_b32 v120, v53, v52, s70
  v_accvgpr_write_b32 a142, v120
  v_perm_b32 v121, v53, v52, s71
  v_accvgpr_write_b32 a206, v121
  v_perm_b32 v122, v55, v54, s70
  v_accvgpr_write_b32 a143, v122
  v_perm_b32 v123, v55, v54, s71
  v_accvgpr_write_b32 a207, v123
  v_perm_b32 v120, v57, v56, s70
  v_accvgpr_write_b32 a144, v120
  v_perm_b32 v121, v57, v56, s71
  v_accvgpr_write_b32 a208, v121
  v_perm_b32 v122, v59, v58, s70
  v_accvgpr_write_b32 a145, v122
  v_perm_b32 v123, v59, v58, s71
  v_accvgpr_write_b32 a209, v123
  v_perm_b32 v120, v61, v60, s70
  v_accvgpr_write_b32 a146, v120
  v_perm_b32 v121, v61, v60, s71
  v_accvgpr_write_b32 a210, v121
  v_perm_b32 v122, v63, v62, s70
  v_accvgpr_write_b32 a147, v122
  v_perm_b32 v123, v63, v62, s71
  v_accvgpr_write_b32 a211, v123
  v_perm_b32 v120, v65, v64, s70
  v_accvgpr_write_b32 a148, v120
  v_perm_b32 v121, v65, v64, s71
  v_accvgpr_write_b32 a212, v121
  v_perm_b32 v122, v67, v66, s70
  v_accvgpr_write_b32 a149, v122
  v_perm_b32 v123, v67, v66, s71
  v_accvgpr_write_b32 a213, v123
  v_perm_b32 v120, v69, v68, s70
  v_accvgpr_write_b32 a150, v120
  v_perm_b32 v121, v69, v68, s71
  v_accvgpr_write_b32 a214, v121
  v_perm_b32 v122, v71, v70, s70
  v_accvgpr_write_b32 a151, v122
  v_perm_b32 v123, v71, v70, s71
  v_accvgpr_write_b32 a215, v123
  s_mov_b32 s72, 1056768
  buffer_load_dword v24, v4, s[52:55], s72 offen
  s_mov_b32 s73, 1059520
  buffer_load_dword v25, v4, s[52:55], s73 offen
  s_mov_b32 s72, 1062272
  buffer_load_dword v26, v4, s[52:55], s72 offen
  s_mov_b32 s73, 1065024
  buffer_load_dword v27, v4, s[52:55], s73 offen
  s_mov_b32 s72, 1067776
  buffer_load_dword v28, v4, s[52:55], s72 offen
  s_mov_b32 s73, 1070528
  buffer_load_dword v29, v4, s[52:55], s73 offen
  s_mov_b32 s72, 1073280
  buffer_load_dword v30, v4, s[52:55], s72 offen
  s_mov_b32 s73, 1076032
  buffer_load_dword v31, v4, s[52:55], s73 offen
  s_mov_b32 s72, 1144832
  buffer_load_dword v32, v4, s[52:55], s72 offen
  s_mov_b32 s73, 1147584
  buffer_load_dword v33, v4, s[52:55], s73 offen
  s_mov_b32 s72, 1150336
  buffer_load_dword v34, v4, s[52:55], s72 offen
  s_mov_b32 s73, 1153088
  buffer_load_dword v35, v4, s[52:55], s73 offen
  s_mov_b32 s72, 1155840
  buffer_load_dword v36, v4, s[52:55], s72 offen
  s_mov_b32 s73, 1158592
  buffer_load_dword v37, v4, s[52:55], s73 offen
  s_mov_b32 s72, 1161344
  buffer_load_dword v38, v4, s[52:55], s72 offen
  s_mov_b32 s73, 1164096
  buffer_load_dword v39, v4, s[52:55], s73 offen
  s_mov_b32 s72, 1232896
  buffer_load_dword v40, v4, s[52:55], s72 offen
  s_mov_b32 s73, 1235648
  buffer_load_dword v41, v4, s[52:55], s73 offen
  s_mov_b32 s72, 1238400
  buffer_load_dword v42, v4, s[52:55], s72 offen
  s_mov_b32 s73, 1241152
  buffer_load_dword v43, v4, s[52:55], s73 offen
  s_mov_b32 s72, 1243904
  buffer_load_dword v44, v4, s[52:55], s72 offen
  s_mov_b32 s73, 1246656
  buffer_load_dword v45, v4, s[52:55], s73 offen
  s_mov_b32 s72, 1249408
  buffer_load_dword v46, v4, s[52:55], s72 offen
  s_mov_b32 s73, 1252160
  buffer_load_dword v47, v4, s[52:55], s73 offen
  s_mov_b32 s72, 1320960
  buffer_load_dword v48, v4, s[52:55], s72 offen
  s_mov_b32 s73, 1323712
  buffer_load_dword v49, v4, s[52:55], s73 offen
  s_mov_b32 s72, 1326464
  buffer_load_dword v50, v4, s[52:55], s72 offen
  s_mov_b32 s73, 1329216
  buffer_load_dword v51, v4, s[52:55], s73 offen
  s_mov_b32 s72, 1331968
  buffer_load_dword v52, v4, s[52:55], s72 offen
  s_mov_b32 s73, 1334720
  buffer_load_dword v53, v4, s[52:55], s73 offen
  s_mov_b32 s72, 1337472
  buffer_load_dword v54, v4, s[52:55], s72 offen
  s_mov_b32 s73, 1340224
  buffer_load_dword v55, v4, s[52:55], s73 offen
  s_waitcnt vmcnt(32)
  v_perm_b32 v120, v73, v72, s70
  v_accvgpr_write_b32 a152, v120
  v_perm_b32 v121, v73, v72, s71
  v_accvgpr_write_b32 a216, v121
  v_perm_b32 v122, v75, v74, s70
  v_accvgpr_write_b32 a153, v122
  v_perm_b32 v123, v75, v74, s71
  v_accvgpr_write_b32 a217, v123
  v_perm_b32 v120, v77, v76, s70
  v_accvgpr_write_b32 a154, v120
  v_perm_b32 v121, v77, v76, s71
  v_accvgpr_write_b32 a218, v121
  v_perm_b32 v122, v79, v78, s70
  v_accvgpr_write_b32 a155, v122
  v_perm_b32 v123, v79, v78, s71
  v_accvgpr_write_b32 a219, v123
  v_perm_b32 v120, v81, v80, s70
  v_accvgpr_write_b32 a156, v120
  v_perm_b32 v121, v81, v80, s71
  v_accvgpr_write_b32 a220, v121
  v_perm_b32 v122, v83, v82, s70
  v_accvgpr_write_b32 a157, v122
  v_perm_b32 v123, v83, v82, s71
  v_accvgpr_write_b32 a221, v123
  v_perm_b32 v120, v85, v84, s70
  v_accvgpr_write_b32 a158, v120
  v_perm_b32 v121, v85, v84, s71
  v_accvgpr_write_b32 a222, v121
  v_perm_b32 v122, v87, v86, s70
  v_accvgpr_write_b32 a159, v122
  v_perm_b32 v123, v87, v86, s71
  v_accvgpr_write_b32 a223, v123
  v_perm_b32 v120, v89, v88, s70
  v_accvgpr_write_b32 a160, v120
  v_perm_b32 v121, v89, v88, s71
  v_accvgpr_write_b32 a224, v121
  v_perm_b32 v122, v91, v90, s70
  v_accvgpr_write_b32 a161, v122
  v_perm_b32 v123, v91, v90, s71
  v_accvgpr_write_b32 a225, v123
  v_perm_b32 v120, v93, v92, s70
  v_accvgpr_write_b32 a162, v120
  v_perm_b32 v121, v93, v92, s71
  v_accvgpr_write_b32 a226, v121
  v_perm_b32 v122, v95, v94, s70
  v_accvgpr_write_b32 a163, v122
  v_perm_b32 v123, v95, v94, s71
  v_accvgpr_write_b32 a227, v123
  v_perm_b32 v120, v97, v96, s70
  v_accvgpr_write_b32 a164, v120
  v_perm_b32 v121, v97, v96, s71
  v_accvgpr_write_b32 a228, v121
  v_perm_b32 v122, v99, v98, s70
  v_accvgpr_write_b32 a165, v122
  v_perm_b32 v123, v99, v98, s71
  v_accvgpr_write_b32 a229, v123
  v_perm_b32 v120, v101, v100, s70
  v_accvgpr_write_b32 a166, v120
  v_perm_b32 v121, v101, v100, s71
  v_accvgpr_write_b32 a230, v121
  v_perm_b32 v122, v103, v102, s70
  v_accvgpr_write_b32 a167, v122
  v_perm_b32 v123, v103, v102, s71
  v_accvgpr_write_b32 a231, v123
  v_perm_b32 v120, v105, v104, s70
  v_accvgpr_write_b32 a168, v120
  v_perm_b32 v121, v105, v104, s71
  v_accvgpr_write_b32 a232, v121
  v_perm_b32 v122, v107, v106, s70
  v_accvgpr_write_b32 a169, v122
  v_perm_b32 v123, v107, v106, s71
  v_accvgpr_write_b32 a233, v123
  v_perm_b32 v120, v109, v108, s70
  v_accvgpr_write_b32 a170, v120
  v_perm_b32 v121, v109, v108, s71
  v_accvgpr_write_b32 a234, v121
  v_perm_b32 v122, v111, v110, s70
  v_accvgpr_write_b32 a171, v122
  v_perm_b32 v123, v111, v110, s71
  v_accvgpr_write_b32 a235, v123
  v_perm_b32 v120, v113, v112, s70
  v_accvgpr_write_b32 a172, v120
  v_perm_b32 v121, v113, v112, s71
  v_accvgpr_write_b32 a236, v121
  v_perm_b32 v122, v115, v114, s70
  v_accvgpr_write_b32 a173, v122
  v_perm_b32 v123, v115, v114, s71
  v_accvgpr_write_b32 a237, v123
  v_perm_b32 v120, v117, v116, s70
  v_accvgpr_write_b32 a174, v120
  v_perm_b32 v121, v117, v116, s71
  v_accvgpr_write_b32 a238, v121
  v_perm_b32 v122, v119, v118, s70
  v_accvgpr_write_b32 a175, v122
  v_perm_b32 v123, v119, v118, s71
  v_accvgpr_write_b32 a239, v123
  s_waitcnt vmcnt(0)
  v_perm_b32 v120, v25, v24, s70
  v_accvgpr_write_b32 a176, v120
  v_perm_b32 v121, v25, v24, s71
  v_accvgpr_write_b32 a240, v121
  v_perm_b32 v122, v27, v26, s70
  v_accvgpr_write_b32 a177, v122
  v_perm_b32 v123, v27, v26, s71
  v_accvgpr_write_b32 a241, v123
  v_perm_b32 v120, v29, v28, s70
  v_accvgpr_write_b32 a178, v120
  v_perm_b32 v121, v29, v28, s71
  v_accvgpr_write_b32 a242, v121
  v_perm_b32 v122, v31, v30, s70
  v_accvgpr_write_b32 a179, v122
  v_perm_b32 v123, v31, v30, s71
  v_accvgpr_write_b32 a243, v123
  v_perm_b32 v120, v33, v32, s70
  v_accvgpr_write_b32 a180, v120
  v_perm_b32 v121, v33, v32, s71
  v_accvgpr_write_b32 a244, v121
  v_perm_b32 v122, v35, v34, s70
  v_accvgpr_write_b32 a181, v122
  v_perm_b32 v123, v35, v34, s71
  v_accvgpr_write_b32 a245, v123
  v_perm_b32 v120, v37, v36, s70
  v_accvgpr_write_b32 a182, v120
  v_perm_b32 v121, v37, v36, s71
  v_accvgpr_write_b32 a246, v121
  v_perm_b32 v122, v39, v38, s70
  v_accvgpr_write_b32 a183, v122
  v_perm_b32 v123, v39, v38, s71
  v_accvgpr_write_b32 a247, v123
  v_perm_b32 v120, v41, v40, s70
  v_accvgpr_write_b32 a184, v120
  v_perm_b32 v121, v41, v40, s71
  v_accvgpr_write_b32 a248, v121
  v_perm_b32 v122, v43, v42, s70
  v_accvgpr_write_b32 a185, v122
  v_perm_b32 v123, v43, v42, s71
  v_accvgpr_write_b32 a249, v123
  v_perm_b32 v120, v45, v44, s70
  v_accvgpr_write_b32 a186, v120
  v_perm_b32 v121, v45, v44, s71
  v_accvgpr_write_b32 a250, v121
  v_perm_b32 v122, v47, v46, s70
  v_accvgpr_write_b32 a187, v122
  v_perm_b32 v123, v47, v46, s71
  v_accvgpr_write_b32 a251, v123
  v_perm_b32 v120, v49, v48, s70
  v_accvgpr_write_b32 a188, v120
  v_perm_b32 v121, v49, v48, s71
  v_accvgpr_write_b32 a252, v121
  v_perm_b32 v122, v51, v50, s70
  v_accvgpr_write_b32 a189, v122
  v_perm_b32 v123, v51, v50, s71
  v_accvgpr_write_b32 a253, v123
  v_perm_b32 v120, v53, v52, s70
  v_accvgpr_write_b32 a190, v120
  v_perm_b32 v121, v53, v52, s71
  v_accvgpr_write_b32 a254, v121
  v_perm_b32 v122, v55, v54, s70
  v_accvgpr_write_b32 a191, v122
  v_perm_b32 v123, v55, v54, s71
  v_accvgpr_write_b32 a255, v123
  s_mov_b32 s72, 0
  buffer_load_dwordx2 v[24:25], v5, s[56:59], s72 offen
  s_mov_b32 s73, 1024
  buffer_load_dwordx2 v[26:27], v5, s[56:59], s73 offen
  s_mov_b32 s72, 2048
  buffer_load_dwordx2 v[28:29], v5, s[56:59], s72 offen
  s_mov_b32 s73, 3072
  buffer_load_dwordx2 v[30:31], v5, s[56:59], s73 offen
  s_mov_b32 s72, 4096
  buffer_load_dwordx2 v[32:33], v5, s[56:59], s72 offen
  s_mov_b32 s73, 5120
  buffer_load_dwordx2 v[34:35], v5, s[56:59], s73 offen
  s_mov_b32 s72, 6144
  buffer_load_dwordx2 v[36:37], v5, s[56:59], s72 offen
  s_mov_b32 s73, 7168
  buffer_load_dwordx2 v[38:39], v5, s[56:59], s73 offen
  s_mov_b32 s72, 16384
  buffer_load_dwordx2 v[40:41], v5, s[56:59], s72 offen
  s_mov_b32 s73, 17408
  buffer_load_dwordx2 v[42:43], v5, s[56:59], s73 offen
  s_mov_b32 s72, 18432
  buffer_load_dwordx2 v[44:45], v5, s[56:59], s72 offen
  s_mov_b32 s73, 19456
  buffer_load_dwordx2 v[46:47], v5, s[56:59], s73 offen
  s_mov_b32 s72, 20480
  buffer_load_dwordx2 v[48:49], v5, s[56:59], s72 offen
  s_mov_b32 s73, 21504
  buffer_load_dwordx2 v[50:51], v5, s[56:59], s73 offen
  s_mov_b32 s72, 22528
  buffer_load_dwordx2 v[52:53], v5, s[56:59], s72 offen
  s_mov_b32 s73, 23552
  buffer_load_dwordx2 v[54:55], v5, s[56:59], s73 offen
  s_waitcnt vmcnt(0)
  v_perm_b32 v192, v26, v24, s70
  v_perm_b32 v208, v26, v24, s71
  v_perm_b32 v224, v27, v25, s70
  v_perm_b32 v240, v27, v25, s71
  v_perm_b32 v193, v30, v28, s70
  v_perm_b32 v209, v30, v28, s71
  v_perm_b32 v225, v31, v29, s70
  v_perm_b32 v241, v31, v29, s71
  v_perm_b32 v194, v34, v32, s70
  v_perm_b32 v210, v34, v32, s71
  v_perm_b32 v226, v35, v33, s70
  v_perm_b32 v242, v35, v33, s71
  v_perm_b32 v195, v38, v36, s70
  v_perm_b32 v211, v38, v36, s71
  v_perm_b32 v227, v39, v37, s70
  v_perm_b32 v243, v39, v37, s71
  v_perm_b32 v196, v42, v40, s70
  v_perm_b32 v212, v42, v40, s71
  v_perm_b32 v228, v43, v41, s70
  v_perm_b32 v244, v43, v41, s71
  v_perm_b32 v197, v46, v44, s70
  v_perm_b32 v213, v46, v44, s71
  v_perm_b32 v229, v47, v45, s70
  v_perm_b32 v245, v47, v45, s71
  v_perm_b32 v198, v50, v48, s70
  v_perm_b32 v214, v50, v48, s71
  v_perm_b32 v230, v51, v49, s70
  v_perm_b32 v246, v51, v49, s71
  v_perm_b32 v199, v54, v52, s70
  v_perm_b32 v215, v54, v52, s71
  v_perm_b32 v231, v55, v53, s70
  v_perm_b32 v247, v55, v53, s71
  s_mov_b32 s72, 32768
  buffer_load_dwordx2 v[24:25], v6, s[56:59], s72 offen
  s_mov_b32 s73, 33792
  buffer_load_dwordx2 v[26:27], v6, s[56:59], s73 offen
  s_mov_b32 s72, 34816
  buffer_load_dwordx2 v[28:29], v6, s[56:59], s72 offen
  s_mov_b32 s73, 35840
  buffer_load_dwordx2 v[30:31], v6, s[56:59], s73 offen
  s_mov_b32 s72, 36864
  buffer_load_dwordx2 v[32:33], v6, s[56:59], s72 offen
  s_mov_b32 s73, 37888
  buffer_load_dwordx2 v[34:35], v6, s[56:59], s73 offen
  s_mov_b32 s72, 38912
  buffer_load_dwordx2 v[36:37], v6, s[56:59], s72 offen
  s_mov_b32 s73, 39936
  buffer_load_dwordx2 v[38:39], v6, s[56:59], s73 offen
  s_mov_b32 s72, 49152
  buffer_load_dwordx2 v[40:41], v6, s[56:59], s72 offen
  s_mov_b32 s73, 50176
  buffer_load_dwordx2 v[42:43], v6, s[56:59], s73 offen
  s_mov_b32 s72, 51200
  buffer_load_dwordx2 v[44:45], v6, s[56:59], s72 offen
  s_mov_b32 s73, 52224
  buffer_load_dwordx2 v[46:47], v6, s[56:59], s73 offen
  s_mov_b32 s72, 53248
  buffer_load_dwordx2 v[48:49], v6, s[56:59], s72 offen
  s_mov_b32 s73, 54272
  buffer_load_dwordx2 v[50:51], v6, s[56:59], s73 offen
  s_mov_b32 s72, 55296
  buffer_load_dwordx2 v[52:53], v6, s[56:59], s72 offen
  s_mov_b32 s73, 56320
  buffer_load_dwordx2 v[54:55], v6, s[56:59], s73 offen
  s_waitcnt vmcnt(0)
  v_perm_b32 v200, v26, v24, s70
  v_perm_b32 v216, v26, v24, s71
  v_perm_b32 v232, v27, v25, s70
  v_perm_b32 v248, v27, v25, s71
  v_perm_b32 v201, v30, v28, s70
  v_perm_b32 v217, v30, v28, s71
  v_perm_b32 v233, v31, v29, s70
  v_perm_b32 v249, v31, v29, s71
  v_perm_b32 v202, v34, v32, s70
  v_perm_b32 v218, v34, v32, s71
  v_perm_b32 v234, v35, v33, s70
  v_perm_b32 v250, v35, v33, s71
  v_perm_b32 v203, v38, v36, s70
  v_perm_b32 v219, v38, v36, s71
  v_perm_b32 v235, v39, v37, s70
  v_perm_b32 v251, v39, v37, s71
  v_perm_b32 v204, v42, v40, s70
  v_perm_b32 v220, v42, v40, s71
  v_perm_b32 v236, v43, v41, s70
  v_perm_b32 v252, v43, v41, s71
  v_perm_b32 v205, v46, v44, s70
  v_perm_b32 v221, v46, v44, s71
  v_perm_b32 v237, v47, v45, s70
  v_perm_b32 v253, v47, v45, s71
  v_perm_b32 v206, v50, v48, s70
  v_perm_b32 v222, v50, v48, s71
  v_perm_b32 v238, v51, v49, s70
  v_perm_b32 v254, v51, v49, s71
  v_perm_b32 v207, v54, v52, s70
  v_perm_b32 v223, v54, v52, s71
  v_perm_b32 v239, v55, v53, s70
  v_perm_b32 v255, v55, v53, s71
  s_mov_b32 s60, s40
  s_mov_b32 s61, s41
  s_mov_b32 s62, 256
  s_mov_b32 s63, 0x00020000
  v_mov_b32 v33, 0
  s_nop 1
mw_110:
  buffer_load_dword v32, v33, s[60:63], 0 offen offset:68 sc1
  s_waitcnt vmcnt(0)
  v_readfirstlane_b32 s72, v32
  s_nop 0
  s_cmp_ge_u32 s72, 256
  s_nop 1
  s_cbranch_scc1 md_111
  s_sub_u32 s69, s69, 1
  s_cbranch_scc0 mw_110
  s_branch mega_exit
md_111:
  buffer_load_dwordx4 v[24:27], v33, s[60:63], 0 offen sc1
  buffer_load_dwordx4 v[28:31], v33, s[60:63], 0 offen offset:16 sc1
  s_waitcnt vmcnt(0)
  v_xor_b32 v24, 32, v24
  v_xor_b32 v25, 32, v25
  v_xor_b32 v26, 32, v26
  v_xor_b32 v27, 32, v27
  v_xor_b32 v28, 32, v28
  v_xor_b32 v29, 32, v29
  v_xor_b32 v30, 32, v30
  v_xor_b32 v31, 32, v31
  v_or3_b32 v24, v24, v25, v26
  v_or3_b32 v24, v24, v27, v28
  v_or3_b32 v24, v24, v29, v30
  v_or_b32 v24, v24, v31
  s_nop 0
  v_readfirstlane_b32 s68, v24
  s_mov_b32 s60, s40
  s_mov_b32 s61, s41
  s_mov_b32 s62, 256
  s_mov_b32 s63, 0x00020000
  s_nop 0
iw_112:
  buffer_load_dword v24, off, s[60:63], 0 offset:192 sc1
  s_waitcnt vmcnt(0)
  v_readfirstlane_b32 s72, v24
  s_nop 0
  s_cmp_ge_u32 s72, 208
  s_nop 1
  s_cbranch_scc1 id_113
  s_sub_u32 s69, s69, 1
  s_cbranch_scc0 iw_112
  s_branch mega_exit
id_113:
  s_lshl_b32 s72, s66, 13
  v_lshlrev_b32 v4, 4, v1
  v_add_u32 v4, s72, v4
  s_lshl_b32 s72, s66, 3
  v_and_b32 v24, 31, v1
  v_xor_b32 v24, s72, v24
  v_lshlrev_b32 v5, 9, v1
  v_lshl_add_u32 v5, v24, 4, v5
  s_lshl_b32 s72, s64, 22
  s_add_u32 s72, s72, 26214400
  s_lshl_b32 s73, s65, 15
  s_add_u32 s73, s73, s72
  s_lshl_b32 s74, s66, 8
  s_add_u32 s73, s73, s74
  v_lshrrev_b32 v14, 5, v1
  v_lshlrev_b32 v12, 12, v14
  v_and_b32 v15, 31, v1
  v_lshl_add_u32 v12, v15, 3, v12
  v_add_u32 v12, s73, v12
  s_lshl_b32 s72, s64, 9
  s_add_u32 s72, s72, 14683136
  s_lshl_b32 s73, s65, 4
  s_add_u32 s73, s73, s72
  s_lshl_b32 s74, s66, 2
  s_add_u32 s73, s73, s74
  v_mov_b32 v14, s73
  s_lshl_b32 s72, s64, 13
  s_add_u32 s72, s72, 14704640
  v_lshlrev_b32 v15, 2, v15
  v_add_u32 v15, s72, v15
  v_lshlrev_b32 v21, 9, v3
  v_lshl_add_u32 v21, v2, 4, v21
  s_lshl_b32 s73, s76, 8
  v_add_u32 v6, s73, v21
  v_mov_b32 v9, 0
  s_lshl_b32 s74, s77, 11
  s_add_u32 s74, s74, 65536
  v_add_u32 v21, s74, v6
  v_lshlrev_b32 v9, 4, v3
  v_xor_b32 v6, v9, v6
  v_lshlrev_b32 v22, 4, v1
  v_add_u32 v22, 65536, v22
  v_add_u32 v10, 4294950912, v15
  s_lshl_b32 s80, s64, 21
  s_add_u32 s80, s80, 10485760
  s_mov_b32 s81, 1
  s_mov_b32 s82, s80
  s_mov_b32 s85, 0
  v_mov_b32 v7, v5
  s_cmp_lg_u32 s68, 0
  s_cbranch_scc1 f1_top_in
  s_branch f0_top_in
f0_top:
  s_and_b32 s72, s67, 1
  s_lshl_b32 s72, s72, 15
  v_add_u32 v8, s72, v6
  s_xor_b32 s72, s72, 32768
  v_add_u32 v7, s72, v5
  s_add_u32 s85, s67, 1
  s_min_u32 s85, s85, 63
  s_lshl_b32 s82, s85, 15
  s_add_u32 s82, s82, s80
  s_lshl_b32 s85, s85, 7
  s_mov_b32 s83, 0
  buffer_load_dword v24, v10, s[44:47], s85 offen sc1
  s_sub_u32 s86, s67, 4
  s_cselect_b32 s86, 0, s86
  s_cselect_b32 s87, 0, 1
  s_lshl_b32 s86, s86, 7
  buffer_load_dword v25, v15, s[44:47], s86 offen sc1
  s_and_b32 s88, s67, 3
  s_mul_i32 s88, s88, 720896
  s_add_u32 s89, s88, 8192
  s_add_u32 s90, s88, 16384
  s_add_u32 s91, s88, 24576
  s_waitcnt lgkmcnt(0)
  s_barrier
  v_xor_b32 v13, 0, v8
  ds_read_b128 v[96:99], v13 offset:0
  v_xor_b32 v13, 64, v8
  ds_read_b128 v[100:103], v13 offset:2048
  v_xor_b32 v13, 128, v8
  ds_read_b128 v[104:107], v13 offset:4096
  v_xor_b32 v13, 192, v8
  ds_read_b128 v[108:111], v13 offset:6144
  v_xor_b32 v13, 256, v8
  ds_read_b128 v[112:115], v13 offset:8192
  s_waitcnt lgkmcnt(4)
  v_mfma_f32_16x16x32_bf16 v[128:131], a[0:3], v[96:99], 0
  v_mfma_f32_16x16x32_bf16 v[132:135], a[64:67], v[96:99], 0
  v_mfma_f32_16x16x32_bf16 v[136:139], a[128:131], v[96:99], 0
  v_mfma_f32_16x16x32_bf16 v[140:143], a[192:195], v[96:99], 0
  v_xor_b32 v13, 320, v8
  ds_read_b128 v[116:119], v13 offset:10240
  s_waitcnt lgkmcnt(4)
  v_mfma_f32_16x16x32_bf16 v[128:131], a[4:7], v[100:103], v[128:131]
  v_mfma_f32_16x16x32_bf16 v[132:135], a[68:71], v[100:103], v[132:135]
  v_mfma_f32_16x16x32_bf16 v[136:139], a[132:135], v[100:103], v[136:139]
  v_mfma_f32_16x16x32_bf16 v[140:143], a[196:199], v[100:103], v[140:143]
  v_xor_b32 v13, 384, v8
  ds_read_b128 v[120:123], v13 offset:12288
  s_waitcnt lgkmcnt(4)
  v_mfma_f32_16x16x32_bf16 v[128:131], a[8:11], v[104:107], v[128:131]
  v_mfma_f32_16x16x32_bf16 v[132:135], a[72:75], v[104:107], v[132:135]
  v_mfma_f32_16x16x32_bf16 v[136:139], a[136:139], v[104:107], v[136:139]
  v_mfma_f32_16x16x32_bf16 v[140:143], a[200:203], v[104:107], v[140:143]
  v_xor_b32 v13, 448, v8
  ds_read_b128 v[124:127], v13 offset:14336
  s_waitcnt lgkmcnt(4)
  v_mfma_f32_16x16x32_bf16 v[128:131], a[12:15], v[108:111], v[128:131]
  v_mfma_f32_16x16x32_bf16 v[132:135], a[76:79], v[108:111], v[132:135]
  v_mfma_f32_16x16x32_bf16 v[136:139], a[140:143], v[108:111], v[136:139]
  v_mfma_f32_16x16x32_bf16 v[140:143], a[204:207], v[108:111], v[140:143]
  v_xor_b32 v13, 0, v8
  ds_read_b128 v[96:99], v13 offset:16384
  s_waitcnt lgkmcnt(4)
  v_mfma_f32_16x16x32_bf16 v[128:131], a[16:19], v[112:115], v[128:131]
  v_mfma_f32_16x16x32_bf16 v[132:135], a[80:83], v[112:115], v[132:135]
  v_mfma_f32_16x16x32_bf16 v[136:139], a[144:147], v[112:115], v[136:139]
  v_mfma_f32_16x16x32_bf16 v[140:143], a[208:211], v[112:115], v[140:143]
  v_xor_b32 v13, 64, v8
  ds_read_b128 v[100:103], v13 offset:18432
  s_waitcnt lgkmcnt(4)
  v_mfma_f32_16x16x32_bf16 v[128:131], a[20:23], v[116:119], v[128:131]
  v_mfma_f32_16x16x32_bf16 v[132:135], a[84:87], v[116:119], v[132:135]
  v_mfma_f32_16x16x32_bf16 v[136:139], a[148:151], v[116:119], v[136:139]
  v_mfma_f32_16x16x32_bf16 v[140:143], a[212:215], v[116:119], v[140:143]
  v_xor_b32 v13, 128, v8
  ds_read_b128 v[104:107], v13 offset:20480
  s_waitcnt lgkmcnt(4)
  v_mfma_f32_16x16x32_bf16 v[128:131], a[24:27], v[120:123], v[128:131]
  v_mfma_f32_16x16x32_bf16 v[132:135], a[88:91], v[120:123], v[132:135]
  v_mfma_f32_16x16x32_bf16 v[136:139], a[152:155], v[120:123], v[136:139]
  v_mfma_f32_16x16x32_bf16 v[140:143], a[216:219], v[120:123], v[140:143]
  v_xor_b32 v13, 192, v8
  ds_read_b128 v[108:111], v13 offset:22528
  s_waitcnt lgkmcnt(4)
  v_mfma_f32_16x16x32_bf16 v[128:131], a[28:31], v[124:127], v[128:131]
  v_mfma_f32_16x16x32_bf16 v[132:135], a[92:95], v[124:127], v[132:135]
  v_mfma_f32_16x16x32_bf16 v[136:139], a[156:159], v[124:127], v[136:139]
  v_mfma_f32_16x16x32_bf16 v[140:143], a[220:223], v[124:127], v[140:143]
  v_xor_b32 v13, 256, v8
  ds_read_b128 v[112:115], v13 offset:24576
  s_waitcnt lgkmcnt(4)
  v_mfma_f32_16x16x32_bf16 v[128:131], a[32:35], v[96:99], v[128:131]
  v_mfma_f32_16x16x32_bf16 v[132:135], a[96:99], v[96:99], v[132:135]
  v_mfma_f32_16x16x32_bf16 v[136:139], a[160:163], v[96:99], v[136:139]
  v_mfma_f32_16x16x32_bf16 v[140:143], a[224:227], v[96:99], v[140:143]
  v_xor_b32 v13, 320, v8
  ds_read_b128 v[116:119], v13 offset:26624
  s_waitcnt lgkmcnt(4)
  v_mfma_f32_16x16x32_bf16 v[128:131], a[36:39], v[100:103], v[128:131]
  v_mfma_f32_16x16x32_bf16 v[132:135], a[100:103], v[100:103], v[132:135]
  v_mfma_f32_16x16x32_bf16 v[136:139], a[164:167], v[100:103], v[136:139]
  v_mfma_f32_16x16x32_bf16 v[140:143], a[228:231], v[100:103], v[140:143]
  v_xor_b32 v13, 384, v8
  ds_read_b128 v[120:123], v13 offset:28672
  s_waitcnt lgkmcnt(4)
  v_mfma_f32_16x16x32_bf16 v[128:131], a[40:43], v[104:107], v[128:131]
  v_mfma_f32_16x16x32_bf16 v[132:135], a[104:107], v[104:107], v[132:135]
  v_mfma_f32_16x16x32_bf16 v[136:139], a[168:171], v[104:107], v[136:139]
  v_mfma_f32_16x16x32_bf16 v[140:143], a[232:235], v[104:107], v[140:143]
  s_waitcnt vmcnt(0)
  v_mov_b32 v26, s67
  s_mov_b64 exec, 1
  buffer_store_dword v26, v14, s[44:47], 0 offen
  s_mov_b64 exec, -1
  v_xor_b32 v13, 448, v8
  ds_read_b128 v[124:127], v13 offset:30720
  s_waitcnt lgkmcnt(4)
  v_mfma_f32_16x16x32_bf16 v[128:131], a[44:47], v[108:111], v[128:131]
  v_mfma_f32_16x16x32_bf16 v[132:135], a[108:111], v[108:111], v[132:135]
  v_mfma_f32_16x16x32_bf16 v[136:139], a[172:175], v[108:111], v[136:139]
  v_mfma_f32_16x16x32_bf16 v[140:143], a[236:239], v[108:111], v[140:143]
  s_waitcnt vmcnt(1)
  v_cmp_gt_u32 vcc, s81, v24
  s_nop 0
  s_cbranch_vccnz tp_114
  s_add_u32 s84, s82, 4096
  buffer_load_dwordx4 v[64:67], v4, s[44:47], s82 offen offset:0
  buffer_load_dwordx4 v[68:71], v4, s[44:47], s82 offen offset:1024
  buffer_load_dwordx4 v[72:75], v4, s[44:47], s82 offen offset:2048
  buffer_load_dwordx4 v[76:79], v4, s[44:47], s82 offen offset:3072
  buffer_load_dwordx4 v[80:83], v4, s[44:47], s84 offen offset:0
  buffer_load_dwordx4 v[84:87], v4, s[44:47], s84 offen offset:1024
  buffer_load_dwordx4 v[88:91], v4, s[44:47], s84 offen offset:2048
  buffer_load_dwordx4 v[92:95], v4, s[44:47], s84 offen offset:3072
  s_mov_b32 s83, 1
tp_114:
  s_waitcnt lgkmcnt(3)
  v_mfma_f32_16x16x32_bf16 v[128:131], a[48:51], v[112:115], v[128:131]
  v_mfma_f32_16x16x32_bf16 v[132:135], a[112:115], v[112:115], v[132:135]
  v_mfma_f32_16x16x32_bf16 v[136:139], a[176:179], v[112:115], v[136:139]
  v_mfma_f32_16x16x32_bf16 v[140:143], a[240:243], v[112:115], v[140:143]
  s_waitcnt lgkmcnt(2)
  v_mfma_f32_16x16x32_bf16 v[128:131], a[52:55], v[116:119], v[128:131]
  v_mfma_f32_16x16x32_bf16 v[132:135], a[116:119], v[116:119], v[132:135]
  v_mfma_f32_16x16x32_bf16 v[136:139], a[180:183], v[116:119], v[136:139]
  v_mfma_f32_16x16x32_bf16 v[140:143], a[244:247], v[116:119], v[140:143]
  s_waitcnt lgkmcnt(1)
  v_mfma_f32_16x16x32_bf16 v[128:131], a[56:59], v[120:123], v[128:131]
  v_mfma_f32_16x16x32_bf16 v[132:135], a[120:123], v[120:123], v[132:135]
  v_mfma_f32_16x16x32_bf16 v[136:139], a[184:187], v[120:123], v[136:139]
  v_mfma_f32_16x16x32_bf16 v[140:143], a[248:251], v[120:123], v[140:143]
  s_waitcnt lgkmcnt(0)
  v_mfma_f32_16x16x32_bf16 v[128:131], a[60:63], v[124:127], v[128:131]
  v_mfma_f32_16x16x32_bf16 v[132:135], a[124:127], v[124:127], v[132:135]
  v_mfma_f32_16x16x32_bf16 v[136:139], a[188:191], v[124:127], v[136:139]
  v_mfma_f32_16x16x32_bf16 v[140:143], a[252:255], v[124:127], v[140:143]
  s_nop 6
  v_cvt_pk_bf16_f32 v32, v128, v136
  v_cvt_pk_bf16_f32 v33, v129, v137
  v_cvt_pk_bf16_f32 v34, v130, v138
  v_cvt_pk_bf16_f32 v35, v131, v139
  v_cvt_pk_bf16_f32 v36, v132, v140
  v_cvt_pk_bf16_f32 v37, v133, v141
  v_cvt_pk_bf16_f32 v38, v134, v142
  v_cvt_pk_bf16_f32 v39, v135, v143
  v_lshlrev_b32 v40, 16, v32
  v_and_b32 v32, 0xffff0000, v32
  v_mul_f32 v32, v32, v40
  v_lshlrev_b32 v41, 16, v33
  v_and_b32 v33, 0xffff0000, v33
  v_mul_f32 v33, v33, v41
  v_lshlrev_b32 v42, 16, v34
  v_and_b32 v34, 0xffff0000, v34
  v_mul_f32 v34, v34, v42
  v_lshlrev_b32 v43, 16, v35
  v_and_b32 v35, 0xffff0000, v35
  v_mul_f32 v35, v35, v43
  v_lshlrev_b32 v44, 16, v36
  v_and_b32 v36, 0xffff0000, v36
  v_mul_f32 v36, v36, v44
  v_lshlrev_b32 v45, 16, v37
  v_and_b32 v37, 0xffff0000, v37
  v_mul_f32 v37, v37, v45
  v_lshlrev_b32 v46, 16, v38
  v_and_b32 v38, 0xffff0000, v38
  v_mul_f32 v38, v38, v46
  v_lshlrev_b32 v47, 16, v39
  v_and_b32 v39, 0xffff0000, v39
  v_mul_f32 v39, v39, v47
  v_cvt_pk_bf16_f32 v40, v32, v36
  v_cvt_pk_bf16_f32 v41, v33, v37
  v_cvt_pk_bf16_f32 v42, v34, v38
  v_cvt_pk_bf16_f32 v43, v35, v39
  ds_write_b128 v21, v[40:43]
  s_waitcnt lgkmcnt(0)
  s_barrier
  ds_read_b128 v[96:99], v22 offset:0
  ds_read_b128 v[100:103], v22 offset:1024
  ds_read_b128 v[104:107], v22 offset:2048
  ds_read_b128 v[108:111], v22 offset:3072
  s_waitcnt lgkmcnt(3)
  v_mfma_f32_32x32x16_bf16 v[128:143], v[96:99], v[192:195], 0
  v_mfma_f32_32x32x16_bf16 v[144:159], v[96:99], v[208:211], 0
  v_mfma_f32_32x32x16_bf16 v[160:175], v[96:99], v[224:227], 0
  v_mfma_f32_32x32x16_bf16 v[176:191], v[96:99], v[240:243], 0
  s_waitcnt lgkmcnt(2)
  v_mfma_f32_32x32x16_bf16 v[128:143], v[100:103], v[196:199], v[128:143]
  v_mfma_f32_32x32x16_bf16 v[144:159], v[100:103], v[212:215], v[144:159]
  v_mfma_f32_32x32x16_bf16 v[160:175], v[100:103], v[228:231], v[160:175]
  v_mfma_f32_32x32x16_bf16 v[176:191], v[100:103], v[244:247], v[176:191]
  s_waitcnt lgkmcnt(1)
  v_mfma_f32_32x32x16_bf16 v[128:143], v[104:107], v[200:203], v[128:143]
  v_mfma_f32_32x32x16_bf16 v[144:159], v[104:107], v[216:219], v[144:159]
  v_mfma_f32_32x32x16_bf16 v[160:175], v[104:107], v[232:235], v[160:175]
  v_mfma_f32_32x32x16_bf16 v[176:191], v[104:107], v[248:251], v[176:191]
  s_cmp_eq_u32 s83, 1
  s_cbranch_scc0 c_115
  s_waitcnt vmcnt(0)
  v_xor_b32 v13, 0, v7
  ds_write_b128 v13, v[64:67]
  v_xor_b32 v13, 16, v7
  ds_write_b128 v13, v[68:71]
  v_xor_b32 v13, 32, v7
  ds_write_b128 v13, v[72:75]
  v_xor_b32 v13, 48, v7
  ds_write_b128 v13, v[76:79]
c_115:
  s_waitcnt lgkmcnt(0)
  v_mfma_f32_32x32x16_bf16 v[128:143], v[108:111], v[204:207], v[128:143]
  v_mfma_f32_32x32x16_bf16 v[144:159], v[108:111], v[220:223], v[144:159]
  v_mfma_f32_32x32x16_bf16 v[160:175], v[108:111], v[236:239], v[160:175]
  v_mfma_f32_32x32x16_bf16 v[176:191], v[108:111], v[252:255], v[176:191]
  s_cmp_eq_u32 s83, 1
  s_cbranch_scc0 c_116
  v_xor_b32 v13, 64, v7
  ds_write_b128 v13, v[80:83]
  v_xor_b32 v13, 80, v7
  ds_write_b128 v13, v[84:87]
  v_xor_b32 v13, 96, v7
  ds_write_b128 v13, v[88:91]
  v_xor_b32 v13, 112, v7
  ds_write_b128 v13, v[92:95]
c_116:
  v_cmp_gt_u32 vcc, s87, v25
  s_nop 7
  s_cbranch_vccz bp_117
pf_118:
  buffer_load_dword v25, v15, s[44:47], s86 offen sc1
  s_waitcnt vmcnt(0)
  v_cmp_gt_u32 vcc, s87, v25
  s_nop 0
  s_cbranch_vccz pd_119
  s_nop 2
pr_120:
  s_sub_u32 s69, s69, 1
  s_cbranch_scc0 pf_118
  s_branch mega_exit
pd_119:
bp_117:
  v_cvt_pk_bf16_f32 v32, v128, v144
  v_cvt_pk_bf16_f32 v33, v160, v176
  buffer_store_dwordx2 v[32:33], v12, s[44:47], s88 offen offset:0
  v_cvt_pk_bf16_f32 v34, v129, v145
  v_cvt_pk_bf16_f32 v35, v161, v177
  buffer_store_dwordx2 v[34:35], v12, s[44:47], s88 offen offset:1024
  v_cvt_pk_bf16_f32 v36, v130, v146
  v_cvt_pk_bf16_f32 v37, v162, v178
  buffer_store_dwordx2 v[36:37], v12, s[44:47], s88 offen offset:2048
  v_cvt_pk_bf16_f32 v38, v131, v147
  v_cvt_pk_bf16_f32 v39, v163, v179
  buffer_store_dwordx2 v[38:39], v12, s[44:47], s88 offen offset:3072
  v_cvt_pk_bf16_f32 v40, v132, v148
  v_cvt_pk_bf16_f32 v41, v164, v180
  buffer_store_dwordx2 v[40:41], v12, s[44:47], s89 offen offset:0
  v_cvt_pk_bf16_f32 v42, v133, v149
  v_cvt_pk_bf16_f32 v43, v165, v181
  buffer_store_dwordx2 v[42:43], v12, s[44:47], s89 offen offset:1024
  v_cvt_pk_bf16_f32 v44, v134, v150
  v_cvt_pk_bf16_f32 v45, v166, v182
  buffer_store_dwordx2 v[44:45], v12, s[44:47], s89 offen offset:2048
  v_cvt_pk_bf16_f32 v46, v135, v151
  v_cvt_pk_bf16_f32 v47, v167, v183
  buffer_store_dwordx2 v[46:47], v12, s[44:47], s89 offen offset:3072
  v_cvt_pk_bf16_f32 v48, v136, v152
  v_cvt_pk_bf16_f32 v49, v168, v184
  buffer_store_dwordx2 v[48:49], v12, s[44:47], s90 offen offset:0
  v_cvt_pk_bf16_f32 v50, v137, v153
  v_cvt_pk_bf16_f32 v51, v169, v185
  buffer_store_dwordx2 v[50:51], v12, s[44:47], s90 offen offset:1024
  v_cvt_pk_bf16_f32 v52, v138, v154
  v_cvt_pk_bf16_f32 v53, v170, v186
  buffer_store_dwordx2 v[52:53], v12, s[44:47], s90 offen offset:2048
  v_cvt_pk_bf16_f32 v54, v139, v155
  v_cvt_pk_bf16_f32 v55, v171, v187
  buffer_store_dwordx2 v[54:55], v12, s[44:47], s90 offen offset:3072
  v_cvt_pk_bf16_f32 v56, v140, v156
  v_cvt_pk_bf16_f32 v57, v172, v188
  buffer_store_dwordx2 v[56:57], v12, s[44:47], s91 offen offset:0
  v_cvt_pk_bf16_f32 v58, v141, v157
  v_cvt_pk_bf16_f32 v59, v173, v189
  buffer_store_dwordx2 v[58:59], v12, s[44:47], s91 offen offset:1024
  v_cvt_pk_bf16_f32 v60, v142, v158
  v_cvt_pk_bf16_f32 v61, v174, v190
  buffer_store_dwordx2 v[60:61], v12, s[44:47], s91 offen offset:2048
  v_cvt_pk_bf16_f32 v62, v143, v159
  v_cvt_pk_bf16_f32 v63, v175, v191
  buffer_store_dwordx2 v[62:63], v12, s[44:47], s91 offen offset:3072
  s_add_u32 s67, s67, 1
  s_cmp_ge_u32 s67, 64
  s_cbranch_scc1 f0_top_end
  s_cmp_eq_u32 s83, 1
  s_cbranch_scc1 f0_top
  s_waitcnt vmcnt(0)
  v_mov_b32 v26, s67
  s_mov_b64 exec, 1
  buffer_store_dword v26, v14, s[44:47], 0 offen
  s_mov_b64 exec, -1
f0_top_in:
pf_121:
  buffer_load_dword v24, v10, s[44:47], s85 offen sc1
  s_waitcnt vmcnt(0)
  v_cmp_gt_u32 vcc, s81, v24
  s_nop 0
  s_cbranch_vccz pd_122
  s_nop 2
pr_123:
  s_sub_u32 s69, s69, 1
  s_cbranch_scc0 pf_121
  s_branch mega_exit
pd_122:
  s_add_u32 s84, s82, 4096
  buffer_load_dwordx4 v[64:67], v4, s[44:47], s82 offen offset:0
  buffer_load_dwordx4 v[68:71], v4, s[44:47], s82 offen offset:1024
  buffer_load_dwordx4 v[72:75], v4, s[44:47], s82 offen offset:2048
  buffer_load_dwordx4 v[76:79], v4, s[44:47], s82 offen offset:3072
  buffer_load_dwordx4 v[80:83], v4, s[44:47], s84 offen offset:0
  buffer_load_dwordx4 v[84:87], v4, s[44:47], s84 offen offset:1024
  buffer_load_dwordx4 v[88:91], v4, s[44:47], s84 offen offset:2048
  buffer_load_dwordx4 v[92:95], v4, s[44:47], s84 offen offset:3072
  s_waitcnt vmcnt(0)
  v_xor_b32 v13, 0, v7
  ds_write_b128 v13, v[64:67]
  v_xor_b32 v13, 16, v7
  ds_write_b128 v13, v[68:71]
  v_xor_b32 v13, 32, v7
  ds_write_b128 v13, v[72:75]
  v_xor_b32 v13, 48, v7
  ds_write_b128 v13, v[76:79]
  v_xor_b32 v13, 64, v7
  ds_write_b128 v13, v[80:83]
  v_xor_b32 v13, 80, v7
  ds_write_b128 v13, v[84:87]
  v_xor_b32 v13, 96, v7
  ds_write_b128 v13, v[88:91]
  v_xor_b32 v13, 112, v7
  ds_write_b128 v13, v[92:95]
  s_branch f0_top
f0_top_end:
  s_waitcnt vmcnt(0)
  v_mov_b32 v26, s67
  s_mov_b64 exec, 1
  buffer_store_dword v26, v14, s[44:47], 0 offen
  s_mov_b64 exec, -1
  s_branch mega_end
f1_top:
  s_and_b32 s72, s67, 1
  s_lshl_b32 s72, s72, 15
  v_add_u32 v8, s72, v6
  s_xor_b32 s72, s72, 32768
  v_add_u32 v7, s72, v5
  s_add_u32 s85, s67, 1
  s_min_u32 s85, s85, 63
  s_lshl_b32 s82, s85, 15
  s_add_u32 s82, s82, s80
  s_lshl_b32 s85, s85, 7
  s_mov_b32 s83, 0
  buffer_load_dword v24, v10, s[44:47], s85 offen sc1
  s_sub_u32 s86, s67, 4
  s_cselect_b32 s86, 0, s86
  s_cselect_b32 s87, 0, 1
  s_lshl_b32 s86, s86, 7
  buffer_load_dword v25, v15, s[44:47], s86 offen sc1
  s_and_b32 s88, s67, 3
  s_mul_i32 s88, s88, 720896
  s_add_u32 s89, s88, 8192
  s_add_u32 s90, s88, 16384
  s_add_u32 s91, s88, 24576
  s_waitcnt lgkmcnt(0)
  s_barrier
  v_xor_b32 v13, 0, v8
  ds_read_b128 v[96:99], v13 offset:0
  v_xor_b32 v13, 64, v8
  ds_read_b128 v[100:103], v13 offset:2048
  v_xor_b32 v13, 128, v8
  ds_read_b128 v[104:107], v13 offset:4096
  v_xor_b32 v13, 192, v8
  ds_read_b128 v[108:111], v13 offset:6144
  v_xor_b32 v13, 256, v8
  ds_read_b128 v[112:115], v13 offset:8192
  s_waitcnt lgkmcnt(4)
  v_mfma_f32_16x16x32_bf16 v[128:131], a[0:3], v[96:99], 0
  v_mfma_f32_16x16x32_bf16 v[132:135], a[64:67], v[96:99], 0
  v_mfma_f32_16x16x32_bf16 v[136:139], a[128:131], v[96:99], 0
  v_mfma_f32_16x16x32_bf16 v[140:143], a[192:195], v[96:99], 0
  v_xor_b32 v13, 320, v8
  ds_read_b128 v[116:119], v13 offset:10240
  s_waitcnt lgkmcnt(4)
  v_mfma_f32_16x16x32_bf16 v[128:131], a[4:7], v[100:103], v[128:131]
  v_mfma_f32_16x16x32_bf16 v[132:135], a[68:71], v[100:103], v[132:135]
  v_mfma_f32_16x16x32_bf16 v[136:139], a[132:135], v[100:103], v[136:139]
  v_mfma_f32_16x16x32_bf16 v[140:143], a[196:199], v[100:103], v[140:143]
  v_xor_b32 v13, 384, v8
  ds_read_b128 v[120:123], v13 offset:12288
  s_waitcnt lgkmcnt(4)
  v_mfma_f32_16x16x32_bf16 v[128:131], a[8:11], v[104:107], v[128:131]
  v_mfma_f32_16x16x32_bf16 v[132:135], a[72:75], v[104:107], v[132:135]
  v_mfma_f32_16x16x32_bf16 v[136:139], a[136:139], v[104:107], v[136:139]
  v_mfma_f32_16x16x32_bf16 v[140:143], a[200:203], v[104:107], v[140:143]
  v_xor_b32 v13, 448, v8
  ds_read_b128 v[124:127], v13 offset:14336
  s_waitcnt lgkmcnt(4)
  v_mfma_f32_16x16x32_bf16 v[128:131], a[12:15], v[108:111], v[128:131]
  v_mfma_f32_16x16x32_bf16 v[132:135], a[76:79], v[108:111], v[132:135]
  v_mfma_f32_16x16x32_bf16 v[136:139], a[140:143], v[108:111], v[136:139]
  v_mfma_f32_16x16x32_bf16 v[140:143], a[204:207], v[108:111], v[140:143]
  v_xor_b32 v13, 0, v8
  ds_read_b128 v[96:99], v13 offset:16384
  s_waitcnt lgkmcnt(4)
  v_mfma_f32_16x16x32_bf16 v[128:131], a[16:19], v[112:115], v[128:131]
  v_mfma_f32_16x16x32_bf16 v[132:135], a[80:83], v[112:115], v[132:135]
  v_mfma_f32_16x16x32_bf16 v[136:139], a[144:147], v[112:115], v[136:139]
  v_mfma_f32_16x16x32_bf16 v[140:143], a[208:211], v[112:115], v[140:143]
  v_xor_b32 v13, 64, v8
  ds_read_b128 v[100:103], v13 offset:18432
  s_waitcnt lgkmcnt(4)
  v_mfma_f32_16x16x32_bf16 v[128:131], a[20:23], v[116:119], v[128:131]
  v_mfma_f32_16x16x32_bf16 v[132:135], a[84:87], v[116:119], v[132:135]
  v_mfma_f32_16x16x32_bf16 v[136:139], a[148:151], v[116:119], v[136:139]
  v_mfma_f32_16x16x32_bf16 v[140:143], a[212:215], v[116:119], v[140:143]
  v_xor_b32 v13, 128, v8
  ds_read_b128 v[104:107], v13 offset:20480
  s_waitcnt lgkmcnt(4)
  v_mfma_f32_16x16x32_bf16 v[128:131], a[24:27], v[120:123], v[128:131]
  v_mfma_f32_16x16x32_bf16 v[132:135], a[88:91], v[120:123], v[132:135]
  v_mfma_f32_16x16x32_bf16 v[136:139], a[152:155], v[120:123], v[136:139]
  v_mfma_f32_16x16x32_bf16 v[140:143], a[216:219], v[120:123], v[140:143]
  v_xor_b32 v13, 192, v8
  ds_read_b128 v[108:111], v13 offset:22528
  s_waitcnt lgkmcnt(4)
  v_mfma_f32_16x16x32_bf16 v[128:131], a[28:31], v[124:127], v[128:131]
  v_mfma_f32_16x16x32_bf16 v[132:135], a[92:95], v[124:127], v[132:135]
  v_mfma_f32_16x16x32_bf16 v[136:139], a[156:159], v[124:127], v[136:139]
  v_mfma_f32_16x16x32_bf16 v[140:143], a[220:223], v[124:127], v[140:143]
  v_xor_b32 v13, 256, v8
  ds_read_b128 v[112:115], v13 offset:24576
  s_waitcnt lgkmcnt(4)
  v_mfma_f32_16x16x32_bf16 v[128:131], a[32:35], v[96:99], v[128:131]
  v_mfma_f32_16x16x32_bf16 v[132:135], a[96:99], v[96:99], v[132:135]
  v_mfma_f32_16x16x32_bf16 v[136:139], a[160:163], v[96:99], v[136:139]
  v_mfma_f32_16x16x32_bf16 v[140:143], a[224:227], v[96:99], v[140:143]
  v_xor_b32 v13, 320, v8
  ds_read_b128 v[116:119], v13 offset:26624
  s_waitcnt lgkmcnt(4)
  v_mfma_f32_16x16x32_bf16 v[128:131], a[36:39], v[100:103], v[128:131]
  v_mfma_f32_16x16x32_bf16 v[132:135], a[100:103], v[100:103], v[132:135]
  v_mfma_f32_16x16x32_bf16 v[136:139], a[164:167], v[100:103], v[136:139]
  v_mfma_f32_16x16x32_bf16 v[140:143], a[228:231], v[100:103], v[140:143]
  v_xor_b32 v13, 384, v8
  ds_read_b128 v[120:123], v13 offset:28672
  s_waitcnt lgkmcnt(4)
  v_mfma_f32_16x16x32_bf16 v[128:131], a[40:43], v[104:107], v[128:131]
  v_mfma_f32_16x16x32_bf16 v[132:135], a[104:107], v[104:107], v[132:135]
  v_mfma_f32_16x16x32_bf16 v[136:139], a[168:171], v[104:107], v[136:139]
  v_mfma_f32_16x16x32_bf16 v[140:143], a[232:235], v[104:107], v[140:143]
  s_waitcnt vmcnt(0)
  v_mov_b32 v26, s67
  s_mov_b64 exec, 1
  buffer_store_dword v26, v14, s[44:47], 0 offen sc1
  s_mov_b64 exec, -1
  v_xor_b32 v13, 448, v8
  ds_read_b128 v[124:127], v13 offset:30720
  s_waitcnt lgkmcnt(4)
  v_mfma_f32_16x16x32_bf16 v[128:131], a[44:47], v[108:111], v[128:131]
  v_mfma_f32_16x16x32_bf16 v[132:135], a[108:111], v[108:111], v[132:135]
  v_mfma_f32_16x16x32_bf16 v[136:139], a[172:175], v[108:111], v[136:139]
  v_mfma_f32_16x16x32_bf16 v[140:143], a[236:239], v[108:111], v[140:143]
  s_waitcnt vmcnt(1)
  v_cmp_gt_u32 vcc, s81, v24
  s_nop 0
  s_cbranch_vccnz tp_124
  s_add_u32 s84, s82, 4096
  buffer_load_dwordx4 v[64:67], v4, s[44:47], s82 offen offset:0
  buffer_load_dwordx4 v[68:71], v4, s[44:47], s82 offen offset:1024
  buffer_load_dwordx4 v[72:75], v4, s[44:47], s82 offen offset:2048
  buffer_load_dwordx4 v[76:79], v4, s[44:47], s82 offen offset:3072
  buffer_load_dwordx4 v[80:83], v4, s[44:47], s84 offen offset:0
  buffer_load_dwordx4 v[84:87], v4, s[44:47], s84 offen offset:1024
  buffer_load_dwordx4 v[88:91], v4, s[44:47], s84 offen offset:2048
  buffer_load_dwordx4 v[92:95], v4, s[44:47], s84 offen offset:3072
  s_mov_b32 s83, 1
tp_124:
  s_waitcnt lgkmcnt(3)
  v_mfma_f32_16x16x32_bf16 v[128:131], a[48:51], v[112:115], v[128:131]
  v_mfma_f32_16x16x32_bf16 v[132:135], a[112:115], v[112:115], v[132:135]
  v_mfma_f32_16x16x32_bf16 v[136:139], a[176:179], v[112:115], v[136:139]
  v_mfma_f32_16x16x32_bf16 v[140:143], a[240:243], v[112:115], v[140:143]
  s_waitcnt lgkmcnt(2)
  v_mfma_f32_16x16x32_bf16 v[128:131], a[52:55], v[116:119], v[128:131]
  v_mfma_f32_16x16x32_bf16 v[132:135], a[116:119], v[116:119], v[132:135]
  v_mfma_f32_16x16x32_bf16 v[136:139], a[180:183], v[116:119], v[136:139]
  v_mfma_f32_16x16x32_bf16 v[140:143], a[244:247], v[116:119], v[140:143]
  s_waitcnt lgkmcnt(1)
  v_mfma_f32_16x16x32_bf16 v[128:131], a[56:59], v[120:123], v[128:131]
  v_mfma_f32_16x16x32_bf16 v[132:135], a[120:123], v[120:123], v[132:135]
  v_mfma_f32_16x16x32_bf16 v[136:139], a[184:187], v[120:123], v[136:139]
  v_mfma_f32_16x16x32_bf16 v[140:143], a[248:251], v[120:123], v[140:143]
  s_waitcnt lgkmcnt(0)
  v_mfma_f32_16x16x32_bf16 v[128:131], a[60:63], v[124:127], v[128:131]
  v_mfma_f32_16x16x32_bf16 v[132:135], a[124:127], v[124:127], v[132:135]
  v_mfma_f32_16x16x32_bf16 v[136:139], a[188:191], v[124:127], v[136:139]
  v_mfma_f32_16x16x32_bf16 v[140:143], a[252:255], v[124:127], v[140:143]
  s_nop 6
  v_cvt_pk_bf16_f32 v32, v128, v136
  v_cvt_pk_bf16_f32 v33, v129, v137
  v_cvt_pk_bf16_f32 v34, v130, v138
  v_cvt_pk_bf16_f32 v35, v131, v139
  v_cvt_pk_bf16_f32 v36, v132, v140
  v_cvt_pk_bf16_f32 v37, v133, v141
  v_cvt_pk_bf16_f32 v38, v134, v142
  v_cvt_pk_bf16_f32 v39, v135, v143
  v_lshlrev_b32 v40, 16, v32
  v_and_b32 v32, 0xffff0000, v32
  v_mul_f32 v32, v32, v40
  v_lshlrev_b32 v41, 16, v33
  v_and_b32 v33, 0xffff0000, v33
  v_mul_f32 v33, v33, v41
  v_lshlrev_b32 v42, 16, v34
  v_and_b32 v34, 0xffff0000, v34
  v_mul_f32 v34, v34, v42
  v_lshlrev_b32 v43, 16, v35
  v_and_b32 v35, 0xffff0000, v35
  v_mul_f32 v35, v35, v43
  v_lshlrev_b32 v44, 16, v36
  v_and_b32 v36, 0xffff0000, v36
  v_mul_f32 v36, v36, v44
  v_lshlrev_b32 v45, 16, v37
  v_and_b32 v37, 0xffff0000, v37
  v_mul_f32 v37, v37, v45
  v_lshlrev_b32 v46, 16, v38
  v_and_b32 v38, 0xffff0000, v38
  v_mul_f32 v38, v38, v46
  v_lshlrev_b32 v47, 16, v39
  v_and_b32 v39, 0xffff0000, v39
  v_mul_f32 v39, v39, v47
  v_cvt_pk_bf16_f32 v40, v32, v36
  v_cvt_pk_bf16_f32 v41, v33, v37
  v_cvt_pk_bf16_f32 v42, v34, v38
  v_cvt_pk_bf16_f32 v43, v35, v39
  ds_write_b128 v21, v[40:43]
  s_waitcnt lgkmcnt(0)
  s_barrier
  ds_read_b128 v[96:99], v22 offset:0
  ds_read_b128 v[100:103], v22 offset:1024
  ds_read_b128 v[104:107], v22 offset:2048
  ds_read_b128 v[108:111], v22 offset:3072
  s_waitcnt lgkmcnt(3)
  v_mfma_f32_32x32x16_bf16 v[128:143], v[96:99], v[192:195], 0
  v_mfma_f32_32x32x16_bf16 v[144:159], v[96:99], v[208:211], 0
  v_mfma_f32_32x32x16_bf16 v[160:175], v[96:99], v[224:227], 0
  v_mfma_f32_32x32x16_bf16 v[176:191], v[96:99], v[240:243], 0
  s_waitcnt lgkmcnt(2)
  v_mfma_f32_32x32x16_bf16 v[128:143], v[100:103], v[196:199], v[128:143]
  v_mfma_f32_32x32x16_bf16 v[144:159], v[100:103], v[212:215], v[144:159]
  v_mfma_f32_32x32x16_bf16 v[160:175], v[100:103], v[228:231], v[160:175]
  v_mfma_f32_32x32x16_bf16 v[176:191], v[100:103], v[244:247], v[176:191]
  s_waitcnt lgkmcnt(1)
  v_mfma_f32_32x32x16_bf16 v[128:143], v[104:107], v[200:203], v[128:143]
  v_mfma_f32_32x32x16_bf16 v[144:159], v[104:107], v[216:219], v[144:159]
  v_mfma_f32_32x32x16_bf16 v[160:175], v[104:107], v[232:235], v[160:175]
  v_mfma_f32_32x32x16_bf16 v[176:191], v[104:107], v[248:251], v[176:191]
  s_cmp_eq_u32 s83, 1
  s_cbranch_scc0 c_125
  s_waitcnt vmcnt(0)
  v_xor_b32 v13, 0, v7
  ds_write_b128 v13, v[64:67]
  v_xor_b32 v13, 16, v7
  ds_write_b128 v13, v[68:71]
  v_xor_b32 v13, 32, v7
  ds_write_b128 v13, v[72:75]
  v_xor_b32 v13, 48, v7
  ds_write_b128 v13, v[76:79]
c_125:
  s_waitcnt lgkmcnt(0)
  v_mfma_f32_32x32x16_bf16 v[128:143], v[108:111], v[204:207], v[128:143]
  v_mfma_f32_32x32x16_bf16 v[144:159], v[108:111], v[220:223], v[144:159]
  v_mfma_f32_32x32x16_bf16 v[160:175], v[108:111], v[236:239], v[160:175]
  v_mfma_f32_32x32x16_bf16 v[176:191], v[108:111], v[252:255], v[176:191]
  s_cmp_eq_u32 s83, 1
  s_cbranch_scc0 c_126
  v_xor_b32 v13, 64, v7
  ds_write_b128 v13, v[80:83]
  v_xor_b32 v13, 80, v7
  ds_write_b128 v13, v[84:87]
  v_xor_b32 v13, 96, v7
  ds_write_b128 v13, v[88:91]
  v_xor_b32 v13, 112, v7
  ds_write_b128 v13, v[92:95]
c_126:
  v_cmp_gt_u32 vcc, s87, v25
  s_nop 7
  s_cbranch_vccz bp_127
pf_128:
  buffer_load_dword v25, v15, s[44:47], s86 offen sc1
  s_waitcnt vmcnt(0)
  v_cmp_gt_u32 vcc, s87, v25
  s_nop 0
  s_cbranch_vccz pd_129
  s_nop 2
pr_130:
  s_sub_u32 s69, s69, 1
  s_cbranch_scc0 pf_128
  s_branch mega_exit
pd_129:
bp_127:
  v_cvt_pk_bf16_f32 v32, v128, v144
  v_cvt_pk_bf16_f32 v33, v160, v176
  buffer_store_dwordx2 v[32:33], v12, s[44:47], s88 offen offset:0 sc1
  v_cvt_pk_bf16_f32 v34, v129, v145
  v_cvt_pk_bf16_f32 v35, v161, v177
  buffer_store_dwordx2 v[34:35], v12, s[44:47], s88 offen offset:1024 sc1
  v_cvt_pk_bf16_f32 v36, v130, v146
  v_cvt_pk_bf16_f32 v37, v162, v178
  buffer_store_dwordx2 v[36:37], v12, s[44:47], s88 offen offset:2048 sc1
  v_cvt_pk_bf16_f32 v38, v131, v147
  v_cvt_pk_bf16_f32 v39, v163, v179
  buffer_store_dwordx2 v[38:39], v12, s[44:47], s88 offen offset:3072 sc1
  v_cvt_pk_bf16_f32 v40, v132, v148
  v_cvt_pk_bf16_f32 v41, v164, v180
  buffer_store_dwordx2 v[40:41], v12, s[44:47], s89 offen offset:0 sc1
  v_cvt_pk_bf16_f32 v42, v133, v149
  v_cvt_pk_bf16_f32 v43, v165, v181
  buffer_store_dwordx2 v[42:43], v12, s[44:47], s89 offen offset:1024 sc1
  v_cvt_pk_bf16_f32 v44, v134, v150
  v_cvt_pk_bf16_f32 v45, v166, v182
  buffer_store_dwordx2 v[44:45], v12, s[44:47], s89 offen offset:2048 sc1
  v_cvt_pk_bf16_f32 v46, v135, v151
  v_cvt_pk_bf16_f32 v47, v167, v183
  buffer_store_dwordx2 v[46:47], v12, s[44:47], s89 offen offset:3072 sc1
  v_cvt_pk_bf16_f32 v48, v136, v152
  v_cvt_pk_bf16_f32 v49, v168, v184
  buffer_store_dwordx2 v[48:49], v12, s[44:47], s90 offen offset:0 sc1
  v_cvt_pk_bf16_f32 v50, v137, v153
  v_cvt_pk_bf16_f32 v51, v169, v185
  buffer_store_dwordx2 v[50:51], v12, s[44:47], s90 offen offset:1024 sc1
  v_cvt_pk_bf16_f32 v52, v138, v154
  v_cvt_pk_bf16_f32 v53, v170, v186
  buffer_store_dwordx2 v[52:53], v12, s[44:47], s90 offen offset:2048 sc1
  v_cvt_pk_bf16_f32 v54, v139, v155
  v_cvt_pk_bf16_f32 v55, v171, v187
  buffer_store_dwordx2 v[54:55], v12, s[44:47], s90 offen offset:3072 sc1
  v_cvt_pk_bf16_f32 v56, v140, v156
  v_cvt_pk_bf16_f32 v57, v172, v188
  buffer_store_dwordx2 v[56:57], v12, s[44:47], s91 offen offset:0 sc1
  v_cvt_pk_bf16_f32 v58, v141, v157
  v_cvt_pk_bf16_f32 v59, v173, v189
  buffer_store_dwordx2 v[58:59], v12, s[44:47], s91 offen offset:1024 sc1
  v_cvt_pk_bf16_f32 v60, v142, v158
  v_cvt_pk_bf16_f32 v61, v174, v190
  buffer_store_dwordx2 v[60:61], v12, s[44:47], s91 offen offset:2048 sc1
  v_cvt_pk_bf16_f32 v62, v143, v159
  v_cvt_pk_bf16_f32 v63, v175, v191
  buffer_store_dwordx2 v[62:63], v12, s[44:47], s91 offen offset:3072 sc1
  s_add_u32 s67, s67, 1
  s_cmp_ge_u32 s67, 64
  s_cbranch_scc1 f1_top_end
  s_cmp_eq_u32 s83, 1
  s_cbranch_scc1 f1_top
  s_waitcnt vmcnt(0)
  v_mov_b32 v26, s67
  s_mov_b64 exec, 1
  buffer_store_dword v26, v14, s[44:47], 0 offen sc1
  s_mov_b64 exec, -1
f1_top_in:
pf_131:
  buffer_load_dword v24, v10, s[44:47], s85 offen sc1
  s_waitcnt vmcnt(0)
  v_cmp_gt_u32 vcc, s81, v24
  s_nop 0
  s_cbranch_vccz pd_132
  s_nop 2
pr_133:
  s_sub_u32 s69, s69, 1
  s_cbranch_scc0 pf_131
  s_branch mega_exit
pd_132:
  s_add_u32 s84, s82, 4096
  buffer_load_dwordx4 v[64:67], v4, s[44:47], s82 offen offset:0
  buffer_load_dwordx4 v[68:71], v4, s[44:47], s82 offen offset:1024
  buffer_load_dwordx4 v[72:75], v4, s[44:47], s82 offen offset:2048
  buffer_load_dwordx4 v[76:79], v4, s[44:47], s82 offen offset:3072
  buffer_load_dwordx4 v[80:83], v4, s[44:47], s84 offen offset:0
  buffer_load_dwordx4 v[84:87], v4, s[44:47], s84 offen offset:1024
  buffer_load_dwordx4 v[88:91], v4, s[44:47], s84 offen offset:2048
  buffer_load_dwordx4 v[92:95], v4, s[44:47], s84 offen offset:3072
  s_waitcnt vmcnt(0)
  v_xor_b32 v13, 0, v7
  ds_write_b128 v13, v[64:67]
  v_xor_b32 v13, 16, v7
  ds_write_b128 v13, v[68:71]
  v_xor_b32 v13, 32, v7
  ds_write_b128 v13, v[72:75]
  v_xor_b32 v13, 48, v7
  ds_write_b128 v13, v[76:79]
  v_xor_b32 v13, 64, v7
  ds_write_b128 v13, v[80:83]
  v_xor_b32 v13, 80, v7
  ds_write_b128 v13, v[84:87]
  v_xor_b32 v13, 96, v7
  ds_write_b128 v13, v[88:91]
  v_xor_b32 v13, 112, v7
  ds_write_b128 v13, v[92:95]
  s_branch f1_top
f1_top_end:
  s_waitcnt vmcnt(0)
  v_mov_b32 v26, s67
  s_mov_b64 exec, 1
  buffer_store_dword v26, v14, s[44:47], 0 offen sc1
  s_mov_b64 exec, -1
  s_branch mega_end
mega_end:
mega_exit:
  s_waitcnt vmcnt(0)
  s_endpgm
.section .rodata,"a"
.p2align 6
.amdhsa_kernel mega_kernel
  .amdhsa_next_free_vgpr 512
  .amdhsa_next_free_sgpr 102
  .amdhsa_accum_offset 256
  .amdhsa_group_segment_fixed_size 0
  .amdhsa_kernarg_size 112
  .amdhsa_user_sgpr_count 2
  .amdhsa_user_sgpr_kernarg_segment_ptr 1
  .amdhsa_system_sgpr_workgroup_id_x 1
.end_amdhsa_kernel
```
